```python
import torch

def _softmax(x, axis=-1):
    return torch.softmax(x, dim=axis)
def _gelu(x):
    return torch.nn.functional.gelu(x, approximate="tanh")
def _silu(x):
    return torch.nn.functional.silu(x)
def _sigmoid(x):
    return torch.sigmoid(x)
def _layernorm(x, axis=-1, eps=1e-5):
    m = x.mean(dim=axis, keepdim=True)
    v = x.var(dim=axis, keepdim=True, unbiased=False)
    return (x - m) / torch.sqrt(v + eps)
def _scatter_add(tgt, idx, src, axis=0):
    return tgt.clone().index_add_(axis, idx, src)
def _segment_sum(src, seg, n):
    out = torch.zeros((n,) + src.shape[1:], dtype=src.dtype)
    return out.index_add_(0, seg, src)
def _pad(x, pw):
    flat = tuple(v for pair in reversed(pw) for v in pair)
    return torch.nn.functional.pad(x, flat)

kernel_name = 'parallel_sum__softmax_full_mha__mixer_channel_mlp__prompt'

def setup_inputs():

    _w = (lambda a: (lambda t: t.to(torch.bfloat16) if t.is_floating_point() else t)(torch.as_tensor(a)))
    def _A_setup():
        B, S, D = 1, 2048, 1024
        return {
            "x": _w((lambda *s: torch.randn(*s, dtype=torch.bfloat16) * 0.05)(B, S, D)),
            "wqkv": _w((lambda *s: torch.randn(*s, dtype=torch.bfloat16) * 0.05)(D, 3 * D)),
            "wo": _w((lambda *s: torch.randn(*s, dtype=torch.bfloat16) * 0.05)(D, D)),
        }
    _A_in = _A_setup()

    def _B_setup():
        B, S, D, F = 1, 2048, 1024, 3584
        return {
            "x": _w((lambda *s: torch.randn(*s, dtype=torch.bfloat16) * 0.05)(B, S, D)),
            "w1": _w((lambda *s: torch.randn(*s, dtype=torch.bfloat16) * 3.2)(D, F) * (D ** -0.5)),
            "b1": _w((lambda *s: torch.randn(*s, dtype=torch.bfloat16) * 1.6)(F)),
            "w2": _w((lambda *s: torch.randn(*s, dtype=torch.bfloat16) * 0.4)(F, D) * (F ** -0.5)),
            "b2": _w((lambda *s: torch.randn(*s, dtype=torch.bfloat16) * 0.8)(D)),
        }
    _B_in = _B_setup()

    return {
        "A_x": _A_in["x"],
        "A_wqkv": _A_in["wqkv"],
        "A_wo": _A_in["wo"],
        "B_x": _B_in["x"],
        "B_w1": _B_in["w1"],
        "B_b1": _B_in["b1"],
        "B_w2": _B_in["w2"],
        "B_b2": _B_in["b2"],
    }

def reference(A_x, A_wqkv, A_wo, B_x, B_w1, B_b1, B_w2, B_b2):
    def _A_ref(x, wqkv, wo):
        B, S, D = x.shape
        H = 32; Dh = D // H
        qkv = (lambda x, *d: x.permute(*d))((x @ wqkv).reshape(B, S, 3, H, Dh), 2, 0, 3, 1, 4)
        q, k, v = qkv[0], qkv[1], qkv[2]
        scale = Dh ** -0.5
        scores = torch.einsum("bhqd,bhkd->bhqk", q, k) * scale
        p = _softmax(scores, axis=-1)
        o = torch.einsum("bhqk,bhkd->bhqd", p, v)
        return (lambda x, *d: x.permute(*d))(o, 0, 2, 1, 3).reshape(B, S, D) @ wo

    def _B_ref(x, w1, b1, w2, b2):
        y = _layernorm(x, axis=-1)
        h = _gelu(torch.einsum("bsd,df->bsf", y, w1) + b1)
        return torch.einsum("bsf,fd->bsd", h, w2) + b2

    x = A_x
    xn = _layernorm(x, axis=-1)
    return x + _A_ref(xn, A_wqkv, A_wo) + _B_ref(xn, B_w1, B_b1, B_w2, B_b2)
```

```asm
; @launch grid=(256,1,1) block=(256,1,1) lds=163840
.amdgcn_target "amdgcn-amd-amdhsa--gfx950"
.text
.globl parallel_sum__softmax_full_mha__mixer_channel_mlp__prompt_kernel
.p2align 8
.type parallel_sum__softmax_full_mha__mixer_channel_mlp__prompt_kernel,@function
parallel_sum__softmax_full_mha__mixer_channel_mlp__prompt_kernel:
    s_cmp_ge_u32 s2, 256
    s_cbranch_scc1 L_end
    s_load_dwordx16 s[84:99], s[0:1], 0
    s_load_dwordx2 s[100:101], s[0:1], 64
    s_load_dwordx4 s[4:7], s[0:1], 72
    v_lshrrev_b32 v2, 6, v0
    v_and_b32 v1, 63, v0
    v_readfirstlane_b32 s24, v2
    v_and_b32 v129, 7, v0
    v_bfe_u32 v130, v0, 3, 3
    s_lshl_b32 s3, s2, 3
    v_add_u32 v132, s3, v129
    v_lshlrev_b32 v133, 11, v132
    v_lshl_add_u32 v133, v2, 9, v133
    v_lshl_add_u32 v133, v130, 4, v133
    v_mov_b32 v131, v2
    s_and_b32 s3, s2, 7
    s_lshr_b32 s29, s2, 3
    s_and_b32 s25, s3, 1
    s_xor_b32 s25, s25, 0
    s_lshl_b32 s25, s25, 2
    s_and_b32 s26, s29, 3
    s_add_u32 s25, s25, s26
    s_lshr_b32 s26, s3, 1
    s_lshl_b32 s26, s26, 3
    s_lshr_b32 s29, s29, 2
    s_add_u32 s26, s26, s29
    s_and_b32 s27, s26, 1
    s_lshr_b32 s28, s26, 1
    s_lshl_b32 s37, s25, 3
    s_lshl_b32 s38, s24, 1
    s_add_u32 s37, s37, s38
    s_add_u32 s38, s37, s27
    s_xor_b32 s39, s27, 1
    s_add_u32 s39, s37, s39
    s_mul_i32 s44, s28, 7
    s_mul_i32 s45, s27, 3
    s_add_u32 s44, s44, s45
    s_add_u32 s45, s44, s27
    s_lshl_b32 s46, s45, 6
    s_xor_b32 s47, s27, 1
    s_mul_i32 s47, s47, 3
    s_add_u32 s47, s47, s44
    s_lshl_b32 s48, s47, 6
    s_waitcnt lgkmcnt(0)
    s_mov_b32 s40, s84
    s_mov_b32 s41, s85
    s_mov_b32 s42, 0x400000
    s_mov_b32 s43, 0x20000
    s_mov_b32 s8, s6
    s_mov_b32 s9, s7
    s_mov_b32 s10, 0x10000000
    s_mov_b32 s11, 0x20000
    v_lshlrev_b32 v37, 11, v132
    buffer_load_ushort v37, v37, s[40:43], 0 offen
    v_mov_b32 v30, 0
    v_mov_b32 v31, 0x430000
    v_lshlrev_b32 v27, 6, v0
    s_cmp_lg_u32 s2, 0
    s_cbranch_scc1 L_lnc
    s_mov_b32 s60, 0x410000
    buffer_store_dword v30, v27, s[8:11], s60 offen sc1
    buffer_load_dword v26, v31, s[8:11], 0 offen sc1
L_lnc:
    buffer_load_dwordx4 v[136:139], v133, s[40:43], 0 offen offset:0
    buffer_load_dwordx4 v[140:143], v133, s[40:43], 0 offen offset:128
    buffer_load_dwordx4 v[144:147], v133, s[40:43], 0 offen offset:256
    buffer_load_dwordx4 v[148:151], v133, s[40:43], 0 offen offset:384
    s_getpc_b64 s[62:63]
L_pc1:
    s_sub_u32 s62, s62, L_pc1-parallel_sum__softmax_full_mha__mixer_channel_mlp__prompt_kernel
    s_subb_u32 s63, s63, 0
    s_lshr_b32 s3, s2, 3
    s_lshl_b32 s3, s3, 2
    s_add_u32 s3, s3, s24
    s_lshl_b32 s3, s3, 10
    s_add_u32 s3, s3, parallel_sum__softmax_full_mha__mixer_channel_mlp__prompt_kernel-parallel_sum__softmax_full_mha__mixer_channel_mlp__prompt_kernel
    v_lshl_add_u32 v33, v1, 4, s3
    v_min_u32 v33, L_zend-parallel_sum__softmax_full_mha__mixer_channel_mlp__prompt_kernel-4, v33
    global_load_dword v33, v33, s[62:63]
    s_mov_b32 s12, s86
    s_mov_b32 s13, s87
    s_mov_b32 s14, 0x600000
    s_mov_b32 s15, 0x20000
    s_mov_b32 s16, s92
    s_mov_b32 s17, s93
    s_mov_b32 s18, 0x700000
    s_mov_b32 s19, 0x20000
    s_mov_b32 s20, s94
    s_mov_b32 s21, s95
    s_mov_b32 s22, 0x1c00
    s_mov_b32 s23, 0x20000
    s_lshl_b32 s51, s27, 11
    s_lshl_b32 s52, s28, 7
    s_add_u32 s51, s51, s52
    s_lshl_b32 s52, s26, 6
    s_add_u32 s52, s52, 4096
    s_sub_u32 s52, s52, 128
    s_sub_u32 s52, s52, s51
    s_mul_i32 s53, s24, 16*6144
    s_add_u32 s53, s53, s51
    s_movk_i32 s54, 6144
    v_add_u32 v19, 0, v1
    v_mul_u32_u24 v20, 171, v19
    v_lshrrev_b32 v20, 11, v20
    v_mul_u32_u24 v21, 12, v20
    v_sub_u32 v21, v19, v21
    v_mul_u32_u24 v20, s54, v20
    v_lshl_add_u32 v20, v21, 4, v20
    v_mov_b32 v22, s52
    v_cmp_le_u32 vcc, 8, v21
    s_nop 1
    v_cndmask_b32 v22, 0, v22, vcc
    v_add3_u32 v3, v20, v22, s53
    v_subrev_u32 v3, 0, v3
    v_add_u32 v19, 64, v1
    v_mul_u32_u24 v20, 171, v19
    v_lshrrev_b32 v20, 11, v20
    v_mul_u32_u24 v21, 12, v20
    v_sub_u32 v21, v19, v21
    v_mul_u32_u24 v20, s54, v20
    v_lshl_add_u32 v20, v21, 4, v20
    v_mov_b32 v22, s52
    v_cmp_le_u32 vcc, 8, v21
    s_nop 1
    v_cndmask_b32 v22, 0, v22, vcc
    v_add3_u32 v4, v20, v22, s53
    v_subrev_u32 v4, 1024, v4
    v_add_u32 v19, 128, v1
    v_mul_u32_u24 v20, 171, v19
    v_lshrrev_b32 v20, 11, v20
    v_mul_u32_u24 v21, 12, v20
    v_sub_u32 v21, v19, v21
    v_mul_u32_u24 v20, s54, v20
    v_lshl_add_u32 v20, v21, 4, v20
    v_mov_b32 v22, s52
    v_cmp_le_u32 vcc, 8, v21
    s_nop 1
    v_cndmask_b32 v22, 0, v22, vcc
    v_add3_u32 v5, v20, v22, s53
    v_subrev_u32 v5, 2048, v5
    v_lshrrev_b32 v19, 4, v1
    v_bfe_u32 v20, v1, 2, 2
    v_xor_b32 v20, v20, v19
    v_and_b32 v21, 3, v1
    v_lshlrev_b32 v21, 4, v21
    v_lshl_add_u32 v21, v20, 6, v21
    s_movk_i32 s54, 7168
    v_mul_u32_u24 v19, s54, v19
    s_mul_i32 s53, s24, 16*7168
    s_lshl_b32 s55, s44, 6
    s_add_u32 s53, s53, s55
    v_add3_u32 v6, v19, v21, s53
    v_add_u32 v7, 27648, v6
    v_add_u32 v8, 55296, v6
    v_add_u32 v9, 82944, v6
    s_mov_b32 s32, 0
    s_mov_b32 s33, 0
    s_mul_i32 s34, s24, 3072
    s_lshl_b32 s35, s24, 12
    s_add_u32 s35, s35, 49152
    v_lshrrev_b32 v15, 5, v1
    v_lshlrev_b32 v15, 3, v15
    s_mul_i32 s3, s2, 192
    s_sub_u32 s3, s3, 64
    s_cmp_eq_u32 s24, 0
    s_cselect_b32 s3, 0x1000000, s3
    v_add_u32 v24, s3, v0
    v_lshlrev_b32 v24, 6, v24
    s_mov_b32 s49, 0
    s_mov_b32 s50, 0
    buffer_load_dwordx2 v[48:49], v15, s[20:23], s46 offen offset:0
    buffer_load_dwordx2 v[50:51], v15, s[20:23], s46 offen offset:16
    buffer_load_dwordx2 v[52:53], v15, s[20:23], s46 offen offset:32
    buffer_load_dwordx2 v[54:55], v15, s[20:23], s46 offen offset:48
    buffer_load_dwordx2 v[56:57], v15, s[20:23], s46 offen offset:64
    buffer_load_dwordx2 v[58:59], v15, s[20:23], s46 offen offset:80
    buffer_load_dwordx2 v[60:61], v15, s[20:23], s46 offen offset:96
    buffer_load_dwordx2 v[62:63], v15, s[20:23], s46 offen offset:112
    buffer_load_dwordx2 v[64:65], v15, s[20:23], s46 offen offset:128
    buffer_load_dwordx2 v[66:67], v15, s[20:23], s46 offen offset:144
    buffer_load_dwordx2 v[68:69], v15, s[20:23], s46 offen offset:160
    buffer_load_dwordx2 v[70:71], v15, s[20:23], s46 offen offset:176
    buffer_load_dwordx2 v[72:73], v15, s[20:23], s48 offen offset:0
    buffer_load_dwordx2 v[74:75], v15, s[20:23], s48 offen offset:16
    buffer_load_dwordx2 v[76:77], v15, s[20:23], s48 offen offset:32
    buffer_load_dwordx2 v[78:79], v15, s[20:23], s48 offen offset:48
    v_lshrrev_b32 v19, 5, v1
    v_bfe_u32 v20, v1, 2, 2
    v_lshl_add_u32 v19, v19, 3, v20
    v_bfe_u32 v21, v1, 4, 1
    v_and_b32 v22, 3, v1
    v_lshlrev_b32 v22, 3, v22
    v_lshl_add_u32 v22, v21, 5, v22
    v_mul_u32_u24 v10, 192, v19
    v_add_u32 v10, v10, v22
    v_lshl_add_u32 v23, v19, 8, v22
    v_add_u32 v23, 49152, v23
    s_add_u32 s55, s27, 0
    v_xor_b32 v21, s55, v20
    v_lshl_add_u32 v11, v21, 6, v23
    s_add_u32 s55, s27, 1
    v_xor_b32 v21, s55, v20
    v_lshl_add_u32 v12, v21, 6, v23
    s_add_u32 s55, s27, 2
    v_xor_b32 v21, s55, v20
    v_lshl_add_u32 v13, v21, 6, v23
    s_sub_u32 s55, s47, s44
    v_xor_b32 v21, s55, v20
    v_lshl_add_u32 v14, v21, 6, v23
    v_lshlrev_b32 v2, 4, v1
    s_lshl_b32 s30, s38, 16
    s_lshl_b32 s31, s39, 16
    v_lshrrev_b32 v134, 5, v132
    v_lshlrev_b32 v134, 16, v134
    v_lshl_add_u32 v134, v131, 14, v134
    v_lshrrev_b32 v135, 1, v130
    v_lshl_add_u32 v134, v135, 10, v134
    v_and_b32 v135, 31, v132
    v_lshl_add_u32 v134, v135, 4, v134
    v_and_b32 v135, 1, v130
    v_lshl_add_u32 v134, v135, 9, v134
    v_lshlrev_b32 v188, 4, v129
    v_add_u32 v188, 114688, v188
    v_lshl_add_u32 v189, v131, 2, v188
    s_mov_b32 s56, 0xffff0000
    s_movk_i32 s57, 4096
    s_movk_i32 s58, 8192
    s_movk_i32 s59, 12288
    s_lshr_b32 s60, s2, 5
    s_lshr_b32 s61, s60, 2
    s_xor_b32 s61, s61, 0
    s_and_b32 s60, s60, 3
    s_lshl_b32 s60, s60, 3
    s_add_u32 s60, s60, s61
    s_lshl_b32 s60, s60, 7
    s_and_b32 s61, s2, 31
    s_lshl_b32 s61, s61, 2
    s_add_u32 s60, s60, s61
    s_add_u32 s60, s60, 0x414000
    v_and_b32 v28, 3, v1
    v_lshlrev_b32 v28, 8, v28
    v_lshrrev_b32 v29, 2, v1
    v_lshl_add_u32 v28, v29, 12, v28
    v_add_u32 v28, s60, v28
    s_lshl_b32 s60, s2, 7
    s_add_u32 s60, s60, 0x414000
    v_lshl_add_u32 v29, v1, 2, s60
    s_lshl_b32 s60, s2, 6
    s_add_u32 s60, s60, 0x420000
    v_writelane_b32 v29, s60, 32
    s_cmp_lg_u32 s2, 0
    s_cbranch_scc1 L_lnd
    s_waitcnt vmcnt(21)
    v_add_u32 v26, 0x9e3779b8, v26
    v_or_b32 v26, 1, v26
    s_cmp_lg_u32 s24, 0
    s_cbranch_scc1 L_lnd
    s_mov_b64 exec, 1
    global_store_dword v30, v26, s[4:5] sc1
    s_mov_b64 exec, -1
L_lnd:
    s_waitcnt vmcnt(20)
    v_lshlrev_b32 v152, 16, v136
    v_and_b32 v153, s56, v136
    v_lshlrev_b32 v154, 16, v137
    v_and_b32 v155, s56, v137
    v_lshlrev_b32 v156, 16, v138
    v_and_b32 v157, s56, v138
    v_lshlrev_b32 v158, 16, v139
    v_and_b32 v159, s56, v139
    s_waitcnt vmcnt(19)
    v_lshlrev_b32 v160, 16, v140
    v_and_b32 v161, s56, v140
    v_lshlrev_b32 v162, 16, v141
    v_and_b32 v163, s56, v141
    v_lshlrev_b32 v164, 16, v142
    v_and_b32 v165, s56, v142
    v_lshlrev_b32 v166, 16, v143
    v_and_b32 v167, s56, v143
    s_waitcnt vmcnt(18)
    v_lshlrev_b32 v168, 16, v144
    v_and_b32 v169, s56, v144
    v_lshlrev_b32 v170, 16, v145
    v_and_b32 v171, s56, v145
    v_lshlrev_b32 v172, 16, v146
    v_and_b32 v173, s56, v146
    v_lshlrev_b32 v174, 16, v147
    v_and_b32 v175, s56, v147
    s_waitcnt vmcnt(17)
    v_lshlrev_b32 v176, 16, v148
    v_and_b32 v177, s56, v148
    v_lshlrev_b32 v178, 16, v149
    v_and_b32 v179, s56, v149
    v_lshlrev_b32 v180, 16, v150
    v_and_b32 v181, s56, v150
    v_lshlrev_b32 v182, 16, v151
    v_and_b32 v183, s56, v151
    s_cmp_lg_u32 s2, 0
    s_cbranch_scc1 L_lng
    s_waitcnt vmcnt(0)
L_lng:
    v_lshlrev_b32 v38, 16, v37
    v_sub_f32 v38, 0, v38
    v_mov_b32 v39, v38
    v_pk_add_f32 v[152:153], v[152:153], v[38:39]
    v_pk_add_f32 v[154:155], v[154:155], v[38:39]
    v_pk_add_f32 v[156:157], v[156:157], v[38:39]
    v_pk_add_f32 v[158:159], v[158:159], v[38:39]
    v_pk_add_f32 v[160:161], v[160:161], v[38:39]
    v_pk_add_f32 v[162:163], v[162:163], v[38:39]
    v_pk_add_f32 v[164:165], v[164:165], v[38:39]
    v_pk_add_f32 v[166:167], v[166:167], v[38:39]
    v_pk_add_f32 v[168:169], v[168:169], v[38:39]
    v_pk_add_f32 v[170:171], v[170:171], v[38:39]
    v_pk_add_f32 v[172:173], v[172:173], v[38:39]
    v_pk_add_f32 v[174:175], v[174:175], v[38:39]
    v_pk_add_f32 v[176:177], v[176:177], v[38:39]
    v_pk_add_f32 v[178:179], v[178:179], v[38:39]
    v_pk_add_f32 v[180:181], v[180:181], v[38:39]
    v_pk_add_f32 v[182:183], v[182:183], v[38:39]
    v_pk_add_f32 v[184:185], v[152:153], v[154:155]
    v_pk_mul_f32 v[190:191], v[152:153], v[152:153]
    v_pk_fma_f32 v[190:191], v[154:155], v[154:155], v[190:191]
    v_pk_add_f32 v[184:185], v[184:185], v[156:157]
    v_pk_fma_f32 v[190:191], v[156:157], v[156:157], v[190:191]
    v_pk_add_f32 v[184:185], v[184:185], v[158:159]
    v_pk_fma_f32 v[190:191], v[158:159], v[158:159], v[190:191]
    v_pk_add_f32 v[184:185], v[184:185], v[160:161]
    v_pk_fma_f32 v[190:191], v[160:161], v[160:161], v[190:191]
    v_pk_add_f32 v[184:185], v[184:185], v[162:163]
    v_pk_fma_f32 v[190:191], v[162:163], v[162:163], v[190:191]
    v_pk_add_f32 v[184:185], v[184:185], v[164:165]
    v_pk_fma_f32 v[190:191], v[164:165], v[164:165], v[190:191]
    v_pk_add_f32 v[184:185], v[184:185], v[166:167]
    v_pk_fma_f32 v[190:191], v[166:167], v[166:167], v[190:191]
    v_pk_add_f32 v[184:185], v[184:185], v[168:169]
    v_pk_fma_f32 v[190:191], v[168:169], v[168:169], v[190:191]
    v_pk_add_f32 v[184:185], v[184:185], v[170:171]
    v_pk_fma_f32 v[190:191], v[170:171], v[170:171], v[190:191]
    v_pk_add_f32 v[184:185], v[184:185], v[172:173]
    v_pk_fma_f32 v[190:191], v[172:173], v[172:173], v[190:191]
    v_pk_add_f32 v[184:185], v[184:185], v[174:175]
    v_pk_fma_f32 v[190:191], v[174:175], v[174:175], v[190:191]
    v_pk_add_f32 v[184:185], v[184:185], v[176:177]
    v_pk_fma_f32 v[190:191], v[176:177], v[176:177], v[190:191]
    v_pk_add_f32 v[184:185], v[184:185], v[178:179]
    v_pk_fma_f32 v[190:191], v[178:179], v[178:179], v[190:191]
    v_pk_add_f32 v[184:185], v[184:185], v[180:181]
    v_pk_fma_f32 v[190:191], v[180:181], v[180:181], v[190:191]
    v_pk_add_f32 v[184:185], v[184:185], v[182:183]
    v_pk_fma_f32 v[190:191], v[182:183], v[182:183], v[190:191]
    v_add_f32 v184, v184, v185
    v_add_f32 v190, v190, v191
    s_nop 0
    v_add_f32_dpp v184, v184, v184 row_ror:8 row_mask:0xf bank_mask:0xf
    v_add_f32_dpp v190, v190, v190 row_ror:8 row_mask:0xf bank_mask:0xf
    v_mov_b32 v185, v184
    v_mov_b32 v191, v190
    s_nop 0
    v_permlane16_swap_b32 v184, v185
    v_permlane16_swap_b32 v190, v191
    s_nop 0
    v_add_f32 v184, v184, v185
    v_add_f32 v190, v190, v191
    v_mov_b32 v185, v184
    v_mov_b32 v191, v190
    s_nop 0
    v_permlane32_swap_b32 v184, v185
    v_permlane32_swap_b32 v190, v191
    s_nop 0
    v_add_f32 v184, v184, v185
    v_add_f32 v190, v190, v191
    ds_write_b32 v189, v184
    ds_write_b32 v189, v190 offset:128
    s_waitcnt lgkmcnt(0)
    s_barrier
    ds_read_b128 v[136:139], v188
    ds_read_b128 v[140:143], v188 offset:128
    s_cmp_lg_u32 s2, 0
    s_cbranch_scc1 L_lne
    s_mov_b32 s60, 0x420000
    buffer_store_dword v26, v27, s[8:11], s60 offen sc1
    s_mov_b64 exec, 1
    buffer_store_dword v26, v31, s[8:11], 0 offen sc1
    s_mov_b64 exec, -1
L_lne:
    s_waitcnt lgkmcnt(0)
    v_pk_add_f32 v[136:137], v[136:137], v[138:139]
    v_pk_add_f32 v[140:141], v[140:141], v[142:143]
    v_add_f32 v136, v136, v137
    v_add_f32 v140, v140, v141
    v_mul_f32 v136, 0x3a800000, v136
    v_mul_f32 v140, 0x3a800000, v140
    v_fma_f32 v184, -v136, v136, v140
    v_max_f32 v184, 0, v184
    v_add_f32 v186, 0x3727c5ac, v184
    v_rsq_f32 v186, v186
    v_sub_f32 v136, 0, v136
    v_mov_b32 v137, v136
    v_mov_b32 v187, v186
    v_pk_add_f32 v[152:153], v[152:153], v[136:137]
    v_pk_add_f32 v[154:155], v[154:155], v[136:137]
    v_pk_add_f32 v[156:157], v[156:157], v[136:137]
    v_pk_add_f32 v[158:159], v[158:159], v[136:137]
    v_pk_add_f32 v[160:161], v[160:161], v[136:137]
    v_pk_add_f32 v[162:163], v[162:163], v[136:137]
    v_pk_add_f32 v[164:165], v[164:165], v[136:137]
    v_pk_add_f32 v[166:167], v[166:167], v[136:137]
    v_pk_add_f32 v[168:169], v[168:169], v[136:137]
    v_pk_add_f32 v[170:171], v[170:171], v[136:137]
    v_pk_add_f32 v[172:173], v[172:173], v[136:137]
    v_pk_add_f32 v[174:175], v[174:175], v[136:137]
    v_pk_add_f32 v[176:177], v[176:177], v[136:137]
    v_pk_add_f32 v[178:179], v[178:179], v[136:137]
    v_pk_add_f32 v[180:181], v[180:181], v[136:137]
    v_pk_add_f32 v[182:183], v[182:183], v[136:137]
    v_pk_mul_f32 v[152:153], v[152:153], v[186:187]
    v_pk_mul_f32 v[154:155], v[154:155], v[186:187]
    v_pk_mul_f32 v[156:157], v[156:157], v[186:187]
    v_pk_mul_f32 v[158:159], v[158:159], v[186:187]
    v_pk_mul_f32 v[160:161], v[160:161], v[186:187]
    v_pk_mul_f32 v[162:163], v[162:163], v[186:187]
    v_pk_mul_f32 v[164:165], v[164:165], v[186:187]
    v_pk_mul_f32 v[166:167], v[166:167], v[186:187]
    v_pk_mul_f32 v[168:169], v[168:169], v[186:187]
    v_pk_mul_f32 v[170:171], v[170:171], v[186:187]
    v_pk_mul_f32 v[172:173], v[172:173], v[186:187]
    v_pk_mul_f32 v[174:175], v[174:175], v[186:187]
    v_pk_mul_f32 v[176:177], v[176:177], v[186:187]
    v_pk_mul_f32 v[178:179], v[178:179], v[186:187]
    v_pk_mul_f32 v[180:181], v[180:181], v[186:187]
    v_pk_mul_f32 v[182:183], v[182:183], v[186:187]
    v_cvt_pk_bf16_f32 v136, v152, v153
    v_cvt_pk_bf16_f32 v137, v154, v155
    v_cvt_pk_bf16_f32 v138, v156, v157
    v_cvt_pk_bf16_f32 v139, v158, v159
    v_cvt_pk_bf16_f32 v140, v160, v161
    v_cvt_pk_bf16_f32 v141, v162, v163
    v_cvt_pk_bf16_f32 v142, v164, v165
    v_cvt_pk_bf16_f32 v143, v166, v167
    v_cvt_pk_bf16_f32 v144, v168, v169
    v_cvt_pk_bf16_f32 v145, v170, v171
    v_cvt_pk_bf16_f32 v146, v172, v173
    v_cvt_pk_bf16_f32 v147, v174, v175
    v_cvt_pk_bf16_f32 v148, v176, v177
    v_cvt_pk_bf16_f32 v149, v178, v179
    v_cvt_pk_bf16_f32 v150, v180, v181
    v_cvt_pk_bf16_f32 v151, v182, v183
    buffer_store_dwordx4 v[136:139], v134, s[8:11], 0 offen sc1
    buffer_store_dwordx4 v[140:143], v134, s[8:11], s57 offen sc1
    buffer_store_dwordx4 v[144:147], v134, s[8:11], s58 offen sc1
    buffer_store_dwordx4 v[148:151], v134, s[8:11], s59 offen sc1
    v_mul_f32 v184, v184, v186
    v_mul_f32 v184, v184, v186
    v_add_f32 v184, 0x3727c5ac, v184
    v_sqrt_f32 v184, v184
    v_lshlrev_b32 v132, 2, v132
    s_mov_b32 s60, 0x400000
    s_lshl_b32 s61, s2, 6
    s_add_u32 s61, s61, 0x410000
    v_mov_b32 v187, 0
    v_lshlrev_b32 v133, 14, v0
    s_cmp_lg_u32 s24, 0
    s_cbranch_scc1 L_ln1
    s_mov_b64 exec, 0xff
    buffer_store_dword v184, v132, s[8:11], s60 offen sc1
    s_mov_b64 exec, 3
    global_load_dword v31, v30, s[4:5] sc1
    s_mov_b64 exec, -1
L_ln1:
    s_mov_b32 s40, s4
    s_mov_b32 s41, s5
    s_mov_b32 s42, 0x100
    s_mov_b32 s43, 0x20000
    s_mov_b32 s54, 0xffff0000
    s_cmp_eq_u32 s24, 0
    s_cbranch_scc1 L_ln0
    s_add_u32 m0, s34, 0
    s_nop 0
    buffer_load_dwordx4 v3, s[12:15], s32 offen offset:0 lds
    buffer_load_dwordx4 v4, s[12:15], s32 offen offset:1024 lds
    buffer_load_dwordx4 v5, s[12:15], s32 offen offset:2048 lds
    s_add_u32 m0, s35, 0
    s_nop 0
    buffer_load_dwordx4 v6, s[16:19], s33 offen offset:0 lds
    buffer_load_dwordx4 v7, s[16:19], s33 offen offset:1024 lds
    buffer_load_dwordx4 v8, s[16:19], s33 offen offset:2048 lds
    buffer_load_dwordx4 v9, s[16:19], s33 offen offset:3072 lds
    s_add_u32 s32, s32, 393216
    s_add_u32 s33, s33, 458752
    s_add_u32 m0, s34, 12288
    s_nop 0
    buffer_load_dwordx4 v3, s[12:15], s32 offen offset:0 lds
    buffer_load_dwordx4 v4, s[12:15], s32 offen offset:1024 lds
    buffer_load_dwordx4 v5, s[12:15], s32 offen offset:2048 lds
    s_add_u32 m0, s35, 16384
    s_nop 0
    buffer_load_dwordx4 v6, s[16:19], s33 offen offset:0 lds
    buffer_load_dwordx4 v7, s[16:19], s33 offen offset:1024 lds
    buffer_load_dwordx4 v8, s[16:19], s33 offen offset:2048 lds
    buffer_load_dwordx4 v9, s[16:19], s33 offen offset:3072 lds
    s_add_u32 s32, s32, 393216
    s_add_u32 s33, s33, 458752
    s_add_u32 m0, s34, 24576
    s_nop 0
    buffer_load_dwordx4 v3, s[12:15], s32 offen offset:0 lds
    buffer_load_dwordx4 v4, s[12:15], s32 offen offset:1024 lds
    buffer_load_dwordx4 v5, s[12:15], s32 offen offset:2048 lds
    s_add_u32 m0, s35, 32768
    s_nop 0
    buffer_load_dwordx4 v6, s[16:19], s33 offen offset:0 lds
    buffer_load_dwordx4 v7, s[16:19], s33 offen offset:1024 lds
    buffer_load_dwordx4 v8, s[16:19], s33 offen offset:2048 lds
    buffer_load_dwordx4 v9, s[16:19], s33 offen offset:3072 lds
    s_add_u32 s32, s32, 393216
    s_add_u32 s33, s33, 458752
    s_waitcnt vmcnt(21)
    s_barrier
    s_branch L_ln3
L_ln0:
    s_waitcnt vmcnt(0)
    s_barrier
    s_mov_b32 s61, 0x40000
    s_branch L_lt1
L_lt0:
    global_load_dword v31, v30, s[4:5] sc1
    s_sub_u32 s61, s61, 1
    s_cbranch_scc1 L_lt2
    s_waitcnt vmcnt(0)
L_lt1:
    v_readfirstlane_b32 s60, v31
    s_cmp_eq_u32 s60, 0
    s_cbranch_scc1 L_lt0
L_lt2:
    s_waitcnt vmcnt(0)
    v_mov_b32 v31, s60
    s_mov_b32 exec_hi, 0
    buffer_store_dword v31, v28, s[8:11], 0 offen sc1
    s_mov_b32 exec_hi, 1
    s_mov_b32 s61, 0x40000
L_lt3:
    global_load_dword v32, v29, s[6:7] sc1
    s_waitcnt vmcnt(0)
    v_cmp_ne_u32 vcc, s60, v32
    s_cbranch_vccz L_lt4
    s_sub_u32 s61, s61, 1
    s_cbranch_scc0 L_lt3
L_lt4:
    s_mov_b64 exec, -1
L_ln2:
    s_add_u32 m0, s34, 0
    s_nop 0
    buffer_load_dwordx4 v3, s[12:15], s32 offen offset:0 lds
    buffer_load_dwordx4 v4, s[12:15], s32 offen offset:1024 lds
    buffer_load_dwordx4 v5, s[12:15], s32 offen offset:2048 lds
    s_add_u32 m0, s35, 0
    s_nop 0
    buffer_load_dwordx4 v6, s[16:19], s33 offen offset:0 lds
    buffer_load_dwordx4 v7, s[16:19], s33 offen offset:1024 lds
    buffer_load_dwordx4 v8, s[16:19], s33 offen offset:2048 lds
    buffer_load_dwordx4 v9, s[16:19], s33 offen offset:3072 lds
    s_add_u32 s32, s32, 393216
    s_add_u32 s33, s33, 458752
    s_add_u32 m0, s34, 12288
    s_nop 0
    buffer_load_dwordx4 v3, s[12:15], s32 offen offset:0 lds
    buffer_load_dwordx4 v4, s[12:15], s32 offen offset:1024 lds
    buffer_load_dwordx4 v5, s[12:15], s32 offen offset:2048 lds
    s_add_u32 m0, s35, 16384
    s_nop 0
    buffer_load_dwordx4 v6, s[16:19], s33 offen offset:0 lds
    buffer_load_dwordx4 v7, s[16:19], s33 offen offset:1024 lds
    buffer_load_dwordx4 v8, s[16:19], s33 offen offset:2048 lds
    buffer_load_dwordx4 v9, s[16:19], s33 offen offset:3072 lds
    s_add_u32 s32, s32, 393216
    s_add_u32 s33, s33, 458752
    s_add_u32 m0, s34, 24576
    s_nop 0
    buffer_load_dwordx4 v3, s[12:15], s32 offen offset:0 lds
    buffer_load_dwordx4 v4, s[12:15], s32 offen offset:1024 lds
    buffer_load_dwordx4 v5, s[12:15], s32 offen offset:2048 lds
    s_add_u32 m0, s35, 32768
    s_nop 0
    buffer_load_dwordx4 v6, s[16:19], s33 offen offset:0 lds
    buffer_load_dwordx4 v7, s[16:19], s33 offen offset:1024 lds
    buffer_load_dwordx4 v8, s[16:19], s33 offen offset:2048 lds
    buffer_load_dwordx4 v9, s[16:19], s33 offen offset:3072 lds
    s_add_u32 s32, s32, 393216
    s_add_u32 s33, s33, 458752
L_ln3:
    v_lshlrev_b32 v80, 16, v48
    v_and_b32 v81, s54, v48
    v_lshlrev_b32 v82, 16, v49
    v_and_b32 v83, s54, v49
    v_lshlrev_b32 v84, 16, v50
    v_and_b32 v85, s54, v50
    v_lshlrev_b32 v86, 16, v51
    v_and_b32 v87, s54, v51
    v_lshlrev_b32 v88, 16, v52
    v_and_b32 v89, s54, v52
    v_lshlrev_b32 v90, 16, v53
    v_and_b32 v91, s54, v53
    v_lshlrev_b32 v92, 16, v54
    v_and_b32 v93, s54, v54
    v_lshlrev_b32 v94, 16, v55
    v_and_b32 v95, s54, v55
    v_lshlrev_b32 v96, 16, v56
    v_and_b32 v97, s54, v56
    v_lshlrev_b32 v98, 16, v57
    v_and_b32 v99, s54, v57
    v_lshlrev_b32 v100, 16, v58
    v_and_b32 v101, s54, v58
    v_lshlrev_b32 v102, 16, v59
    v_and_b32 v103, s54, v59
    v_lshlrev_b32 v104, 16, v60
    v_and_b32 v105, s54, v60
    v_lshlrev_b32 v106, 16, v61
    v_and_b32 v107, s54, v61
    v_lshlrev_b32 v108, 16, v62
    v_and_b32 v109, s54, v62
    v_lshlrev_b32 v110, 16, v63
    v_and_b32 v111, s54, v63
    v_lshlrev_b32 v112, 16, v64
    v_and_b32 v113, s54, v64
    v_lshlrev_b32 v114, 16, v65
    v_and_b32 v115, s54, v65
    v_lshlrev_b32 v116, 16, v66
    v_and_b32 v117, s54, v66
    v_lshlrev_b32 v118, 16, v67
    v_and_b32 v119, s54, v67
    v_lshlrev_b32 v120, 16, v68
    v_and_b32 v121, s54, v68
    v_lshlrev_b32 v122, 16, v69
    v_and_b32 v123, s54, v69
    v_lshlrev_b32 v124, 16, v70
    v_and_b32 v125, s54, v70
    v_lshlrev_b32 v126, 16, v71
    v_and_b32 v127, s54, v71
    v_lshlrev_b32 v128, 16, v72
    v_and_b32 v129, s54, v72
    v_lshlrev_b32 v130, 16, v73
    v_and_b32 v131, s54, v73
    v_lshlrev_b32 v132, 16, v74
    v_and_b32 v133, s54, v74
    v_lshlrev_b32 v134, 16, v75
    v_and_b32 v135, s54, v75
    v_lshlrev_b32 v136, 16, v76
    v_and_b32 v137, s54, v76
    v_lshlrev_b32 v138, 16, v77
    v_and_b32 v139, s54, v77
    v_lshlrev_b32 v140, 16, v78
    v_and_b32 v141, s54, v78
    v_lshlrev_b32 v142, 16, v79
    v_and_b32 v143, s54, v79
    v_mov_b32 v48, 0
    v_mov_b32 v49, 0
    v_mov_b32 v50, 0
    v_mov_b32 v51, 0
    v_mov_b32 v52, 0
    v_mov_b32 v53, 0
    v_mov_b32 v54, 0
    v_mov_b32 v55, 0
    v_mov_b32 v56, 0
    v_mov_b32 v57, 0
    v_mov_b32 v58, 0
    v_mov_b32 v59, 0
    v_mov_b32 v60, 0
    v_mov_b32 v61, 0
    v_mov_b32 v62, 0
    v_mov_b32 v63, 0
    v_mov_b32 v64, 0
    v_mov_b32 v65, 0
    v_mov_b32 v66, 0
    v_mov_b32 v67, 0
    v_mov_b32 v68, 0
    v_mov_b32 v69, 0
    v_mov_b32 v70, 0
    v_mov_b32 v71, 0
    v_mov_b32 v72, 0
    v_mov_b32 v73, 0
    v_mov_b32 v74, 0
    v_mov_b32 v75, 0
    v_mov_b32 v76, 0
    v_mov_b32 v77, 0
    v_mov_b32 v78, 0
    v_mov_b32 v79, 0
    v_and_b32 v18, 31, v1
    v_lshlrev_b32 v18, 2, v18
    s_lshl_b32 s60, s38, 7
    s_add_u32 s60, s60, 0x400000
    s_lshl_b32 s61, s39, 7
    s_add_u32 s61, s61, 0x400000
    s_barrier
    buffer_load_dword v16, v18, s[8:11], s60 offen sc1
    buffer_load_dword v17, v18, s[8:11], s61 offen sc1
    buffer_load_dwordx4 a[0:3], v2, s[8:11], s30 offen offset:0 sc1
    buffer_load_dwordx4 a[4:7], v2, s[8:11], s31 offen offset:0 sc1
    buffer_load_dwordx4 a[8:11], v2, s[8:11], s30 offen offset:1024 sc1
    buffer_load_dwordx4 a[12:15], v2, s[8:11], s31 offen offset:1024 sc1
    buffer_load_dwordx4 a[16:19], v2, s[8:11], s30 offen offset:2048 sc1
    buffer_load_dwordx4 a[20:23], v2, s[8:11], s31 offen offset:2048 sc1
    buffer_load_dwordx4 a[24:27], v2, s[8:11], s30 offen offset:3072 sc1
    buffer_load_dwordx4 a[28:31], v2, s[8:11], s31 offen offset:3072 sc1
    s_add_u32 s30, s30, 4096
    s_add_u32 s31, s31, 4096
    buffer_load_dwordx4 a[32:35], v2, s[8:11], s30 offen offset:0 sc1
    buffer_load_dwordx4 a[36:39], v2, s[8:11], s31 offen offset:0 sc1
    buffer_load_dwordx4 a[40:43], v2, s[8:11], s30 offen offset:1024 sc1
    buffer_load_dwordx4 a[44:47], v2, s[8:11], s31 offen offset:1024 sc1
    buffer_load_dwordx4 a[48:51], v2, s[8:11], s30 offen offset:2048 sc1
    buffer_load_dwordx4 a[52:55], v2, s[8:11], s31 offen offset:2048 sc1
    buffer_load_dwordx4 a[56:59], v2, s[8:11], s30 offen offset:3072 sc1
    buffer_load_dwordx4 a[60:63], v2, s[8:11], s31 offen offset:3072 sc1
    s_add_u32 s30, s30, 4096
    s_add_u32 s31, s31, 4096
    buffer_load_dwordx4 a[64:67], v2, s[8:11], s30 offen offset:0 sc1
    buffer_load_dwordx4 a[68:71], v2, s[8:11], s31 offen offset:0 sc1
    buffer_load_dwordx4 a[72:75], v2, s[8:11], s30 offen offset:1024 sc1
    buffer_load_dwordx4 a[76:79], v2, s[8:11], s31 offen offset:1024 sc1
    buffer_load_dwordx4 a[80:83], v2, s[8:11], s30 offen offset:2048 sc1
    buffer_load_dwordx4 a[84:87], v2, s[8:11], s31 offen offset:2048 sc1
    buffer_load_dwordx4 a[88:91], v2, s[8:11], s30 offen offset:3072 sc1
    buffer_load_dwordx4 a[92:95], v2, s[8:11], s31 offen offset:3072 sc1
    s_add_u32 s30, s30, 4096
    s_add_u32 s31, s31, 4096
    s_waitcnt vmcnt(24)
    v_mul_f32 v144, v80, v16
    v_mul_f32 v145, v81, v16
    v_mul_f32 v146, v82, v16
    v_mul_f32 v147, v83, v16
    v_mul_f32 v148, v84, v16
    v_mul_f32 v149, v85, v16
    v_mul_f32 v150, v86, v16
    v_mul_f32 v151, v87, v16
    v_mul_f32 v152, v88, v16
    v_mul_f32 v153, v89, v16
    v_mul_f32 v154, v90, v16
    v_mul_f32 v155, v91, v16
    v_mul_f32 v156, v92, v16
    v_mul_f32 v157, v93, v16
    v_mul_f32 v158, v94, v16
    v_mul_f32 v159, v95, v16
    v_mul_f32 v160, v80, v17
    v_mul_f32 v161, v81, v17
    v_mul_f32 v162, v82, v17
    v_mul_f32 v163, v83, v17
    v_mul_f32 v164, v84, v17
    v_mul_f32 v165, v85, v17
    v_mul_f32 v166, v86, v17
    v_mul_f32 v167, v87, v17
    v_mul_f32 v168, v88, v17
    v_mul_f32 v169, v89, v17
    v_mul_f32 v170, v90, v17
    v_mul_f32 v171, v91, v17
    v_mul_f32 v172, v92, v17
    v_mul_f32 v173, v93, v17
    v_mul_f32 v174, v94, v17
    v_mul_f32 v175, v95, v17
    v_mul_f32 v176, v96, v16
    v_mul_f32 v177, v97, v16
    v_mul_f32 v178, v98, v16
    v_mul_f32 v179, v99, v16
    v_mul_f32 v180, v100, v16
    v_mul_f32 v181, v101, v16
    v_mul_f32 v182, v102, v16
    v_mul_f32 v183, v103, v16
    v_mul_f32 v184, v104, v16
    v_mul_f32 v185, v105, v16
    v_mul_f32 v186, v106, v16
    v_mul_f32 v187, v107, v16
    v_mul_f32 v188, v108, v16
    v_mul_f32 v189, v109, v16
    v_mul_f32 v190, v110, v16
    v_mul_f32 v191, v111, v16
    v_mul_f32 v192, v96, v17
    v_mul_f32 v193, v97, v17
    v_mul_f32 v194, v98, v17
    v_mul_f32 v195, v99, v17
    v_mul_f32 v196, v100, v17
    v_mul_f32 v197, v101, v17
    v_mul_f32 v198, v102, v17
    v_mul_f32 v199, v103, v17
    v_mul_f32 v200, v104, v17
    v_mul_f32 v201, v105, v17
    v_mul_f32 v202, v106, v17
    v_mul_f32 v203, v107, v17
    v_mul_f32 v204, v108, v17
    v_mul_f32 v205, v109, v17
    v_mul_f32 v206, v110, v17
    v_mul_f32 v207, v111, v17
    v_mul_f32 v208, v112, v16
    v_mul_f32 v209, v113, v16
    v_mul_f32 v210, v114, v16
    v_mul_f32 v211, v115, v16
    v_mul_f32 v212, v116, v16
    v_mul_f32 v213, v117, v16
    v_mul_f32 v214, v118, v16
    v_mul_f32 v215, v119, v16
    v_mul_f32 v216, v120, v16
    v_mul_f32 v217, v121, v16
    v_mul_f32 v218, v122, v16
    v_mul_f32 v219, v123, v16
    v_mul_f32 v220, v124, v16
    v_mul_f32 v221, v125, v16
    v_mul_f32 v222, v126, v16
    v_mul_f32 v223, v127, v16
    v_mul_f32 v224, v112, v17
    v_mul_f32 v225, v113, v17
    v_mul_f32 v226, v114, v17
    v_mul_f32 v227, v115, v17
    v_mul_f32 v228, v116, v17
    v_mul_f32 v229, v117, v17
    v_mul_f32 v230, v118, v17
    v_mul_f32 v231, v119, v17
    v_mul_f32 v232, v120, v17
    v_mul_f32 v233, v121, v17
    v_mul_f32 v234, v122, v17
    v_mul_f32 v235, v123, v17
    v_mul_f32 v236, v124, v17
    v_mul_f32 v237, v125, v17
    v_mul_f32 v238, v126, v17
    v_mul_f32 v239, v127, v17
    v_mul_f32 v240, v128, v16
    v_mul_f32 v241, v129, v16
    v_mul_f32 v242, v130, v16
    v_mul_f32 v243, v131, v16
    v_mul_f32 v244, v132, v16
    v_mul_f32 v245, v133, v16
    v_mul_f32 v246, v134, v16
    v_mul_f32 v247, v135, v16
    v_mul_f32 v248, v136, v16
    v_mul_f32 v249, v137, v16
    v_mul_f32 v250, v138, v16
    v_mul_f32 v251, v139, v16
    v_mul_f32 v252, v140, v16
    v_mul_f32 v253, v141, v16
    v_mul_f32 v254, v142, v16
    v_mul_f32 v255, v143, v16
    v_mov_b32 v80, 0
    v_mov_b32 v81, 0
    v_mov_b32 v82, 0
    v_mov_b32 v83, 0
    v_mov_b32 v84, 0
    v_mov_b32 v85, 0
    v_mov_b32 v86, 0
    v_mov_b32 v87, 0
    v_mov_b32 v88, 0
    v_mov_b32 v89, 0
    v_mov_b32 v90, 0
    v_mov_b32 v91, 0
    v_mov_b32 v92, 0
    v_mov_b32 v93, 0
    v_mov_b32 v94, 0
    v_mov_b32 v95, 0
    v_mov_b32 v96, 0
    v_mov_b32 v97, 0
    v_mov_b32 v98, 0
    v_mov_b32 v99, 0
    v_mov_b32 v100, 0
    v_mov_b32 v101, 0
    v_mov_b32 v102, 0
    v_mov_b32 v103, 0
    v_mov_b32 v104, 0
    v_mov_b32 v105, 0
    v_mov_b32 v106, 0
    v_mov_b32 v107, 0
    v_mov_b32 v108, 0
    v_mov_b32 v109, 0
    v_mov_b32 v110, 0
    v_mov_b32 v111, 0
    v_mov_b32 v112, 0
    v_mov_b32 v113, 0
    v_mov_b32 v114, 0
    v_mov_b32 v115, 0
    v_mov_b32 v116, 0
    v_mov_b32 v117, 0
    v_mov_b32 v118, 0
    v_mov_b32 v119, 0
    v_mov_b32 v120, 0
    v_mov_b32 v121, 0
    v_mov_b32 v122, 0
    v_mov_b32 v123, 0
    v_mov_b32 v124, 0
    v_mov_b32 v125, 0
    v_mov_b32 v126, 0
    v_mov_b32 v127, 0
    v_mov_b32 v128, 0
    v_mov_b32 v129, 0
    v_mov_b32 v130, 0
    v_mov_b32 v131, 0
    v_mov_b32 v132, 0
    v_mov_b32 v133, 0
    v_mov_b32 v134, 0
    v_mov_b32 v135, 0
    v_mov_b32 v136, 0
    v_mov_b32 v137, 0
    v_mov_b32 v138, 0
    v_mov_b32 v139, 0
    v_mov_b32 v140, 0
    v_mov_b32 v141, 0
    v_mov_b32 v142, 0
    v_mov_b32 v143, 0
    s_waitcnt vmcnt(16)
    s_barrier
    ds_read_b64_tr_b16 a[128:129], v10 offset:0
    ds_read_b64_tr_b16 a[130:131], v10 offset:768
    ds_read_b64_tr_b16 a[132:133], v10 offset:64
    ds_read_b64_tr_b16 a[134:135], v10 offset:832
    ds_read_b64_tr_b16 a[136:137], v10 offset:128
    ds_read_b64_tr_b16 a[138:139], v10 offset:896
    ds_read_b64_tr_b16 a[140:141], v11 offset:0
    ds_read_b64_tr_b16 a[142:143], v11 offset:1024
    ds_read_b64_tr_b16 a[144:145], v12 offset:0
    ds_read_b64_tr_b16 a[146:147], v12 offset:1024
    s_add_u32 m0, s34, 36864
    s_nop 0
    buffer_load_dwordx4 v3, s[12:15], s32 offen offset:0 lds
    s_waitcnt lgkmcnt(8)
    v_mfma_f32_32x32x16_bf16 v[48:63], a[128:131], a[0:3], v[48:63]
    v_mfma_f32_32x32x16_bf16 v[64:79], a[128:131], a[4:7], v[64:79]
    ds_read_b64_tr_b16 a[148:149], v13 offset:0
    ds_read_b64_tr_b16 a[150:151], v13 offset:1024
    s_waitcnt lgkmcnt(8)
    v_mfma_f32_32x32x16_bf16 v[80:95], a[132:135], a[0:3], v[80:95]
    buffer_load_dwordx4 v4, s[12:15], s32 offen offset:1024 lds
    v_mfma_f32_32x32x16_bf16 v[96:111], a[132:135], a[4:7], v[96:111]
    ds_read_b64_tr_b16 a[152:153], v14 offset:0
    ds_read_b64_tr_b16 a[154:155], v14 offset:1024
    s_waitcnt lgkmcnt(8)
    v_mfma_f32_32x32x16_bf16 v[112:127], a[0:3], a[136:139], v[112:127]
    ds_read_b64_tr_b16 a[156:157], v10 offset:3072
    ds_read_b64_tr_b16 a[158:159], v10 offset:3840
    v_mfma_f32_32x32x16_bf16 v[128:143], a[4:7], a[136:139], v[128:143]
    buffer_load_dwordx4 v5, s[12:15], s32 offen offset:2048 lds
    s_waitcnt lgkmcnt(8)
    v_mfma_f32_32x32x16_bf16 v[144:159], a[140:143], a[0:3], v[144:159]
    ds_read_b64_tr_b16 a[128:129], v10 offset:3136
    ds_read_b64_tr_b16 a[130:131], v10 offset:3904
    v_mfma_f32_32x32x16_bf16 v[160:175], a[140:143], a[4:7], v[160:175]
    s_waitcnt lgkmcnt(8)
    v_mfma_f32_32x32x16_bf16 v[176:191], a[144:147], a[0:3], v[176:191]
    ds_read_b64_tr_b16 a[132:133], v10 offset:3200
    ds_read_b64_tr_b16 a[134:135], v10 offset:3968
    s_add_u32 m0, s35, 49152
    s_nop 0
    buffer_load_dwordx4 v6, s[16:19], s33 offen offset:0 lds
    v_mfma_f32_32x32x16_bf16 v[192:207], a[144:147], a[4:7], v[192:207]
    s_waitcnt lgkmcnt(8)
    v_mfma_f32_32x32x16_bf16 v[208:223], a[148:151], a[0:3], v[208:223]
    ds_read_b64_tr_b16 a[136:137], v11 offset:4096
    ds_read_b64_tr_b16 a[138:139], v11 offset:5120
    v_mfma_f32_32x32x16_bf16 v[224:239], a[148:151], a[4:7], v[224:239]
    buffer_load_dwordx4 v7, s[16:19], s33 offen offset:1024 lds
    s_waitcnt lgkmcnt(8)
    v_mfma_f32_32x32x16_bf16 v[240:255], a[152:155], a[0:3], v[240:255]
    ds_read_b64_tr_b16 a[140:141], v12 offset:4096
    ds_read_b64_tr_b16 a[142:143], v12 offset:5120
    s_waitcnt lgkmcnt(8)
    v_mfma_f32_32x32x16_bf16 v[48:63], a[156:159], a[8:11], v[48:63]
    v_mfma_f32_32x32x16_bf16 v[64:79], a[156:159], a[12:15], v[64:79]
    ds_read_b64_tr_b16 a[144:145], v13 offset:4096
    ds_read_b64_tr_b16 a[146:147], v13 offset:5120
    buffer_load_dwordx4 v8, s[16:19], s33 offen offset:2048 lds
    s_waitcnt lgkmcnt(8)
    v_mfma_f32_32x32x16_bf16 v[80:95], a[128:131], a[8:11], v[80:95]
    v_mfma_f32_32x32x16_bf16 v[96:111], a[128:131], a[12:15], v[96:111]
    ds_read_b64_tr_b16 a[148:149], v14 offset:4096
    ds_read_b64_tr_b16 a[150:151], v14 offset:5120
    s_waitcnt lgkmcnt(8)
    v_mfma_f32_32x32x16_bf16 v[112:127], a[8:11], a[132:135], v[112:127]
    ds_read_b64_tr_b16 a[152:153], v10 offset:6144
    ds_read_b64_tr_b16 a[154:155], v10 offset:6912
    buffer_load_dwordx4 v9, s[16:19], s33 offen offset:3072 lds
    s_add_u32 s32, s32, 393216
    s_add_u32 s33, s33, 458752
    v_mfma_f32_32x32x16_bf16 v[128:143], a[12:15], a[132:135], v[128:143]
    s_waitcnt lgkmcnt(8)
    v_mfma_f32_32x32x16_bf16 v[144:159], a[136:139], a[8:11], v[144:159]
    ds_read_b64_tr_b16 a[156:157], v10 offset:6208
    ds_read_b64_tr_b16 a[158:159], v10 offset:6976
    v_mfma_f32_32x32x16_bf16 v[160:175], a[136:139], a[12:15], v[160:175]
    buffer_load_dwordx4 a[96:99], v2, s[8:11], s30 offen offset:0 sc1
    s_waitcnt lgkmcnt(8)
    v_mfma_f32_32x32x16_bf16 v[176:191], a[140:143], a[8:11], v[176:191]
    ds_read_b64_tr_b16 a[128:129], v10 offset:6272
    ds_read_b64_tr_b16 a[130:131], v10 offset:7040
    v_mfma_f32_32x32x16_bf16 v[192:207], a[140:143], a[12:15], v[192:207]
    s_waitcnt lgkmcnt(8)
    v_mfma_f32_32x32x16_bf16 v[208:223], a[144:147], a[8:11], v[208:223]
    ds_read_b64_tr_b16 a[132:133], v11 offset:8192
    ds_read_b64_tr_b16 a[134:135], v11 offset:9216
    buffer_load_dwordx4 a[100:103], v2, s[8:11], s31 offen offset:0 sc1
    v_mfma_f32_32x32x16_bf16 v[224:239], a[144:147], a[12:15], v[224:239]
    s_waitcnt lgkmcnt(8)
    v_mfma_f32_32x32x16_bf16 v[240:255], a[148:151], a[8:11], v[240:255]
    ds_read_b64_tr_b16 a[136:137], v12 offset:8192
    ds_read_b64_tr_b16 a[138:139], v12 offset:9216
    s_waitcnt lgkmcnt(8)
    v_mfma_f32_32x32x16_bf16 v[48:63], a[152:155], a[16:19], v[48:63]
    buffer_load_dwordx4 a[104:107], v2, s[8:11], s30 offen offset:1024 sc1
    v_mfma_f32_32x32x16_bf16 v[64:79], a[152:155], a[20:23], v[64:79]
    ds_read_b64_tr_b16 a[140:141], v13 offset:8192
    ds_read_b64_tr_b16 a[142:143], v13 offset:9216
    s_waitcnt lgkmcnt(8)
    v_mfma_f32_32x32x16_bf16 v[80:95], a[156:159], a[16:19], v[80:95]
    v_mfma_f32_32x32x16_bf16 v[96:111], a[156:159], a[20:23], v[96:111]
    ds_read_b64_tr_b16 a[144:145], v14 offset:8192
    ds_read_b64_tr_b16 a[146:147], v14 offset:9216
    buffer_load_dwordx4 a[108:111], v2, s[8:11], s31 offen offset:1024 sc1
    s_waitcnt lgkmcnt(8)
    v_mfma_f32_32x32x16_bf16 v[112:127], a[16:19], a[128:131], v[112:127]
    ds_read_b64_tr_b16 a[148:149], v10 offset:9216
    ds_read_b64_tr_b16 a[150:151], v10 offset:9984
    v_mfma_f32_32x32x16_bf16 v[128:143], a[20:23], a[128:131], v[128:143]
    s_waitcnt lgkmcnt(8)
    v_mfma_f32_32x32x16_bf16 v[144:159], a[132:135], a[16:19], v[144:159]
    ds_read_b64_tr_b16 a[152:153], v10 offset:9280
    ds_read_b64_tr_b16 a[154:155], v10 offset:10048
    buffer_load_dwordx4 a[112:115], v2, s[8:11], s30 offen offset:2048 sc1
    v_mfma_f32_32x32x16_bf16 v[160:175], a[132:135], a[20:23], v[160:175]
    s_waitcnt lgkmcnt(8)
    v_mfma_f32_32x32x16_bf16 v[176:191], a[136:139], a[16:19], v[176:191]
    ds_read_b64_tr_b16 a[156:157], v10 offset:9344
    ds_read_b64_tr_b16 a[158:159], v10 offset:10112
    v_mfma_f32_32x32x16_bf16 v[192:207], a[136:139], a[20:23], v[192:207]
    buffer_load_dwordx4 a[116:119], v2, s[8:11], s31 offen offset:2048 sc1
    s_waitcnt lgkmcnt(8)
    v_mfma_f32_32x32x16_bf16 v[208:223], a[140:143], a[16:19], v[208:223]
    ds_read_b64_tr_b16 a[128:129], v11 offset:12288
    ds_read_b64_tr_b16 a[130:131], v11 offset:13312
    v_mfma_f32_32x32x16_bf16 v[224:239], a[140:143], a[20:23], v[224:239]
    s_waitcnt lgkmcnt(8)
    v_mfma_f32_32x32x16_bf16 v[240:255], a[144:147], a[16:19], v[240:255]
    ds_read_b64_tr_b16 a[132:133], v12 offset:12288
    ds_read_b64_tr_b16 a[134:135], v12 offset:13312
    buffer_load_dwordx4 a[120:123], v2, s[8:11], s30 offen offset:3072 sc1
    s_waitcnt lgkmcnt(8)
    v_mfma_f32_32x32x16_bf16 v[48:63], a[148:151], a[24:27], v[48:63]
    v_mfma_f32_32x32x16_bf16 v[64:79], a[148:151], a[28:31], v[64:79]
    ds_read_b64_tr_b16 a[136:137], v13 offset:12288
    ds_read_b64_tr_b16 a[138:139], v13 offset:13312
    s_waitcnt lgkmcnt(8)
    v_mfma_f32_32x32x16_bf16 v[80:95], a[152:155], a[24:27], v[80:95]
    buffer_load_dwordx4 a[124:127], v2, s[8:11], s31 offen offset:3072 sc1
    s_add_u32 s30, s30, 4096
    s_add_u32 s31, s31, 4096
    v_mfma_f32_32x32x16_bf16 v[96:111], a[152:155], a[28:31], v[96:111]
    ds_read_b64_tr_b16 a[140:141], v14 offset:12288
    ds_read_b64_tr_b16 a[142:143], v14 offset:13312
    s_waitcnt lgkmcnt(8)
    v_mfma_f32_32x32x16_bf16 v[112:127], a[24:27], a[156:159], v[112:127]
    v_mfma_f32_32x32x16_bf16 v[128:143], a[28:31], a[156:159], v[128:143]
    s_waitcnt lgkmcnt(6)
    v_mfma_f32_32x32x16_bf16 v[144:159], a[128:131], a[24:27], v[144:159]
    s_waitcnt vmcnt(23) lgkmcnt(0)
    s_barrier
    ds_read_b64_tr_b16 a[144:145], v10 offset:12288
    ds_read_b64_tr_b16 a[146:147], v10 offset:13056
    ds_read_b64_tr_b16 a[148:149], v10 offset:12352
    ds_read_b64_tr_b16 a[150:151], v10 offset:13120
    v_mfma_f32_32x32x16_bf16 v[160:175], a[128:131], a[28:31], v[160:175]
    v_mfma_f32_32x32x16_bf16 v[176:191], a[132:135], a[24:27], v[176:191]
    ds_read_b64_tr_b16 a[152:153], v10 offset:12416
    ds_read_b64_tr_b16 a[154:155], v10 offset:13184
    v_mfma_f32_32x32x16_bf16 v[192:207], a[132:135], a[28:31], v[192:207]
    v_mfma_f32_32x32x16_bf16 v[208:223], a[136:139], a[24:27], v[208:223]
    ds_read_b64_tr_b16 a[156:157], v11 offset:16384
    ds_read_b64_tr_b16 a[158:159], v11 offset:17408
    v_mfma_f32_32x32x16_bf16 v[224:239], a[136:139], a[28:31], v[224:239]
    v_mfma_f32_32x32x16_bf16 v[240:255], a[140:143], a[24:27], v[240:255]
    ds_read_b64_tr_b16 a[128:129], v12 offset:16384
    ds_read_b64_tr_b16 a[130:131], v12 offset:17408
    s_add_u32 m0, s34, 0
    s_nop 0
    buffer_load_dwordx4 v3, s[12:15], s32 offen offset:0 lds
    s_waitcnt lgkmcnt(8)
    v_mfma_f32_32x32x16_bf16 v[48:63], a[144:147], a[32:35], v[48:63]
    v_mfma_f32_32x32x16_bf16 v[64:79], a[144:147], a[36:39], v[64:79]
    ds_read_b64_tr_b16 a[132:133], v13 offset:16384
    ds_read_b64_tr_b16 a[134:135], v13 offset:17408
    s_waitcnt lgkmcnt(8)
    v_mfma_f32_32x32x16_bf16 v[80:95], a[148:151], a[32:35], v[80:95]
    buffer_load_dwordx4 v4, s[12:15], s32 offen offset:1024 lds
    v_mfma_f32_32x32x16_bf16 v[96:111], a[148:151], a[36:39], v[96:111]
    ds_read_b64_tr_b16 a[136:137], v14 offset:16384
    ds_read_b64_tr_b16 a[138:139], v14 offset:17408
    s_waitcnt lgkmcnt(8)
    v_mfma_f32_32x32x16_bf16 v[112:127], a[32:35], a[152:155], v[112:127]
    ds_read_b64_tr_b16 a[140:141], v10 offset:15360
    ds_read_b64_tr_b16 a[142:143], v10 offset:16128
    v_mfma_f32_32x32x16_bf16 v[128:143], a[36:39], a[152:155], v[128:143]
    buffer_load_dwordx4 v5, s[12:15], s32 offen offset:2048 lds
    s_waitcnt lgkmcnt(8)
    v_mfma_f32_32x32x16_bf16 v[144:159], a[156:159], a[32:35], v[144:159]
    ds_read_b64_tr_b16 a[144:145], v10 offset:15424
    ds_read_b64_tr_b16 a[146:147], v10 offset:16192
    v_mfma_f32_32x32x16_bf16 v[160:175], a[156:159], a[36:39], v[160:175]
    s_waitcnt lgkmcnt(8)
    v_mfma_f32_32x32x16_bf16 v[176:191], a[128:131], a[32:35], v[176:191]
    ds_read_b64_tr_b16 a[148:149], v10 offset:15488
    ds_read_b64_tr_b16 a[150:151], v10 offset:16256
    s_add_u32 m0, s35, 0
    s_nop 0
    buffer_load_dwordx4 v6, s[16:19], s33 offen offset:0 lds
    v_mfma_f32_32x32x16_bf16 v[192:207], a[128:131], a[36:39], v[192:207]
    s_waitcnt lgkmcnt(8)
    v_mfma_f32_32x32x16_bf16 v[208:223], a[132:135], a[32:35], v[208:223]
    ds_read_b64_tr_b16 a[152:153], v11 offset:20480
    ds_read_b64_tr_b16 a[154:155], v11 offset:21504
    v_mfma_f32_32x32x16_bf16 v[224:239], a[132:135], a[36:39], v[224:239]
    buffer_load_dwordx4 v7, s[16:19], s33 offen offset:1024 lds
    s_waitcnt lgkmcnt(8)
    v_mfma_f32_32x32x16_bf16 v[240:255], a[136:139], a[32:35], v[240:255]
    ds_read_b64_tr_b16 a[156:157], v12 offset:20480
    ds_read_b64_tr_b16 a[158:159], v12 offset:21504
    s_waitcnt lgkmcnt(8)
    v_mfma_f32_32x32x16_bf16 v[48:63], a[140:143], a[40:43], v[48:63]
    v_mfma_f32_32x32x16_bf16 v[64:79], a[140:143], a[44:47], v[64:79]
    ds_read_b64_tr_b16 a[128:129], v13 offset:20480
    ds_read_b64_tr_b16 a[130:131], v13 offset:21504
    buffer_load_dwordx4 v8, s[16:19], s33 offen offset:2048 lds
    s_waitcnt lgkmcnt(8)
    v_mfma_f32_32x32x16_bf16 v[80:95], a[144:147], a[40:43], v[80:95]
    v_mfma_f32_32x32x16_bf16 v[96:111], a[144:147], a[44:47], v[96:111]
    ds_read_b64_tr_b16 a[132:133], v14 offset:20480
    ds_read_b64_tr_b16 a[134:135], v14 offset:21504
    s_waitcnt lgkmcnt(8)
    v_mfma_f32_32x32x16_bf16 v[112:127], a[40:43], a[148:151], v[112:127]
    ds_read_b64_tr_b16 a[136:137], v10 offset:18432
    ds_read_b64_tr_b16 a[138:139], v10 offset:19200
    buffer_load_dwordx4 v9, s[16:19], s33 offen offset:3072 lds
    s_add_u32 s32, s32, 393216
    s_add_u32 s33, s33, 458752
    v_mfma_f32_32x32x16_bf16 v[128:143], a[44:47], a[148:151], v[128:143]
    s_waitcnt lgkmcnt(8)
    v_mfma_f32_32x32x16_bf16 v[144:159], a[152:155], a[40:43], v[144:159]
    ds_read_b64_tr_b16 a[140:141], v10 offset:18496
    ds_read_b64_tr_b16 a[142:143], v10 offset:19264
    v_mfma_f32_32x32x16_bf16 v[160:175], a[152:155], a[44:47], v[160:175]
    buffer_load_dwordx4 a[0:3], v2, s[8:11], s30 offen offset:0 sc1
    s_waitcnt lgkmcnt(8)
    v_mfma_f32_32x32x16_bf16 v[176:191], a[156:159], a[40:43], v[176:191]
    ds_read_b64_tr_b16 a[144:145], v10 offset:18560
    ds_read_b64_tr_b16 a[146:147], v10 offset:19328
    v_mfma_f32_32x32x16_bf16 v[192:207], a[156:159], a[44:47], v[192:207]
    s_waitcnt lgkmcnt(8)
    v_mfma_f32_32x32x16_bf16 v[208:223], a[128:131], a[40:43], v[208:223]
    ds_read_b64_tr_b16 a[148:149], v11 offset:24576
    ds_read_b64_tr_b16 a[150:151], v11 offset:25600
    buffer_load_dwordx4 a[4:7], v2, s[8:11], s31 offen offset:0 sc1
    v_mfma_f32_32x32x16_bf16 v[224:239], a[128:131], a[44:47], v[224:239]
    s_waitcnt lgkmcnt(8)
    v_mfma_f32_32x32x16_bf16 v[240:255], a[132:135], a[40:43], v[240:255]
    ds_read_b64_tr_b16 a[152:153], v12 offset:24576
    ds_read_b64_tr_b16 a[154:155], v12 offset:25600
    s_waitcnt lgkmcnt(8)
    v_mfma_f32_32x32x16_bf16 v[48:63], a[136:139], a[48:51], v[48:63]
    buffer_load_dwordx4 a[8:11], v2, s[8:11], s30 offen offset:1024 sc1
    v_mfma_f32_32x32x16_bf16 v[64:79], a[136:139], a[52:55], v[64:79]
    ds_read_b64_tr_b16 a[156:157], v13 offset:24576
    ds_read_b64_tr_b16 a[158:159], v13 offset:25600
    s_waitcnt lgkmcnt(8)
    v_mfma_f32_32x32x16_bf16 v[80:95], a[140:143], a[48:51], v[80:95]
    v_mfma_f32_32x32x16_bf16 v[96:111], a[140:143], a[52:55], v[96:111]
    ds_read_b64_tr_b16 a[128:129], v14 offset:24576
    ds_read_b64_tr_b16 a[130:131], v14 offset:25600
    buffer_load_dwordx4 a[12:15], v2, s[8:11], s31 offen offset:1024 sc1
    s_waitcnt lgkmcnt(8)
    v_mfma_f32_32x32x16_bf16 v[112:127], a[48:51], a[144:147], v[112:127]
    ds_read_b64_tr_b16 a[132:133], v10 offset:21504
    ds_read_b64_tr_b16 a[134:135], v10 offset:22272
    v_mfma_f32_32x32x16_bf16 v[128:143], a[52:55], a[144:147], v[128:143]
    s_waitcnt lgkmcnt(8)
    v_mfma_f32_32x32x16_bf16 v[144:159], a[148:151], a[48:51], v[144:159]
    ds_read_b64_tr_b16 a[136:137], v10 offset:21568
    ds_read_b64_tr_b16 a[138:139], v10 offset:22336
    buffer_load_dwordx4 a[16:19], v2, s[8:11], s30 offen offset:2048 sc1
    v_mfma_f32_32x32x16_bf16 v[160:175], a[148:151], a[52:55], v[160:175]
    s_waitcnt lgkmcnt(8)
    v_mfma_f32_32x32x16_bf16 v[176:191], a[152:155], a[48:51], v[176:191]
    ds_read_b64_tr_b16 a[140:141], v10 offset:21632
    ds_read_b64_tr_b16 a[142:143], v10 offset:22400
    v_mfma_f32_32x32x16_bf16 v[192:207], a[152:155], a[52:55], v[192:207]
    buffer_load_dwordx4 a[20:23], v2, s[8:11], s31 offen offset:2048 sc1
    s_waitcnt lgkmcnt(8)
    v_mfma_f32_32x32x16_bf16 v[208:223], a[156:159], a[48:51], v[208:223]
    ds_read_b64_tr_b16 a[144:145], v11 offset:28672
    ds_read_b64_tr_b16 a[146:147], v11 offset:29696
    v_mfma_f32_32x32x16_bf16 v[224:239], a[156:159], a[52:55], v[224:239]
    s_waitcnt lgkmcnt(8)
    v_mfma_f32_32x32x16_bf16 v[240:255], a[128:131], a[48:51], v[240:255]
    ds_read_b64_tr_b16 a[148:149], v12 offset:28672
    ds_read_b64_tr_b16 a[150:151], v12 offset:29696
    buffer_load_dwordx4 a[24:27], v2, s[8:11], s30 offen offset:3072 sc1
    s_waitcnt lgkmcnt(8)
    v_mfma_f32_32x32x16_bf16 v[48:63], a[132:135], a[56:59], v[48:63]
    v_mfma_f32_32x32x16_bf16 v[64:79], a[132:135], a[60:63], v[64:79]
    ds_read_b64_tr_b16 a[152:153], v13 offset:28672
    ds_read_b64_tr_b16 a[154:155], v13 offset:29696
    s_waitcnt lgkmcnt(8)
    v_mfma_f32_32x32x16_bf16 v[80:95], a[136:139], a[56:59], v[80:95]
    buffer_load_dwordx4 a[28:31], v2, s[8:11], s31 offen offset:3072 sc1
    s_add_u32 s30, s30, 4096
    s_add_u32 s31, s31, 4096
    v_mfma_f32_32x32x16_bf16 v[96:111], a[136:139], a[60:63], v[96:111]
    ds_read_b64_tr_b16 a[156:157], v14 offset:28672
    ds_read_b64_tr_b16 a[158:159], v14 offset:29696
    s_waitcnt lgkmcnt(8)
    v_mfma_f32_32x32x16_bf16 v[112:127], a[56:59], a[140:143], v[112:127]
    v_mfma_f32_32x32x16_bf16 v[128:143], a[60:63], a[140:143], v[128:143]
    s_waitcnt lgkmcnt(6)
    v_mfma_f32_32x32x16_bf16 v[144:159], a[144:147], a[56:59], v[144:159]
    s_waitcnt vmcnt(30) lgkmcnt(0)
    s_barrier
    ds_read_b64_tr_b16 a[128:129], v10 offset:24576
    ds_read_b64_tr_b16 a[130:131], v10 offset:25344
    ds_read_b64_tr_b16 a[132:133], v10 offset:24640
    ds_read_b64_tr_b16 a[134:135], v10 offset:25408
    v_mfma_f32_32x32x16_bf16 v[160:175], a[144:147], a[60:63], v[160:175]
    v_mfma_f32_32x32x16_bf16 v[176:191], a[148:151], a[56:59], v[176:191]
    ds_read_b64_tr_b16 a[136:137], v10 offset:24704
    ds_read_b64_tr_b16 a[138:139], v10 offset:25472
    v_mfma_f32_32x32x16_bf16 v[192:207], a[148:151], a[60:63], v[192:207]
    v_mfma_f32_32x32x16_bf16 v[208:223], a[152:155], a[56:59], v[208:223]
    ds_read_b64_tr_b16 a[140:141], v11 offset:32768
    ds_read_b64_tr_b16 a[142:143], v11 offset:33792
    v_mfma_f32_32x32x16_bf16 v[224:239], a[152:155], a[60:63], v[224:239]
    v_mfma_f32_32x32x16_bf16 v[240:255], a[156:159], a[56:59], v[240:255]
    ds_read_b64_tr_b16 a[144:145], v12 offset:32768
    ds_read_b64_tr_b16 a[146:147], v12 offset:33792
    s_add_u32 m0, s34, 12288
    s_nop 0
    buffer_load_dwordx4 v3, s[12:15], s32 offen offset:0 lds
    s_waitcnt lgkmcnt(8)
    v_mfma_f32_32x32x16_bf16 v[48:63], a[128:131], a[64:67], v[48:63]
    v_mfma_f32_32x32x16_bf16 v[64:79], a[128:131], a[68:71], v[64:79]
    ds_read_b64_tr_b16 a[148:149], v13 offset:32768
    ds_read_b64_tr_b16 a[150:151], v13 offset:33792
    s_waitcnt lgkmcnt(8)
    v_mfma_f32_32x32x16_bf16 v[80:95], a[132:135], a[64:67], v[80:95]
    buffer_load_dwordx4 v4, s[12:15], s32 offen offset:1024 lds
    v_mfma_f32_32x32x16_bf16 v[96:111], a[132:135], a[68:71], v[96:111]
    ds_read_b64_tr_b16 a[152:153], v14 offset:32768
    ds_read_b64_tr_b16 a[154:155], v14 offset:33792
    s_waitcnt lgkmcnt(8)
    v_mfma_f32_32x32x16_bf16 v[112:127], a[64:67], a[136:139], v[112:127]
    ds_read_b64_tr_b16 a[156:157], v10 offset:27648
    ds_read_b64_tr_b16 a[158:159], v10 offset:28416
    v_mfma_f32_32x32x16_bf16 v[128:143], a[68:71], a[136:139], v[128:143]
    buffer_load_dwordx4 v5, s[12:15], s32 offen offset:2048 lds
    s_waitcnt lgkmcnt(8)
    v_mfma_f32_32x32x16_bf16 v[144:159], a[140:143], a[64:67], v[144:159]
    ds_read_b64_tr_b16 a[128:129], v10 offset:27712
    ds_read_b64_tr_b16 a[130:131], v10 offset:28480
    v_mfma_f32_32x32x16_bf16 v[160:175], a[140:143], a[68:71], v[160:175]
    s_waitcnt lgkmcnt(8)
    v_mfma_f32_32x32x16_bf16 v[176:191], a[144:147], a[64:67], v[176:191]
    ds_read_b64_tr_b16 a[132:133], v10 offset:27776
    ds_read_b64_tr_b16 a[134:135], v10 offset:28544
    s_add_u32 m0, s35, 16384
    s_nop 0
    buffer_load_dwordx4 v6, s[16:19], s33 offen offset:0 lds
    v_mfma_f32_32x32x16_bf16 v[192:207], a[144:147], a[68:71], v[192:207]
    s_waitcnt lgkmcnt(8)
    v_mfma_f32_32x32x16_bf16 v[208:223], a[148:151], a[64:67], v[208:223]
    ds_read_b64_tr_b16 a[136:137], v11 offset:36864
    ds_read_b64_tr_b16 a[138:139], v11 offset:37888
    v_mfma_f32_32x32x16_bf16 v[224:239], a[148:151], a[68:71], v[224:239]
    buffer_load_dwordx4 v7, s[16:19], s33 offen offset:1024 lds
    s_waitcnt lgkmcnt(8)
    v_mfma_f32_32x32x16_bf16 v[240:255], a[152:155], a[64:67], v[240:255]
    ds_read_b64_tr_b16 a[140:141], v12 offset:36864
    ds_read_b64_tr_b16 a[142:143], v12 offset:37888
    s_waitcnt lgkmcnt(8)
    v_mfma_f32_32x32x16_bf16 v[48:63], a[156:159], a[72:75], v[48:63]
    v_mfma_f32_32x32x16_bf16 v[64:79], a[156:159], a[76:79], v[64:79]
    ds_read_b64_tr_b16 a[144:145], v13 offset:36864
    ds_read_b64_tr_b16 a[146:147], v13 offset:37888
    buffer_load_dwordx4 v8, s[16:19], s33 offen offset:2048 lds
    s_waitcnt lgkmcnt(8)
    v_mfma_f32_32x32x16_bf16 v[80:95], a[128:131], a[72:75], v[80:95]
    v_mfma_f32_32x32x16_bf16 v[96:111], a[128:131], a[76:79], v[96:111]
    ds_read_b64_tr_b16 a[148:149], v14 offset:36864
    ds_read_b64_tr_b16 a[150:151], v14 offset:37888
    s_waitcnt lgkmcnt(8)
    v_mfma_f32_32x32x16_bf16 v[112:127], a[72:75], a[132:135], v[112:127]
    ds_read_b64_tr_b16 a[152:153], v10 offset:30720
    ds_read_b64_tr_b16 a[154:155], v10 offset:31488
    buffer_load_dwordx4 v9, s[16:19], s33 offen offset:3072 lds
    s_add_u32 s32, s32, 393216
    s_add_u32 s33, s33, 458752
    v_mfma_f32_32x32x16_bf16 v[128:143], a[76:79], a[132:135], v[128:143]
    s_waitcnt lgkmcnt(8)
    v_mfma_f32_32x32x16_bf16 v[144:159], a[136:139], a[72:75], v[144:159]
    ds_read_b64_tr_b16 a[156:157], v10 offset:30784
    ds_read_b64_tr_b16 a[158:159], v10 offset:31552
    v_mfma_f32_32x32x16_bf16 v[160:175], a[136:139], a[76:79], v[160:175]
    buffer_load_dwordx4 a[32:35], v2, s[8:11], s30 offen offset:0 sc1
    s_waitcnt lgkmcnt(8)
    v_mfma_f32_32x32x16_bf16 v[176:191], a[140:143], a[72:75], v[176:191]
    ds_read_b64_tr_b16 a[128:129], v10 offset:30848
    ds_read_b64_tr_b16 a[130:131], v10 offset:31616
    v_mfma_f32_32x32x16_bf16 v[192:207], a[140:143], a[76:79], v[192:207]
    s_waitcnt lgkmcnt(8)
    v_mfma_f32_32x32x16_bf16 v[208:223], a[144:147], a[72:75], v[208:223]
    ds_read_b64_tr_b16 a[132:133], v11 offset:40960
    ds_read_b64_tr_b16 a[134:135], v11 offset:41984
    buffer_load_dwordx4 a[36:39], v2, s[8:11], s31 offen offset:0 sc1
    v_mfma_f32_32x32x16_bf16 v[224:239], a[144:147], a[76:79], v[224:239]
    s_waitcnt lgkmcnt(8)
    v_mfma_f32_32x32x16_bf16 v[240:255], a[148:151], a[72:75], v[240:255]
    ds_read_b64_tr_b16 a[136:137], v12 offset:40960
    ds_read_b64_tr_b16 a[138:139], v12 offset:41984
    s_waitcnt lgkmcnt(8)
    v_mfma_f32_32x32x16_bf16 v[48:63], a[152:155], a[80:83], v[48:63]
    buffer_load_dwordx4 a[40:43], v2, s[8:11], s30 offen offset:1024 sc1
    v_mfma_f32_32x32x16_bf16 v[64:79], a[152:155], a[84:87], v[64:79]
    ds_read_b64_tr_b16 a[140:141], v13 offset:40960
    ds_read_b64_tr_b16 a[142:143], v13 offset:41984
    s_waitcnt lgkmcnt(8)
    v_mfma_f32_32x32x16_bf16 v[80:95], a[156:159], a[80:83], v[80:95]
    v_mfma_f32_32x32x16_bf16 v[96:111], a[156:159], a[84:87], v[96:111]
    ds_read_b64_tr_b16 a[144:145], v14 offset:40960
    ds_read_b64_tr_b16 a[146:147], v14 offset:41984
    buffer_load_dwordx4 a[44:47], v2, s[8:11], s31 offen offset:1024 sc1
    s_waitcnt lgkmcnt(8)
    v_mfma_f32_32x32x16_bf16 v[112:127], a[80:83], a[128:131], v[112:127]
    ds_read_b64_tr_b16 a[148:149], v10 offset:33792
    ds_read_b64_tr_b16 a[150:151], v10 offset:34560
    v_mfma_f32_32x32x16_bf16 v[128:143], a[84:87], a[128:131], v[128:143]
    s_waitcnt lgkmcnt(8)
    v_mfma_f32_32x32x16_bf16 v[144:159], a[132:135], a[80:83], v[144:159]
    ds_read_b64_tr_b16 a[152:153], v10 offset:33856
    ds_read_b64_tr_b16 a[154:155], v10 offset:34624
    buffer_load_dwordx4 a[48:51], v2, s[8:11], s30 offen offset:2048 sc1
    v_mfma_f32_32x32x16_bf16 v[160:175], a[132:135], a[84:87], v[160:175]
    s_waitcnt lgkmcnt(8)
    v_mfma_f32_32x32x16_bf16 v[176:191], a[136:139], a[80:83], v[176:191]
    ds_read_b64_tr_b16 a[156:157], v10 offset:33920
    ds_read_b64_tr_b16 a[158:159], v10 offset:34688
    v_mfma_f32_32x32x16_bf16 v[192:207], a[136:139], a[84:87], v[192:207]
    buffer_load_dwordx4 a[52:55], v2, s[8:11], s31 offen offset:2048 sc1
    s_waitcnt lgkmcnt(8)
    v_mfma_f32_32x32x16_bf16 v[208:223], a[140:143], a[80:83], v[208:223]
    ds_read_b64_tr_b16 a[128:129], v11 offset:45056
    ds_read_b64_tr_b16 a[130:131], v11 offset:46080
    v_mfma_f32_32x32x16_bf16 v[224:239], a[140:143], a[84:87], v[224:239]
    s_waitcnt lgkmcnt(8)
    v_mfma_f32_32x32x16_bf16 v[240:255], a[144:147], a[80:83], v[240:255]
    ds_read_b64_tr_b16 a[132:133], v12 offset:45056
    ds_read_b64_tr_b16 a[134:135], v12 offset:46080
    buffer_load_dwordx4 a[56:59], v2, s[8:11], s30 offen offset:3072 sc1
    s_waitcnt lgkmcnt(8)
    v_mfma_f32_32x32x16_bf16 v[48:63], a[148:151], a[88:91], v[48:63]
    v_mfma_f32_32x32x16_bf16 v[64:79], a[148:151], a[92:95], v[64:79]
    ds_read_b64_tr_b16 a[136:137], v13 offset:45056
    ds_read_b64_tr_b16 a[138:139], v13 offset:46080
    s_waitcnt lgkmcnt(8)
    v_mfma_f32_32x32x16_bf16 v[80:95], a[152:155], a[88:91], v[80:95]
    buffer_load_dwordx4 a[60:63], v2, s[8:11], s31 offen offset:3072 sc1
    s_add_u32 s30, s30, 4096
    s_add_u32 s31, s31, 4096
    v_mfma_f32_32x32x16_bf16 v[96:111], a[152:155], a[92:95], v[96:111]
    ds_read_b64_tr_b16 a[140:141], v14 offset:45056
    ds_read_b64_tr_b16 a[142:143], v14 offset:46080
    s_waitcnt lgkmcnt(8)
    v_mfma_f32_32x32x16_bf16 v[112:127], a[88:91], a[156:159], v[112:127]
    v_mfma_f32_32x32x16_bf16 v[128:143], a[92:95], a[156:159], v[128:143]
    s_waitcnt lgkmcnt(6)
    v_mfma_f32_32x32x16_bf16 v[144:159], a[128:131], a[88:91], v[144:159]
    s_waitcnt vmcnt(30) lgkmcnt(0)
    s_barrier
    ds_read_b64_tr_b16 a[144:145], v10 offset:36864
    ds_read_b64_tr_b16 a[146:147], v10 offset:37632
    ds_read_b64_tr_b16 a[148:149], v10 offset:36928
    ds_read_b64_tr_b16 a[150:151], v10 offset:37696
    v_mfma_f32_32x32x16_bf16 v[160:175], a[128:131], a[92:95], v[160:175]
    v_mfma_f32_32x32x16_bf16 v[176:191], a[132:135], a[88:91], v[176:191]
    ds_read_b64_tr_b16 a[152:153], v10 offset:36992
    ds_read_b64_tr_b16 a[154:155], v10 offset:37760
    v_mfma_f32_32x32x16_bf16 v[192:207], a[132:135], a[92:95], v[192:207]
    v_mfma_f32_32x32x16_bf16 v[208:223], a[136:139], a[88:91], v[208:223]
    ds_read_b64_tr_b16 a[156:157], v11 offset:49152
    ds_read_b64_tr_b16 a[158:159], v11 offset:50176
    v_mfma_f32_32x32x16_bf16 v[224:239], a[136:139], a[92:95], v[224:239]
    v_mfma_f32_32x32x16_bf16 v[240:255], a[140:143], a[88:91], v[240:255]
    ds_read_b64_tr_b16 a[128:129], v12 offset:49152
    ds_read_b64_tr_b16 a[130:131], v12 offset:50176
    s_add_u32 m0, s34, 24576
    s_nop 0
    buffer_load_dwordx4 v3, s[12:15], s32 offen offset:0 lds
    s_waitcnt lgkmcnt(8)
    v_mfma_f32_32x32x16_bf16 v[48:63], a[144:147], a[96:99], v[48:63]
    v_mfma_f32_32x32x16_bf16 v[64:79], a[144:147], a[100:103], v[64:79]
    ds_read_b64_tr_b16 a[132:133], v13 offset:49152
    ds_read_b64_tr_b16 a[134:135], v13 offset:50176
    s_waitcnt lgkmcnt(8)
    v_mfma_f32_32x32x16_bf16 v[80:95], a[148:151], a[96:99], v[80:95]
    buffer_load_dwordx4 v4, s[12:15], s32 offen offset:1024 lds
    v_mfma_f32_32x32x16_bf16 v[96:111], a[148:151], a[100:103], v[96:111]
    ds_read_b64_tr_b16 a[136:137], v14 offset:49152
    ds_read_b64_tr_b16 a[138:139], v14 offset:50176
    s_waitcnt lgkmcnt(8)
    v_mfma_f32_32x32x16_bf16 v[112:127], a[96:99], a[152:155], v[112:127]
    ds_read_b64_tr_b16 a[140:141], v10 offset:39936
    ds_read_b64_tr_b16 a[142:143], v10 offset:40704
    v_mfma_f32_32x32x16_bf16 v[128:143], a[100:103], a[152:155], v[128:143]
    buffer_load_dwordx4 v5, s[12:15], s32 offen offset:2048 lds
    s_waitcnt lgkmcnt(8)
    v_mfma_f32_32x32x16_bf16 v[144:159], a[156:159], a[96:99], v[144:159]
    ds_read_b64_tr_b16 a[144:145], v10 offset:40000
    ds_read_b64_tr_b16 a[146:147], v10 offset:40768
    v_mfma_f32_32x32x16_bf16 v[160:175], a[156:159], a[100:103], v[160:175]
    s_waitcnt lgkmcnt(8)
    v_mfma_f32_32x32x16_bf16 v[176:191], a[128:131], a[96:99], v[176:191]
    ds_read_b64_tr_b16 a[148:149], v10 offset:40064
    ds_read_b64_tr_b16 a[150:151], v10 offset:40832
    s_add_u32 m0, s35, 32768
    s_nop 0
    buffer_load_dwordx4 v6, s[16:19], s33 offen offset:0 lds
    v_mfma_f32_32x32x16_bf16 v[192:207], a[128:131], a[100:103], v[192:207]
    s_waitcnt lgkmcnt(8)
    v_mfma_f32_32x32x16_bf16 v[208:223], a[132:135], a[96:99], v[208:223]
    ds_read_b64_tr_b16 a[152:153], v11 offset:53248
    ds_read_b64_tr_b16 a[154:155], v11 offset:54272
    v_mfma_f32_32x32x16_bf16 v[224:239], a[132:135], a[100:103], v[224:239]
    buffer_load_dwordx4 v7, s[16:19], s33 offen offset:1024 lds
    s_waitcnt lgkmcnt(8)
    v_mfma_f32_32x32x16_bf16 v[240:255], a[136:139], a[96:99], v[240:255]
    ds_read_b64_tr_b16 a[156:157], v12 offset:53248
    ds_read_b64_tr_b16 a[158:159], v12 offset:54272
    s_waitcnt lgkmcnt(8)
    v_mfma_f32_32x32x16_bf16 v[48:63], a[140:143], a[104:107], v[48:63]
    v_mfma_f32_32x32x16_bf16 v[64:79], a[140:143], a[108:111], v[64:79]
    ds_read_b64_tr_b16 a[128:129], v13 offset:53248
    ds_read_b64_tr_b16 a[130:131], v13 offset:54272
    buffer_load_dwordx4 v8, s[16:19], s33 offen offset:2048 lds
    s_waitcnt lgkmcnt(8)
    v_mfma_f32_32x32x16_bf16 v[80:95], a[144:147], a[104:107], v[80:95]
    v_mfma_f32_32x32x16_bf16 v[96:111], a[144:147], a[108:111], v[96:111]
    ds_read_b64_tr_b16 a[132:133], v14 offset:53248
    ds_read_b64_tr_b16 a[134:135], v14 offset:54272
    s_waitcnt lgkmcnt(8)
    v_mfma_f32_32x32x16_bf16 v[112:127], a[104:107], a[148:151], v[112:127]
    ds_read_b64_tr_b16 a[136:137], v10 offset:43008
    ds_read_b64_tr_b16 a[138:139], v10 offset:43776
    buffer_load_dwordx4 v9, s[16:19], s33 offen offset:3072 lds
    s_add_u32 s32, s32, 393216
    s_add_u32 s33, s33, 458752
    v_mfma_f32_32x32x16_bf16 v[128:143], a[108:111], a[148:151], v[128:143]
    s_waitcnt lgkmcnt(8)
    v_mfma_f32_32x32x16_bf16 v[144:159], a[152:155], a[104:107], v[144:159]
    ds_read_b64_tr_b16 a[140:141], v10 offset:43072
    ds_read_b64_tr_b16 a[142:143], v10 offset:43840
    v_mfma_f32_32x32x16_bf16 v[160:175], a[152:155], a[108:111], v[160:175]
    buffer_load_dwordx4 a[64:67], v2, s[8:11], s30 offen offset:0 sc1
    s_waitcnt lgkmcnt(8)
    v_mfma_f32_32x32x16_bf16 v[176:191], a[156:159], a[104:107], v[176:191]
    ds_read_b64_tr_b16 a[144:145], v10 offset:43136
    ds_read_b64_tr_b16 a[146:147], v10 offset:43904
    v_mfma_f32_32x32x16_bf16 v[192:207], a[156:159], a[108:111], v[192:207]
    s_waitcnt lgkmcnt(8)
    v_mfma_f32_32x32x16_bf16 v[208:223], a[128:131], a[104:107], v[208:223]
    ds_read_b64_tr_b16 a[148:149], v11 offset:57344
    ds_read_b64_tr_b16 a[150:151], v11 offset:58368
    buffer_load_dwordx4 a[68:71], v2, s[8:11], s31 offen offset:0 sc1
    v_mfma_f32_32x32x16_bf16 v[224:239], a[128:131], a[108:111], v[224:239]
    s_waitcnt lgkmcnt(8)
    v_mfma_f32_32x32x16_bf16 v[240:255], a[132:135], a[104:107], v[240:255]
    ds_read_b64_tr_b16 a[152:153], v12 offset:57344
    ds_read_b64_tr_b16 a[154:155], v12 offset:58368
    s_waitcnt lgkmcnt(8)
    v_mfma_f32_32x32x16_bf16 v[48:63], a[136:139], a[112:115], v[48:63]
    buffer_load_dwordx4 a[72:75], v2, s[8:11], s30 offen offset:1024 sc1
    v_mfma_f32_32x32x16_bf16 v[64:79], a[136:139], a[116:119], v[64:79]
    ds_read_b64_tr_b16 a[156:157], v13 offset:57344
    ds_read_b64_tr_b16 a[158:159], v13 offset:58368
    s_waitcnt lgkmcnt(8)
    v_mfma_f32_32x32x16_bf16 v[80:95], a[140:143], a[112:115], v[80:95]
    v_mfma_f32_32x32x16_bf16 v[96:111], a[140:143], a[116:119], v[96:111]
    ds_read_b64_tr_b16 a[128:129], v14 offset:57344
    ds_read_b64_tr_b16 a[130:131], v14 offset:58368
    buffer_load_dwordx4 a[76:79], v2, s[8:11], s31 offen offset:1024 sc1
    s_waitcnt lgkmcnt(8)
    v_mfma_f32_32x32x16_bf16 v[112:127], a[112:115], a[144:147], v[112:127]
    ds_read_b64_tr_b16 a[132:133], v10 offset:46080
    ds_read_b64_tr_b16 a[134:135], v10 offset:46848
    v_mfma_f32_32x32x16_bf16 v[128:143], a[116:119], a[144:147], v[128:143]
    s_waitcnt lgkmcnt(8)
    v_mfma_f32_32x32x16_bf16 v[144:159], a[148:151], a[112:115], v[144:159]
    ds_read_b64_tr_b16 a[136:137], v10 offset:46144
    ds_read_b64_tr_b16 a[138:139], v10 offset:46912
    buffer_load_dwordx4 a[80:83], v2, s[8:11], s30 offen offset:2048 sc1
    v_mfma_f32_32x32x16_bf16 v[160:175], a[148:151], a[116:119], v[160:175]
    s_waitcnt lgkmcnt(8)
    v_mfma_f32_32x32x16_bf16 v[176:191], a[152:155], a[112:115], v[176:191]
    ds_read_b64_tr_b16 a[140:141], v10 offset:46208
    ds_read_b64_tr_b16 a[142:143], v10 offset:46976
    v_mfma_f32_32x32x16_bf16 v[192:207], a[152:155], a[116:119], v[192:207]
    buffer_load_dwordx4 a[84:87], v2, s[8:11], s31 offen offset:2048 sc1
    s_waitcnt lgkmcnt(8)
    v_mfma_f32_32x32x16_bf16 v[208:223], a[156:159], a[112:115], v[208:223]
    ds_read_b64_tr_b16 a[144:145], v11 offset:61440
    ds_read_b64_tr_b16 a[146:147], v11 offset:62464
    v_mfma_f32_32x32x16_bf16 v[224:239], a[156:159], a[116:119], v[224:239]
    s_waitcnt lgkmcnt(8)
    v_mfma_f32_32x32x16_bf16 v[240:255], a[128:131], a[112:115], v[240:255]
    ds_read_b64_tr_b16 a[148:149], v12 offset:61440
    ds_read_b64_tr_b16 a[150:151], v12 offset:62464
    buffer_load_dwordx4 a[88:91], v2, s[8:11], s30 offen offset:3072 sc1
    s_waitcnt lgkmcnt(8)
    v_mfma_f32_32x32x16_bf16 v[48:63], a[132:135], a[120:123], v[48:63]
    v_mfma_f32_32x32x16_bf16 v[64:79], a[132:135], a[124:127], v[64:79]
    ds_read_b64_tr_b16 a[152:153], v13 offset:61440
    ds_read_b64_tr_b16 a[154:155], v13 offset:62464
    s_waitcnt lgkmcnt(8)
    v_mfma_f32_32x32x16_bf16 v[80:95], a[136:139], a[120:123], v[80:95]
    buffer_load_dwordx4 a[92:95], v2, s[8:11], s31 offen offset:3072 sc1
    s_add_u32 s30, s30, 4096
    s_add_u32 s31, s31, 4096
    v_mfma_f32_32x32x16_bf16 v[96:111], a[136:139], a[124:127], v[96:111]
    ds_read_b64_tr_b16 a[156:157], v14 offset:61440
    ds_read_b64_tr_b16 a[158:159], v14 offset:62464
    s_waitcnt lgkmcnt(8)
    v_mfma_f32_32x32x16_bf16 v[112:127], a[120:123], a[140:143], v[112:127]
    v_mfma_f32_32x32x16_bf16 v[128:143], a[124:127], a[140:143], v[128:143]
    s_waitcnt lgkmcnt(6)
    v_mfma_f32_32x32x16_bf16 v[144:159], a[144:147], a[120:123], v[144:159]
    s_waitcnt vmcnt(30) lgkmcnt(0)
    s_barrier
    ds_read_b64_tr_b16 a[128:129], v10 offset:0
    ds_read_b64_tr_b16 a[130:131], v10 offset:768
    ds_read_b64_tr_b16 a[132:133], v10 offset:64
    ds_read_b64_tr_b16 a[134:135], v10 offset:832
    v_mfma_f32_32x32x16_bf16 v[160:175], a[144:147], a[124:127], v[160:175]
    v_mfma_f32_32x32x16_bf16 v[176:191], a[148:151], a[120:123], v[176:191]
    ds_read_b64_tr_b16 a[136:137], v10 offset:128
    ds_read_b64_tr_b16 a[138:139], v10 offset:896
    v_mfma_f32_32x32x16_bf16 v[192:207], a[148:151], a[124:127], v[192:207]
    v_mfma_f32_32x32x16_bf16 v[208:223], a[152:155], a[120:123], v[208:223]
    ds_read_b64_tr_b16 a[140:141], v11 offset:0
    ds_read_b64_tr_b16 a[142:143], v11 offset:1024
    v_mfma_f32_32x32x16_bf16 v[224:239], a[152:155], a[124:127], v[224:239]
    v_mfma_f32_32x32x16_bf16 v[240:255], a[156:159], a[120:123], v[240:255]
    ds_read_b64_tr_b16 a[144:145], v12 offset:0
    ds_read_b64_tr_b16 a[146:147], v12 offset:1024
    s_add_u32 m0, s34, 36864
    s_nop 0
    buffer_load_dwordx4 v3, s[12:15], s32 offen offset:0 lds
    s_waitcnt lgkmcnt(8)
    v_mfma_f32_32x32x16_bf16 v[48:63], a[128:131], a[0:3], v[48:63]
    v_mfma_f32_32x32x16_bf16 v[64:79], a[128:131], a[4:7], v[64:79]
    ds_read_b64_tr_b16 a[148:149], v13 offset:0
    ds_read_b64_tr_b16 a[150:151], v13 offset:1024
    s_waitcnt lgkmcnt(8)
    v_mfma_f32_32x32x16_bf16 v[80:95], a[132:135], a[0:3], v[80:95]
    buffer_load_dwordx4 v4, s[12:15], s32 offen offset:1024 lds
    v_mfma_f32_32x32x16_bf16 v[96:111], a[132:135], a[4:7], v[96:111]
    ds_read_b64_tr_b16 a[152:153], v14 offset:0
    ds_read_b64_tr_b16 a[154:155], v14 offset:1024
    s_waitcnt lgkmcnt(8)
    v_mfma_f32_32x32x16_bf16 v[112:127], a[0:3], a[136:139], v[112:127]
    ds_read_b64_tr_b16 a[156:157], v10 offset:3072
    ds_read_b64_tr_b16 a[158:159], v10 offset:3840
    v_mfma_f32_32x32x16_bf16 v[128:143], a[4:7], a[136:139], v[128:143]
    buffer_load_dwordx4 v5, s[12:15], s32 offen offset:2048 lds
    s_waitcnt lgkmcnt(8)
    v_mfma_f32_32x32x16_bf16 v[144:159], a[140:143], a[0:3], v[144:159]
    ds_read_b64_tr_b16 a[128:129], v10 offset:3136
    ds_read_b64_tr_b16 a[130:131], v10 offset:3904
    v_mfma_f32_32x32x16_bf16 v[160:175], a[140:143], a[4:7], v[160:175]
    s_waitcnt lgkmcnt(8)
    v_mfma_f32_32x32x16_bf16 v[176:191], a[144:147], a[0:3], v[176:191]
    ds_read_b64_tr_b16 a[132:133], v10 offset:3200
    ds_read_b64_tr_b16 a[134:135], v10 offset:3968
    s_add_u32 m0, s35, 49152
    s_nop 0
    buffer_load_dwordx4 v6, s[16:19], s33 offen offset:0 lds
    v_mfma_f32_32x32x16_bf16 v[192:207], a[144:147], a[4:7], v[192:207]
    s_waitcnt lgkmcnt(8)
    v_mfma_f32_32x32x16_bf16 v[208:223], a[148:151], a[0:3], v[208:223]
    ds_read_b64_tr_b16 a[136:137], v11 offset:4096
    ds_read_b64_tr_b16 a[138:139], v11 offset:5120
    v_mfma_f32_32x32x16_bf16 v[224:239], a[148:151], a[4:7], v[224:239]
    buffer_load_dwordx4 v7, s[16:19], s33 offen offset:1024 lds
    s_waitcnt lgkmcnt(8)
    v_mfma_f32_32x32x16_bf16 v[240:255], a[152:155], a[0:3], v[240:255]
    ds_read_b64_tr_b16 a[140:141], v12 offset:4096
    ds_read_b64_tr_b16 a[142:143], v12 offset:5120
    s_waitcnt lgkmcnt(8)
    v_mfma_f32_32x32x16_bf16 v[48:63], a[156:159], a[8:11], v[48:63]
    v_mfma_f32_32x32x16_bf16 v[64:79], a[156:159], a[12:15], v[64:79]
    ds_read_b64_tr_b16 a[144:145], v13 offset:4096
    ds_read_b64_tr_b16 a[146:147], v13 offset:5120
    buffer_load_dwordx4 v8, s[16:19], s33 offen offset:2048 lds
    s_waitcnt lgkmcnt(8)
    v_mfma_f32_32x32x16_bf16 v[80:95], a[128:131], a[8:11], v[80:95]
    v_mfma_f32_32x32x16_bf16 v[96:111], a[128:131], a[12:15], v[96:111]
    ds_read_b64_tr_b16 a[148:149], v14 offset:4096
    ds_read_b64_tr_b16 a[150:151], v14 offset:5120
    s_waitcnt lgkmcnt(8)
    v_mfma_f32_32x32x16_bf16 v[112:127], a[8:11], a[132:135], v[112:127]
    ds_read_b64_tr_b16 a[152:153], v10 offset:6144
    ds_read_b64_tr_b16 a[154:155], v10 offset:6912
    buffer_load_dwordx4 v9, s[16:19], s33 offen offset:3072 lds
    s_add_u32 s32, s32, 393216
    s_add_u32 s33, s33, 458752
    v_mfma_f32_32x32x16_bf16 v[128:143], a[12:15], a[132:135], v[128:143]
    s_waitcnt lgkmcnt(8)
    v_mfma_f32_32x32x16_bf16 v[144:159], a[136:139], a[8:11], v[144:159]
    ds_read_b64_tr_b16 a[156:157], v10 offset:6208
    ds_read_b64_tr_b16 a[158:159], v10 offset:6976
    v_mfma_f32_32x32x16_bf16 v[160:175], a[136:139], a[12:15], v[160:175]
    buffer_load_dwordx4 a[96:99], v2, s[8:11], s30 offen offset:0 sc1
    s_waitcnt lgkmcnt(8)
    v_mfma_f32_32x32x16_bf16 v[176:191], a[140:143], a[8:11], v[176:191]
    ds_read_b64_tr_b16 a[128:129], v10 offset:6272
    ds_read_b64_tr_b16 a[130:131], v10 offset:7040
    v_mfma_f32_32x32x16_bf16 v[192:207], a[140:143], a[12:15], v[192:207]
    s_waitcnt lgkmcnt(8)
    v_mfma_f32_32x32x16_bf16 v[208:223], a[144:147], a[8:11], v[208:223]
    ds_read_b64_tr_b16 a[132:133], v11 offset:8192
    ds_read_b64_tr_b16 a[134:135], v11 offset:9216
    buffer_load_dwordx4 a[100:103], v2, s[8:11], s31 offen offset:0 sc1
    v_mfma_f32_32x32x16_bf16 v[224:239], a[144:147], a[12:15], v[224:239]
    s_waitcnt lgkmcnt(8)
    v_mfma_f32_32x32x16_bf16 v[240:255], a[148:151], a[8:11], v[240:255]
    ds_read_b64_tr_b16 a[136:137], v12 offset:8192
    ds_read_b64_tr_b16 a[138:139], v12 offset:9216
    s_waitcnt lgkmcnt(8)
    v_mfma_f32_32x32x16_bf16 v[48:63], a[152:155], a[16:19], v[48:63]
    buffer_load_dwordx4 a[104:107], v2, s[8:11], s30 offen offset:1024 sc1
    v_mfma_f32_32x32x16_bf16 v[64:79], a[152:155], a[20:23], v[64:79]
    ds_read_b64_tr_b16 a[140:141], v13 offset:8192
    ds_read_b64_tr_b16 a[142:143], v13 offset:9216
    s_waitcnt lgkmcnt(8)
    v_mfma_f32_32x32x16_bf16 v[80:95], a[156:159], a[16:19], v[80:95]
    v_mfma_f32_32x32x16_bf16 v[96:111], a[156:159], a[20:23], v[96:111]
    ds_read_b64_tr_b16 a[144:145], v14 offset:8192
    ds_read_b64_tr_b16 a[146:147], v14 offset:9216
    buffer_load_dwordx4 a[108:111], v2, s[8:11], s31 offen offset:1024 sc1
    s_waitcnt lgkmcnt(8)
    v_mfma_f32_32x32x16_bf16 v[112:127], a[16:19], a[128:131], v[112:127]
    ds_read_b64_tr_b16 a[148:149], v10 offset:9216
    ds_read_b64_tr_b16 a[150:151], v10 offset:9984
    v_mfma_f32_32x32x16_bf16 v[128:143], a[20:23], a[128:131], v[128:143]
    s_waitcnt lgkmcnt(8)
    v_mfma_f32_32x32x16_bf16 v[144:159], a[132:135], a[16:19], v[144:159]
    ds_read_b64_tr_b16 a[152:153], v10 offset:9280
    ds_read_b64_tr_b16 a[154:155], v10 offset:10048
    buffer_load_dwordx4 a[112:115], v2, s[8:11], s30 offen offset:2048 sc1
    v_mfma_f32_32x32x16_bf16 v[160:175], a[132:135], a[20:23], v[160:175]
    s_waitcnt lgkmcnt(8)
    v_mfma_f32_32x32x16_bf16 v[176:191], a[136:139], a[16:19], v[176:191]
    ds_read_b64_tr_b16 a[156:157], v10 offset:9344
    ds_read_b64_tr_b16 a[158:159], v10 offset:10112
    v_mfma_f32_32x32x16_bf16 v[192:207], a[136:139], a[20:23], v[192:207]
    buffer_load_dwordx4 a[116:119], v2, s[8:11], s31 offen offset:2048 sc1
    s_waitcnt lgkmcnt(8)
    v_mfma_f32_32x32x16_bf16 v[208:223], a[140:143], a[16:19], v[208:223]
    ds_read_b64_tr_b16 a[128:129], v11 offset:12288
    ds_read_b64_tr_b16 a[130:131], v11 offset:13312
    v_mfma_f32_32x32x16_bf16 v[224:239], a[140:143], a[20:23], v[224:239]
    s_waitcnt lgkmcnt(8)
    v_mfma_f32_32x32x16_bf16 v[240:255], a[144:147], a[16:19], v[240:255]
    ds_read_b64_tr_b16 a[132:133], v12 offset:12288
    ds_read_b64_tr_b16 a[134:135], v12 offset:13312
    buffer_load_dwordx4 a[120:123], v2, s[8:11], s30 offen offset:3072 sc1
    s_waitcnt lgkmcnt(8)
    v_mfma_f32_32x32x16_bf16 v[48:63], a[148:151], a[24:27], v[48:63]
    v_mfma_f32_32x32x16_bf16 v[64:79], a[148:151], a[28:31], v[64:79]
    ds_read_b64_tr_b16 a[136:137], v13 offset:12288
    ds_read_b64_tr_b16 a[138:139], v13 offset:13312
    s_waitcnt lgkmcnt(8)
    v_mfma_f32_32x32x16_bf16 v[80:95], a[152:155], a[24:27], v[80:95]
    buffer_load_dwordx4 a[124:127], v2, s[8:11], s31 offen offset:3072 sc1
    s_add_u32 s30, s30, 4096
    s_add_u32 s31, s31, 4096
    v_mfma_f32_32x32x16_bf16 v[96:111], a[152:155], a[28:31], v[96:111]
    ds_read_b64_tr_b16 a[140:141], v14 offset:12288
    ds_read_b64_tr_b16 a[142:143], v14 offset:13312
    s_waitcnt lgkmcnt(8)
    v_mfma_f32_32x32x16_bf16 v[112:127], a[24:27], a[156:159], v[112:127]
    v_mfma_f32_32x32x16_bf16 v[128:143], a[28:31], a[156:159], v[128:143]
    s_waitcnt lgkmcnt(6)
    v_mfma_f32_32x32x16_bf16 v[144:159], a[128:131], a[24:27], v[144:159]
    s_waitcnt vmcnt(30) lgkmcnt(0)
    s_barrier
    ds_read_b64_tr_b16 a[144:145], v10 offset:12288
    ds_read_b64_tr_b16 a[146:147], v10 offset:13056
    ds_read_b64_tr_b16 a[148:149], v10 offset:12352
    ds_read_b64_tr_b16 a[150:151], v10 offset:13120
    v_mfma_f32_32x32x16_bf16 v[160:175], a[128:131], a[28:31], v[160:175]
    v_mfma_f32_32x32x16_bf16 v[176:191], a[132:135], a[24:27], v[176:191]
    ds_read_b64_tr_b16 a[152:153], v10 offset:12416
    ds_read_b64_tr_b16 a[154:155], v10 offset:13184
    v_mfma_f32_32x32x16_bf16 v[192:207], a[132:135], a[28:31], v[192:207]
    v_mfma_f32_32x32x16_bf16 v[208:223], a[136:139], a[24:27], v[208:223]
    ds_read_b64_tr_b16 a[156:157], v11 offset:16384
    ds_read_b64_tr_b16 a[158:159], v11 offset:17408
    v_mfma_f32_32x32x16_bf16 v[224:239], a[136:139], a[28:31], v[224:239]
    v_mfma_f32_32x32x16_bf16 v[240:255], a[140:143], a[24:27], v[240:255]
    ds_read_b64_tr_b16 a[128:129], v12 offset:16384
    ds_read_b64_tr_b16 a[130:131], v12 offset:17408
    s_add_u32 m0, s34, 0
    s_nop 0
    buffer_load_dwordx4 v3, s[12:15], s32 offen offset:0 lds
    s_waitcnt lgkmcnt(8)
    v_mfma_f32_32x32x16_bf16 v[48:63], a[144:147], a[32:35], v[48:63]
    v_mfma_f32_32x32x16_bf16 v[64:79], a[144:147], a[36:39], v[64:79]
    ds_read_b64_tr_b16 a[132:133], v13 offset:16384
    ds_read_b64_tr_b16 a[134:135], v13 offset:17408
    s_waitcnt lgkmcnt(8)
    v_mfma_f32_32x32x16_bf16 v[80:95], a[148:151], a[32:35], v[80:95]
    buffer_load_dwordx4 v4, s[12:15], s32 offen offset:1024 lds
    v_mfma_f32_32x32x16_bf16 v[96:111], a[148:151], a[36:39], v[96:111]
    ds_read_b64_tr_b16 a[136:137], v14 offset:16384
    ds_read_b64_tr_b16 a[138:139], v14 offset:17408
    s_waitcnt lgkmcnt(8)
    v_mfma_f32_32x32x16_bf16 v[112:127], a[32:35], a[152:155], v[112:127]
    ds_read_b64_tr_b16 a[140:141], v10 offset:15360
    ds_read_b64_tr_b16 a[142:143], v10 offset:16128
    v_mfma_f32_32x32x16_bf16 v[128:143], a[36:39], a[152:155], v[128:143]
    buffer_load_dwordx4 v5, s[12:15], s32 offen offset:2048 lds
    s_waitcnt lgkmcnt(8)
    v_mfma_f32_32x32x16_bf16 v[144:159], a[156:159], a[32:35], v[144:159]
    ds_read_b64_tr_b16 a[144:145], v10 offset:15424
    ds_read_b64_tr_b16 a[146:147], v10 offset:16192
    v_mfma_f32_32x32x16_bf16 v[160:175], a[156:159], a[36:39], v[160:175]
    s_waitcnt lgkmcnt(8)
    v_mfma_f32_32x32x16_bf16 v[176:191], a[128:131], a[32:35], v[176:191]
    ds_read_b64_tr_b16 a[148:149], v10 offset:15488
    ds_read_b64_tr_b16 a[150:151], v10 offset:16256
    s_add_u32 m0, s35, 0
    s_nop 0
    buffer_load_dwordx4 v6, s[16:19], s33 offen offset:0 lds
    v_mfma_f32_32x32x16_bf16 v[192:207], a[128:131], a[36:39], v[192:207]
    s_waitcnt lgkmcnt(8)
    v_mfma_f32_32x32x16_bf16 v[208:223], a[132:135], a[32:35], v[208:223]
    ds_read_b64_tr_b16 a[152:153], v11 offset:20480
    ds_read_b64_tr_b16 a[154:155], v11 offset:21504
    v_mfma_f32_32x32x16_bf16 v[224:239], a[132:135], a[36:39], v[224:239]
    buffer_load_dwordx4 v7, s[16:19], s33 offen offset:1024 lds
    s_waitcnt lgkmcnt(8)
    v_mfma_f32_32x32x16_bf16 v[240:255], a[136:139], a[32:35], v[240:255]
    ds_read_b64_tr_b16 a[156:157], v12 offset:20480
    ds_read_b64_tr_b16 a[158:159], v12 offset:21504
    s_waitcnt lgkmcnt(8)
    v_mfma_f32_32x32x16_bf16 v[48:63], a[140:143], a[40:43], v[48:63]
    v_mfma_f32_32x32x16_bf16 v[64:79], a[140:143], a[44:47], v[64:79]
    ds_read_b64_tr_b16 a[128:129], v13 offset:20480
    ds_read_b64_tr_b16 a[130:131], v13 offset:21504
    buffer_load_dwordx4 v8, s[16:19], s33 offen offset:2048 lds
    s_waitcnt lgkmcnt(8)
    v_mfma_f32_32x32x16_bf16 v[80:95], a[144:147], a[40:43], v[80:95]
    v_mfma_f32_32x32x16_bf16 v[96:111], a[144:147], a[44:47], v[96:111]
    ds_read_b64_tr_b16 a[132:133], v14 offset:20480
    ds_read_b64_tr_b16 a[134:135], v14 offset:21504
    s_waitcnt lgkmcnt(8)
    v_mfma_f32_32x32x16_bf16 v[112:127], a[40:43], a[148:151], v[112:127]
    ds_read_b64_tr_b16 a[136:137], v10 offset:18432
    ds_read_b64_tr_b16 a[138:139], v10 offset:19200
    buffer_load_dwordx4 v9, s[16:19], s33 offen offset:3072 lds
    s_add_u32 s32, s32, 393216
    s_add_u32 s33, s33, 458752
    v_mfma_f32_32x32x16_bf16 v[128:143], a[44:47], a[148:151], v[128:143]
    s_waitcnt lgkmcnt(8)
    v_mfma_f32_32x32x16_bf16 v[144:159], a[152:155], a[40:43], v[144:159]
    ds_read_b64_tr_b16 a[140:141], v10 offset:18496
    ds_read_b64_tr_b16 a[142:143], v10 offset:19264
    v_mfma_f32_32x32x16_bf16 v[160:175], a[152:155], a[44:47], v[160:175]
    buffer_load_dwordx4 a[0:3], v2, s[8:11], s30 offen offset:0 sc1
    s_waitcnt lgkmcnt(8)
    v_mfma_f32_32x32x16_bf16 v[176:191], a[156:159], a[40:43], v[176:191]
    ds_read_b64_tr_b16 a[144:145], v10 offset:18560
    ds_read_b64_tr_b16 a[146:147], v10 offset:19328
    v_mfma_f32_32x32x16_bf16 v[192:207], a[156:159], a[44:47], v[192:207]
    s_waitcnt lgkmcnt(8)
    v_mfma_f32_32x32x16_bf16 v[208:223], a[128:131], a[40:43], v[208:223]
    ds_read_b64_tr_b16 a[148:149], v11 offset:24576
    ds_read_b64_tr_b16 a[150:151], v11 offset:25600
    buffer_load_dwordx4 a[4:7], v2, s[8:11], s31 offen offset:0 sc1
    v_mfma_f32_32x32x16_bf16 v[224:239], a[128:131], a[44:47], v[224:239]
    s_waitcnt lgkmcnt(8)
    v_mfma_f32_32x32x16_bf16 v[240:255], a[132:135], a[40:43], v[240:255]
    ds_read_b64_tr_b16 a[152:153], v12 offset:24576
    ds_read_b64_tr_b16 a[154:155], v12 offset:25600
    s_waitcnt lgkmcnt(8)
    v_mfma_f32_32x32x16_bf16 v[48:63], a[136:139], a[48:51], v[48:63]
    buffer_load_dwordx4 a[8:11], v2, s[8:11], s30 offen offset:1024 sc1
    v_mfma_f32_32x32x16_bf16 v[64:79], a[136:139], a[52:55], v[64:79]
    ds_read_b64_tr_b16 a[156:157], v13 offset:24576
    ds_read_b64_tr_b16 a[158:159], v13 offset:25600
    s_waitcnt lgkmcnt(8)
    v_mfma_f32_32x32x16_bf16 v[80:95], a[140:143], a[48:51], v[80:95]
    v_mfma_f32_32x32x16_bf16 v[96:111], a[140:143], a[52:55], v[96:111]
    ds_read_b64_tr_b16 a[128:129], v14 offset:24576
    ds_read_b64_tr_b16 a[130:131], v14 offset:25600
    buffer_load_dwordx4 a[12:15], v2, s[8:11], s31 offen offset:1024 sc1
    s_waitcnt lgkmcnt(8)
    v_mfma_f32_32x32x16_bf16 v[112:127], a[48:51], a[144:147], v[112:127]
    ds_read_b64_tr_b16 a[132:133], v10 offset:21504
    ds_read_b64_tr_b16 a[134:135], v10 offset:22272
    v_mfma_f32_32x32x16_bf16 v[128:143], a[52:55], a[144:147], v[128:143]
    s_waitcnt lgkmcnt(8)
    v_mfma_f32_32x32x16_bf16 v[144:159], a[148:151], a[48:51], v[144:159]
    ds_read_b64_tr_b16 a[136:137], v10 offset:21568
    ds_read_b64_tr_b16 a[138:139], v10 offset:22336
    buffer_load_dwordx4 a[16:19], v2, s[8:11], s30 offen offset:2048 sc1
    v_mfma_f32_32x32x16_bf16 v[160:175], a[148:151], a[52:55], v[160:175]
    s_waitcnt lgkmcnt(8)
    v_mfma_f32_32x32x16_bf16 v[176:191], a[152:155], a[48:51], v[176:191]
    ds_read_b64_tr_b16 a[140:141], v10 offset:21632
    ds_read_b64_tr_b16 a[142:143], v10 offset:22400
    v_mfma_f32_32x32x16_bf16 v[192:207], a[152:155], a[52:55], v[192:207]
    buffer_load_dwordx4 a[20:23], v2, s[8:11], s31 offen offset:2048 sc1
    s_waitcnt lgkmcnt(8)
    v_mfma_f32_32x32x16_bf16 v[208:223], a[156:159], a[48:51], v[208:223]
    ds_read_b64_tr_b16 a[144:145], v11 offset:28672
    ds_read_b64_tr_b16 a[146:147], v11 offset:29696
    v_mfma_f32_32x32x16_bf16 v[224:239], a[156:159], a[52:55], v[224:239]
    s_waitcnt lgkmcnt(8)
    v_mfma_f32_32x32x16_bf16 v[240:255], a[128:131], a[48:51], v[240:255]
    ds_read_b64_tr_b16 a[148:149], v12 offset:28672
    ds_read_b64_tr_b16 a[150:151], v12 offset:29696
    buffer_load_dwordx4 a[24:27], v2, s[8:11], s30 offen offset:3072 sc1
    s_waitcnt lgkmcnt(8)
    v_mfma_f32_32x32x16_bf16 v[48:63], a[132:135], a[56:59], v[48:63]
    v_mfma_f32_32x32x16_bf16 v[64:79], a[132:135], a[60:63], v[64:79]
    ds_read_b64_tr_b16 a[152:153], v13 offset:28672
    ds_read_b64_tr_b16 a[154:155], v13 offset:29696
    s_waitcnt lgkmcnt(8)
    v_mfma_f32_32x32x16_bf16 v[80:95], a[136:139], a[56:59], v[80:95]
    buffer_load_dwordx4 a[28:31], v2, s[8:11], s31 offen offset:3072 sc1
    s_add_u32 s30, s30, 4096
    s_add_u32 s31, s31, 4096
    v_mfma_f32_32x32x16_bf16 v[96:111], a[136:139], a[60:63], v[96:111]
    ds_read_b64_tr_b16 a[156:157], v14 offset:28672
    ds_read_b64_tr_b16 a[158:159], v14 offset:29696
    s_waitcnt lgkmcnt(8)
    v_mfma_f32_32x32x16_bf16 v[112:127], a[56:59], a[140:143], v[112:127]
    v_mfma_f32_32x32x16_bf16 v[128:143], a[60:63], a[140:143], v[128:143]
    s_waitcnt lgkmcnt(6)
    v_mfma_f32_32x32x16_bf16 v[144:159], a[144:147], a[56:59], v[144:159]
    s_waitcnt vmcnt(30) lgkmcnt(0)
    s_barrier
    ds_read_b64_tr_b16 a[128:129], v10 offset:24576
    ds_read_b64_tr_b16 a[130:131], v10 offset:25344
    ds_read_b64_tr_b16 a[132:133], v10 offset:24640
    ds_read_b64_tr_b16 a[134:135], v10 offset:25408
    v_mfma_f32_32x32x16_bf16 v[160:175], a[144:147], a[60:63], v[160:175]
    v_mfma_f32_32x32x16_bf16 v[176:191], a[148:151], a[56:59], v[176:191]
    ds_read_b64_tr_b16 a[136:137], v10 offset:24704
    ds_read_b64_tr_b16 a[138:139], v10 offset:25472
    v_mfma_f32_32x32x16_bf16 v[192:207], a[148:151], a[60:63], v[192:207]
    v_mfma_f32_32x32x16_bf16 v[208:223], a[152:155], a[56:59], v[208:223]
    ds_read_b64_tr_b16 a[140:141], v11 offset:32768
    ds_read_b64_tr_b16 a[142:143], v11 offset:33792
    v_mfma_f32_32x32x16_bf16 v[224:239], a[152:155], a[60:63], v[224:239]
    v_mfma_f32_32x32x16_bf16 v[240:255], a[156:159], a[56:59], v[240:255]
    ds_read_b64_tr_b16 a[144:145], v12 offset:32768
    ds_read_b64_tr_b16 a[146:147], v12 offset:33792
    s_add_u32 m0, s34, 12288
    s_nop 0
    buffer_load_dwordx4 v3, s[12:15], s32 offen offset:0 lds
    s_waitcnt lgkmcnt(8)
    v_mfma_f32_32x32x16_bf16 v[48:63], a[128:131], a[64:67], v[48:63]
    v_mfma_f32_32x32x16_bf16 v[64:79], a[128:131], a[68:71], v[64:79]
    ds_read_b64_tr_b16 a[148:149], v13 offset:32768
    ds_read_b64_tr_b16 a[150:151], v13 offset:33792
    s_waitcnt lgkmcnt(8)
    v_mfma_f32_32x32x16_bf16 v[80:95], a[132:135], a[64:67], v[80:95]
    buffer_load_dwordx4 v4, s[12:15], s32 offen offset:1024 lds
    v_mfma_f32_32x32x16_bf16 v[96:111], a[132:135], a[68:71], v[96:111]
    ds_read_b64_tr_b16 a[152:153], v14 offset:32768
    ds_read_b64_tr_b16 a[154:155], v14 offset:33792
    s_waitcnt lgkmcnt(8)
    v_mfma_f32_32x32x16_bf16 v[112:127], a[64:67], a[136:139], v[112:127]
    ds_read_b64_tr_b16 a[156:157], v10 offset:27648
    ds_read_b64_tr_b16 a[158:159], v10 offset:28416
    v_mfma_f32_32x32x16_bf16 v[128:143], a[68:71], a[136:139], v[128:143]
    buffer_load_dwordx4 v5, s[12:15], s32 offen offset:2048 lds
    s_waitcnt lgkmcnt(8)
    v_mfma_f32_32x32x16_bf16 v[144:159], a[140:143], a[64:67], v[144:159]
    ds_read_b64_tr_b16 a[128:129], v10 offset:27712
    ds_read_b64_tr_b16 a[130:131], v10 offset:28480
    v_mfma_f32_32x32x16_bf16 v[160:175], a[140:143], a[68:71], v[160:175]
    s_waitcnt lgkmcnt(8)
    v_mfma_f32_32x32x16_bf16 v[176:191], a[144:147], a[64:67], v[176:191]
    ds_read_b64_tr_b16 a[132:133], v10 offset:27776
    ds_read_b64_tr_b16 a[134:135], v10 offset:28544
    s_add_u32 m0, s35, 16384
    s_nop 0
    buffer_load_dwordx4 v6, s[16:19], s33 offen offset:0 lds
    v_mfma_f32_32x32x16_bf16 v[192:207], a[144:147], a[68:71], v[192:207]
    s_waitcnt lgkmcnt(8)
    v_mfma_f32_32x32x16_bf16 v[208:223], a[148:151], a[64:67], v[208:223]
    ds_read_b64_tr_b16 a[136:137], v11 offset:36864
    ds_read_b64_tr_b16 a[138:139], v11 offset:37888
    v_mfma_f32_32x32x16_bf16 v[224:239], a[148:151], a[68:71], v[224:239]
    buffer_load_dwordx4 v7, s[16:19], s33 offen offset:1024 lds
    s_waitcnt lgkmcnt(8)
    v_mfma_f32_32x32x16_bf16 v[240:255], a[152:155], a[64:67], v[240:255]
    ds_read_b64_tr_b16 a[140:141], v12 offset:36864
    ds_read_b64_tr_b16 a[142:143], v12 offset:37888
    s_waitcnt lgkmcnt(8)
    v_mfma_f32_32x32x16_bf16 v[48:63], a[156:159], a[72:75], v[48:63]
    v_mfma_f32_32x32x16_bf16 v[64:79], a[156:159], a[76:79], v[64:79]
    ds_read_b64_tr_b16 a[144:145], v13 offset:36864
    ds_read_b64_tr_b16 a[146:147], v13 offset:37888
    buffer_load_dwordx4 v8, s[16:19], s33 offen offset:2048 lds
    s_waitcnt lgkmcnt(8)
    v_mfma_f32_32x32x16_bf16 v[80:95], a[128:131], a[72:75], v[80:95]
    v_mfma_f32_32x32x16_bf16 v[96:111], a[128:131], a[76:79], v[96:111]
    ds_read_b64_tr_b16 a[148:149], v14 offset:36864
    ds_read_b64_tr_b16 a[150:151], v14 offset:37888
    s_waitcnt lgkmcnt(8)
    v_mfma_f32_32x32x16_bf16 v[112:127], a[72:75], a[132:135], v[112:127]
    ds_read_b64_tr_b16 a[152:153], v10 offset:30720
    ds_read_b64_tr_b16 a[154:155], v10 offset:31488
    buffer_load_dwordx4 v9, s[16:19], s33 offen offset:3072 lds
    s_add_u32 s32, s32, 393216
    s_add_u32 s33, s33, 458752
    v_mfma_f32_32x32x16_bf16 v[128:143], a[76:79], a[132:135], v[128:143]
    s_waitcnt lgkmcnt(8)
    v_mfma_f32_32x32x16_bf16 v[144:159], a[136:139], a[72:75], v[144:159]
    ds_read_b64_tr_b16 a[156:157], v10 offset:30784
    ds_read_b64_tr_b16 a[158:159], v10 offset:31552
    v_mfma_f32_32x32x16_bf16 v[160:175], a[136:139], a[76:79], v[160:175]
    buffer_load_dwordx4 a[32:35], v2, s[8:11], s30 offen offset:0 sc1
    s_waitcnt lgkmcnt(8)
    v_mfma_f32_32x32x16_bf16 v[176:191], a[140:143], a[72:75], v[176:191]
    ds_read_b64_tr_b16 a[128:129], v10 offset:30848
    ds_read_b64_tr_b16 a[130:131], v10 offset:31616
    v_mfma_f32_32x32x16_bf16 v[192:207], a[140:143], a[76:79], v[192:207]
    s_waitcnt lgkmcnt(8)
    v_mfma_f32_32x32x16_bf16 v[208:223], a[144:147], a[72:75], v[208:223]
    ds_read_b64_tr_b16 a[132:133], v11 offset:40960
    ds_read_b64_tr_b16 a[134:135], v11 offset:41984
    buffer_load_dwordx4 a[36:39], v2, s[8:11], s31 offen offset:0 sc1
    v_mfma_f32_32x32x16_bf16 v[224:239], a[144:147], a[76:79], v[224:239]
    s_waitcnt lgkmcnt(8)
    v_mfma_f32_32x32x16_bf16 v[240:255], a[148:151], a[72:75], v[240:255]
    ds_read_b64_tr_b16 a[136:137], v12 offset:40960
    ds_read_b64_tr_b16 a[138:139], v12 offset:41984
    s_waitcnt lgkmcnt(8)
    v_mfma_f32_32x32x16_bf16 v[48:63], a[152:155], a[80:83], v[48:63]
    buffer_load_dwordx4 a[40:43], v2, s[8:11], s30 offen offset:1024 sc1
    v_mfma_f32_32x32x16_bf16 v[64:79], a[152:155], a[84:87], v[64:79]
    ds_read_b64_tr_b16 a[140:141], v13 offset:40960
    ds_read_b64_tr_b16 a[142:143], v13 offset:41984
    s_waitcnt lgkmcnt(8)
    v_mfma_f32_32x32x16_bf16 v[80:95], a[156:159], a[80:83], v[80:95]
    v_mfma_f32_32x32x16_bf16 v[96:111], a[156:159], a[84:87], v[96:111]
    ds_read_b64_tr_b16 a[144:145], v14 offset:40960
    ds_read_b64_tr_b16 a[146:147], v14 offset:41984
    buffer_load_dwordx4 a[44:47], v2, s[8:11], s31 offen offset:1024 sc1
    s_waitcnt lgkmcnt(8)
    v_mfma_f32_32x32x16_bf16 v[112:127], a[80:83], a[128:131], v[112:127]
    ds_read_b64_tr_b16 a[148:149], v10 offset:33792
    ds_read_b64_tr_b16 a[150:151], v10 offset:34560
    v_mfma_f32_32x32x16_bf16 v[128:143], a[84:87], a[128:131], v[128:143]
    s_waitcnt lgkmcnt(8)
    v_mfma_f32_32x32x16_bf16 v[144:159], a[132:135], a[80:83], v[144:159]
    ds_read_b64_tr_b16 a[152:153], v10 offset:33856
    ds_read_b64_tr_b16 a[154:155], v10 offset:34624
    buffer_load_dwordx4 a[48:51], v2, s[8:11], s30 offen offset:2048 sc1
    v_mfma_f32_32x32x16_bf16 v[160:175], a[132:135], a[84:87], v[160:175]
    s_waitcnt lgkmcnt(8)
    v_mfma_f32_32x32x16_bf16 v[176:191], a[136:139], a[80:83], v[176:191]
    ds_read_b64_tr_b16 a[156:157], v10 offset:33920
    ds_read_b64_tr_b16 a[158:159], v10 offset:34688
    v_mfma_f32_32x32x16_bf16 v[192:207], a[136:139], a[84:87], v[192:207]
    buffer_load_dwordx4 a[52:55], v2, s[8:11], s31 offen offset:2048 sc1
    s_waitcnt lgkmcnt(8)
    v_mfma_f32_32x32x16_bf16 v[208:223], a[140:143], a[80:83], v[208:223]
    ds_read_b64_tr_b16 a[128:129], v11 offset:45056
    ds_read_b64_tr_b16 a[130:131], v11 offset:46080
    v_mfma_f32_32x32x16_bf16 v[224:239], a[140:143], a[84:87], v[224:239]
    s_waitcnt lgkmcnt(8)
    v_mfma_f32_32x32x16_bf16 v[240:255], a[144:147], a[80:83], v[240:255]
    ds_read_b64_tr_b16 a[132:133], v12 offset:45056
    ds_read_b64_tr_b16 a[134:135], v12 offset:46080
    buffer_load_dwordx4 a[56:59], v2, s[8:11], s30 offen offset:3072 sc1
    s_waitcnt lgkmcnt(8)
    v_mfma_f32_32x32x16_bf16 v[48:63], a[148:151], a[88:91], v[48:63]
    v_mfma_f32_32x32x16_bf16 v[64:79], a[148:151], a[92:95], v[64:79]
    ds_read_b64_tr_b16 a[136:137], v13 offset:45056
    ds_read_b64_tr_b16 a[138:139], v13 offset:46080
    s_waitcnt lgkmcnt(8)
    v_mfma_f32_32x32x16_bf16 v[80:95], a[152:155], a[88:91], v[80:95]
    buffer_load_dwordx4 a[60:63], v2, s[8:11], s31 offen offset:3072 sc1
    s_add_u32 s30, s30, 4096
    s_add_u32 s31, s31, 4096
    v_mfma_f32_32x32x16_bf16 v[96:111], a[152:155], a[92:95], v[96:111]
    ds_read_b64_tr_b16 a[140:141], v14 offset:45056
    ds_read_b64_tr_b16 a[142:143], v14 offset:46080
    s_waitcnt lgkmcnt(8)
    v_mfma_f32_32x32x16_bf16 v[112:127], a[88:91], a[156:159], v[112:127]
    v_mfma_f32_32x32x16_bf16 v[128:143], a[92:95], a[156:159], v[128:143]
    s_waitcnt lgkmcnt(6)
    v_mfma_f32_32x32x16_bf16 v[144:159], a[128:131], a[88:91], v[144:159]
    s_waitcnt vmcnt(30) lgkmcnt(0)
    s_barrier
    ds_read_b64_tr_b16 a[144:145], v10 offset:36864
    ds_read_b64_tr_b16 a[146:147], v10 offset:37632
    ds_read_b64_tr_b16 a[148:149], v10 offset:36928
    ds_read_b64_tr_b16 a[150:151], v10 offset:37696
    v_mfma_f32_32x32x16_bf16 v[160:175], a[128:131], a[92:95], v[160:175]
    v_mfma_f32_32x32x16_bf16 v[176:191], a[132:135], a[88:91], v[176:191]
    ds_read_b64_tr_b16 a[152:153], v10 offset:36992
    ds_read_b64_tr_b16 a[154:155], v10 offset:37760
    v_mfma_f32_32x32x16_bf16 v[192:207], a[132:135], a[92:95], v[192:207]
    v_mfma_f32_32x32x16_bf16 v[208:223], a[136:139], a[88:91], v[208:223]
    ds_read_b64_tr_b16 a[156:157], v11 offset:49152
    ds_read_b64_tr_b16 a[158:159], v11 offset:50176
    v_mfma_f32_32x32x16_bf16 v[224:239], a[136:139], a[92:95], v[224:239]
    v_mfma_f32_32x32x16_bf16 v[240:255], a[140:143], a[88:91], v[240:255]
    ds_read_b64_tr_b16 a[128:129], v12 offset:49152
    ds_read_b64_tr_b16 a[130:131], v12 offset:50176
    s_add_u32 m0, s34, 24576
    s_nop 0
    buffer_load_dwordx4 v3, s[12:15], s32 offen offset:0 lds
    s_waitcnt lgkmcnt(8)
    v_mfma_f32_32x32x16_bf16 v[48:63], a[144:147], a[96:99], v[48:63]
    v_mfma_f32_32x32x16_bf16 v[64:79], a[144:147], a[100:103], v[64:79]
    ds_read_b64_tr_b16 a[132:133], v13 offset:49152
    ds_read_b64_tr_b16 a[134:135], v13 offset:50176
    s_waitcnt lgkmcnt(8)
    v_mfma_f32_32x32x16_bf16 v[80:95], a[148:151], a[96:99], v[80:95]
    buffer_load_dwordx4 v4, s[12:15], s32 offen offset:1024 lds
    v_mfma_f32_32x32x16_bf16 v[96:111], a[148:151], a[100:103], v[96:111]
    ds_read_b64_tr_b16 a[136:137], v14 offset:49152
    ds_read_b64_tr_b16 a[138:139], v14 offset:50176
    s_waitcnt lgkmcnt(8)
    v_mfma_f32_32x32x16_bf16 v[112:127], a[96:99], a[152:155], v[112:127]
    ds_read_b64_tr_b16 a[140:141], v10 offset:39936
    ds_read_b64_tr_b16 a[142:143], v10 offset:40704
    v_mfma_f32_32x32x16_bf16 v[128:143], a[100:103], a[152:155], v[128:143]
    buffer_load_dwordx4 v5, s[12:15], s32 offen offset:2048 lds
    s_waitcnt lgkmcnt(8)
    v_mfma_f32_32x32x16_bf16 v[144:159], a[156:159], a[96:99], v[144:159]
    ds_read_b64_tr_b16 a[144:145], v10 offset:40000
    ds_read_b64_tr_b16 a[146:147], v10 offset:40768
    v_mfma_f32_32x32x16_bf16 v[160:175], a[156:159], a[100:103], v[160:175]
    s_waitcnt lgkmcnt(8)
    v_mfma_f32_32x32x16_bf16 v[176:191], a[128:131], a[96:99], v[176:191]
    ds_read_b64_tr_b16 a[148:149], v10 offset:40064
    ds_read_b64_tr_b16 a[150:151], v10 offset:40832
    s_add_u32 m0, s35, 32768
    s_nop 0
    buffer_load_dwordx4 v6, s[16:19], s33 offen offset:0 lds
    v_mfma_f32_32x32x16_bf16 v[192:207], a[128:131], a[100:103], v[192:207]
    s_waitcnt lgkmcnt(8)
    v_mfma_f32_32x32x16_bf16 v[208:223], a[132:135], a[96:99], v[208:223]
    ds_read_b64_tr_b16 a[152:153], v11 offset:53248
    ds_read_b64_tr_b16 a[154:155], v11 offset:54272
    v_mfma_f32_32x32x16_bf16 v[224:239], a[132:135], a[100:103], v[224:239]
    buffer_load_dwordx4 v7, s[16:19], s33 offen offset:1024 lds
    s_waitcnt lgkmcnt(8)
    v_mfma_f32_32x32x16_bf16 v[240:255], a[136:139], a[96:99], v[240:255]
    ds_read_b64_tr_b16 a[156:157], v12 offset:53248
    ds_read_b64_tr_b16 a[158:159], v12 offset:54272
    s_waitcnt lgkmcnt(8)
    v_mfma_f32_32x32x16_bf16 v[48:63], a[140:143], a[104:107], v[48:63]
    v_mfma_f32_32x32x16_bf16 v[64:79], a[140:143], a[108:111], v[64:79]
    ds_read_b64_tr_b16 a[128:129], v13 offset:53248
    ds_read_b64_tr_b16 a[130:131], v13 offset:54272
    buffer_load_dwordx4 v8, s[16:19], s33 offen offset:2048 lds
    s_waitcnt lgkmcnt(8)
    v_mfma_f32_32x32x16_bf16 v[80:95], a[144:147], a[104:107], v[80:95]
    v_mfma_f32_32x32x16_bf16 v[96:111], a[144:147], a[108:111], v[96:111]
    ds_read_b64_tr_b16 a[132:133], v14 offset:53248
    ds_read_b64_tr_b16 a[134:135], v14 offset:54272
    s_waitcnt lgkmcnt(8)
    v_mfma_f32_32x32x16_bf16 v[112:127], a[104:107], a[148:151], v[112:127]
    ds_read_b64_tr_b16 a[136:137], v10 offset:43008
    ds_read_b64_tr_b16 a[138:139], v10 offset:43776
    buffer_load_dwordx4 v9, s[16:19], s33 offen offset:3072 lds
    s_add_u32 s32, s32, 393216
    s_add_u32 s33, s33, 458752
    v_mfma_f32_32x32x16_bf16 v[128:143], a[108:111], a[148:151], v[128:143]
    s_waitcnt lgkmcnt(8)
    v_mfma_f32_32x32x16_bf16 v[144:159], a[152:155], a[104:107], v[144:159]
    ds_read_b64_tr_b16 a[140:141], v10 offset:43072
    ds_read_b64_tr_b16 a[142:143], v10 offset:43840
    v_mfma_f32_32x32x16_bf16 v[160:175], a[152:155], a[108:111], v[160:175]
    buffer_load_dwordx4 a[64:67], v2, s[8:11], s30 offen offset:0 sc1
    s_waitcnt lgkmcnt(8)
    v_mfma_f32_32x32x16_bf16 v[176:191], a[156:159], a[104:107], v[176:191]
    ds_read_b64_tr_b16 a[144:145], v10 offset:43136
    ds_read_b64_tr_b16 a[146:147], v10 offset:43904
    v_mfma_f32_32x32x16_bf16 v[192:207], a[156:159], a[108:111], v[192:207]
    s_waitcnt lgkmcnt(8)
    v_mfma_f32_32x32x16_bf16 v[208:223], a[128:131], a[104:107], v[208:223]
    ds_read_b64_tr_b16 a[148:149], v11 offset:57344
    ds_read_b64_tr_b16 a[150:151], v11 offset:58368
    buffer_load_dwordx4 a[68:71], v2, s[8:11], s31 offen offset:0 sc1
    v_mfma_f32_32x32x16_bf16 v[224:239], a[128:131], a[108:111], v[224:239]
    s_waitcnt lgkmcnt(8)
    v_mfma_f32_32x32x16_bf16 v[240:255], a[132:135], a[104:107], v[240:255]
    ds_read_b64_tr_b16 a[152:153], v12 offset:57344
    ds_read_b64_tr_b16 a[154:155], v12 offset:58368
    s_waitcnt lgkmcnt(8)
    v_mfma_f32_32x32x16_bf16 v[48:63], a[136:139], a[112:115], v[48:63]
    buffer_load_dwordx4 a[72:75], v2, s[8:11], s30 offen offset:1024 sc1
    v_mfma_f32_32x32x16_bf16 v[64:79], a[136:139], a[116:119], v[64:79]
    ds_read_b64_tr_b16 a[156:157], v13 offset:57344
    ds_read_b64_tr_b16 a[158:159], v13 offset:58368
    s_waitcnt lgkmcnt(8)
    v_mfma_f32_32x32x16_bf16 v[80:95], a[140:143], a[112:115], v[80:95]
    v_mfma_f32_32x32x16_bf16 v[96:111], a[140:143], a[116:119], v[96:111]
    ds_read_b64_tr_b16 a[128:129], v14 offset:57344
    ds_read_b64_tr_b16 a[130:131], v14 offset:58368
    buffer_load_dwordx4 a[76:79], v2, s[8:11], s31 offen offset:1024 sc1
    s_waitcnt lgkmcnt(8)
    v_mfma_f32_32x32x16_bf16 v[112:127], a[112:115], a[144:147], v[112:127]
    ds_read_b64_tr_b16 a[132:133], v10 offset:46080
    ds_read_b64_tr_b16 a[134:135], v10 offset:46848
    v_mfma_f32_32x32x16_bf16 v[128:143], a[116:119], a[144:147], v[128:143]
    s_waitcnt lgkmcnt(8)
    v_mfma_f32_32x32x16_bf16 v[144:159], a[148:151], a[112:115], v[144:159]
    ds_read_b64_tr_b16 a[136:137], v10 offset:46144
    ds_read_b64_tr_b16 a[138:139], v10 offset:46912
    buffer_load_dwordx4 a[80:83], v2, s[8:11], s30 offen offset:2048 sc1
    v_mfma_f32_32x32x16_bf16 v[160:175], a[148:151], a[116:119], v[160:175]
    s_waitcnt lgkmcnt(8)
    v_mfma_f32_32x32x16_bf16 v[176:191], a[152:155], a[112:115], v[176:191]
    ds_read_b64_tr_b16 a[140:141], v10 offset:46208
    ds_read_b64_tr_b16 a[142:143], v10 offset:46976
    v_mfma_f32_32x32x16_bf16 v[192:207], a[152:155], a[116:119], v[192:207]
    buffer_load_dwordx4 a[84:87], v2, s[8:11], s31 offen offset:2048 sc1
    s_waitcnt lgkmcnt(8)
    v_mfma_f32_32x32x16_bf16 v[208:223], a[156:159], a[112:115], v[208:223]
    ds_read_b64_tr_b16 a[144:145], v11 offset:61440
    ds_read_b64_tr_b16 a[146:147], v11 offset:62464
    v_mfma_f32_32x32x16_bf16 v[224:239], a[156:159], a[116:119], v[224:239]
    s_waitcnt lgkmcnt(8)
    v_mfma_f32_32x32x16_bf16 v[240:255], a[128:131], a[112:115], v[240:255]
    ds_read_b64_tr_b16 a[148:149], v12 offset:61440
    ds_read_b64_tr_b16 a[150:151], v12 offset:62464
    buffer_load_dwordx4 a[88:91], v2, s[8:11], s30 offen offset:3072 sc1
    s_waitcnt lgkmcnt(8)
    v_mfma_f32_32x32x16_bf16 v[48:63], a[132:135], a[120:123], v[48:63]
    v_mfma_f32_32x32x16_bf16 v[64:79], a[132:135], a[124:127], v[64:79]
    ds_read_b64_tr_b16 a[152:153], v13 offset:61440
    ds_read_b64_tr_b16 a[154:155], v13 offset:62464
    s_waitcnt lgkmcnt(8)
    v_mfma_f32_32x32x16_bf16 v[80:95], a[136:139], a[120:123], v[80:95]
    buffer_load_dwordx4 a[92:95], v2, s[8:11], s31 offen offset:3072 sc1
    s_add_u32 s30, s30, 4096
    s_add_u32 s31, s31, 4096
    v_mfma_f32_32x32x16_bf16 v[96:111], a[136:139], a[124:127], v[96:111]
    ds_read_b64_tr_b16 a[156:157], v14 offset:61440
    ds_read_b64_tr_b16 a[158:159], v14 offset:62464
    s_waitcnt lgkmcnt(8)
    v_mfma_f32_32x32x16_bf16 v[112:127], a[120:123], a[140:143], v[112:127]
    v_mfma_f32_32x32x16_bf16 v[128:143], a[124:127], a[140:143], v[128:143]
    s_waitcnt lgkmcnt(6)
    v_mfma_f32_32x32x16_bf16 v[144:159], a[144:147], a[120:123], v[144:159]
    s_waitcnt vmcnt(30) lgkmcnt(0)
    s_barrier
    ds_read_b64_tr_b16 a[128:129], v10 offset:0
    ds_read_b64_tr_b16 a[130:131], v10 offset:768
    ds_read_b64_tr_b16 a[132:133], v10 offset:64
    ds_read_b64_tr_b16 a[134:135], v10 offset:832
    v_mfma_f32_32x32x16_bf16 v[160:175], a[144:147], a[124:127], v[160:175]
    v_mfma_f32_32x32x16_bf16 v[176:191], a[148:151], a[120:123], v[176:191]
    ds_read_b64_tr_b16 a[136:137], v10 offset:128
    ds_read_b64_tr_b16 a[138:139], v10 offset:896
    v_mfma_f32_32x32x16_bf16 v[192:207], a[148:151], a[124:127], v[192:207]
    v_mfma_f32_32x32x16_bf16 v[208:223], a[152:155], a[120:123], v[208:223]
    ds_read_b64_tr_b16 a[140:141], v11 offset:0
    ds_read_b64_tr_b16 a[142:143], v11 offset:1024
    v_mfma_f32_32x32x16_bf16 v[224:239], a[152:155], a[124:127], v[224:239]
    v_mfma_f32_32x32x16_bf16 v[240:255], a[156:159], a[120:123], v[240:255]
    ds_read_b64_tr_b16 a[144:145], v12 offset:0
    ds_read_b64_tr_b16 a[146:147], v12 offset:1024
    s_add_u32 m0, s34, 36864
    s_nop 0
    buffer_load_dwordx4 v3, s[12:15], s32 offen offset:0 lds
    s_waitcnt lgkmcnt(8)
    v_mfma_f32_32x32x16_bf16 v[48:63], a[128:131], a[0:3], v[48:63]
    v_mfma_f32_32x32x16_bf16 v[64:79], a[128:131], a[4:7], v[64:79]
    ds_read_b64_tr_b16 a[148:149], v13 offset:0
    ds_read_b64_tr_b16 a[150:151], v13 offset:1024
    s_waitcnt lgkmcnt(8)
    v_mfma_f32_32x32x16_bf16 v[80:95], a[132:135], a[0:3], v[80:95]
    buffer_load_dwordx4 v4, s[12:15], s32 offen offset:1024 lds
    v_mfma_f32_32x32x16_bf16 v[96:111], a[132:135], a[4:7], v[96:111]
    ds_read_b64_tr_b16 a[152:153], v14 offset:0
    ds_read_b64_tr_b16 a[154:155], v14 offset:1024
    s_waitcnt lgkmcnt(8)
    v_mfma_f32_32x32x16_bf16 v[112:127], a[0:3], a[136:139], v[112:127]
    ds_read_b64_tr_b16 a[156:157], v10 offset:3072
    ds_read_b64_tr_b16 a[158:159], v10 offset:3840
    v_mfma_f32_32x32x16_bf16 v[128:143], a[4:7], a[136:139], v[128:143]
    buffer_load_dwordx4 v5, s[12:15], s32 offen offset:2048 lds
    s_waitcnt lgkmcnt(8)
    v_mfma_f32_32x32x16_bf16 v[144:159], a[140:143], a[0:3], v[144:159]
    ds_read_b64_tr_b16 a[128:129], v10 offset:3136
    ds_read_b64_tr_b16 a[130:131], v10 offset:3904
    v_mfma_f32_32x32x16_bf16 v[160:175], a[140:143], a[4:7], v[160:175]
    s_waitcnt lgkmcnt(8)
    v_mfma_f32_32x32x16_bf16 v[176:191], a[144:147], a[0:3], v[176:191]
    ds_read_b64_tr_b16 a[132:133], v10 offset:3200
    ds_read_b64_tr_b16 a[134:135], v10 offset:3968
    s_add_u32 m0, s35, 49152
    s_nop 0
    buffer_load_dwordx4 v6, s[16:19], s33 offen offset:0 lds
    v_mfma_f32_32x32x16_bf16 v[192:207], a[144:147], a[4:7], v[192:207]
    s_waitcnt lgkmcnt(8)
    v_mfma_f32_32x32x16_bf16 v[208:223], a[148:151], a[0:3], v[208:223]
    ds_read_b64_tr_b16 a[136:137], v11 offset:4096
    ds_read_b64_tr_b16 a[138:139], v11 offset:5120
    v_mfma_f32_32x32x16_bf16 v[224:239], a[148:151], a[4:7], v[224:239]
    buffer_load_dwordx4 v7, s[16:19], s33 offen offset:1024 lds
    s_waitcnt lgkmcnt(8)
    v_mfma_f32_32x32x16_bf16 v[240:255], a[152:155], a[0:3], v[240:255]
    ds_read_b64_tr_b16 a[140:141], v12 offset:4096
    ds_read_b64_tr_b16 a[142:143], v12 offset:5120
    s_waitcnt lgkmcnt(8)
    v_mfma_f32_32x32x16_bf16 v[48:63], a[156:159], a[8:11], v[48:63]
    v_mfma_f32_32x32x16_bf16 v[64:79], a[156:159], a[12:15], v[64:79]
    ds_read_b64_tr_b16 a[144:145], v13 offset:4096
    ds_read_b64_tr_b16 a[146:147], v13 offset:5120
    buffer_load_dwordx4 v8, s[16:19], s33 offen offset:2048 lds
    s_waitcnt lgkmcnt(8)
    v_mfma_f32_32x32x16_bf16 v[80:95], a[128:131], a[8:11], v[80:95]
    v_mfma_f32_32x32x16_bf16 v[96:111], a[128:131], a[12:15], v[96:111]
    ds_read_b64_tr_b16 a[148:149], v14 offset:4096
    ds_read_b64_tr_b16 a[150:151], v14 offset:5120
    s_waitcnt lgkmcnt(8)
    v_mfma_f32_32x32x16_bf16 v[112:127], a[8:11], a[132:135], v[112:127]
    ds_read_b64_tr_b16 a[152:153], v10 offset:6144
    ds_read_b64_tr_b16 a[154:155], v10 offset:6912
    buffer_load_dwordx4 v9, s[16:19], s33 offen offset:3072 lds
    s_add_u32 s32, s32, 393216
    s_add_u32 s33, s33, 458752
    v_mfma_f32_32x32x16_bf16 v[128:143], a[12:15], a[132:135], v[128:143]
    s_waitcnt lgkmcnt(8)
    v_mfma_f32_32x32x16_bf16 v[144:159], a[136:139], a[8:11], v[144:159]
    ds_read_b64_tr_b16 a[156:157], v10 offset:6208
    ds_read_b64_tr_b16 a[158:159], v10 offset:6976
    v_mfma_f32_32x32x16_bf16 v[160:175], a[136:139], a[12:15], v[160:175]
    buffer_load_dwordx4 a[96:99], v2, s[8:11], s30 offen offset:0 sc1
    s_waitcnt lgkmcnt(8)
    v_mfma_f32_32x32x16_bf16 v[176:191], a[140:143], a[8:11], v[176:191]
    ds_read_b64_tr_b16 a[128:129], v10 offset:6272
    ds_read_b64_tr_b16 a[130:131], v10 offset:7040
    v_mfma_f32_32x32x16_bf16 v[192:207], a[140:143], a[12:15], v[192:207]
    s_waitcnt lgkmcnt(8)
    v_mfma_f32_32x32x16_bf16 v[208:223], a[144:147], a[8:11], v[208:223]
    ds_read_b64_tr_b16 a[132:133], v11 offset:8192
    ds_read_b64_tr_b16 a[134:135], v11 offset:9216
    buffer_load_dwordx4 a[100:103], v2, s[8:11], s31 offen offset:0 sc1
    v_mfma_f32_32x32x16_bf16 v[224:239], a[144:147], a[12:15], v[224:239]
    s_waitcnt lgkmcnt(8)
    v_mfma_f32_32x32x16_bf16 v[240:255], a[148:151], a[8:11], v[240:255]
    ds_read_b64_tr_b16 a[136:137], v12 offset:8192
    ds_read_b64_tr_b16 a[138:139], v12 offset:9216
    s_waitcnt lgkmcnt(8)
    v_mfma_f32_32x32x16_bf16 v[48:63], a[152:155], a[16:19], v[48:63]
    buffer_load_dwordx4 a[104:107], v2, s[8:11], s30 offen offset:1024 sc1
    v_mfma_f32_32x32x16_bf16 v[64:79], a[152:155], a[20:23], v[64:79]
    ds_read_b64_tr_b16 a[140:141], v13 offset:8192
    ds_read_b64_tr_b16 a[142:143], v13 offset:9216
    s_waitcnt lgkmcnt(8)
    v_mfma_f32_32x32x16_bf16 v[80:95], a[156:159], a[16:19], v[80:95]
    v_mfma_f32_32x32x16_bf16 v[96:111], a[156:159], a[20:23], v[96:111]
    ds_read_b64_tr_b16 a[144:145], v14 offset:8192
    ds_read_b64_tr_b16 a[146:147], v14 offset:9216
    buffer_load_dwordx4 a[108:111], v2, s[8:11], s31 offen offset:1024 sc1
    s_waitcnt lgkmcnt(8)
    v_mfma_f32_32x32x16_bf16 v[112:127], a[16:19], a[128:131], v[112:127]
    ds_read_b64_tr_b16 a[148:149], v10 offset:9216
    ds_read_b64_tr_b16 a[150:151], v10 offset:9984
    v_mfma_f32_32x32x16_bf16 v[128:143], a[20:23], a[128:131], v[128:143]
    s_waitcnt lgkmcnt(8)
    v_mfma_f32_32x32x16_bf16 v[144:159], a[132:135], a[16:19], v[144:159]
    ds_read_b64_tr_b16 a[152:153], v10 offset:9280
    ds_read_b64_tr_b16 a[154:155], v10 offset:10048
    buffer_load_dwordx4 a[112:115], v2, s[8:11], s30 offen offset:2048 sc1
    v_mfma_f32_32x32x16_bf16 v[160:175], a[132:135], a[20:23], v[160:175]
    s_waitcnt lgkmcnt(8)
    v_mfma_f32_32x32x16_bf16 v[176:191], a[136:139], a[16:19], v[176:191]
    ds_read_b64_tr_b16 a[156:157], v10 offset:9344
    ds_read_b64_tr_b16 a[158:159], v10 offset:10112
    v_mfma_f32_32x32x16_bf16 v[192:207], a[136:139], a[20:23], v[192:207]
    buffer_load_dwordx4 a[116:119], v2, s[8:11], s31 offen offset:2048 sc1
    s_waitcnt lgkmcnt(8)
    v_mfma_f32_32x32x16_bf16 v[208:223], a[140:143], a[16:19], v[208:223]
    ds_read_b64_tr_b16 a[128:129], v11 offset:12288
    ds_read_b64_tr_b16 a[130:131], v11 offset:13312
    v_mfma_f32_32x32x16_bf16 v[224:239], a[140:143], a[20:23], v[224:239]
    s_waitcnt lgkmcnt(8)
    v_mfma_f32_32x32x16_bf16 v[240:255], a[144:147], a[16:19], v[240:255]
    ds_read_b64_tr_b16 a[132:133], v12 offset:12288
    ds_read_b64_tr_b16 a[134:135], v12 offset:13312
    buffer_load_dwordx4 a[120:123], v2, s[8:11], s30 offen offset:3072 sc1
    s_waitcnt lgkmcnt(8)
    v_mfma_f32_32x32x16_bf16 v[48:63], a[148:151], a[24:27], v[48:63]
    v_mfma_f32_32x32x16_bf16 v[64:79], a[148:151], a[28:31], v[64:79]
    ds_read_b64_tr_b16 a[136:137], v13 offset:12288
    ds_read_b64_tr_b16 a[138:139], v13 offset:13312
    s_waitcnt lgkmcnt(8)
    v_mfma_f32_32x32x16_bf16 v[80:95], a[152:155], a[24:27], v[80:95]
    buffer_load_dwordx4 a[124:127], v2, s[8:11], s31 offen offset:3072 sc1
    s_add_u32 s30, s30, 4096
    s_add_u32 s31, s31, 4096
    v_mfma_f32_32x32x16_bf16 v[96:111], a[152:155], a[28:31], v[96:111]
    ds_read_b64_tr_b16 a[140:141], v14 offset:12288
    ds_read_b64_tr_b16 a[142:143], v14 offset:13312
    s_waitcnt lgkmcnt(8)
    v_mfma_f32_32x32x16_bf16 v[112:127], a[24:27], a[156:159], v[112:127]
    v_mfma_f32_32x32x16_bf16 v[128:143], a[28:31], a[156:159], v[128:143]
    s_waitcnt lgkmcnt(6)
    v_mfma_f32_32x32x16_bf16 v[144:159], a[128:131], a[24:27], v[144:159]
    s_waitcnt vmcnt(30) lgkmcnt(0)
    s_barrier
    ds_read_b64_tr_b16 a[144:145], v10 offset:12288
    ds_read_b64_tr_b16 a[146:147], v10 offset:13056
    ds_read_b64_tr_b16 a[148:149], v10 offset:12352
    ds_read_b64_tr_b16 a[150:151], v10 offset:13120
    v_mfma_f32_32x32x16_bf16 v[160:175], a[128:131], a[28:31], v[160:175]
    v_mfma_f32_32x32x16_bf16 v[176:191], a[132:135], a[24:27], v[176:191]
    ds_read_b64_tr_b16 a[152:153], v10 offset:12416
    ds_read_b64_tr_b16 a[154:155], v10 offset:13184
    v_mfma_f32_32x32x16_bf16 v[192:207], a[132:135], a[28:31], v[192:207]
    v_mfma_f32_32x32x16_bf16 v[208:223], a[136:139], a[24:27], v[208:223]
    ds_read_b64_tr_b16 a[156:157], v11 offset:16384
    ds_read_b64_tr_b16 a[158:159], v11 offset:17408
    v_mfma_f32_32x32x16_bf16 v[224:239], a[136:139], a[28:31], v[224:239]
    v_mfma_f32_32x32x16_bf16 v[240:255], a[140:143], a[24:27], v[240:255]
    ds_read_b64_tr_b16 a[128:129], v12 offset:16384
    ds_read_b64_tr_b16 a[130:131], v12 offset:17408
    s_add_u32 m0, s34, 0
    s_nop 0
    buffer_load_dwordx4 v3, s[12:15], s32 offen offset:0 lds
    s_waitcnt lgkmcnt(8)
    v_mfma_f32_32x32x16_bf16 v[48:63], a[144:147], a[32:35], v[48:63]
    v_mfma_f32_32x32x16_bf16 v[64:79], a[144:147], a[36:39], v[64:79]
    ds_read_b64_tr_b16 a[132:133], v13 offset:16384
    ds_read_b64_tr_b16 a[134:135], v13 offset:17408
    s_waitcnt lgkmcnt(8)
    v_mfma_f32_32x32x16_bf16 v[80:95], a[148:151], a[32:35], v[80:95]
    buffer_load_dwordx4 v4, s[12:15], s32 offen offset:1024 lds
    v_mfma_f32_32x32x16_bf16 v[96:111], a[148:151], a[36:39], v[96:111]
    ds_read_b64_tr_b16 a[136:137], v14 offset:16384
    ds_read_b64_tr_b16 a[138:139], v14 offset:17408
    s_waitcnt lgkmcnt(8)
    v_mfma_f32_32x32x16_bf16 v[112:127], a[32:35], a[152:155], v[112:127]
    ds_read_b64_tr_b16 a[140:141], v10 offset:15360
    ds_read_b64_tr_b16 a[142:143], v10 offset:16128
    v_mfma_f32_32x32x16_bf16 v[128:143], a[36:39], a[152:155], v[128:143]
    buffer_load_dwordx4 v5, s[12:15], s32 offen offset:2048 lds
    s_waitcnt lgkmcnt(8)
    v_mfma_f32_32x32x16_bf16 v[144:159], a[156:159], a[32:35], v[144:159]
    ds_read_b64_tr_b16 a[144:145], v10 offset:15424
    ds_read_b64_tr_b16 a[146:147], v10 offset:16192
    v_mfma_f32_32x32x16_bf16 v[160:175], a[156:159], a[36:39], v[160:175]
    s_waitcnt lgkmcnt(8)
    v_mfma_f32_32x32x16_bf16 v[176:191], a[128:131], a[32:35], v[176:191]
    ds_read_b64_tr_b16 a[148:149], v10 offset:15488
    ds_read_b64_tr_b16 a[150:151], v10 offset:16256
    s_add_u32 m0, s35, 0
    s_nop 0
    buffer_load_dwordx4 v6, s[16:19], s33 offen offset:0 lds
    v_mfma_f32_32x32x16_bf16 v[192:207], a[128:131], a[36:39], v[192:207]
    s_waitcnt lgkmcnt(8)
    v_mfma_f32_32x32x16_bf16 v[208:223], a[132:135], a[32:35], v[208:223]
    ds_read_b64_tr_b16 a[152:153], v11 offset:20480
    ds_read_b64_tr_b16 a[154:155], v11 offset:21504
    v_mfma_f32_32x32x16_bf16 v[224:239], a[132:135], a[36:39], v[224:239]
    buffer_load_dwordx4 v7, s[16:19], s33 offen offset:1024 lds
    s_waitcnt lgkmcnt(8)
    v_mfma_f32_32x32x16_bf16 v[240:255], a[136:139], a[32:35], v[240:255]
    ds_read_b64_tr_b16 a[156:157], v12 offset:20480
    ds_read_b64_tr_b16 a[158:159], v12 offset:21504
    s_waitcnt lgkmcnt(8)
    v_mfma_f32_32x32x16_bf16 v[48:63], a[140:143], a[40:43], v[48:63]
    v_mfma_f32_32x32x16_bf16 v[64:79], a[140:143], a[44:47], v[64:79]
    ds_read_b64_tr_b16 a[128:129], v13 offset:20480
    ds_read_b64_tr_b16 a[130:131], v13 offset:21504
    buffer_load_dwordx4 v8, s[16:19], s33 offen offset:2048 lds
    s_waitcnt lgkmcnt(8)
    v_mfma_f32_32x32x16_bf16 v[80:95], a[144:147], a[40:43], v[80:95]
    v_mfma_f32_32x32x16_bf16 v[96:111], a[144:147], a[44:47], v[96:111]
    ds_read_b64_tr_b16 a[132:133], v14 offset:20480
    ds_read_b64_tr_b16 a[134:135], v14 offset:21504
    s_waitcnt lgkmcnt(8)
    v_mfma_f32_32x32x16_bf16 v[112:127], a[40:43], a[148:151], v[112:127]
    ds_read_b64_tr_b16 a[136:137], v10 offset:18432
    ds_read_b64_tr_b16 a[138:139], v10 offset:19200
    buffer_load_dwordx4 v9, s[16:19], s33 offen offset:3072 lds
    s_add_u32 s32, s32, 393216
    s_add_u32 s33, s33, 458752
    v_mfma_f32_32x32x16_bf16 v[128:143], a[44:47], a[148:151], v[128:143]
    s_waitcnt lgkmcnt(8)
    v_mfma_f32_32x32x16_bf16 v[144:159], a[152:155], a[40:43], v[144:159]
    ds_read_b64_tr_b16 a[140:141], v10 offset:18496
    ds_read_b64_tr_b16 a[142:143], v10 offset:19264
    v_mfma_f32_32x32x16_bf16 v[160:175], a[152:155], a[44:47], v[160:175]
    buffer_load_dwordx4 a[0:3], v2, s[8:11], s30 offen offset:0 sc1
    s_waitcnt lgkmcnt(8)
    v_mfma_f32_32x32x16_bf16 v[176:191], a[156:159], a[40:43], v[176:191]
    ds_read_b64_tr_b16 a[144:145], v10 offset:18560
    ds_read_b64_tr_b16 a[146:147], v10 offset:19328
    v_mfma_f32_32x32x16_bf16 v[192:207], a[156:159], a[44:47], v[192:207]
    s_waitcnt lgkmcnt(8)
    v_mfma_f32_32x32x16_bf16 v[208:223], a[128:131], a[40:43], v[208:223]
    ds_read_b64_tr_b16 a[148:149], v11 offset:24576
    ds_read_b64_tr_b16 a[150:151], v11 offset:25600
    buffer_load_dwordx4 a[4:7], v2, s[8:11], s31 offen offset:0 sc1
    v_mfma_f32_32x32x16_bf16 v[224:239], a[128:131], a[44:47], v[224:239]
    s_waitcnt lgkmcnt(8)
    v_mfma_f32_32x32x16_bf16 v[240:255], a[132:135], a[40:43], v[240:255]
    ds_read_b64_tr_b16 a[152:153], v12 offset:24576
    ds_read_b64_tr_b16 a[154:155], v12 offset:25600
    s_waitcnt lgkmcnt(8)
    v_mfma_f32_32x32x16_bf16 v[48:63], a[136:139], a[48:51], v[48:63]
    buffer_load_dwordx4 a[8:11], v2, s[8:11], s30 offen offset:1024 sc1
    v_mfma_f32_32x32x16_bf16 v[64:79], a[136:139], a[52:55], v[64:79]
    ds_read_b64_tr_b16 a[156:157], v13 offset:24576
    ds_read_b64_tr_b16 a[158:159], v13 offset:25600
    s_waitcnt lgkmcnt(8)
    v_mfma_f32_32x32x16_bf16 v[80:95], a[140:143], a[48:51], v[80:95]
    v_mfma_f32_32x32x16_bf16 v[96:111], a[140:143], a[52:55], v[96:111]
    ds_read_b64_tr_b16 a[128:129], v14 offset:24576
    ds_read_b64_tr_b16 a[130:131], v14 offset:25600
    buffer_load_dwordx4 a[12:15], v2, s[8:11], s31 offen offset:1024 sc1
    s_waitcnt lgkmcnt(8)
    v_mfma_f32_32x32x16_bf16 v[112:127], a[48:51], a[144:147], v[112:127]
    ds_read_b64_tr_b16 a[132:133], v10 offset:21504
    ds_read_b64_tr_b16 a[134:135], v10 offset:22272
    v_mfma_f32_32x32x16_bf16 v[128:143], a[52:55], a[144:147], v[128:143]
    s_waitcnt lgkmcnt(8)
    v_mfma_f32_32x32x16_bf16 v[144:159], a[148:151], a[48:51], v[144:159]
    ds_read_b64_tr_b16 a[136:137], v10 offset:21568
    ds_read_b64_tr_b16 a[138:139], v10 offset:22336
    buffer_load_dwordx4 a[16:19], v2, s[8:11], s30 offen offset:2048 sc1
    v_mfma_f32_32x32x16_bf16 v[160:175], a[148:151], a[52:55], v[160:175]
    s_waitcnt lgkmcnt(8)
    v_mfma_f32_32x32x16_bf16 v[176:191], a[152:155], a[48:51], v[176:191]
    ds_read_b64_tr_b16 a[140:141], v10 offset:21632
    ds_read_b64_tr_b16 a[142:143], v10 offset:22400
    v_mfma_f32_32x32x16_bf16 v[192:207], a[152:155], a[52:55], v[192:207]
    buffer_load_dwordx4 a[20:23], v2, s[8:11], s31 offen offset:2048 sc1
    s_waitcnt lgkmcnt(8)
    v_mfma_f32_32x32x16_bf16 v[208:223], a[156:159], a[48:51], v[208:223]
    ds_read_b64_tr_b16 a[144:145], v11 offset:28672
    ds_read_b64_tr_b16 a[146:147], v11 offset:29696
    v_mfma_f32_32x32x16_bf16 v[224:239], a[156:159], a[52:55], v[224:239]
    s_waitcnt lgkmcnt(8)
    v_mfma_f32_32x32x16_bf16 v[240:255], a[128:131], a[48:51], v[240:255]
    ds_read_b64_tr_b16 a[148:149], v12 offset:28672
    ds_read_b64_tr_b16 a[150:151], v12 offset:29696
    buffer_load_dwordx4 a[24:27], v2, s[8:11], s30 offen offset:3072 sc1
    s_waitcnt lgkmcnt(8)
    v_mfma_f32_32x32x16_bf16 v[48:63], a[132:135], a[56:59], v[48:63]
    v_mfma_f32_32x32x16_bf16 v[64:79], a[132:135], a[60:63], v[64:79]
    ds_read_b64_tr_b16 a[152:153], v13 offset:28672
    ds_read_b64_tr_b16 a[154:155], v13 offset:29696
    s_waitcnt lgkmcnt(8)
    v_mfma_f32_32x32x16_bf16 v[80:95], a[136:139], a[56:59], v[80:95]
    buffer_load_dwordx4 a[28:31], v2, s[8:11], s31 offen offset:3072 sc1
    s_add_u32 s30, s30, 4096
    s_add_u32 s31, s31, 4096
    v_mfma_f32_32x32x16_bf16 v[96:111], a[136:139], a[60:63], v[96:111]
    ds_read_b64_tr_b16 a[156:157], v14 offset:28672
    ds_read_b64_tr_b16 a[158:159], v14 offset:29696
    s_waitcnt lgkmcnt(8)
    v_mfma_f32_32x32x16_bf16 v[112:127], a[56:59], a[140:143], v[112:127]
    v_mfma_f32_32x32x16_bf16 v[128:143], a[60:63], a[140:143], v[128:143]
    s_waitcnt lgkmcnt(6)
    v_mfma_f32_32x32x16_bf16 v[144:159], a[144:147], a[56:59], v[144:159]
    s_waitcnt vmcnt(30) lgkmcnt(0)
    s_barrier
    ds_read_b64_tr_b16 a[128:129], v10 offset:24576
    ds_read_b64_tr_b16 a[130:131], v10 offset:25344
    ds_read_b64_tr_b16 a[132:133], v10 offset:24640
    ds_read_b64_tr_b16 a[134:135], v10 offset:25408
    v_mfma_f32_32x32x16_bf16 v[160:175], a[144:147], a[60:63], v[160:175]
    v_mfma_f32_32x32x16_bf16 v[176:191], a[148:151], a[56:59], v[176:191]
    ds_read_b64_tr_b16 a[136:137], v10 offset:24704
    ds_read_b64_tr_b16 a[138:139], v10 offset:25472
    v_mfma_f32_32x32x16_bf16 v[192:207], a[148:151], a[60:63], v[192:207]
    v_mfma_f32_32x32x16_bf16 v[208:223], a[152:155], a[56:59], v[208:223]
    ds_read_b64_tr_b16 a[140:141], v11 offset:32768
    ds_read_b64_tr_b16 a[142:143], v11 offset:33792
    v_mfma_f32_32x32x16_bf16 v[224:239], a[152:155], a[60:63], v[224:239]
    v_mfma_f32_32x32x16_bf16 v[240:255], a[156:159], a[56:59], v[240:255]
    ds_read_b64_tr_b16 a[144:145], v12 offset:32768
    ds_read_b64_tr_b16 a[146:147], v12 offset:33792
    s_add_u32 m0, s34, 12288
    s_nop 0
    buffer_load_dwordx4 v3, s[12:15], s32 offen offset:0 lds
    s_waitcnt lgkmcnt(8)
    v_mfma_f32_32x32x16_bf16 v[48:63], a[128:131], a[64:67], v[48:63]
    v_mfma_f32_32x32x16_bf16 v[64:79], a[128:131], a[68:71], v[64:79]
    ds_read_b64_tr_b16 a[148:149], v13 offset:32768
    ds_read_b64_tr_b16 a[150:151], v13 offset:33792
    s_waitcnt lgkmcnt(8)
    v_mfma_f32_32x32x16_bf16 v[80:95], a[132:135], a[64:67], v[80:95]
    buffer_load_dwordx4 v4, s[12:15], s32 offen offset:1024 lds
    v_mfma_f32_32x32x16_bf16 v[96:111], a[132:135], a[68:71], v[96:111]
    ds_read_b64_tr_b16 a[152:153], v14 offset:32768
    ds_read_b64_tr_b16 a[154:155], v14 offset:33792
    s_waitcnt lgkmcnt(8)
    v_mfma_f32_32x32x16_bf16 v[112:127], a[64:67], a[136:139], v[112:127]
    ds_read_b64_tr_b16 a[156:157], v10 offset:27648
    ds_read_b64_tr_b16 a[158:159], v10 offset:28416
    v_mfma_f32_32x32x16_bf16 v[128:143], a[68:71], a[136:139], v[128:143]
    buffer_load_dwordx4 v5, s[12:15], s32 offen offset:2048 lds
    s_waitcnt lgkmcnt(8)
    v_mfma_f32_32x32x16_bf16 v[144:159], a[140:143], a[64:67], v[144:159]
    ds_read_b64_tr_b16 a[128:129], v10 offset:27712
    ds_read_b64_tr_b16 a[130:131], v10 offset:28480
    v_mfma_f32_32x32x16_bf16 v[160:175], a[140:143], a[68:71], v[160:175]
    s_waitcnt lgkmcnt(8)
    v_mfma_f32_32x32x16_bf16 v[176:191], a[144:147], a[64:67], v[176:191]
    ds_read_b64_tr_b16 a[132:133], v10 offset:27776
    ds_read_b64_tr_b16 a[134:135], v10 offset:28544
    s_add_u32 m0, s35, 16384
    s_nop 0
    buffer_load_dwordx4 v6, s[16:19], s33 offen offset:0 lds
    v_mfma_f32_32x32x16_bf16 v[192:207], a[144:147], a[68:71], v[192:207]
    s_waitcnt lgkmcnt(8)
    v_mfma_f32_32x32x16_bf16 v[208:223], a[148:151], a[64:67], v[208:223]
    ds_read_b64_tr_b16 a[136:137], v11 offset:36864
    ds_read_b64_tr_b16 a[138:139], v11 offset:37888
    v_mfma_f32_32x32x16_bf16 v[224:239], a[148:151], a[68:71], v[224:239]
    buffer_load_dwordx4 v7, s[16:19], s33 offen offset:1024 lds
    s_waitcnt lgkmcnt(8)
    v_mfma_f32_32x32x16_bf16 v[240:255], a[152:155], a[64:67], v[240:255]
    ds_read_b64_tr_b16 a[140:141], v12 offset:36864
    ds_read_b64_tr_b16 a[142:143], v12 offset:37888
    s_waitcnt lgkmcnt(8)
    v_mfma_f32_32x32x16_bf16 v[48:63], a[156:159], a[72:75], v[48:63]
    v_mfma_f32_32x32x16_bf16 v[64:79], a[156:159], a[76:79], v[64:79]
    ds_read_b64_tr_b16 a[144:145], v13 offset:36864
    ds_read_b64_tr_b16 a[146:147], v13 offset:37888
    buffer_load_dwordx4 v8, s[16:19], s33 offen offset:2048 lds
    s_waitcnt lgkmcnt(8)
    v_mfma_f32_32x32x16_bf16 v[80:95], a[128:131], a[72:75], v[80:95]
    v_mfma_f32_32x32x16_bf16 v[96:111], a[128:131], a[76:79], v[96:111]
    ds_read_b64_tr_b16 a[148:149], v14 offset:36864
    ds_read_b64_tr_b16 a[150:151], v14 offset:37888
    s_waitcnt lgkmcnt(8)
    v_mfma_f32_32x32x16_bf16 v[112:127], a[72:75], a[132:135], v[112:127]
    ds_read_b64_tr_b16 a[152:153], v10 offset:30720
    ds_read_b64_tr_b16 a[154:155], v10 offset:31488
    buffer_load_dwordx4 v9, s[16:19], s33 offen offset:3072 lds
    s_add_u32 s32, s32, 393216
    s_add_u32 s33, s33, 458752
    v_mfma_f32_32x32x16_bf16 v[128:143], a[76:79], a[132:135], v[128:143]
    s_waitcnt lgkmcnt(8)
    v_mfma_f32_32x32x16_bf16 v[144:159], a[136:139], a[72:75], v[144:159]
    ds_read_b64_tr_b16 a[156:157], v10 offset:30784
    ds_read_b64_tr_b16 a[158:159], v10 offset:31552
    v_mfma_f32_32x32x16_bf16 v[160:175], a[136:139], a[76:79], v[160:175]
    buffer_load_dwordx4 a[32:35], v2, s[8:11], s30 offen offset:0 sc1
    s_waitcnt lgkmcnt(8)
    v_mfma_f32_32x32x16_bf16 v[176:191], a[140:143], a[72:75], v[176:191]
    ds_read_b64_tr_b16 a[128:129], v10 offset:30848
    ds_read_b64_tr_b16 a[130:131], v10 offset:31616
    v_mfma_f32_32x32x16_bf16 v[192:207], a[140:143], a[76:79], v[192:207]
    s_waitcnt lgkmcnt(8)
    v_mfma_f32_32x32x16_bf16 v[208:223], a[144:147], a[72:75], v[208:223]
    ds_read_b64_tr_b16 a[132:133], v11 offset:40960
    ds_read_b64_tr_b16 a[134:135], v11 offset:41984
    buffer_load_dwordx4 a[36:39], v2, s[8:11], s31 offen offset:0 sc1
    v_mfma_f32_32x32x16_bf16 v[224:239], a[144:147], a[76:79], v[224:239]
    s_waitcnt lgkmcnt(8)
    v_mfma_f32_32x32x16_bf16 v[240:255], a[148:151], a[72:75], v[240:255]
    ds_read_b64_tr_b16 a[136:137], v12 offset:40960
    ds_read_b64_tr_b16 a[138:139], v12 offset:41984
    s_waitcnt lgkmcnt(8)
    v_mfma_f32_32x32x16_bf16 v[48:63], a[152:155], a[80:83], v[48:63]
    buffer_load_dwordx4 a[40:43], v2, s[8:11], s30 offen offset:1024 sc1
    v_mfma_f32_32x32x16_bf16 v[64:79], a[152:155], a[84:87], v[64:79]
    ds_read_b64_tr_b16 a[140:141], v13 offset:40960
    ds_read_b64_tr_b16 a[142:143], v13 offset:41984
    s_waitcnt lgkmcnt(8)
    v_mfma_f32_32x32x16_bf16 v[80:95], a[156:159], a[80:83], v[80:95]
    v_mfma_f32_32x32x16_bf16 v[96:111], a[156:159], a[84:87], v[96:111]
    ds_read_b64_tr_b16 a[144:145], v14 offset:40960
    ds_read_b64_tr_b16 a[146:147], v14 offset:41984
    buffer_load_dwordx4 a[44:47], v2, s[8:11], s31 offen offset:1024 sc1
    s_waitcnt lgkmcnt(8)
    v_mfma_f32_32x32x16_bf16 v[112:127], a[80:83], a[128:131], v[112:127]
    ds_read_b64_tr_b16 a[148:149], v10 offset:33792
    ds_read_b64_tr_b16 a[150:151], v10 offset:34560
    v_mfma_f32_32x32x16_bf16 v[128:143], a[84:87], a[128:131], v[128:143]
    s_waitcnt lgkmcnt(8)
    v_mfma_f32_32x32x16_bf16 v[144:159], a[132:135], a[80:83], v[144:159]
    ds_read_b64_tr_b16 a[152:153], v10 offset:33856
    ds_read_b64_tr_b16 a[154:155], v10 offset:34624
    buffer_load_dwordx4 a[48:51], v2, s[8:11], s30 offen offset:2048 sc1
    v_mfma_f32_32x32x16_bf16 v[160:175], a[132:135], a[84:87], v[160:175]
    s_waitcnt lgkmcnt(8)
    v_mfma_f32_32x32x16_bf16 v[176:191], a[136:139], a[80:83], v[176:191]
    ds_read_b64_tr_b16 a[156:157], v10 offset:33920
    ds_read_b64_tr_b16 a[158:159], v10 offset:34688
    v_mfma_f32_32x32x16_bf16 v[192:207], a[136:139], a[84:87], v[192:207]
    buffer_load_dwordx4 a[52:55], v2, s[8:11], s31 offen offset:2048 sc1
    s_waitcnt lgkmcnt(8)
    v_mfma_f32_32x32x16_bf16 v[208:223], a[140:143], a[80:83], v[208:223]
    ds_read_b64_tr_b16 a[128:129], v11 offset:45056
    ds_read_b64_tr_b16 a[130:131], v11 offset:46080
    v_mfma_f32_32x32x16_bf16 v[224:239], a[140:143], a[84:87], v[224:239]
    s_waitcnt lgkmcnt(8)
    v_mfma_f32_32x32x16_bf16 v[240:255], a[144:147], a[80:83], v[240:255]
    ds_read_b64_tr_b16 a[132:133], v12 offset:45056
    ds_read_b64_tr_b16 a[134:135], v12 offset:46080
    buffer_load_dwordx4 a[56:59], v2, s[8:11], s30 offen offset:3072 sc1
    s_waitcnt lgkmcnt(8)
    v_mfma_f32_32x32x16_bf16 v[48:63], a[148:151], a[88:91], v[48:63]
    v_mfma_f32_32x32x16_bf16 v[64:79], a[148:151], a[92:95], v[64:79]
    ds_read_b64_tr_b16 a[136:137], v13 offset:45056
    ds_read_b64_tr_b16 a[138:139], v13 offset:46080
    s_waitcnt lgkmcnt(8)
    v_mfma_f32_32x32x16_bf16 v[80:95], a[152:155], a[88:91], v[80:95]
    buffer_load_dwordx4 a[60:63], v2, s[8:11], s31 offen offset:3072 sc1
    s_add_u32 s30, s30, 4096
    s_add_u32 s31, s31, 4096
    v_mfma_f32_32x32x16_bf16 v[96:111], a[152:155], a[92:95], v[96:111]
    ds_read_b64_tr_b16 a[140:141], v14 offset:45056
    ds_read_b64_tr_b16 a[142:143], v14 offset:46080
    s_waitcnt lgkmcnt(8)
    v_mfma_f32_32x32x16_bf16 v[112:127], a[88:91], a[156:159], v[112:127]
    v_mfma_f32_32x32x16_bf16 v[128:143], a[92:95], a[156:159], v[128:143]
    s_waitcnt lgkmcnt(6)
    v_mfma_f32_32x32x16_bf16 v[144:159], a[128:131], a[88:91], v[144:159]
    s_waitcnt vmcnt(30) lgkmcnt(0)
    s_barrier
    ds_read_b64_tr_b16 a[144:145], v10 offset:36864
    ds_read_b64_tr_b16 a[146:147], v10 offset:37632
    ds_read_b64_tr_b16 a[148:149], v10 offset:36928
    ds_read_b64_tr_b16 a[150:151], v10 offset:37696
    v_mfma_f32_32x32x16_bf16 v[160:175], a[128:131], a[92:95], v[160:175]
    v_mfma_f32_32x32x16_bf16 v[176:191], a[132:135], a[88:91], v[176:191]
    ds_read_b64_tr_b16 a[152:153], v10 offset:36992
    ds_read_b64_tr_b16 a[154:155], v10 offset:37760
    v_mfma_f32_32x32x16_bf16 v[192:207], a[132:135], a[92:95], v[192:207]
    v_mfma_f32_32x32x16_bf16 v[208:223], a[136:139], a[88:91], v[208:223]
    ds_read_b64_tr_b16 a[156:157], v11 offset:49152
    ds_read_b64_tr_b16 a[158:159], v11 offset:50176
    v_mfma_f32_32x32x16_bf16 v[224:239], a[136:139], a[92:95], v[224:239]
    v_mfma_f32_32x32x16_bf16 v[240:255], a[140:143], a[88:91], v[240:255]
    ds_read_b64_tr_b16 a[128:129], v12 offset:49152
    ds_read_b64_tr_b16 a[130:131], v12 offset:50176
    s_add_u32 m0, s34, 24576
    s_nop 0
    buffer_load_dwordx4 v3, s[12:15], s32 offen offset:0 lds
    s_waitcnt lgkmcnt(8)
    v_mfma_f32_32x32x16_bf16 v[48:63], a[144:147], a[96:99], v[48:63]
    v_mfma_f32_32x32x16_bf16 v[64:79], a[144:147], a[100:103], v[64:79]
    ds_read_b64_tr_b16 a[132:133], v13 offset:49152
    ds_read_b64_tr_b16 a[134:135], v13 offset:50176
    s_waitcnt lgkmcnt(8)
    v_mfma_f32_32x32x16_bf16 v[80:95], a[148:151], a[96:99], v[80:95]
    buffer_load_dwordx4 v4, s[12:15], s32 offen offset:1024 lds
    v_mfma_f32_32x32x16_bf16 v[96:111], a[148:151], a[100:103], v[96:111]
    ds_read_b64_tr_b16 a[136:137], v14 offset:49152
    ds_read_b64_tr_b16 a[138:139], v14 offset:50176
    s_waitcnt lgkmcnt(8)
    v_mfma_f32_32x32x16_bf16 v[112:127], a[96:99], a[152:155], v[112:127]
    ds_read_b64_tr_b16 a[140:141], v10 offset:39936
    ds_read_b64_tr_b16 a[142:143], v10 offset:40704
    v_mfma_f32_32x32x16_bf16 v[128:143], a[100:103], a[152:155], v[128:143]
    buffer_load_dwordx4 v5, s[12:15], s32 offen offset:2048 lds
    s_waitcnt lgkmcnt(8)
    v_mfma_f32_32x32x16_bf16 v[144:159], a[156:159], a[96:99], v[144:159]
    ds_read_b64_tr_b16 a[144:145], v10 offset:40000
    ds_read_b64_tr_b16 a[146:147], v10 offset:40768
    v_mfma_f32_32x32x16_bf16 v[160:175], a[156:159], a[100:103], v[160:175]
    s_waitcnt lgkmcnt(8)
    v_mfma_f32_32x32x16_bf16 v[176:191], a[128:131], a[96:99], v[176:191]
    ds_read_b64_tr_b16 a[148:149], v10 offset:40064
    ds_read_b64_tr_b16 a[150:151], v10 offset:40832
    s_add_u32 m0, s35, 32768
    s_nop 0
    buffer_load_dwordx4 v6, s[16:19], s33 offen offset:0 lds
    v_mfma_f32_32x32x16_bf16 v[192:207], a[128:131], a[100:103], v[192:207]
    s_waitcnt lgkmcnt(8)
    v_mfma_f32_32x32x16_bf16 v[208:223], a[132:135], a[96:99], v[208:223]
    ds_read_b64_tr_b16 a[152:153], v11 offset:53248
    ds_read_b64_tr_b16 a[154:155], v11 offset:54272
    v_mfma_f32_32x32x16_bf16 v[224:239], a[132:135], a[100:103], v[224:239]
    buffer_load_dwordx4 v7, s[16:19], s33 offen offset:1024 lds
    s_waitcnt lgkmcnt(8)
    v_mfma_f32_32x32x16_bf16 v[240:255], a[136:139], a[96:99], v[240:255]
    ds_read_b64_tr_b16 a[156:157], v12 offset:53248
    ds_read_b64_tr_b16 a[158:159], v12 offset:54272
    s_waitcnt lgkmcnt(8)
    v_mfma_f32_32x32x16_bf16 v[48:63], a[140:143], a[104:107], v[48:63]
    v_mfma_f32_32x32x16_bf16 v[64:79], a[140:143], a[108:111], v[64:79]
    ds_read_b64_tr_b16 a[128:129], v13 offset:53248
    ds_read_b64_tr_b16 a[130:131], v13 offset:54272
    buffer_load_dwordx4 v8, s[16:19], s33 offen offset:2048 lds
    s_waitcnt lgkmcnt(8)
    v_mfma_f32_32x32x16_bf16 v[80:95], a[144:147], a[104:107], v[80:95]
    v_mfma_f32_32x32x16_bf16 v[96:111], a[144:147], a[108:111], v[96:111]
    ds_read_b64_tr_b16 a[132:133], v14 offset:53248
    ds_read_b64_tr_b16 a[134:135], v14 offset:54272
    s_waitcnt lgkmcnt(8)
    v_mfma_f32_32x32x16_bf16 v[112:127], a[104:107], a[148:151], v[112:127]
    ds_read_b64_tr_b16 a[136:137], v10 offset:43008
    ds_read_b64_tr_b16 a[138:139], v10 offset:43776
    buffer_load_dwordx4 v9, s[16:19], s33 offen offset:3072 lds
    s_add_u32 s32, s32, 393216
    s_add_u32 s33, s33, 458752
    v_mfma_f32_32x32x16_bf16 v[128:143], a[108:111], a[148:151], v[128:143]
    s_waitcnt lgkmcnt(8)
    v_mfma_f32_32x32x16_bf16 v[144:159], a[152:155], a[104:107], v[144:159]
    ds_read_b64_tr_b16 a[140:141], v10 offset:43072
    ds_read_b64_tr_b16 a[142:143], v10 offset:43840
    v_mfma_f32_32x32x16_bf16 v[160:175], a[152:155], a[108:111], v[160:175]
    buffer_load_dwordx4 a[64:67], v2, s[8:11], s30 offen offset:0 sc1
    s_waitcnt lgkmcnt(8)
    v_mfma_f32_32x32x16_bf16 v[176:191], a[156:159], a[104:107], v[176:191]
    ds_read_b64_tr_b16 a[144:145], v10 offset:43136
    ds_read_b64_tr_b16 a[146:147], v10 offset:43904
    v_mfma_f32_32x32x16_bf16 v[192:207], a[156:159], a[108:111], v[192:207]
    s_waitcnt lgkmcnt(8)
    v_mfma_f32_32x32x16_bf16 v[208:223], a[128:131], a[104:107], v[208:223]
    ds_read_b64_tr_b16 a[148:149], v11 offset:57344
    ds_read_b64_tr_b16 a[150:151], v11 offset:58368
    buffer_load_dwordx4 a[68:71], v2, s[8:11], s31 offen offset:0 sc1
    v_mfma_f32_32x32x16_bf16 v[224:239], a[128:131], a[108:111], v[224:239]
    s_waitcnt lgkmcnt(8)
    v_mfma_f32_32x32x16_bf16 v[240:255], a[132:135], a[104:107], v[240:255]
    ds_read_b64_tr_b16 a[152:153], v12 offset:57344
    ds_read_b64_tr_b16 a[154:155], v12 offset:58368
    s_waitcnt lgkmcnt(8)
    v_mfma_f32_32x32x16_bf16 v[48:63], a[136:139], a[112:115], v[48:63]
    buffer_load_dwordx4 a[72:75], v2, s[8:11], s30 offen offset:1024 sc1
    v_mfma_f32_32x32x16_bf16 v[64:79], a[136:139], a[116:119], v[64:79]
    ds_read_b64_tr_b16 a[156:157], v13 offset:57344
    ds_read_b64_tr_b16 a[158:159], v13 offset:58368
    s_waitcnt lgkmcnt(8)
    v_mfma_f32_32x32x16_bf16 v[80:95], a[140:143], a[112:115], v[80:95]
    v_mfma_f32_32x32x16_bf16 v[96:111], a[140:143], a[116:119], v[96:111]
    ds_read_b64_tr_b16 a[128:129], v14 offset:57344
    ds_read_b64_tr_b16 a[130:131], v14 offset:58368
    buffer_load_dwordx4 a[76:79], v2, s[8:11], s31 offen offset:1024 sc1
    s_waitcnt lgkmcnt(8)
    v_mfma_f32_32x32x16_bf16 v[112:127], a[112:115], a[144:147], v[112:127]
    ds_read_b64_tr_b16 a[132:133], v10 offset:46080
    ds_read_b64_tr_b16 a[134:135], v10 offset:46848
    v_mfma_f32_32x32x16_bf16 v[128:143], a[116:119], a[144:147], v[128:143]
    s_waitcnt lgkmcnt(8)
    v_mfma_f32_32x32x16_bf16 v[144:159], a[148:151], a[112:115], v[144:159]
    ds_read_b64_tr_b16 a[136:137], v10 offset:46144
    ds_read_b64_tr_b16 a[138:139], v10 offset:46912
    buffer_load_dwordx4 a[80:83], v2, s[8:11], s30 offen offset:2048 sc1
    v_mfma_f32_32x32x16_bf16 v[160:175], a[148:151], a[116:119], v[160:175]
    s_waitcnt lgkmcnt(8)
    v_mfma_f32_32x32x16_bf16 v[176:191], a[152:155], a[112:115], v[176:191]
    ds_read_b64_tr_b16 a[140:141], v10 offset:46208
    ds_read_b64_tr_b16 a[142:143], v10 offset:46976
    v_mfma_f32_32x32x16_bf16 v[192:207], a[152:155], a[116:119], v[192:207]
    buffer_load_dwordx4 a[84:87], v2, s[8:11], s31 offen offset:2048 sc1
    s_waitcnt lgkmcnt(8)
    v_mfma_f32_32x32x16_bf16 v[208:223], a[156:159], a[112:115], v[208:223]
    ds_read_b64_tr_b16 a[144:145], v11 offset:61440
    ds_read_b64_tr_b16 a[146:147], v11 offset:62464
    v_mfma_f32_32x32x16_bf16 v[224:239], a[156:159], a[116:119], v[224:239]
    s_waitcnt lgkmcnt(8)
    v_mfma_f32_32x32x16_bf16 v[240:255], a[128:131], a[112:115], v[240:255]
    ds_read_b64_tr_b16 a[148:149], v12 offset:61440
    ds_read_b64_tr_b16 a[150:151], v12 offset:62464
    buffer_load_dwordx4 a[88:91], v2, s[8:11], s30 offen offset:3072 sc1
    s_waitcnt lgkmcnt(8)
    v_mfma_f32_32x32x16_bf16 v[48:63], a[132:135], a[120:123], v[48:63]
    v_mfma_f32_32x32x16_bf16 v[64:79], a[132:135], a[124:127], v[64:79]
    ds_read_b64_tr_b16 a[152:153], v13 offset:61440
    ds_read_b64_tr_b16 a[154:155], v13 offset:62464
    s_waitcnt lgkmcnt(8)
    v_mfma_f32_32x32x16_bf16 v[80:95], a[136:139], a[120:123], v[80:95]
    buffer_load_dwordx4 a[92:95], v2, s[8:11], s31 offen offset:3072 sc1
    s_add_u32 s30, s30, 4096
    s_add_u32 s31, s31, 4096
    v_mfma_f32_32x32x16_bf16 v[96:111], a[136:139], a[124:127], v[96:111]
    ds_read_b64_tr_b16 a[156:157], v14 offset:61440
    ds_read_b64_tr_b16 a[158:159], v14 offset:62464
    s_waitcnt lgkmcnt(8)
    v_mfma_f32_32x32x16_bf16 v[112:127], a[120:123], a[140:143], v[112:127]
    v_mfma_f32_32x32x16_bf16 v[128:143], a[124:127], a[140:143], v[128:143]
    s_waitcnt lgkmcnt(6)
    v_mfma_f32_32x32x16_bf16 v[144:159], a[144:147], a[120:123], v[144:159]
    s_waitcnt vmcnt(30) lgkmcnt(0)
    s_barrier
    ds_read_b64_tr_b16 a[128:129], v10 offset:0
    ds_read_b64_tr_b16 a[130:131], v10 offset:768
    ds_read_b64_tr_b16 a[132:133], v10 offset:64
    ds_read_b64_tr_b16 a[134:135], v10 offset:832
    v_mfma_f32_32x32x16_bf16 v[160:175], a[144:147], a[124:127], v[160:175]
    v_mfma_f32_32x32x16_bf16 v[176:191], a[148:151], a[120:123], v[176:191]
    ds_read_b64_tr_b16 a[136:137], v10 offset:128
    ds_read_b64_tr_b16 a[138:139], v10 offset:896
    v_mfma_f32_32x32x16_bf16 v[192:207], a[148:151], a[124:127], v[192:207]
    v_mfma_f32_32x32x16_bf16 v[208:223], a[152:155], a[120:123], v[208:223]
    ds_read_b64_tr_b16 a[140:141], v11 offset:0
    ds_read_b64_tr_b16 a[142:143], v11 offset:1024
    v_mfma_f32_32x32x16_bf16 v[224:239], a[152:155], a[124:127], v[224:239]
    v_mfma_f32_32x32x16_bf16 v[240:255], a[156:159], a[120:123], v[240:255]
    ds_read_b64_tr_b16 a[144:145], v12 offset:0
    ds_read_b64_tr_b16 a[146:147], v12 offset:1024
    s_add_u32 m0, s34, 36864
    s_nop 0
    buffer_load_dwordx4 v3, s[12:15], s32 offen offset:0 lds
    s_waitcnt lgkmcnt(8)
    v_mfma_f32_32x32x16_bf16 v[48:63], a[128:131], a[0:3], v[48:63]
    v_mfma_f32_32x32x16_bf16 v[64:79], a[128:131], a[4:7], v[64:79]
    ds_read_b64_tr_b16 a[148:149], v13 offset:0
    ds_read_b64_tr_b16 a[150:151], v13 offset:1024
    s_waitcnt lgkmcnt(8)
    v_mfma_f32_32x32x16_bf16 v[80:95], a[132:135], a[0:3], v[80:95]
    buffer_load_dwordx4 v4, s[12:15], s32 offen offset:1024 lds
    v_mfma_f32_32x32x16_bf16 v[96:111], a[132:135], a[4:7], v[96:111]
    ds_read_b64_tr_b16 a[152:153], v14 offset:0
    ds_read_b64_tr_b16 a[154:155], v14 offset:1024
    s_waitcnt lgkmcnt(8)
    v_mfma_f32_32x32x16_bf16 v[112:127], a[0:3], a[136:139], v[112:127]
    ds_read_b64_tr_b16 a[156:157], v10 offset:3072
    ds_read_b64_tr_b16 a[158:159], v10 offset:3840
    v_mfma_f32_32x32x16_bf16 v[128:143], a[4:7], a[136:139], v[128:143]
    buffer_load_dwordx4 v5, s[12:15], s32 offen offset:2048 lds
    s_waitcnt lgkmcnt(8)
    v_mfma_f32_32x32x16_bf16 v[144:159], a[140:143], a[0:3], v[144:159]
    ds_read_b64_tr_b16 a[128:129], v10 offset:3136
    ds_read_b64_tr_b16 a[130:131], v10 offset:3904
    v_mfma_f32_32x32x16_bf16 v[160:175], a[140:143], a[4:7], v[160:175]
    s_waitcnt lgkmcnt(8)
    v_mfma_f32_32x32x16_bf16 v[176:191], a[144:147], a[0:3], v[176:191]
    ds_read_b64_tr_b16 a[132:133], v10 offset:3200
    ds_read_b64_tr_b16 a[134:135], v10 offset:3968
    s_add_u32 m0, s35, 49152
    s_nop 0
    buffer_load_dwordx4 v6, s[16:19], s33 offen offset:0 lds
    v_mfma_f32_32x32x16_bf16 v[192:207], a[144:147], a[4:7], v[192:207]
    s_waitcnt lgkmcnt(8)
    v_mfma_f32_32x32x16_bf16 v[208:223], a[148:151], a[0:3], v[208:223]
    ds_read_b64_tr_b16 a[136:137], v11 offset:4096
    ds_read_b64_tr_b16 a[138:139], v11 offset:5120
    v_mfma_f32_32x32x16_bf16 v[224:239], a[148:151], a[4:7], v[224:239]
    buffer_load_dwordx4 v7, s[16:19], s33 offen offset:1024 lds
    s_waitcnt lgkmcnt(8)
    v_mfma_f32_32x32x16_bf16 v[240:255], a[152:155], a[0:3], v[240:255]
    ds_read_b64_tr_b16 a[140:141], v12 offset:4096
    ds_read_b64_tr_b16 a[142:143], v12 offset:5120
    s_waitcnt lgkmcnt(8)
    v_mfma_f32_32x32x16_bf16 v[48:63], a[156:159], a[8:11], v[48:63]
    v_mfma_f32_32x32x16_bf16 v[64:79], a[156:159], a[12:15], v[64:79]
    ds_read_b64_tr_b16 a[144:145], v13 offset:4096
    ds_read_b64_tr_b16 a[146:147], v13 offset:5120
    buffer_load_dwordx4 v8, s[16:19], s33 offen offset:2048 lds
    s_waitcnt lgkmcnt(8)
    v_mfma_f32_32x32x16_bf16 v[80:95], a[128:131], a[8:11], v[80:95]
    v_mfma_f32_32x32x16_bf16 v[96:111], a[128:131], a[12:15], v[96:111]
    ds_read_b64_tr_b16 a[148:149], v14 offset:4096
    ds_read_b64_tr_b16 a[150:151], v14 offset:5120
    s_waitcnt lgkmcnt(8)
    v_mfma_f32_32x32x16_bf16 v[112:127], a[8:11], a[132:135], v[112:127]
    ds_read_b64_tr_b16 a[152:153], v10 offset:6144
    ds_read_b64_tr_b16 a[154:155], v10 offset:6912
    buffer_load_dwordx4 v9, s[16:19], s33 offen offset:3072 lds
    s_add_u32 s32, s32, 393216
    s_add_u32 s33, s33, 458752
    v_mfma_f32_32x32x16_bf16 v[128:143], a[12:15], a[132:135], v[128:143]
    s_waitcnt lgkmcnt(8)
    v_mfma_f32_32x32x16_bf16 v[144:159], a[136:139], a[8:11], v[144:159]
    ds_read_b64_tr_b16 a[156:157], v10 offset:6208
    ds_read_b64_tr_b16 a[158:159], v10 offset:6976
    v_mfma_f32_32x32x16_bf16 v[160:175], a[136:139], a[12:15], v[160:175]
    buffer_load_dwordx4 a[96:99], v2, s[8:11], s30 offen offset:0 sc1
    s_waitcnt lgkmcnt(8)
    v_mfma_f32_32x32x16_bf16 v[176:191], a[140:143], a[8:11], v[176:191]
    ds_read_b64_tr_b16 a[128:129], v10 offset:6272
    ds_read_b64_tr_b16 a[130:131], v10 offset:7040
    v_mfma_f32_32x32x16_bf16 v[192:207], a[140:143], a[12:15], v[192:207]
    s_waitcnt lgkmcnt(8)
    v_mfma_f32_32x32x16_bf16 v[208:223], a[144:147], a[8:11], v[208:223]
    ds_read_b64_tr_b16 a[132:133], v11 offset:8192
    ds_read_b64_tr_b16 a[134:135], v11 offset:9216
    buffer_load_dwordx4 a[100:103], v2, s[8:11], s31 offen offset:0 sc1
    v_mfma_f32_32x32x16_bf16 v[224:239], a[144:147], a[12:15], v[224:239]
    s_waitcnt lgkmcnt(8)
    v_mfma_f32_32x32x16_bf16 v[240:255], a[148:151], a[8:11], v[240:255]
    ds_read_b64_tr_b16 a[136:137], v12 offset:8192
    ds_read_b64_tr_b16 a[138:139], v12 offset:9216
    s_waitcnt lgkmcnt(8)
    v_mfma_f32_32x32x16_bf16 v[48:63], a[152:155], a[16:19], v[48:63]
    buffer_load_dwordx4 a[104:107], v2, s[8:11], s30 offen offset:1024 sc1
    v_mfma_f32_32x32x16_bf16 v[64:79], a[152:155], a[20:23], v[64:79]
    ds_read_b64_tr_b16 a[140:141], v13 offset:8192
    ds_read_b64_tr_b16 a[142:143], v13 offset:9216
    s_waitcnt lgkmcnt(8)
    v_mfma_f32_32x32x16_bf16 v[80:95], a[156:159], a[16:19], v[80:95]
    v_mfma_f32_32x32x16_bf16 v[96:111], a[156:159], a[20:23], v[96:111]
    ds_read_b64_tr_b16 a[144:145], v14 offset:8192
    ds_read_b64_tr_b16 a[146:147], v14 offset:9216
    buffer_load_dwordx4 a[108:111], v2, s[8:11], s31 offen offset:1024 sc1
    s_waitcnt lgkmcnt(8)
    v_mfma_f32_32x32x16_bf16 v[112:127], a[16:19], a[128:131], v[112:127]
    ds_read_b64_tr_b16 a[148:149], v10 offset:9216
    ds_read_b64_tr_b16 a[150:151], v10 offset:9984
    v_mfma_f32_32x32x16_bf16 v[128:143], a[20:23], a[128:131], v[128:143]
    s_waitcnt lgkmcnt(8)
    v_mfma_f32_32x32x16_bf16 v[144:159], a[132:135], a[16:19], v[144:159]
    ds_read_b64_tr_b16 a[152:153], v10 offset:9280
    ds_read_b64_tr_b16 a[154:155], v10 offset:10048
    buffer_load_dwordx4 a[112:115], v2, s[8:11], s30 offen offset:2048 sc1
    v_mfma_f32_32x32x16_bf16 v[160:175], a[132:135], a[20:23], v[160:175]
    s_waitcnt lgkmcnt(8)
    v_mfma_f32_32x32x16_bf16 v[176:191], a[136:139], a[16:19], v[176:191]
    ds_read_b64_tr_b16 a[156:157], v10 offset:9344
    ds_read_b64_tr_b16 a[158:159], v10 offset:10112
    v_mfma_f32_32x32x16_bf16 v[192:207], a[136:139], a[20:23], v[192:207]
    buffer_load_dwordx4 a[116:119], v2, s[8:11], s31 offen offset:2048 sc1
    s_waitcnt lgkmcnt(8)
    v_mfma_f32_32x32x16_bf16 v[208:223], a[140:143], a[16:19], v[208:223]
    ds_read_b64_tr_b16 a[128:129], v11 offset:12288
    ds_read_b64_tr_b16 a[130:131], v11 offset:13312
    v_mfma_f32_32x32x16_bf16 v[224:239], a[140:143], a[20:23], v[224:239]
    s_waitcnt lgkmcnt(8)
    v_mfma_f32_32x32x16_bf16 v[240:255], a[144:147], a[16:19], v[240:255]
    ds_read_b64_tr_b16 a[132:133], v12 offset:12288
    ds_read_b64_tr_b16 a[134:135], v12 offset:13312
    buffer_load_dwordx4 a[120:123], v2, s[8:11], s30 offen offset:3072 sc1
    s_waitcnt lgkmcnt(8)
    v_mfma_f32_32x32x16_bf16 v[48:63], a[148:151], a[24:27], v[48:63]
    v_mfma_f32_32x32x16_bf16 v[64:79], a[148:151], a[28:31], v[64:79]
    ds_read_b64_tr_b16 a[136:137], v13 offset:12288
    ds_read_b64_tr_b16 a[138:139], v13 offset:13312
    s_waitcnt lgkmcnt(8)
    v_mfma_f32_32x32x16_bf16 v[80:95], a[152:155], a[24:27], v[80:95]
    buffer_load_dwordx4 a[124:127], v2, s[8:11], s31 offen offset:3072 sc1
    s_add_u32 s30, s30, 4096
    s_add_u32 s31, s31, 4096
    v_mfma_f32_32x32x16_bf16 v[96:111], a[152:155], a[28:31], v[96:111]
    ds_read_b64_tr_b16 a[140:141], v14 offset:12288
    ds_read_b64_tr_b16 a[142:143], v14 offset:13312
    s_waitcnt lgkmcnt(8)
    v_mfma_f32_32x32x16_bf16 v[112:127], a[24:27], a[156:159], v[112:127]
    v_mfma_f32_32x32x16_bf16 v[128:143], a[28:31], a[156:159], v[128:143]
    s_waitcnt lgkmcnt(6)
    v_mfma_f32_32x32x16_bf16 v[144:159], a[128:131], a[24:27], v[144:159]
    s_waitcnt vmcnt(30) lgkmcnt(0)
    s_barrier
    ds_read_b64_tr_b16 a[144:145], v10 offset:12288
    ds_read_b64_tr_b16 a[146:147], v10 offset:13056
    ds_read_b64_tr_b16 a[148:149], v10 offset:12352
    ds_read_b64_tr_b16 a[150:151], v10 offset:13120
    v_mfma_f32_32x32x16_bf16 v[160:175], a[128:131], a[28:31], v[160:175]
    v_mfma_f32_32x32x16_bf16 v[176:191], a[132:135], a[24:27], v[176:191]
    ds_read_b64_tr_b16 a[152:153], v10 offset:12416
    ds_read_b64_tr_b16 a[154:155], v10 offset:13184
    v_mfma_f32_32x32x16_bf16 v[192:207], a[132:135], a[28:31], v[192:207]
    v_mfma_f32_32x32x16_bf16 v[208:223], a[136:139], a[24:27], v[208:223]
    ds_read_b64_tr_b16 a[156:157], v11 offset:16384
    ds_read_b64_tr_b16 a[158:159], v11 offset:17408
    v_mfma_f32_32x32x16_bf16 v[224:239], a[136:139], a[28:31], v[224:239]
    v_mfma_f32_32x32x16_bf16 v[240:255], a[140:143], a[24:27], v[240:255]
    ds_read_b64_tr_b16 a[128:129], v12 offset:16384
    ds_read_b64_tr_b16 a[130:131], v12 offset:17408
    s_waitcnt lgkmcnt(8)
    v_mfma_f32_32x32x16_bf16 v[48:63], a[144:147], a[32:35], v[48:63]
    v_mfma_f32_32x32x16_bf16 v[64:79], a[144:147], a[36:39], v[64:79]
    ds_read_b64_tr_b16 a[132:133], v13 offset:16384
    ds_read_b64_tr_b16 a[134:135], v13 offset:17408
    s_waitcnt lgkmcnt(8)
    v_mfma_f32_32x32x16_bf16 v[80:95], a[148:151], a[32:35], v[80:95]
    v_mfma_f32_32x32x16_bf16 v[96:111], a[148:151], a[36:39], v[96:111]
    ds_read_b64_tr_b16 a[136:137], v14 offset:16384
    ds_read_b64_tr_b16 a[138:139], v14 offset:17408
    s_waitcnt lgkmcnt(8)
    v_mfma_f32_32x32x16_bf16 v[112:127], a[32:35], a[152:155], v[112:127]
    ds_read_b64_tr_b16 a[140:141], v10 offset:15360
    ds_read_b64_tr_b16 a[142:143], v10 offset:16128
    v_mfma_f32_32x32x16_bf16 v[128:143], a[36:39], a[152:155], v[128:143]
    s_waitcnt lgkmcnt(8)
    v_mfma_f32_32x32x16_bf16 v[144:159], a[156:159], a[32:35], v[144:159]
    ds_read_b64_tr_b16 a[144:145], v10 offset:15424
    ds_read_b64_tr_b16 a[146:147], v10 offset:16192
    v_mfma_f32_32x32x16_bf16 v[160:175], a[156:159], a[36:39], v[160:175]
    s_waitcnt lgkmcnt(8)
    v_mfma_f32_32x32x16_bf16 v[176:191], a[128:131], a[32:35], v[176:191]
    ds_read_b64_tr_b16 a[148:149], v10 offset:15488
    ds_read_b64_tr_b16 a[150:151], v10 offset:16256
    v_mfma_f32_32x32x16_bf16 v[192:207], a[128:131], a[36:39], v[192:207]
    s_waitcnt lgkmcnt(8)
    v_mfma_f32_32x32x16_bf16 v[208:223], a[132:135], a[32:35], v[208:223]
    ds_read_b64_tr_b16 a[152:153], v11 offset:20480
    ds_read_b64_tr_b16 a[154:155], v11 offset:21504
    v_mfma_f32_32x32x16_bf16 v[224:239], a[132:135], a[36:39], v[224:239]
    s_waitcnt lgkmcnt(8)
    v_mfma_f32_32x32x16_bf16 v[240:255], a[136:139], a[32:35], v[240:255]
    ds_read_b64_tr_b16 a[156:157], v12 offset:20480
    ds_read_b64_tr_b16 a[158:159], v12 offset:21504
    s_waitcnt lgkmcnt(8)
    v_mfma_f32_32x32x16_bf16 v[48:63], a[140:143], a[40:43], v[48:63]
    v_mfma_f32_32x32x16_bf16 v[64:79], a[140:143], a[44:47], v[64:79]
    ds_read_b64_tr_b16 a[128:129], v13 offset:20480
    ds_read_b64_tr_b16 a[130:131], v13 offset:21504
    s_waitcnt lgkmcnt(8)
    v_mfma_f32_32x32x16_bf16 v[80:95], a[144:147], a[40:43], v[80:95]
    v_mfma_f32_32x32x16_bf16 v[96:111], a[144:147], a[44:47], v[96:111]
    ds_read_b64_tr_b16 a[132:133], v14 offset:20480
    ds_read_b64_tr_b16 a[134:135], v14 offset:21504
    s_waitcnt lgkmcnt(8)
    v_mfma_f32_32x32x16_bf16 v[112:127], a[40:43], a[148:151], v[112:127]
    ds_read_b64_tr_b16 a[136:137], v10 offset:18432
    ds_read_b64_tr_b16 a[138:139], v10 offset:19200
    v_mfma_f32_32x32x16_bf16 v[128:143], a[44:47], a[148:151], v[128:143]
    s_waitcnt lgkmcnt(8)
    v_mfma_f32_32x32x16_bf16 v[144:159], a[152:155], a[40:43], v[144:159]
    ds_read_b64_tr_b16 a[140:141], v10 offset:18496
    ds_read_b64_tr_b16 a[142:143], v10 offset:19264
    v_mfma_f32_32x32x16_bf16 v[160:175], a[152:155], a[44:47], v[160:175]
    s_waitcnt lgkmcnt(8)
    v_mfma_f32_32x32x16_bf16 v[176:191], a[156:159], a[40:43], v[176:191]
    ds_read_b64_tr_b16 a[144:145], v10 offset:18560
    ds_read_b64_tr_b16 a[146:147], v10 offset:19328
    v_mfma_f32_32x32x16_bf16 v[192:207], a[156:159], a[44:47], v[192:207]
    s_waitcnt lgkmcnt(8)
    v_mfma_f32_32x32x16_bf16 v[208:223], a[128:131], a[40:43], v[208:223]
    ds_read_b64_tr_b16 a[148:149], v11 offset:24576
    ds_read_b64_tr_b16 a[150:151], v11 offset:25600
    v_mfma_f32_32x32x16_bf16 v[224:239], a[128:131], a[44:47], v[224:239]
    s_waitcnt lgkmcnt(8)
    v_mfma_f32_32x32x16_bf16 v[240:255], a[132:135], a[40:43], v[240:255]
    ds_read_b64_tr_b16 a[152:153], v12 offset:24576
    ds_read_b64_tr_b16 a[154:155], v12 offset:25600
    s_waitcnt lgkmcnt(8)
    v_mfma_f32_32x32x16_bf16 v[48:63], a[136:139], a[48:51], v[48:63]
    v_mfma_f32_32x32x16_bf16 v[64:79], a[136:139], a[52:55], v[64:79]
    ds_read_b64_tr_b16 a[156:157], v13 offset:24576
    ds_read_b64_tr_b16 a[158:159], v13 offset:25600
    s_waitcnt lgkmcnt(8)
    v_mfma_f32_32x32x16_bf16 v[80:95], a[140:143], a[48:51], v[80:95]
    v_mfma_f32_32x32x16_bf16 v[96:111], a[140:143], a[52:55], v[96:111]
    ds_read_b64_tr_b16 a[128:129], v14 offset:24576
    ds_read_b64_tr_b16 a[130:131], v14 offset:25600
    s_waitcnt lgkmcnt(8)
    v_mfma_f32_32x32x16_bf16 v[112:127], a[48:51], a[144:147], v[112:127]
    ds_read_b64_tr_b16 a[132:133], v10 offset:21504
    ds_read_b64_tr_b16 a[134:135], v10 offset:22272
    v_mfma_f32_32x32x16_bf16 v[128:143], a[52:55], a[144:147], v[128:143]
    s_waitcnt lgkmcnt(8)
    v_mfma_f32_32x32x16_bf16 v[144:159], a[148:151], a[48:51], v[144:159]
    ds_read_b64_tr_b16 a[136:137], v10 offset:21568
    ds_read_b64_tr_b16 a[138:139], v10 offset:22336
    v_mfma_f32_32x32x16_bf16 v[160:175], a[148:151], a[52:55], v[160:175]
    s_waitcnt lgkmcnt(8)
    v_mfma_f32_32x32x16_bf16 v[176:191], a[152:155], a[48:51], v[176:191]
    ds_read_b64_tr_b16 a[140:141], v10 offset:21632
    ds_read_b64_tr_b16 a[142:143], v10 offset:22400
    v_mfma_f32_32x32x16_bf16 v[192:207], a[152:155], a[52:55], v[192:207]
    s_waitcnt lgkmcnt(8)
    v_mfma_f32_32x32x16_bf16 v[208:223], a[156:159], a[48:51], v[208:223]
    ds_read_b64_tr_b16 a[144:145], v11 offset:28672
    ds_read_b64_tr_b16 a[146:147], v11 offset:29696
    v_mfma_f32_32x32x16_bf16 v[224:239], a[156:159], a[52:55], v[224:239]
    s_waitcnt lgkmcnt(8)
    v_mfma_f32_32x32x16_bf16 v[240:255], a[128:131], a[48:51], v[240:255]
    ds_read_b64_tr_b16 a[148:149], v12 offset:28672
    ds_read_b64_tr_b16 a[150:151], v12 offset:29696
    s_waitcnt lgkmcnt(8)
    v_mfma_f32_32x32x16_bf16 v[48:63], a[132:135], a[56:59], v[48:63]
    v_mfma_f32_32x32x16_bf16 v[64:79], a[132:135], a[60:63], v[64:79]
    ds_read_b64_tr_b16 a[152:153], v13 offset:28672
    ds_read_b64_tr_b16 a[154:155], v13 offset:29696
    s_waitcnt lgkmcnt(8)
    v_mfma_f32_32x32x16_bf16 v[80:95], a[136:139], a[56:59], v[80:95]
    v_mfma_f32_32x32x16_bf16 v[96:111], a[136:139], a[60:63], v[96:111]
    ds_read_b64_tr_b16 a[156:157], v14 offset:28672
    ds_read_b64_tr_b16 a[158:159], v14 offset:29696
    s_waitcnt lgkmcnt(8)
    v_mfma_f32_32x32x16_bf16 v[112:127], a[56:59], a[140:143], v[112:127]
    v_mfma_f32_32x32x16_bf16 v[128:143], a[60:63], a[140:143], v[128:143]
    s_waitcnt lgkmcnt(6)
    v_mfma_f32_32x32x16_bf16 v[144:159], a[144:147], a[56:59], v[144:159]
    s_waitcnt vmcnt(15) lgkmcnt(0)
    s_barrier
    ds_read_b64_tr_b16 a[128:129], v10 offset:24576
    ds_read_b64_tr_b16 a[130:131], v10 offset:25344
    ds_read_b64_tr_b16 a[132:133], v10 offset:24640
    ds_read_b64_tr_b16 a[134:135], v10 offset:25408
    v_mfma_f32_32x32x16_bf16 v[160:175], a[144:147], a[60:63], v[160:175]
    v_mfma_f32_32x32x16_bf16 v[176:191], a[148:151], a[56:59], v[176:191]
    ds_read_b64_tr_b16 a[136:137], v10 offset:24704
    ds_read_b64_tr_b16 a[138:139], v10 offset:25472
    v_mfma_f32_32x32x16_bf16 v[192:207], a[148:151], a[60:63], v[192:207]
    v_mfma_f32_32x32x16_bf16 v[208:223], a[152:155], a[56:59], v[208:223]
    ds_read_b64_tr_b16 a[140:141], v11 offset:32768
    ds_read_b64_tr_b16 a[142:143], v11 offset:33792
    v_mfma_f32_32x32x16_bf16 v[224:239], a[152:155], a[60:63], v[224:239]
    v_mfma_f32_32x32x16_bf16 v[240:255], a[156:159], a[56:59], v[240:255]
    ds_read_b64_tr_b16 a[144:145], v12 offset:32768
    ds_read_b64_tr_b16 a[146:147], v12 offset:33792
    s_waitcnt lgkmcnt(8)
    v_mfma_f32_32x32x16_bf16 v[48:63], a[128:131], a[64:67], v[48:63]
    v_mfma_f32_32x32x16_bf16 v[64:79], a[128:131], a[68:71], v[64:79]
    ds_read_b64_tr_b16 a[148:149], v13 offset:32768
    ds_read_b64_tr_b16 a[150:151], v13 offset:33792
    s_waitcnt lgkmcnt(8)
    v_mfma_f32_32x32x16_bf16 v[80:95], a[132:135], a[64:67], v[80:95]
    v_mfma_f32_32x32x16_bf16 v[96:111], a[132:135], a[68:71], v[96:111]
    ds_read_b64_tr_b16 a[152:153], v14 offset:32768
    ds_read_b64_tr_b16 a[154:155], v14 offset:33792
    s_waitcnt lgkmcnt(8)
    v_mfma_f32_32x32x16_bf16 v[112:127], a[64:67], a[136:139], v[112:127]
    ds_read_b64_tr_b16 a[156:157], v10 offset:27648
    ds_read_b64_tr_b16 a[158:159], v10 offset:28416
    v_mfma_f32_32x32x16_bf16 v[128:143], a[68:71], a[136:139], v[128:143]
    s_waitcnt lgkmcnt(8)
    v_mfma_f32_32x32x16_bf16 v[144:159], a[140:143], a[64:67], v[144:159]
    ds_read_b64_tr_b16 a[128:129], v10 offset:27712
    ds_read_b64_tr_b16 a[130:131], v10 offset:28480
    v_mfma_f32_32x32x16_bf16 v[160:175], a[140:143], a[68:71], v[160:175]
    s_waitcnt lgkmcnt(8)
    v_mfma_f32_32x32x16_bf16 v[176:191], a[144:147], a[64:67], v[176:191]
    ds_read_b64_tr_b16 a[132:133], v10 offset:27776
    ds_read_b64_tr_b16 a[134:135], v10 offset:28544
    v_mfma_f32_32x32x16_bf16 v[192:207], a[144:147], a[68:71], v[192:207]
    s_waitcnt lgkmcnt(8)
    v_mfma_f32_32x32x16_bf16 v[208:223], a[148:151], a[64:67], v[208:223]
    ds_read_b64_tr_b16 a[136:137], v11 offset:36864
    ds_read_b64_tr_b16 a[138:139], v11 offset:37888
    v_mfma_f32_32x32x16_bf16 v[224:239], a[148:151], a[68:71], v[224:239]
    s_waitcnt lgkmcnt(8)
    v_mfma_f32_32x32x16_bf16 v[240:255], a[152:155], a[64:67], v[240:255]
    ds_read_b64_tr_b16 a[140:141], v12 offset:36864
    ds_read_b64_tr_b16 a[142:143], v12 offset:37888
    s_waitcnt lgkmcnt(8)
    v_mfma_f32_32x32x16_bf16 v[48:63], a[156:159], a[72:75], v[48:63]
    v_mfma_f32_32x32x16_bf16 v[64:79], a[156:159], a[76:79], v[64:79]
    ds_read_b64_tr_b16 a[144:145], v13 offset:36864
    ds_read_b64_tr_b16 a[146:147], v13 offset:37888
    s_waitcnt lgkmcnt(8)
    v_mfma_f32_32x32x16_bf16 v[80:95], a[128:131], a[72:75], v[80:95]
    v_mfma_f32_32x32x16_bf16 v[96:111], a[128:131], a[76:79], v[96:111]
    ds_read_b64_tr_b16 a[148:149], v14 offset:36864
    ds_read_b64_tr_b16 a[150:151], v14 offset:37888
    s_waitcnt lgkmcnt(8)
    v_mfma_f32_32x32x16_bf16 v[112:127], a[72:75], a[132:135], v[112:127]
    ds_read_b64_tr_b16 a[152:153], v10 offset:30720
    ds_read_b64_tr_b16 a[154:155], v10 offset:31488
    v_mfma_f32_32x32x16_bf16 v[128:143], a[76:79], a[132:135], v[128:143]
    s_waitcnt lgkmcnt(8)
    v_mfma_f32_32x32x16_bf16 v[144:159], a[136:139], a[72:75], v[144:159]
    ds_read_b64_tr_b16 a[156:157], v10 offset:30784
    ds_read_b64_tr_b16 a[158:159], v10 offset:31552
    v_mfma_f32_32x32x16_bf16 v[160:175], a[136:139], a[76:79], v[160:175]
    s_waitcnt lgkmcnt(8)
    v_mfma_f32_32x32x16_bf16 v[176:191], a[140:143], a[72:75], v[176:191]
    ds_read_b64_tr_b16 a[128:129], v10 offset:30848
    ds_read_b64_tr_b16 a[130:131], v10 offset:31616
    v_mfma_f32_32x32x16_bf16 v[192:207], a[140:143], a[76:79], v[192:207]
    s_waitcnt lgkmcnt(8)
    v_mfma_f32_32x32x16_bf16 v[208:223], a[144:147], a[72:75], v[208:223]
    ds_read_b64_tr_b16 a[132:133], v11 offset:40960
    ds_read_b64_tr_b16 a[134:135], v11 offset:41984
    v_mfma_f32_32x32x16_bf16 v[224:239], a[144:147], a[76:79], v[224:239]
    s_waitcnt lgkmcnt(8)
    v_mfma_f32_32x32x16_bf16 v[240:255], a[148:151], a[72:75], v[240:255]
    ds_read_b64_tr_b16 a[136:137], v12 offset:40960
    ds_read_b64_tr_b16 a[138:139], v12 offset:41984
    s_waitcnt lgkmcnt(8)
    v_mfma_f32_32x32x16_bf16 v[48:63], a[152:155], a[80:83], v[48:63]
    v_mfma_f32_32x32x16_bf16 v[64:79], a[152:155], a[84:87], v[64:79]
    ds_read_b64_tr_b16 a[140:141], v13 offset:40960
    ds_read_b64_tr_b16 a[142:143], v13 offset:41984
    s_waitcnt lgkmcnt(8)
    v_mfma_f32_32x32x16_bf16 v[80:95], a[156:159], a[80:83], v[80:95]
    v_mfma_f32_32x32x16_bf16 v[96:111], a[156:159], a[84:87], v[96:111]
    ds_read_b64_tr_b16 a[144:145], v14 offset:40960
    ds_read_b64_tr_b16 a[146:147], v14 offset:41984
    s_waitcnt lgkmcnt(8)
    v_mfma_f32_32x32x16_bf16 v[112:127], a[80:83], a[128:131], v[112:127]
    ds_read_b64_tr_b16 a[148:149], v10 offset:33792
    ds_read_b64_tr_b16 a[150:151], v10 offset:34560
    v_mfma_f32_32x32x16_bf16 v[128:143], a[84:87], a[128:131], v[128:143]
    s_waitcnt lgkmcnt(8)
    v_mfma_f32_32x32x16_bf16 v[144:159], a[132:135], a[80:83], v[144:159]
    ds_read_b64_tr_b16 a[152:153], v10 offset:33856
    ds_read_b64_tr_b16 a[154:155], v10 offset:34624
    v_mfma_f32_32x32x16_bf16 v[160:175], a[132:135], a[84:87], v[160:175]
    s_waitcnt lgkmcnt(8)
    v_mfma_f32_32x32x16_bf16 v[176:191], a[136:139], a[80:83], v[176:191]
    ds_read_b64_tr_b16 a[156:157], v10 offset:33920
    ds_read_b64_tr_b16 a[158:159], v10 offset:34688
    v_mfma_f32_32x32x16_bf16 v[192:207], a[136:139], a[84:87], v[192:207]
    s_waitcnt lgkmcnt(8)
    v_mfma_f32_32x32x16_bf16 v[208:223], a[140:143], a[80:83], v[208:223]
    ds_read_b64_tr_b16 a[128:129], v11 offset:45056
    ds_read_b64_tr_b16 a[130:131], v11 offset:46080
    v_mfma_f32_32x32x16_bf16 v[224:239], a[140:143], a[84:87], v[224:239]
    s_waitcnt lgkmcnt(8)
    v_mfma_f32_32x32x16_bf16 v[240:255], a[144:147], a[80:83], v[240:255]
    ds_read_b64_tr_b16 a[132:133], v12 offset:45056
    ds_read_b64_tr_b16 a[134:135], v12 offset:46080
    s_waitcnt lgkmcnt(8)
    v_mfma_f32_32x32x16_bf16 v[48:63], a[148:151], a[88:91], v[48:63]
    v_mfma_f32_32x32x16_bf16 v[64:79], a[148:151], a[92:95], v[64:79]
    ds_read_b64_tr_b16 a[136:137], v13 offset:45056
    ds_read_b64_tr_b16 a[138:139], v13 offset:46080
    s_waitcnt lgkmcnt(8)
    v_mfma_f32_32x32x16_bf16 v[80:95], a[152:155], a[88:91], v[80:95]
    v_mfma_f32_32x32x16_bf16 v[96:111], a[152:155], a[92:95], v[96:111]
    ds_read_b64_tr_b16 a[140:141], v14 offset:45056
    ds_read_b64_tr_b16 a[142:143], v14 offset:46080
    s_waitcnt lgkmcnt(8)
    v_mfma_f32_32x32x16_bf16 v[112:127], a[88:91], a[156:159], v[112:127]
    v_mfma_f32_32x32x16_bf16 v[128:143], a[92:95], a[156:159], v[128:143]
    s_waitcnt lgkmcnt(6)
    v_mfma_f32_32x32x16_bf16 v[144:159], a[128:131], a[88:91], v[144:159]
    s_waitcnt vmcnt(0) lgkmcnt(0)
    s_barrier
    ds_read_b64_tr_b16 a[144:145], v10 offset:36864
    ds_read_b64_tr_b16 a[146:147], v10 offset:37632
    ds_read_b64_tr_b16 a[148:149], v10 offset:36928
    ds_read_b64_tr_b16 a[150:151], v10 offset:37696
    v_mfma_f32_32x32x16_bf16 v[160:175], a[128:131], a[92:95], v[160:175]
    v_mfma_f32_32x32x16_bf16 v[176:191], a[132:135], a[88:91], v[176:191]
    ds_read_b64_tr_b16 a[152:153], v10 offset:36992
    ds_read_b64_tr_b16 a[154:155], v10 offset:37760
    v_mfma_f32_32x32x16_bf16 v[192:207], a[132:135], a[92:95], v[192:207]
    v_mfma_f32_32x32x16_bf16 v[208:223], a[136:139], a[88:91], v[208:223]
    ds_read_b64_tr_b16 a[156:157], v11 offset:49152
    ds_read_b64_tr_b16 a[158:159], v11 offset:50176
    v_mfma_f32_32x32x16_bf16 v[224:239], a[136:139], a[92:95], v[224:239]
    v_mfma_f32_32x32x16_bf16 v[240:255], a[140:143], a[88:91], v[240:255]
    ds_read_b64_tr_b16 a[128:129], v12 offset:49152
    ds_read_b64_tr_b16 a[130:131], v12 offset:50176
    s_waitcnt lgkmcnt(8)
    v_mfma_f32_32x32x16_bf16 v[48:63], a[144:147], a[96:99], v[48:63]
    v_mfma_f32_32x32x16_bf16 v[64:79], a[144:147], a[100:103], v[64:79]
    ds_read_b64_tr_b16 a[132:133], v13 offset:49152
    ds_read_b64_tr_b16 a[134:135], v13 offset:50176
    s_waitcnt lgkmcnt(8)
    v_mfma_f32_32x32x16_bf16 v[80:95], a[148:151], a[96:99], v[80:95]
    v_mfma_f32_32x32x16_bf16 v[96:111], a[148:151], a[100:103], v[96:111]
    ds_read_b64_tr_b16 a[136:137], v14 offset:49152
    ds_read_b64_tr_b16 a[138:139], v14 offset:50176
    s_waitcnt lgkmcnt(8)
    v_mfma_f32_32x32x16_bf16 v[112:127], a[96:99], a[152:155], v[112:127]
    ds_read_b64_tr_b16 a[140:141], v10 offset:39936
    ds_read_b64_tr_b16 a[142:143], v10 offset:40704
    v_mfma_f32_32x32x16_bf16 v[128:143], a[100:103], a[152:155], v[128:143]
    s_waitcnt lgkmcnt(8)
    v_mfma_f32_32x32x16_bf16 v[144:159], a[156:159], a[96:99], v[144:159]
    ds_read_b64_tr_b16 a[144:145], v10 offset:40000
    ds_read_b64_tr_b16 a[146:147], v10 offset:40768
    v_mfma_f32_32x32x16_bf16 v[160:175], a[156:159], a[100:103], v[160:175]
    s_waitcnt lgkmcnt(8)
    v_mfma_f32_32x32x16_bf16 v[176:191], a[128:131], a[96:99], v[176:191]
    ds_read_b64_tr_b16 a[148:149], v10 offset:40064
    ds_read_b64_tr_b16 a[150:151], v10 offset:40832
    v_mfma_f32_32x32x16_bf16 v[192:207], a[128:131], a[100:103], v[192:207]
    s_waitcnt lgkmcnt(8)
    v_mfma_f32_32x32x16_bf16 v[208:223], a[132:135], a[96:99], v[208:223]
    ds_read_b64_tr_b16 a[152:153], v11 offset:53248
    ds_read_b64_tr_b16 a[154:155], v11 offset:54272
    v_mfma_f32_32x32x16_bf16 v[224:239], a[132:135], a[100:103], v[224:239]
    s_waitcnt lgkmcnt(8)
    v_mfma_f32_32x32x16_bf16 v[240:255], a[136:139], a[96:99], v[240:255]
    ds_read_b64_tr_b16 a[156:157], v12 offset:53248
    ds_read_b64_tr_b16 a[158:159], v12 offset:54272
    s_waitcnt lgkmcnt(8)
    v_mfma_f32_32x32x16_bf16 v[48:63], a[140:143], a[104:107], v[48:63]
    v_mfma_f32_32x32x16_bf16 v[64:79], a[140:143], a[108:111], v[64:79]
    ds_read_b64_tr_b16 a[128:129], v13 offset:53248
    ds_read_b64_tr_b16 a[130:131], v13 offset:54272
    s_waitcnt lgkmcnt(8)
    v_mfma_f32_32x32x16_bf16 v[80:95], a[144:147], a[104:107], v[80:95]
    v_mfma_f32_32x32x16_bf16 v[96:111], a[144:147], a[108:111], v[96:111]
    ds_read_b64_tr_b16 a[132:133], v14 offset:53248
    ds_read_b64_tr_b16 a[134:135], v14 offset:54272
    s_waitcnt lgkmcnt(8)
    v_mfma_f32_32x32x16_bf16 v[112:127], a[104:107], a[148:151], v[112:127]
    ds_read_b64_tr_b16 a[136:137], v10 offset:43008
    ds_read_b64_tr_b16 a[138:139], v10 offset:43776
    v_mfma_f32_32x32x16_bf16 v[128:143], a[108:111], a[148:151], v[128:143]
    s_waitcnt lgkmcnt(8)
    v_mfma_f32_32x32x16_bf16 v[144:159], a[152:155], a[104:107], v[144:159]
    ds_read_b64_tr_b16 a[140:141], v10 offset:43072
    ds_read_b64_tr_b16 a[142:143], v10 offset:43840
    v_mfma_f32_32x32x16_bf16 v[160:175], a[152:155], a[108:111], v[160:175]
    s_waitcnt lgkmcnt(8)
    v_mfma_f32_32x32x16_bf16 v[176:191], a[156:159], a[104:107], v[176:191]
    ds_read_b64_tr_b16 a[144:145], v10 offset:43136
    ds_read_b64_tr_b16 a[146:147], v10 offset:43904
    v_mfma_f32_32x32x16_bf16 v[192:207], a[156:159], a[108:111], v[192:207]
    s_waitcnt lgkmcnt(8)
    v_mfma_f32_32x32x16_bf16 v[208:223], a[128:131], a[104:107], v[208:223]
    ds_read_b64_tr_b16 a[148:149], v11 offset:57344
    ds_read_b64_tr_b16 a[150:151], v11 offset:58368
    v_mfma_f32_32x32x16_bf16 v[224:239], a[128:131], a[108:111], v[224:239]
    s_waitcnt lgkmcnt(8)
    v_mfma_f32_32x32x16_bf16 v[240:255], a[132:135], a[104:107], v[240:255]
    ds_read_b64_tr_b16 a[152:153], v12 offset:57344
    ds_read_b64_tr_b16 a[154:155], v12 offset:58368
    s_waitcnt lgkmcnt(8)
    v_mfma_f32_32x32x16_bf16 v[48:63], a[136:139], a[112:115], v[48:63]
    v_mfma_f32_32x32x16_bf16 v[64:79], a[136:139], a[116:119], v[64:79]
    ds_read_b64_tr_b16 a[156:157], v13 offset:57344
    ds_read_b64_tr_b16 a[158:159], v13 offset:58368
    s_waitcnt lgkmcnt(8)
    v_mfma_f32_32x32x16_bf16 v[80:95], a[140:143], a[112:115], v[80:95]
    v_mfma_f32_32x32x16_bf16 v[96:111], a[140:143], a[116:119], v[96:111]
    ds_read_b64_tr_b16 a[128:129], v14 offset:57344
    ds_read_b64_tr_b16 a[130:131], v14 offset:58368
    s_waitcnt lgkmcnt(8)
    v_mfma_f32_32x32x16_bf16 v[112:127], a[112:115], a[144:147], v[112:127]
    ds_read_b64_tr_b16 a[132:133], v10 offset:46080
    ds_read_b64_tr_b16 a[134:135], v10 offset:46848
    v_mfma_f32_32x32x16_bf16 v[128:143], a[116:119], a[144:147], v[128:143]
    s_waitcnt lgkmcnt(8)
    v_mfma_f32_32x32x16_bf16 v[144:159], a[148:151], a[112:115], v[144:159]
    ds_read_b64_tr_b16 a[136:137], v10 offset:46144
    ds_read_b64_tr_b16 a[138:139], v10 offset:46912
    v_mfma_f32_32x32x16_bf16 v[160:175], a[148:151], a[116:119], v[160:175]
    s_waitcnt lgkmcnt(8)
    v_mfma_f32_32x32x16_bf16 v[176:191], a[152:155], a[112:115], v[176:191]
    ds_read_b64_tr_b16 a[140:141], v10 offset:46208
    ds_read_b64_tr_b16 a[142:143], v10 offset:46976
    v_mfma_f32_32x32x16_bf16 v[192:207], a[152:155], a[116:119], v[192:207]
    s_waitcnt lgkmcnt(8)
    v_mfma_f32_32x32x16_bf16 v[208:223], a[156:159], a[112:115], v[208:223]
    ds_read_b64_tr_b16 a[144:145], v11 offset:61440
    ds_read_b64_tr_b16 a[146:147], v11 offset:62464
    v_mfma_f32_32x32x16_bf16 v[224:239], a[156:159], a[116:119], v[224:239]
    s_waitcnt lgkmcnt(8)
    v_mfma_f32_32x32x16_bf16 v[240:255], a[128:131], a[112:115], v[240:255]
    ds_read_b64_tr_b16 a[148:149], v12 offset:61440
    ds_read_b64_tr_b16 a[150:151], v12 offset:62464
    s_waitcnt lgkmcnt(8)
    v_mfma_f32_32x32x16_bf16 v[48:63], a[132:135], a[120:123], v[48:63]
    v_mfma_f32_32x32x16_bf16 v[64:79], a[132:135], a[124:127], v[64:79]
    ds_read_b64_tr_b16 a[152:153], v13 offset:61440
    ds_read_b64_tr_b16 a[154:155], v13 offset:62464
    s_waitcnt lgkmcnt(8)
    v_mfma_f32_32x32x16_bf16 v[80:95], a[136:139], a[120:123], v[80:95]
    v_mfma_f32_32x32x16_bf16 v[96:111], a[136:139], a[124:127], v[96:111]
    ds_read_b64_tr_b16 a[156:157], v14 offset:61440
    ds_read_b64_tr_b16 a[158:159], v14 offset:62464
    s_waitcnt lgkmcnt(8)
    v_mfma_f32_32x32x16_bf16 v[112:127], a[120:123], a[140:143], v[112:127]
    v_mfma_f32_32x32x16_bf16 v[128:143], a[124:127], a[140:143], v[128:143]
    s_waitcnt lgkmcnt(6)
    v_mfma_f32_32x32x16_bf16 v[144:159], a[144:147], a[120:123], v[144:159]
    v_mfma_f32_32x32x16_bf16 v[160:175], a[144:147], a[124:127], v[160:175]
    s_waitcnt lgkmcnt(4)
    v_mfma_f32_32x32x16_bf16 v[176:191], a[148:151], a[120:123], v[176:191]
    v_mfma_f32_32x32x16_bf16 v[192:207], a[148:151], a[124:127], v[192:207]
    s_waitcnt lgkmcnt(2)
    v_mfma_f32_32x32x16_bf16 v[208:223], a[152:155], a[120:123], v[208:223]
    v_mfma_f32_32x32x16_bf16 v[224:239], a[152:155], a[124:127], v[224:239]
    s_waitcnt lgkmcnt(0)
    v_mfma_f32_32x32x16_bf16 v[240:255], a[156:159], a[120:123], v[240:255]
    s_cmp_eq_u32 s27, 0
    s_cselect_b32 s56, 0x3e8293ee, 1.0
    s_mov_b32 s57, s56
    s_mul_i32 s58, s27, 0x400000
    s_add_u32 s58, s58, 0x500000
    s_lshl_b32 s59, s28, 18
    s_add_u32 s58, s58, s59
    s_lshl_b32 s59, s26, 17
    s_add_u32 s59, s59, 0xd00000
    s_lshl_b32 s3, s38, 11
    s_add_u32 s60, s58, s3
    s_add_u32 s62, s60, 0x20000
    s_add_u32 s64, s59, s3
    s_mul_i32 s3, s38, 294912
    s_add_u32 s3, s3, 0x1110000
    s_lshl_b32 s36, s45, 11
    s_add_u32 s66, s3, s36
    s_lshl_b32 s36, s47, 11
    s_add_u32 s68, s3, s36
    s_lshl_b32 s3, s39, 11
    s_add_u32 s61, s58, s3
    s_add_u32 s63, s61, 0x20000
    s_add_u32 s65, s59, s3
    s_mul_i32 s3, s39, 294912
    s_add_u32 s3, s3, 0x1110000
    s_lshl_b32 s36, s45, 11
    s_add_u32 s67, s3, s36
    v_pk_mul_f32 v[48:49], v[48:49], s[56:57]
    v_pk_mul_f32 v[50:51], v[50:51], s[56:57]
    v_pk_mul_f32 v[52:53], v[52:53], s[56:57]
    v_pk_mul_f32 v[54:55], v[54:55], s[56:57]
    v_pk_mul_f32 v[56:57], v[56:57], s[56:57]
    v_pk_mul_f32 v[58:59], v[58:59], s[56:57]
    v_pk_mul_f32 v[60:61], v[60:61], s[56:57]
    v_pk_mul_f32 v[62:63], v[62:63], s[56:57]
    v_cvt_pk_bf16_f32 v48, v48, v49
    v_cvt_pk_bf16_f32 v49, v50, v51
    v_cvt_pk_bf16_f32 v50, v52, v53
    v_cvt_pk_bf16_f32 v51, v54, v55
    v_cvt_pk_bf16_f32 v52, v56, v57
    v_cvt_pk_bf16_f32 v53, v58, v59
    v_cvt_pk_bf16_f32 v54, v60, v61
    v_cvt_pk_bf16_f32 v55, v62, v63
    buffer_store_dwordx4 v[48:51], v2, s[8:11], s60 offen offset:0 sc1
    buffer_store_dwordx4 v[52:55], v2, s[8:11], s60 offen offset:1024 sc1
    v_pk_mul_f32 v[64:65], v[64:65], s[56:57]
    v_pk_mul_f32 v[66:67], v[66:67], s[56:57]
    v_pk_mul_f32 v[68:69], v[68:69], s[56:57]
    v_pk_mul_f32 v[70:71], v[70:71], s[56:57]
    v_pk_mul_f32 v[72:73], v[72:73], s[56:57]
    v_pk_mul_f32 v[74:75], v[74:75], s[56:57]
    v_pk_mul_f32 v[76:77], v[76:77], s[56:57]
    v_pk_mul_f32 v[78:79], v[78:79], s[56:57]
    v_cvt_pk_bf16_f32 v64, v64, v65
    v_cvt_pk_bf16_f32 v65, v66, v67
    v_cvt_pk_bf16_f32 v66, v68, v69
    v_cvt_pk_bf16_f32 v67, v70, v71
    v_cvt_pk_bf16_f32 v68, v72, v73
    v_cvt_pk_bf16_f32 v69, v74, v75
    v_cvt_pk_bf16_f32 v70, v76, v77
    v_cvt_pk_bf16_f32 v71, v78, v79
    buffer_store_dwordx4 v[64:67], v2, s[8:11], s61 offen offset:0 sc1
    buffer_store_dwordx4 v[68:71], v2, s[8:11], s61 offen offset:1024 sc1
    v_pk_mul_f32 v[80:81], v[80:81], s[56:57]
    v_pk_mul_f32 v[82:83], v[82:83], s[56:57]
    v_pk_mul_f32 v[84:85], v[84:85], s[56:57]
    v_pk_mul_f32 v[86:87], v[86:87], s[56:57]
    v_pk_mul_f32 v[88:89], v[88:89], s[56:57]
    v_pk_mul_f32 v[90:91], v[90:91], s[56:57]
    v_pk_mul_f32 v[92:93], v[92:93], s[56:57]
    v_pk_mul_f32 v[94:95], v[94:95], s[56:57]
    v_cvt_pk_bf16_f32 v80, v80, v81
    v_cvt_pk_bf16_f32 v81, v82, v83
    v_cvt_pk_bf16_f32 v82, v84, v85
    v_cvt_pk_bf16_f32 v83, v86, v87
    v_cvt_pk_bf16_f32 v84, v88, v89
    v_cvt_pk_bf16_f32 v85, v90, v91
    v_cvt_pk_bf16_f32 v86, v92, v93
    v_cvt_pk_bf16_f32 v87, v94, v95
    buffer_store_dwordx4 v[80:83], v2, s[8:11], s62 offen offset:0 sc1
    buffer_store_dwordx4 v[84:87], v2, s[8:11], s62 offen offset:1024 sc1
    v_pk_mul_f32 v[96:97], v[96:97], s[56:57]
    v_pk_mul_f32 v[98:99], v[98:99], s[56:57]
    v_pk_mul_f32 v[100:101], v[100:101], s[56:57]
    v_pk_mul_f32 v[102:103], v[102:103], s[56:57]
    v_pk_mul_f32 v[104:105], v[104:105], s[56:57]
    v_pk_mul_f32 v[106:107], v[106:107], s[56:57]
    v_pk_mul_f32 v[108:109], v[108:109], s[56:57]
    v_pk_mul_f32 v[110:111], v[110:111], s[56:57]
    v_cvt_pk_bf16_f32 v96, v96, v97
    v_cvt_pk_bf16_f32 v97, v98, v99
    v_cvt_pk_bf16_f32 v98, v100, v101
    v_cvt_pk_bf16_f32 v99, v102, v103
    v_cvt_pk_bf16_f32 v100, v104, v105
    v_cvt_pk_bf16_f32 v101, v106, v107
    v_cvt_pk_bf16_f32 v102, v108, v109
    v_cvt_pk_bf16_f32 v103, v110, v111
    buffer_store_dwordx4 v[96:99], v2, s[8:11], s63 offen offset:0 sc1
    buffer_store_dwordx4 v[100:103], v2, s[8:11], s63 offen offset:1024 sc1
    v_cvt_pk_bf16_f32 v112, v112, v113
    v_cvt_pk_bf16_f32 v113, v114, v115
    v_cvt_pk_bf16_f32 v114, v116, v117
    v_cvt_pk_bf16_f32 v115, v118, v119
    v_cvt_pk_bf16_f32 v116, v120, v121
    v_cvt_pk_bf16_f32 v117, v122, v123
    v_cvt_pk_bf16_f32 v118, v124, v125
    v_cvt_pk_bf16_f32 v119, v126, v127
    buffer_store_dwordx4 v[112:115], v2, s[8:11], s64 offen offset:0 sc1
    buffer_store_dwordx4 v[116:119], v2, s[8:11], s64 offen offset:1024 sc1
    v_cvt_pk_bf16_f32 v128, v128, v129
    v_cvt_pk_bf16_f32 v129, v130, v131
    v_cvt_pk_bf16_f32 v130, v132, v133
    v_cvt_pk_bf16_f32 v131, v134, v135
    v_cvt_pk_bf16_f32 v132, v136, v137
    v_cvt_pk_bf16_f32 v133, v138, v139
    v_cvt_pk_bf16_f32 v134, v140, v141
    v_cvt_pk_bf16_f32 v135, v142, v143
    buffer_store_dwordx4 v[128:131], v2, s[8:11], s65 offen offset:0 sc1
    buffer_store_dwordx4 v[132:135], v2, s[8:11], s65 offen offset:1024 sc1
    s_mov_b32 s12, s88
    s_mov_b32 s13, s89
    s_mov_b32 s14, 0x200000
    s_mov_b32 s15, 0x20000
    s_mov_b32 s16, s96
    s_mov_b32 s17, s97
    s_mov_b32 s18, 0x700000
    s_mov_b32 s19, 0x20000
    v_rcp_f32 v18, v16
    v_mov_b32 v20, v16
    v_mov_b32 v21, v16
    v_mul_f32 v22, 0xc0135761, v18
    v_mul_f32 v19, v18, v18
    v_mul_f32 v23, 0xc0135761, v18
    v_mul_f32 v19, v19, v18
    v_mul_f32 v4, 0xbdd2d3e8, v19
    v_mul_f32 v5, 0xbdd2d3e8, v19
    v_rcp_f32 v18, v17
    v_mov_b32 v26, v17
    v_mov_b32 v27, v17
    v_mul_f32 v28, 0xc0135761, v18
    v_mul_f32 v19, v18, v18
    v_mul_f32 v29, 0xc0135761, v18
    v_mul_f32 v19, v19, v18
    v_mul_f32 v10, 0xbdd2d3e8, v19
    v_mul_f32 v11, 0xbdd2d3e8, v19
    v_pk_mul_f32 v[32:33], v[144:145], v[144:145]
    v_pk_mul_f32 v[34:35], v[146:147], v[146:147]
    v_pk_mul_f32 v[36:37], v[148:149], v[148:149]
    v_pk_mul_f32 v[38:39], v[150:151], v[150:151]
    v_pk_mul_f32 v[40:41], v[152:153], v[152:153]
    v_pk_mul_f32 v[42:43], v[154:155], v[154:155]
    v_pk_mul_f32 v[44:45], v[156:157], v[156:157]
    v_pk_mul_f32 v[46:47], v[158:159], v[158:159]
    v_pk_fma_f32 v[32:33], v[32:33], v[4:5], v[22:23]
    v_pk_fma_f32 v[34:35], v[34:35], v[4:5], v[22:23]
    v_pk_fma_f32 v[36:37], v[36:37], v[4:5], v[22:23]
    v_pk_fma_f32 v[38:39], v[38:39], v[4:5], v[22:23]
    v_pk_fma_f32 v[40:41], v[40:41], v[4:5], v[22:23]
    v_pk_fma_f32 v[42:43], v[42:43], v[4:5], v[22:23]
    v_pk_fma_f32 v[44:45], v[44:45], v[4:5], v[22:23]
    v_pk_fma_f32 v[46:47], v[46:47], v[4:5], v[22:23]
    v_pk_mul_f32 v[32:33], v[32:33], v[144:145]
    v_pk_mul_f32 v[34:35], v[34:35], v[146:147]
    v_pk_mul_f32 v[36:37], v[36:37], v[148:149]
    v_pk_mul_f32 v[38:39], v[38:39], v[150:151]
    v_pk_mul_f32 v[40:41], v[40:41], v[152:153]
    v_pk_mul_f32 v[42:43], v[42:43], v[154:155]
    v_pk_mul_f32 v[44:45], v[44:45], v[156:157]
    v_pk_mul_f32 v[46:47], v[46:47], v[158:159]
    v_exp_f32 v32, v32
    v_exp_f32 v33, v33
    v_exp_f32 v34, v34
    v_exp_f32 v35, v35
    v_exp_f32 v36, v36
    v_exp_f32 v37, v37
    v_exp_f32 v38, v38
    v_exp_f32 v39, v39
    v_exp_f32 v40, v40
    v_exp_f32 v41, v41
    v_exp_f32 v42, v42
    v_exp_f32 v43, v43
    v_exp_f32 v44, v44
    v_exp_f32 v45, v45
    v_exp_f32 v46, v46
    v_exp_f32 v47, v47
    v_pk_fma_f32 v[32:33], v[32:33], v[20:21], v[20:21]
    v_pk_fma_f32 v[34:35], v[34:35], v[20:21], v[20:21]
    v_pk_fma_f32 v[36:37], v[36:37], v[20:21], v[20:21]
    v_pk_fma_f32 v[38:39], v[38:39], v[20:21], v[20:21]
    v_pk_fma_f32 v[40:41], v[40:41], v[20:21], v[20:21]
    v_pk_fma_f32 v[42:43], v[42:43], v[20:21], v[20:21]
    v_pk_fma_f32 v[44:45], v[44:45], v[20:21], v[20:21]
    v_pk_fma_f32 v[46:47], v[46:47], v[20:21], v[20:21]
    v_rcp_f32 v32, v32
    v_rcp_f32 v33, v33
    v_rcp_f32 v34, v34
    v_rcp_f32 v35, v35
    v_rcp_f32 v36, v36
    v_rcp_f32 v37, v37
    v_rcp_f32 v38, v38
    v_rcp_f32 v39, v39
    v_rcp_f32 v40, v40
    v_rcp_f32 v41, v41
    v_rcp_f32 v42, v42
    v_rcp_f32 v43, v43
    v_rcp_f32 v44, v44
    v_rcp_f32 v45, v45
    v_rcp_f32 v46, v46
    v_rcp_f32 v47, v47
    v_pk_mul_f32 v[144:145], v[144:145], v[32:33]
    v_pk_mul_f32 v[146:147], v[146:147], v[34:35]
    v_pk_mul_f32 v[148:149], v[148:149], v[36:37]
    v_pk_mul_f32 v[150:151], v[150:151], v[38:39]
    v_pk_mul_f32 v[152:153], v[152:153], v[40:41]
    v_pk_mul_f32 v[154:155], v[154:155], v[42:43]
    v_pk_mul_f32 v[156:157], v[156:157], v[44:45]
    v_pk_mul_f32 v[158:159], v[158:159], v[46:47]
    v_cvt_pk_bf16_f32 v144, v144, v145
    v_cvt_pk_bf16_f32 v145, v146, v147
    v_cvt_pk_bf16_f32 v146, v148, v149
    v_cvt_pk_bf16_f32 v147, v150, v151
    v_cvt_pk_bf16_f32 v148, v152, v153
    v_cvt_pk_bf16_f32 v149, v154, v155
    v_cvt_pk_bf16_f32 v150, v156, v157
    v_cvt_pk_bf16_f32 v151, v158, v159
    v_pk_mul_f32 v[32:33], v[160:161], v[160:161]
    v_pk_mul_f32 v[34:35], v[162:163], v[162:163]
    v_pk_mul_f32 v[36:37], v[164:165], v[164:165]
    v_pk_mul_f32 v[38:39], v[166:167], v[166:167]
    v_pk_mul_f32 v[40:41], v[168:169], v[168:169]
    v_pk_mul_f32 v[42:43], v[170:171], v[170:171]
    v_pk_mul_f32 v[44:45], v[172:173], v[172:173]
    v_pk_mul_f32 v[46:47], v[174:175], v[174:175]
    v_pk_fma_f32 v[32:33], v[32:33], v[10:11], v[28:29]
    v_pk_fma_f32 v[34:35], v[34:35], v[10:11], v[28:29]
    v_pk_fma_f32 v[36:37], v[36:37], v[10:11], v[28:29]
    v_pk_fma_f32 v[38:39], v[38:39], v[10:11], v[28:29]
    v_pk_fma_f32 v[40:41], v[40:41], v[10:11], v[28:29]
    v_pk_fma_f32 v[42:43], v[42:43], v[10:11], v[28:29]
    v_pk_fma_f32 v[44:45], v[44:45], v[10:11], v[28:29]
    v_pk_fma_f32 v[46:47], v[46:47], v[10:11], v[28:29]
    v_pk_mul_f32 v[32:33], v[32:33], v[160:161]
    v_pk_mul_f32 v[34:35], v[34:35], v[162:163]
    v_pk_mul_f32 v[36:37], v[36:37], v[164:165]
    v_pk_mul_f32 v[38:39], v[38:39], v[166:167]
    v_pk_mul_f32 v[40:41], v[40:41], v[168:169]
    v_pk_mul_f32 v[42:43], v[42:43], v[170:171]
    v_pk_mul_f32 v[44:45], v[44:45], v[172:173]
    v_pk_mul_f32 v[46:47], v[46:47], v[174:175]
    v_exp_f32 v32, v32
    v_exp_f32 v33, v33
    v_exp_f32 v34, v34
    v_exp_f32 v35, v35
    v_exp_f32 v36, v36
    v_exp_f32 v37, v37
    v_exp_f32 v38, v38
    v_exp_f32 v39, v39
    v_exp_f32 v40, v40
    v_exp_f32 v41, v41
    v_exp_f32 v42, v42
    v_exp_f32 v43, v43
    v_exp_f32 v44, v44
    v_exp_f32 v45, v45
    v_exp_f32 v46, v46
    v_exp_f32 v47, v47
    v_pk_fma_f32 v[32:33], v[32:33], v[26:27], v[26:27]
    v_pk_fma_f32 v[34:35], v[34:35], v[26:27], v[26:27]
    v_pk_fma_f32 v[36:37], v[36:37], v[26:27], v[26:27]
    v_pk_fma_f32 v[38:39], v[38:39], v[26:27], v[26:27]
    v_pk_fma_f32 v[40:41], v[40:41], v[26:27], v[26:27]
    v_pk_fma_f32 v[42:43], v[42:43], v[26:27], v[26:27]
    v_pk_fma_f32 v[44:45], v[44:45], v[26:27], v[26:27]
    v_pk_fma_f32 v[46:47], v[46:47], v[26:27], v[26:27]
    v_rcp_f32 v32, v32
    v_rcp_f32 v33, v33
    v_rcp_f32 v34, v34
    v_rcp_f32 v35, v35
    v_rcp_f32 v36, v36
    v_rcp_f32 v37, v37
    v_rcp_f32 v38, v38
    v_rcp_f32 v39, v39
    v_rcp_f32 v40, v40
    v_rcp_f32 v41, v41
    v_rcp_f32 v42, v42
    v_rcp_f32 v43, v43
    v_rcp_f32 v44, v44
    v_rcp_f32 v45, v45
    v_rcp_f32 v46, v46
    v_rcp_f32 v47, v47
    v_pk_mul_f32 v[160:161], v[160:161], v[32:33]
    v_pk_mul_f32 v[162:163], v[162:163], v[34:35]
    v_pk_mul_f32 v[164:165], v[164:165], v[36:37]
    v_pk_mul_f32 v[166:167], v[166:167], v[38:39]
    v_pk_mul_f32 v[168:169], v[168:169], v[40:41]
    v_pk_mul_f32 v[170:171], v[170:171], v[42:43]
    v_pk_mul_f32 v[172:173], v[172:173], v[44:45]
    v_pk_mul_f32 v[174:175], v[174:175], v[46:47]
    v_cvt_pk_bf16_f32 v160, v160, v161
    v_cvt_pk_bf16_f32 v161, v162, v163
    v_cvt_pk_bf16_f32 v162, v164, v165
    v_cvt_pk_bf16_f32 v163, v166, v167
    v_cvt_pk_bf16_f32 v164, v168, v169
    v_cvt_pk_bf16_f32 v165, v170, v171
    v_cvt_pk_bf16_f32 v166, v172, v173
    v_cvt_pk_bf16_f32 v167, v174, v175
    v_pk_mul_f32 v[32:33], v[176:177], v[176:177]
    v_pk_mul_f32 v[34:35], v[178:179], v[178:179]
    v_pk_mul_f32 v[36:37], v[180:181], v[180:181]
    v_pk_mul_f32 v[38:39], v[182:183], v[182:183]
    v_pk_mul_f32 v[40:41], v[184:185], v[184:185]
    v_pk_mul_f32 v[42:43], v[186:187], v[186:187]
    v_pk_mul_f32 v[44:45], v[188:189], v[188:189]
    v_pk_mul_f32 v[46:47], v[190:191], v[190:191]
    v_pk_fma_f32 v[32:33], v[32:33], v[4:5], v[22:23]
    v_pk_fma_f32 v[34:35], v[34:35], v[4:5], v[22:23]
    v_pk_fma_f32 v[36:37], v[36:37], v[4:5], v[22:23]
    v_pk_fma_f32 v[38:39], v[38:39], v[4:5], v[22:23]
    v_pk_fma_f32 v[40:41], v[40:41], v[4:5], v[22:23]
    v_pk_fma_f32 v[42:43], v[42:43], v[4:5], v[22:23]
    v_pk_fma_f32 v[44:45], v[44:45], v[4:5], v[22:23]
    v_pk_fma_f32 v[46:47], v[46:47], v[4:5], v[22:23]
    v_pk_mul_f32 v[32:33], v[32:33], v[176:177]
    v_pk_mul_f32 v[34:35], v[34:35], v[178:179]
    v_pk_mul_f32 v[36:37], v[36:37], v[180:181]
    v_pk_mul_f32 v[38:39], v[38:39], v[182:183]
    v_pk_mul_f32 v[40:41], v[40:41], v[184:185]
    v_pk_mul_f32 v[42:43], v[42:43], v[186:187]
    v_pk_mul_f32 v[44:45], v[44:45], v[188:189]
    v_pk_mul_f32 v[46:47], v[46:47], v[190:191]
    v_exp_f32 v32, v32
    v_exp_f32 v33, v33
    v_exp_f32 v34, v34
    v_exp_f32 v35, v35
    v_exp_f32 v36, v36
    v_exp_f32 v37, v37
    v_exp_f32 v38, v38
    v_exp_f32 v39, v39
    v_exp_f32 v40, v40
    v_exp_f32 v41, v41
    v_exp_f32 v42, v42
    v_exp_f32 v43, v43
    v_exp_f32 v44, v44
    v_exp_f32 v45, v45
    v_exp_f32 v46, v46
    v_exp_f32 v47, v47
    v_pk_fma_f32 v[32:33], v[32:33], v[20:21], v[20:21]
    v_pk_fma_f32 v[34:35], v[34:35], v[20:21], v[20:21]
    v_pk_fma_f32 v[36:37], v[36:37], v[20:21], v[20:21]
    v_pk_fma_f32 v[38:39], v[38:39], v[20:21], v[20:21]
    v_pk_fma_f32 v[40:41], v[40:41], v[20:21], v[20:21]
    v_pk_fma_f32 v[42:43], v[42:43], v[20:21], v[20:21]
    v_pk_fma_f32 v[44:45], v[44:45], v[20:21], v[20:21]
    v_pk_fma_f32 v[46:47], v[46:47], v[20:21], v[20:21]
    v_rcp_f32 v32, v32
    v_rcp_f32 v33, v33
    v_rcp_f32 v34, v34
    v_rcp_f32 v35, v35
    v_rcp_f32 v36, v36
    v_rcp_f32 v37, v37
    v_rcp_f32 v38, v38
    v_rcp_f32 v39, v39
    v_rcp_f32 v40, v40
    v_rcp_f32 v41, v41
    v_rcp_f32 v42, v42
    v_rcp_f32 v43, v43
    v_rcp_f32 v44, v44
    v_rcp_f32 v45, v45
    v_rcp_f32 v46, v46
    v_rcp_f32 v47, v47
    v_pk_mul_f32 v[176:177], v[176:177], v[32:33]
    v_pk_mul_f32 v[178:179], v[178:179], v[34:35]
    v_pk_mul_f32 v[180:181], v[180:181], v[36:37]
    v_pk_mul_f32 v[182:183], v[182:183], v[38:39]
    v_pk_mul_f32 v[184:185], v[184:185], v[40:41]
    v_pk_mul_f32 v[186:187], v[186:187], v[42:43]
    v_pk_mul_f32 v[188:189], v[188:189], v[44:45]
    v_pk_mul_f32 v[190:191], v[190:191], v[46:47]
    v_cvt_pk_bf16_f32 v176, v176, v177
    v_cvt_pk_bf16_f32 v177, v178, v179
    v_cvt_pk_bf16_f32 v178, v180, v181
    v_cvt_pk_bf16_f32 v179, v182, v183
    v_cvt_pk_bf16_f32 v180, v184, v185
    v_cvt_pk_bf16_f32 v181, v186, v187
    v_cvt_pk_bf16_f32 v182, v188, v189
    v_cvt_pk_bf16_f32 v183, v190, v191
    v_pk_mul_f32 v[32:33], v[192:193], v[192:193]
    v_pk_mul_f32 v[34:35], v[194:195], v[194:195]
    v_pk_mul_f32 v[36:37], v[196:197], v[196:197]
    v_pk_mul_f32 v[38:39], v[198:199], v[198:199]
    v_pk_mul_f32 v[40:41], v[200:201], v[200:201]
    v_pk_mul_f32 v[42:43], v[202:203], v[202:203]
    v_pk_mul_f32 v[44:45], v[204:205], v[204:205]
    v_pk_mul_f32 v[46:47], v[206:207], v[206:207]
    v_pk_fma_f32 v[32:33], v[32:33], v[10:11], v[28:29]
    v_pk_fma_f32 v[34:35], v[34:35], v[10:11], v[28:29]
    v_pk_fma_f32 v[36:37], v[36:37], v[10:11], v[28:29]
    v_pk_fma_f32 v[38:39], v[38:39], v[10:11], v[28:29]
    v_pk_fma_f32 v[40:41], v[40:41], v[10:11], v[28:29]
    v_pk_fma_f32 v[42:43], v[42:43], v[10:11], v[28:29]
    v_pk_fma_f32 v[44:45], v[44:45], v[10:11], v[28:29]
    v_pk_fma_f32 v[46:47], v[46:47], v[10:11], v[28:29]
    v_pk_mul_f32 v[32:33], v[32:33], v[192:193]
    v_pk_mul_f32 v[34:35], v[34:35], v[194:195]
    v_pk_mul_f32 v[36:37], v[36:37], v[196:197]
    v_pk_mul_f32 v[38:39], v[38:39], v[198:199]
    v_pk_mul_f32 v[40:41], v[40:41], v[200:201]
    v_pk_mul_f32 v[42:43], v[42:43], v[202:203]
    v_pk_mul_f32 v[44:45], v[44:45], v[204:205]
    v_pk_mul_f32 v[46:47], v[46:47], v[206:207]
    v_exp_f32 v32, v32
    v_exp_f32 v33, v33
    v_exp_f32 v34, v34
    v_exp_f32 v35, v35
    v_exp_f32 v36, v36
    v_exp_f32 v37, v37
    v_exp_f32 v38, v38
    v_exp_f32 v39, v39
    v_exp_f32 v40, v40
    v_exp_f32 v41, v41
    v_exp_f32 v42, v42
    v_exp_f32 v43, v43
    v_exp_f32 v44, v44
    v_exp_f32 v45, v45
    v_exp_f32 v46, v46
    v_exp_f32 v47, v47
    v_pk_fma_f32 v[32:33], v[32:33], v[26:27], v[26:27]
    v_pk_fma_f32 v[34:35], v[34:35], v[26:27], v[26:27]
    v_pk_fma_f32 v[36:37], v[36:37], v[26:27], v[26:27]
    v_pk_fma_f32 v[38:39], v[38:39], v[26:27], v[26:27]
    v_pk_fma_f32 v[40:41], v[40:41], v[26:27], v[26:27]
    v_pk_fma_f32 v[42:43], v[42:43], v[26:27], v[26:27]
    v_pk_fma_f32 v[44:45], v[44:45], v[26:27], v[26:27]
    v_pk_fma_f32 v[46:47], v[46:47], v[26:27], v[26:27]
    v_rcp_f32 v32, v32
    v_rcp_f32 v33, v33
    v_rcp_f32 v34, v34
    v_rcp_f32 v35, v35
    v_rcp_f32 v36, v36
    v_rcp_f32 v37, v37
    v_rcp_f32 v38, v38
    v_rcp_f32 v39, v39
    v_rcp_f32 v40, v40
    v_rcp_f32 v41, v41
    v_rcp_f32 v42, v42
    v_rcp_f32 v43, v43
    v_rcp_f32 v44, v44
    v_rcp_f32 v45, v45
    v_rcp_f32 v46, v46
    v_rcp_f32 v47, v47
    v_pk_mul_f32 v[192:193], v[192:193], v[32:33]
    v_pk_mul_f32 v[194:195], v[194:195], v[34:35]
    v_pk_mul_f32 v[196:197], v[196:197], v[36:37]
    v_pk_mul_f32 v[198:199], v[198:199], v[38:39]
    v_pk_mul_f32 v[200:201], v[200:201], v[40:41]
    v_pk_mul_f32 v[202:203], v[202:203], v[42:43]
    v_pk_mul_f32 v[204:205], v[204:205], v[44:45]
    v_pk_mul_f32 v[206:207], v[206:207], v[46:47]
    v_cvt_pk_bf16_f32 v192, v192, v193
    v_cvt_pk_bf16_f32 v193, v194, v195
    v_cvt_pk_bf16_f32 v194, v196, v197
    v_cvt_pk_bf16_f32 v195, v198, v199
    v_cvt_pk_bf16_f32 v196, v200, v201
    v_cvt_pk_bf16_f32 v197, v202, v203
    v_cvt_pk_bf16_f32 v198, v204, v205
    v_cvt_pk_bf16_f32 v199, v206, v207
    s_waitcnt vmcnt(0)
    s_lshl_b32 s3, s28, 7
    s_add_u32 s3, s3, 0x410800
    s_mov_b64 exec, 1
    v_mov_b32 v3, 1
    buffer_atomic_add v3, off, s[8:11], s3 sc1
    s_mov_b64 exec, -1
    v_pk_mul_f32 v[32:33], v[208:209], v[208:209]
    v_pk_mul_f32 v[34:35], v[210:211], v[210:211]
    v_pk_mul_f32 v[36:37], v[212:213], v[212:213]
    v_pk_mul_f32 v[38:39], v[214:215], v[214:215]
    v_pk_mul_f32 v[40:41], v[216:217], v[216:217]
    v_pk_mul_f32 v[42:43], v[218:219], v[218:219]
    v_pk_mul_f32 v[44:45], v[220:221], v[220:221]
    v_pk_mul_f32 v[46:47], v[222:223], v[222:223]
    v_pk_fma_f32 v[32:33], v[32:33], v[4:5], v[22:23]
    v_pk_fma_f32 v[34:35], v[34:35], v[4:5], v[22:23]
    v_pk_fma_f32 v[36:37], v[36:37], v[4:5], v[22:23]
    v_pk_fma_f32 v[38:39], v[38:39], v[4:5], v[22:23]
    v_pk_fma_f32 v[40:41], v[40:41], v[4:5], v[22:23]
    v_pk_fma_f32 v[42:43], v[42:43], v[4:5], v[22:23]
    v_pk_fma_f32 v[44:45], v[44:45], v[4:5], v[22:23]
    v_pk_fma_f32 v[46:47], v[46:47], v[4:5], v[22:23]
    v_pk_mul_f32 v[32:33], v[32:33], v[208:209]
    v_pk_mul_f32 v[34:35], v[34:35], v[210:211]
    v_pk_mul_f32 v[36:37], v[36:37], v[212:213]
    v_pk_mul_f32 v[38:39], v[38:39], v[214:215]
    v_pk_mul_f32 v[40:41], v[40:41], v[216:217]
    v_pk_mul_f32 v[42:43], v[42:43], v[218:219]
    v_pk_mul_f32 v[44:45], v[44:45], v[220:221]
    v_pk_mul_f32 v[46:47], v[46:47], v[222:223]
    v_exp_f32 v32, v32
    v_exp_f32 v33, v33
    v_exp_f32 v34, v34
    v_exp_f32 v35, v35
    v_exp_f32 v36, v36
    v_exp_f32 v37, v37
    v_exp_f32 v38, v38
    v_exp_f32 v39, v39
    v_exp_f32 v40, v40
    v_exp_f32 v41, v41
    v_exp_f32 v42, v42
    v_exp_f32 v43, v43
    v_exp_f32 v44, v44
    v_exp_f32 v45, v45
    v_exp_f32 v46, v46
    v_exp_f32 v47, v47
    v_pk_fma_f32 v[32:33], v[32:33], v[20:21], v[20:21]
    v_pk_fma_f32 v[34:35], v[34:35], v[20:21], v[20:21]
    v_pk_fma_f32 v[36:37], v[36:37], v[20:21], v[20:21]
    v_pk_fma_f32 v[38:39], v[38:39], v[20:21], v[20:21]
    v_pk_fma_f32 v[40:41], v[40:41], v[20:21], v[20:21]
    v_pk_fma_f32 v[42:43], v[42:43], v[20:21], v[20:21]
    v_pk_fma_f32 v[44:45], v[44:45], v[20:21], v[20:21]
    v_pk_fma_f32 v[46:47], v[46:47], v[20:21], v[20:21]
    v_rcp_f32 v32, v32
    v_rcp_f32 v33, v33
    v_rcp_f32 v34, v34
    v_rcp_f32 v35, v35
    v_rcp_f32 v36, v36
    v_rcp_f32 v37, v37
    v_rcp_f32 v38, v38
    v_rcp_f32 v39, v39
    v_rcp_f32 v40, v40
    v_rcp_f32 v41, v41
    v_rcp_f32 v42, v42
    v_rcp_f32 v43, v43
    v_rcp_f32 v44, v44
    v_rcp_f32 v45, v45
    v_rcp_f32 v46, v46
    v_rcp_f32 v47, v47
    v_pk_mul_f32 v[208:209], v[208:209], v[32:33]
    v_pk_mul_f32 v[210:211], v[210:211], v[34:35]
    v_pk_mul_f32 v[212:213], v[212:213], v[36:37]
    v_pk_mul_f32 v[214:215], v[214:215], v[38:39]
    v_pk_mul_f32 v[216:217], v[216:217], v[40:41]
    v_pk_mul_f32 v[218:219], v[218:219], v[42:43]
    v_pk_mul_f32 v[220:221], v[220:221], v[44:45]
    v_pk_mul_f32 v[222:223], v[222:223], v[46:47]
    v_cvt_pk_bf16_f32 v208, v208, v209
    v_cvt_pk_bf16_f32 v209, v210, v211
    v_cvt_pk_bf16_f32 v210, v212, v213
    v_cvt_pk_bf16_f32 v211, v214, v215
    v_cvt_pk_bf16_f32 v212, v216, v217
    v_cvt_pk_bf16_f32 v213, v218, v219
    v_cvt_pk_bf16_f32 v214, v220, v221
    v_cvt_pk_bf16_f32 v215, v222, v223
    v_pk_mul_f32 v[32:33], v[224:225], v[224:225]
    v_pk_mul_f32 v[34:35], v[226:227], v[226:227]
    v_pk_mul_f32 v[36:37], v[228:229], v[228:229]
    v_pk_mul_f32 v[38:39], v[230:231], v[230:231]
    v_pk_mul_f32 v[40:41], v[232:233], v[232:233]
    v_pk_mul_f32 v[42:43], v[234:235], v[234:235]
    v_pk_mul_f32 v[44:45], v[236:237], v[236:237]
    v_pk_mul_f32 v[46:47], v[238:239], v[238:239]
    v_pk_fma_f32 v[32:33], v[32:33], v[10:11], v[28:29]
    v_pk_fma_f32 v[34:35], v[34:35], v[10:11], v[28:29]
    v_pk_fma_f32 v[36:37], v[36:37], v[10:11], v[28:29]
    v_pk_fma_f32 v[38:39], v[38:39], v[10:11], v[28:29]
    v_pk_fma_f32 v[40:41], v[40:41], v[10:11], v[28:29]
    v_pk_fma_f32 v[42:43], v[42:43], v[10:11], v[28:29]
    v_pk_fma_f32 v[44:45], v[44:45], v[10:11], v[28:29]
    v_pk_fma_f32 v[46:47], v[46:47], v[10:11], v[28:29]
    v_pk_mul_f32 v[32:33], v[32:33], v[224:225]
    v_pk_mul_f32 v[34:35], v[34:35], v[226:227]
    v_pk_mul_f32 v[36:37], v[36:37], v[228:229]
    v_pk_mul_f32 v[38:39], v[38:39], v[230:231]
    v_pk_mul_f32 v[40:41], v[40:41], v[232:233]
    v_pk_mul_f32 v[42:43], v[42:43], v[234:235]
    v_pk_mul_f32 v[44:45], v[44:45], v[236:237]
    v_pk_mul_f32 v[46:47], v[46:47], v[238:239]
    v_exp_f32 v32, v32
    v_exp_f32 v33, v33
    v_exp_f32 v34, v34
    v_exp_f32 v35, v35
    v_exp_f32 v36, v36
    v_exp_f32 v37, v37
    v_exp_f32 v38, v38
    v_exp_f32 v39, v39
    v_exp_f32 v40, v40
    v_exp_f32 v41, v41
    v_exp_f32 v42, v42
    v_exp_f32 v43, v43
    v_exp_f32 v44, v44
    v_exp_f32 v45, v45
    v_exp_f32 v46, v46
    v_exp_f32 v47, v47
    v_pk_fma_f32 v[32:33], v[32:33], v[26:27], v[26:27]
    v_pk_fma_f32 v[34:35], v[34:35], v[26:27], v[26:27]
    v_pk_fma_f32 v[36:37], v[36:37], v[26:27], v[26:27]
    v_pk_fma_f32 v[38:39], v[38:39], v[26:27], v[26:27]
    v_pk_fma_f32 v[40:41], v[40:41], v[26:27], v[26:27]
    v_pk_fma_f32 v[42:43], v[42:43], v[26:27], v[26:27]
    v_pk_fma_f32 v[44:45], v[44:45], v[26:27], v[26:27]
    v_pk_fma_f32 v[46:47], v[46:47], v[26:27], v[26:27]
    v_rcp_f32 v32, v32
    v_rcp_f32 v33, v33
    v_rcp_f32 v34, v34
    v_rcp_f32 v35, v35
    v_rcp_f32 v36, v36
    v_rcp_f32 v37, v37
    v_rcp_f32 v38, v38
    v_rcp_f32 v39, v39
    v_rcp_f32 v40, v40
    v_rcp_f32 v41, v41
    v_rcp_f32 v42, v42
    v_rcp_f32 v43, v43
    v_rcp_f32 v44, v44
    v_rcp_f32 v45, v45
    v_rcp_f32 v46, v46
    v_rcp_f32 v47, v47
    v_pk_mul_f32 v[224:225], v[224:225], v[32:33]
    v_pk_mul_f32 v[226:227], v[226:227], v[34:35]
    v_pk_mul_f32 v[228:229], v[228:229], v[36:37]
    v_pk_mul_f32 v[230:231], v[230:231], v[38:39]
    v_pk_mul_f32 v[232:233], v[232:233], v[40:41]
    v_pk_mul_f32 v[234:235], v[234:235], v[42:43]
    v_pk_mul_f32 v[236:237], v[236:237], v[44:45]
    v_pk_mul_f32 v[238:239], v[238:239], v[46:47]
    v_cvt_pk_bf16_f32 v224, v224, v225
    v_cvt_pk_bf16_f32 v225, v226, v227
    v_cvt_pk_bf16_f32 v226, v228, v229
    v_cvt_pk_bf16_f32 v227, v230, v231
    v_cvt_pk_bf16_f32 v228, v232, v233
    v_cvt_pk_bf16_f32 v229, v234, v235
    v_cvt_pk_bf16_f32 v230, v236, v237
    v_cvt_pk_bf16_f32 v231, v238, v239
    v_pk_mul_f32 v[32:33], v[240:241], v[240:241]
    v_pk_mul_f32 v[34:35], v[242:243], v[242:243]
    v_pk_mul_f32 v[36:37], v[244:245], v[244:245]
    v_pk_mul_f32 v[38:39], v[246:247], v[246:247]
    v_pk_mul_f32 v[40:41], v[248:249], v[248:249]
    v_pk_mul_f32 v[42:43], v[250:251], v[250:251]
    v_pk_mul_f32 v[44:45], v[252:253], v[252:253]
    v_pk_mul_f32 v[46:47], v[254:255], v[254:255]
    v_pk_fma_f32 v[32:33], v[32:33], v[4:5], v[22:23]
    v_pk_fma_f32 v[34:35], v[34:35], v[4:5], v[22:23]
    v_pk_fma_f32 v[36:37], v[36:37], v[4:5], v[22:23]
    v_pk_fma_f32 v[38:39], v[38:39], v[4:5], v[22:23]
    v_pk_fma_f32 v[40:41], v[40:41], v[4:5], v[22:23]
    v_pk_fma_f32 v[42:43], v[42:43], v[4:5], v[22:23]
    v_pk_fma_f32 v[44:45], v[44:45], v[4:5], v[22:23]
    v_pk_fma_f32 v[46:47], v[46:47], v[4:5], v[22:23]
    v_pk_mul_f32 v[32:33], v[32:33], v[240:241]
    v_pk_mul_f32 v[34:35], v[34:35], v[242:243]
    v_pk_mul_f32 v[36:37], v[36:37], v[244:245]
    v_pk_mul_f32 v[38:39], v[38:39], v[246:247]
    v_pk_mul_f32 v[40:41], v[40:41], v[248:249]
    v_pk_mul_f32 v[42:43], v[42:43], v[250:251]
    v_pk_mul_f32 v[44:45], v[44:45], v[252:253]
    v_pk_mul_f32 v[46:47], v[46:47], v[254:255]
    v_exp_f32 v32, v32
    v_exp_f32 v33, v33
    v_exp_f32 v34, v34
    v_exp_f32 v35, v35
    v_exp_f32 v36, v36
    v_exp_f32 v37, v37
    v_exp_f32 v38, v38
    v_exp_f32 v39, v39
    v_exp_f32 v40, v40
    v_exp_f32 v41, v41
    v_exp_f32 v42, v42
    v_exp_f32 v43, v43
    v_exp_f32 v44, v44
    v_exp_f32 v45, v45
    v_exp_f32 v46, v46
    v_exp_f32 v47, v47
    v_pk_fma_f32 v[32:33], v[32:33], v[20:21], v[20:21]
    v_pk_fma_f32 v[34:35], v[34:35], v[20:21], v[20:21]
    v_pk_fma_f32 v[36:37], v[36:37], v[20:21], v[20:21]
    v_pk_fma_f32 v[38:39], v[38:39], v[20:21], v[20:21]
    v_pk_fma_f32 v[40:41], v[40:41], v[20:21], v[20:21]
    v_pk_fma_f32 v[42:43], v[42:43], v[20:21], v[20:21]
    v_pk_fma_f32 v[44:45], v[44:45], v[20:21], v[20:21]
    v_pk_fma_f32 v[46:47], v[46:47], v[20:21], v[20:21]
    v_rcp_f32 v32, v32
    v_rcp_f32 v33, v33
    v_rcp_f32 v34, v34
    v_rcp_f32 v35, v35
    v_rcp_f32 v36, v36
    v_rcp_f32 v37, v37
    v_rcp_f32 v38, v38
    v_rcp_f32 v39, v39
    v_rcp_f32 v40, v40
    v_rcp_f32 v41, v41
    v_rcp_f32 v42, v42
    v_rcp_f32 v43, v43
    v_rcp_f32 v44, v44
    v_rcp_f32 v45, v45
    v_rcp_f32 v46, v46
    v_rcp_f32 v47, v47
    v_pk_mul_f32 v[240:241], v[240:241], v[32:33]
    v_pk_mul_f32 v[242:243], v[242:243], v[34:35]
    v_pk_mul_f32 v[244:245], v[244:245], v[36:37]
    v_pk_mul_f32 v[246:247], v[246:247], v[38:39]
    v_pk_mul_f32 v[248:249], v[248:249], v[40:41]
    v_pk_mul_f32 v[250:251], v[250:251], v[42:43]
    v_pk_mul_f32 v[252:253], v[252:253], v[44:45]
    v_pk_mul_f32 v[254:255], v[254:255], v[46:47]
    v_cvt_pk_bf16_f32 v240, v240, v241
    v_cvt_pk_bf16_f32 v241, v242, v243
    v_cvt_pk_bf16_f32 v242, v244, v245
    v_cvt_pk_bf16_f32 v243, v246, v247
    v_cvt_pk_bf16_f32 v244, v248, v249
    v_cvt_pk_bf16_f32 v245, v250, v251
    v_cvt_pk_bf16_f32 v246, v252, v253
    v_cvt_pk_bf16_f32 v247, v254, v255
    s_bfe_u32 s62, s2, 0x10005
    s_and_b32 s3, s2, 0x1e
    s_or_b32 s62, s62, s3
    s_and_b32 s3, s2, 1
    s_lshl_b32 s3, s3, 7
    s_or_b32 s62, s62, s3
    s_lshr_b32 s3, s2, 6
    s_lshl_b32 s3, s3, 5
    s_or_b32 s62, s62, s3
    s_and_b32 s35, s62, 1
    s_bfe_u32 s60, s62, 0x20001
    s_lshl_b32 s60, s60, 2
    s_bfe_u32 s3, s62, 0x20003
    s_add_u32 s60, s60, s3
    s_lshr_b32 s59, s62, 5
    s_lshl_b32 s59, s59, 8
    s_lshl_b32 s39, s60, 2
    s_add_u32 s39, s39, s24
    s_mul_i32 s38, s39, 294912
    s_add_u32 s38, s38, 0x1100000
    s_mul_i32 s3, s35, 106496
    s_add_u32 s37, s38, s3
    s_add_u32 s37, s37, 65536
    s_mul_i32 s32, s35, 3407872
    s_lshl_b32 s34, s24, 13
    s_add_u32 s34, s34, 32768
    s_lshl_b32 s39, s39, 16
    s_add_u32 s39, s39, s59
    s_lshr_b32 s60, s60, 1
    s_lshl_b32 s60, s60, 7
    s_add_u32 s61, s60, 0x411000
    s_add_u32 s60, s60, 0x410000
    s_lshr_b32 s3, s62, 1
    s_lshl_b32 s62, s3, 16
    s_lshl_b32 s63, s24, 14
    s_add_u32 s62, s62, s63
    s_add_u32 s62, s62, 0x2400000
    s_lshl_b32 s63, s3, 6
    s_add_u32 s63, s63, 0x412000
    s_cmp_eq_u32 s24, 0
    s_cselect_b32 s64, 128, 0
    s_cselect_b32 s65, 1, 0
    v_lshrrev_b32 v26, 4, v1
    v_bfe_u32 v27, v1, 2, 2
    v_xor_b32 v28, v27, v26
    v_and_b32 v29, 3, v1
    v_lshlrev_b32 v30, 4, v29
    v_lshl_add_u32 v30, v28, 6, v30
    v_lshl_add_u32 v30, v26, 11, v30
    s_lshl_b32 s3, s24, 16
    s_add_u32 s3, s3, s59
    v_add_u32 v8, s3, v30
    v_add_u32 v9, 7168, v8
    v_add_u32 v10, 14336, v8
    v_add_u32 v11, 21504, v8
    v_lshrrev_b32 v26, 5, v1
    v_lshl_add_u32 v28, v26, 2, v27
    v_bfe_u32 v30, v1, 4, 1
    v_lshlrev_b32 v29, 3, v29
    v_lshl_add_u32 v29, v30, 5, v29
    v_lshl_add_u32 v29, v28, 8, v29
    v_add_u32 v29, 32768, v29
    v_xor_b32 v30, 0, v27
    v_lshl_add_u32 v12, v30, 6, v29
    v_add_u32 v16, 0x10000, v12
    v_xor_b32 v30, 1, v27
    v_lshl_add_u32 v13, v30, 6, v29
    v_add_u32 v17, 0x10000, v13
    v_xor_b32 v30, 2, v27
    v_lshl_add_u32 v14, v30, 6, v29
    v_add_u32 v18, 0x10000, v14
    v_xor_b32 v30, 3, v27
    v_lshl_add_u32 v15, v30, 6, v29
    v_add_u32 v19, 0x10000, v15
    v_and_b32 v28, 31, v1
    v_lshlrev_b32 v22, 3, v26
    v_lshl_add_u32 v21, v28, 8, v22
    v_and_b32 v28, 15, v1
    v_lshl_add_u32 v21, v28, 4, v21
    s_lshl_b32 s3, s24, 13
    v_add_u32 v21, s3, v21
    v_add_u32 v20, s3, v2
    v_lshrrev_b32 v26, 4, v1
    v_xor_b32 v27, v28, v26
    v_lshlrev_b32 v27, 4, v27
    v_lshl_add_u32 v28, v26, 11, v27
    v_xor_b32 v29, 64, v28
    v_add_u32 v29, 7168, v29
    v_xor_b32 v30, 128, v28
    v_add_u32 v30, 14336, v30
    v_xor_b32 v31, 192, v28
    v_add_u32 v31, 21504, v31
    s_and_b32 s3, s2, 7
    s_lshr_b32 s25, s2, 3
    s_lshl_b32 s3, s3, 2
    s_lshr_b32 s26, s25, 3
    s_add_u32 s26, s26, s3
    s_and_b32 s27, s25, 7
    s_lshr_b32 s3, s26, 1
    s_lshl_b32 s3, s3, 7
    s_add_u32 s36, s3, 0x410800
    s_cmp_lg_u32 s24, 0
    s_cbranch_scc1 L_at1
    s_mov_b32 vcc_lo, 0x40000
L_atp:
    v_mov_b32 v3, s36
    global_load_dword v3, v3, s[6:7] sc1
    s_sub_u32 vcc_lo, vcc_lo, 1
    s_cbranch_scc1 L_atpx
    s_waitcnt vmcnt(0)
    v_readfirstlane_b32 s3, v3
    s_cmp_ge_u32 s3, 64
    s_cbranch_scc0 L_atp
L_atpx:
    s_waitcnt vmcnt(0)
L_at1:
    s_getpc_b64 s[44:45]
L_pc2:
    s_sub_u32 s44, s44, L_pc2-parallel_sum__softmax_full_mha__mixer_channel_mlp__prompt_kernel
    s_subb_u32 s45, s45, 0
    s_lshr_b32 s3, s2, 3
    s_lshl_b32 s3, s3, 2
    s_add_u32 s3, s3, s24
    s_lshl_b32 s3, s3, 10
    s_add_u32 s3, s3, L_at1-parallel_sum__softmax_full_mha__mixer_channel_mlp__prompt_kernel
    v_lshl_add_u32 v3, v1, 4, s3
    v_min_u32 v3, L_zend-parallel_sum__softmax_full_mha__mixer_channel_mlp__prompt_kernel-4, v3
    global_load_dword v3, v3, s[44:45]
    s_lshl_b32 s29, s26, 17
    s_lshl_b32 s3, s24, 15
    s_add_u32 s30, s29, s3
    s_add_u32 s31, s30, 0xd00000
    s_add_u32 s30, s30, 0x900000
    s_add_u32 s3, s24, 0
    s_and_b32 s3, s3, 3
    s_lshl_b32 s3, s3, 1
    s_lshl_b32 s33, s27, 3
    s_add_u32 s44, s33, s3
    s_lshl_b32 s3, s44, 11
    s_add_u32 s3, s3, s29
    s_add_u32 s48, s3, 0x500000
    s_add_u32 s3, s24, 1
    s_and_b32 s3, s3, 3
    s_lshl_b32 s3, s3, 1
    s_lshl_b32 s33, s27, 3
    s_add_u32 s45, s33, s3
    s_lshl_b32 s3, s45, 11
    s_add_u32 s3, s3, s29
    s_add_u32 s49, s3, 0x500000
    s_add_u32 s3, s24, 2
    s_and_b32 s3, s3, 3
    s_lshl_b32 s3, s3, 1
    s_lshl_b32 s33, s27, 3
    s_add_u32 s46, s33, s3
    s_lshl_b32 s3, s46, 11
    s_add_u32 s3, s3, s29
    s_add_u32 s50, s3, 0x500000
    s_add_u32 s3, s24, 3
    s_and_b32 s3, s3, 3
    s_lshl_b32 s3, s3, 1
    s_lshl_b32 s33, s27, 3
    s_add_u32 s47, s33, s3
    s_lshl_b32 s3, s47, 11
    s_add_u32 s3, s3, s29
    s_add_u32 s51, s3, 0x500000
    s_barrier
    buffer_load_dwordx4 v[96:99], v2, s[8:11], s30 offen offset:0 sc1
    buffer_load_dwordx4 v[100:103], v2, s[8:11], s30 offen offset:1024 sc1
    buffer_load_dwordx4 a[0:3], v2, s[8:11], s48 offen offset:0 sc1
    buffer_load_dwordx4 a[4:7], v2, s[8:11], s48 offen offset:1024 sc1
    buffer_load_dwordx4 a[8:11], v2, s[8:11], s48 offen offset:2048 sc1
    buffer_load_dwordx4 a[12:15], v2, s[8:11], s48 offen offset:3072 sc1
    buffer_load_dwordx4 v[120:123], v2, s[8:11], s31 offen offset:0 sc1
    buffer_load_dwordx4 v[124:127], v2, s[8:11], s31 offen offset:1024 sc1
    buffer_load_dwordx4 a[16:19], v2, s[8:11], s49 offen offset:0 sc1
    buffer_load_dwordx4 a[20:23], v2, s[8:11], s49 offen offset:1024 sc1
    buffer_load_dwordx4 a[24:27], v2, s[8:11], s49 offen offset:2048 sc1
    buffer_load_dwordx4 a[28:31], v2, s[8:11], s49 offen offset:3072 sc1
    buffer_load_dwordx4 a[32:35], v2, s[8:11], s50 offen offset:0 sc1
    buffer_load_dwordx4 a[36:39], v2, s[8:11], s50 offen offset:1024 sc1
    buffer_load_dwordx4 a[40:43], v2, s[8:11], s50 offen offset:2048 sc1
    buffer_load_dwordx4 a[44:47], v2, s[8:11], s50 offen offset:3072 sc1
    buffer_load_dwordx4 a[48:51], v2, s[8:11], s51 offen offset:0 sc1
    buffer_load_dwordx4 a[52:55], v2, s[8:11], s51 offen offset:1024 sc1
    buffer_load_dwordx4 a[56:59], v2, s[8:11], s51 offen offset:2048 sc1
    buffer_load_dwordx4 a[60:63], v2, s[8:11], s51 offen offset:3072 sc1
    buffer_load_dwordx4 v[104:107], v2, s[8:11], s30 offen offset:2048 sc1
    buffer_load_dwordx4 v[108:111], v2, s[8:11], s30 offen offset:3072 sc1
    s_add_u32 s30, s30, 4096
    buffer_load_dwordx4 v[128:131], v2, s[8:11], s31 offen offset:2048 sc1
    buffer_load_dwordx4 v[132:135], v2, s[8:11], s31 offen offset:3072 sc1
    s_add_u32 s31, s31, 4096
    buffer_load_dwordx4 v[112:115], v2, s[8:11], s30 offen offset:0 sc1
    buffer_load_dwordx4 v[116:119], v2, s[8:11], s30 offen offset:1024 sc1
    buffer_load_dwordx4 v[136:139], v2, s[8:11], s31 offen offset:0 sc1
    buffer_load_dwordx4 v[140:143], v2, s[8:11], s31 offen offset:1024 sc1
    buffer_load_dwordx4 v[152:155], v2, s[8:11], s30 offen offset:2048 sc1
    buffer_load_dwordx4 v[156:159], v2, s[8:11], s30 offen offset:3072 sc1
    s_add_u32 s30, s30, 4096
    buffer_load_dwordx4 v[168:171], v2, s[8:11], s31 offen offset:2048 sc1
    buffer_load_dwordx4 v[172:175], v2, s[8:11], s31 offen offset:3072 sc1
    s_add_u32 s31, s31, 4096
    v_lshrrev_b32 v4, 2, v1
    v_lshrrev_b32 v5, 4, v1
    v_xor_b32 v4, v4, v5
    v_and_b32 v4, 1, v4
    v_cmp_eq_u32 vcc, 0, v4
    v_mov_b32 v5, 0x3f803f80
    s_mul_i32 s33, s24, 26112
    v_cndmask_b32 v88, 0, v5, vcc
    v_cndmask_b32 v89, 0, v5, vcc
    v_cndmask_b32 v90, 0, v5, vcc
    v_cndmask_b32 v91, 0, v5, vcc
    v_add_u32 v36, s33, v2
    s_add_u32 s3, s24, 1
    s_and_b32 s3, s3, 3
    s_mul_i32 s3, s3, 26112
    s_add_u32 s3, s3, 0
    v_add_u32 v37, s3, v2
    s_add_u32 s3, s24, 2
    s_and_b32 s3, s3, 3
    s_mul_i32 s3, s3, 26112
    s_add_u32 s3, s3, 8704
    v_add_u32 v38, s3, v2
    s_add_u32 s3, s24, 3
    s_and_b32 s3, s3, 3
    s_mul_i32 s3, s3, 26112
    s_add_u32 s3, s3, 17408
    v_add_u32 v39, s3, v2
    v_lshlrev_b32 v40, 2, v1
    v_sub_u32 v40, v40, v2
    v_add_u32 v32, v36, v40
    v_add_u32 v33, v37, v40
    v_add_u32 v34, v38, v40
    v_add_u32 v35, v39, v40
    s_waitcnt vmcnt(28)
    s_and_b32 s3, s2, 1
    s_xor_b32 s3, s3, 0
    s_lshl_b32 s3, s3, 2
    s_bfe_u32 s33, s2, 0x20003
    s_add_u32 s3, s3, s33
    s_lshl_b32 s3, s3, 7
    s_add_u32 s36, s3, 0x410000
    v_mfma_f32_32x32x16_bf16 v[48:63], v[96:99], a[0:3], 0
    v_mfma_f32_32x32x16_bf16 v[48:63], v[100:103], a[4:7], v[48:63]
    s_nop 7
    s_nop 3
    s_waitcnt vmcnt(24)
    v_exp_f32 v48, v48
    v_exp_f32 v49, v49
    v_exp_f32 v50, v50
    v_exp_f32 v51, v51
    v_exp_f32 v52, v52
    v_exp_f32 v53, v53
    v_mfma_f32_32x32x16_bf16 v[64:79], v[96:99], a[8:11], 0
    v_exp_f32 v54, v54
    v_exp_f32 v55, v55
    v_cvt_pk_bf16_f32 v80, v48, v49
    v_cvt_pk_bf16_f32 v81, v50, v51
    v_mfma_f32_32x32x16_bf16 v[64:79], v[100:103], a[12:15], v[64:79]
    v_cvt_pk_bf16_f32 v82, v52, v53
    v_cvt_pk_bf16_f32 v83, v54, v55
    v_exp_f32 v56, v56
    v_exp_f32 v57, v57
    v_mfma_f32_32x32x16_bf16 a[64:79], v[120:123], v[80:83], 0
    v_exp_f32 v58, v58
    v_exp_f32 v59, v59
    v_exp_f32 v60, v60
    v_mfma_f32_16x16x32_bf16 a[192:195], v[88:91], v[80:83], 0
    v_exp_f32 v61, v61
    v_exp_f32 v62, v62
    v_exp_f32 v63, v63
    v_cvt_pk_bf16_f32 v84, v56, v57
    v_cvt_pk_bf16_f32 v85, v58, v59
    v_cvt_pk_bf16_f32 v86, v60, v61
    v_cvt_pk_bf16_f32 v87, v62, v63
    s_waitcnt vmcnt(22)
    v_exp_f32 v64, v64
    v_exp_f32 v65, v65
    v_mfma_f32_32x32x16_bf16 a[64:79], v[124:127], v[84:87], a[64:79]
    v_exp_f32 v66, v66
    v_exp_f32 v67, v67
    v_exp_f32 v68, v68
    v_mfma_f32_16x16x32_bf16 a[192:195], v[88:91], v[84:87], a[192:195]
    v_exp_f32 v69, v69
    v_mfma_f32_32x32x16_bf16 v[48:63], v[96:99], a[16:19], 0
    v_exp_f32 v70, v70
    v_exp_f32 v71, v71
    v_cvt_pk_bf16_f32 v80, v64, v65
    v_cvt_pk_bf16_f32 v81, v66, v67
    v_mfma_f32_32x32x16_bf16 v[48:63], v[100:103], a[20:23], v[48:63]
    v_cvt_pk_bf16_f32 v82, v68, v69
    v_cvt_pk_bf16_f32 v83, v70, v71
    v_exp_f32 v72, v72
    v_exp_f32 v73, v73
    v_mfma_f32_32x32x16_bf16 a[80:95], v[120:123], v[80:83], 0
    v_exp_f32 v74, v74
    v_exp_f32 v75, v75
    v_exp_f32 v76, v76
    v_mfma_f32_16x16x32_bf16 a[196:199], v[88:91], v[80:83], 0
    buffer_load_dwordx4 v[184:187], v2, s[8:11], s30 offen offset:0 sc1
    buffer_load_dwordx4 v[188:191], v2, s[8:11], s30 offen offset:1024 sc1
    v_exp_f32 v77, v77
    v_exp_f32 v78, v78
    v_exp_f32 v79, v79
    buffer_load_dwordx4 v[200:203], v2, s[8:11], s31 offen offset:0 sc1
    buffer_load_dwordx4 v[204:207], v2, s[8:11], s31 offen offset:1024 sc1
    v_cvt_pk_bf16_f32 v84, v72, v73
    v_cvt_pk_bf16_f32 v85, v74, v75
    v_cvt_pk_bf16_f32 v86, v76, v77
    v_cvt_pk_bf16_f32 v87, v78, v79
    s_waitcnt vmcnt(24)
    v_exp_f32 v48, v48
    v_exp_f32 v49, v49
    v_mfma_f32_32x32x16_bf16 a[80:95], v[124:127], v[84:87], a[80:95]
    v_exp_f32 v50, v50
    v_exp_f32 v51, v51
    v_exp_f32 v52, v52
    v_mfma_f32_16x16x32_bf16 a[196:199], v[88:91], v[84:87], a[196:199]
    v_exp_f32 v53, v53
    v_mfma_f32_32x32x16_bf16 v[64:79], v[96:99], a[24:27], 0
    v_exp_f32 v54, v54
    v_exp_f32 v55, v55
    v_cvt_pk_bf16_f32 v80, v48, v49
    v_cvt_pk_bf16_f32 v81, v50, v51
    v_mfma_f32_32x32x16_bf16 v[64:79], v[100:103], a[28:31], v[64:79]
    v_cvt_pk_bf16_f32 v82, v52, v53
    v_cvt_pk_bf16_f32 v83, v54, v55
    v_exp_f32 v56, v56
    v_exp_f32 v57, v57
    v_mfma_f32_32x32x16_bf16 a[96:111], v[120:123], v[80:83], 0
    v_exp_f32 v58, v58
    v_exp_f32 v59, v59
    v_exp_f32 v60, v60
    v_mfma_f32_16x16x32_bf16 a[200:203], v[88:91], v[80:83], 0
    v_exp_f32 v61, v61
    v_exp_f32 v62, v62
    v_exp_f32 v63, v63
    v_cvt_pk_bf16_f32 v84, v56, v57
    v_cvt_pk_bf16_f32 v85, v58, v59
    v_cvt_pk_bf16_f32 v86, v60, v61
    v_cvt_pk_bf16_f32 v87, v62, v63
    s_waitcnt vmcnt(22)
    v_exp_f32 v64, v64
    v_exp_f32 v65, v65
    v_mfma_f32_32x32x16_bf16 a[96:111], v[124:127], v[84:87], a[96:111]
    v_exp_f32 v66, v66
    v_exp_f32 v67, v67
    v_exp_f32 v68, v68
    v_mfma_f32_16x16x32_bf16 a[200:203], v[88:91], v[84:87], a[200:203]
    v_exp_f32 v69, v69
    v_mfma_f32_32x32x16_bf16 v[48:63], v[96:99], a[32:35], 0
    v_exp_f32 v70, v70
    v_exp_f32 v71, v71
    v_cvt_pk_bf16_f32 v80, v64, v65
    v_cvt_pk_bf16_f32 v81, v66, v67
    v_mfma_f32_32x32x16_bf16 v[48:63], v[100:103], a[36:39], v[48:63]
    v_cvt_pk_bf16_f32 v82, v68, v69
    v_cvt_pk_bf16_f32 v83, v70, v71
    v_exp_f32 v72, v72
    v_exp_f32 v73, v73
    v_mfma_f32_32x32x16_bf16 a[112:127], v[120:123], v[80:83], 0
    v_exp_f32 v74, v74
    v_exp_f32 v75, v75
    v_exp_f32 v76, v76
    v_mfma_f32_16x16x32_bf16 a[204:207], v[88:91], v[80:83], 0
    buffer_store_dwordx4 v[144:147], v2, s[8:11], s66 offen offset:0 sc1
    buffer_store_dwordx4 v[148:151], v2, s[8:11], s66 offen offset:1024 sc1
    v_exp_f32 v77, v77
    v_exp_f32 v78, v78
    v_exp_f32 v79, v79
    v_cvt_pk_bf16_f32 v84, v72, v73
    v_cvt_pk_bf16_f32 v85, v74, v75
    v_cvt_pk_bf16_f32 v86, v76, v77
    v_cvt_pk_bf16_f32 v87, v78, v79
    s_waitcnt vmcnt(22)
    v_exp_f32 v48, v48
    v_exp_f32 v49, v49
    v_mfma_f32_32x32x16_bf16 a[112:127], v[124:127], v[84:87], a[112:127]
    v_exp_f32 v50, v50
    v_exp_f32 v51, v51
    v_exp_f32 v52, v52
    v_mfma_f32_16x16x32_bf16 a[204:207], v[88:91], v[84:87], a[204:207]
    v_exp_f32 v53, v53
    v_mfma_f32_32x32x16_bf16 v[64:79], v[96:99], a[40:43], 0
    v_exp_f32 v54, v54
    v_exp_f32 v55, v55
    v_cvt_pk_bf16_f32 v80, v48, v49
    v_cvt_pk_bf16_f32 v81, v50, v51
    v_mfma_f32_32x32x16_bf16 v[64:79], v[100:103], a[44:47], v[64:79]
    v_cvt_pk_bf16_f32 v82, v52, v53
    v_cvt_pk_bf16_f32 v83, v54, v55
    v_exp_f32 v56, v56
    v_exp_f32 v57, v57
    v_mfma_f32_32x32x16_bf16 a[128:143], v[120:123], v[80:83], 0
    v_exp_f32 v58, v58
    v_exp_f32 v59, v59
    v_exp_f32 v60, v60
    v_mfma_f32_16x16x32_bf16 a[208:211], v[88:91], v[80:83], 0
    v_exp_f32 v61, v61
    v_exp_f32 v62, v62
    v_exp_f32 v63, v63
    v_cvt_pk_bf16_f32 v84, v56, v57
    v_cvt_pk_bf16_f32 v85, v58, v59
    v_cvt_pk_bf16_f32 v86, v60, v61
    v_cvt_pk_bf16_f32 v87, v62, v63
    s_waitcnt vmcnt(20)
    v_exp_f32 v64, v64
    v_exp_f32 v65, v65
    v_mfma_f32_32x32x16_bf16 a[128:143], v[124:127], v[84:87], a[128:143]
    v_exp_f32 v66, v66
    v_exp_f32 v67, v67
    v_exp_f32 v68, v68
    v_mfma_f32_16x16x32_bf16 a[208:211], v[88:91], v[84:87], a[208:211]
    v_exp_f32 v69, v69
    v_mfma_f32_32x32x16_bf16 v[48:63], v[96:99], a[48:51], 0
    v_exp_f32 v70, v70
    v_exp_f32 v71, v71
    v_cvt_pk_bf16_f32 v80, v64, v65
    v_cvt_pk_bf16_f32 v81, v66, v67
    v_mfma_f32_32x32x16_bf16 v[48:63], v[100:103], a[52:55], v[48:63]
    v_cvt_pk_bf16_f32 v82, v68, v69
    v_cvt_pk_bf16_f32 v83, v70, v71
    v_exp_f32 v72, v72
    v_exp_f32 v73, v73
    v_mfma_f32_32x32x16_bf16 a[144:159], v[120:123], v[80:83], 0
    v_exp_f32 v74, v74
    v_exp_f32 v75, v75
    v_exp_f32 v76, v76
    v_mfma_f32_16x16x32_bf16 a[212:215], v[88:91], v[80:83], 0
    v_exp_f32 v77, v77
    v_exp_f32 v78, v78
    v_exp_f32 v79, v79
    v_cvt_pk_bf16_f32 v84, v72, v73
    v_cvt_pk_bf16_f32 v85, v74, v75
    v_cvt_pk_bf16_f32 v86, v76, v77
    v_cvt_pk_bf16_f32 v87, v78, v79
    s_waitcnt vmcnt(18)
    v_exp_f32 v48, v48
    v_exp_f32 v49, v49
    v_mfma_f32_32x32x16_bf16 a[144:159], v[124:127], v[84:87], a[144:159]
    v_exp_f32 v50, v50
    v_exp_f32 v51, v51
    v_exp_f32 v52, v52
    v_mfma_f32_16x16x32_bf16 a[212:215], v[88:91], v[84:87], a[212:215]
    v_exp_f32 v53, v53
    v_mfma_f32_32x32x16_bf16 v[64:79], v[96:99], a[56:59], 0
    v_exp_f32 v54, v54
    v_exp_f32 v55, v55
    v_cvt_pk_bf16_f32 v80, v48, v49
    v_cvt_pk_bf16_f32 v81, v50, v51
    v_mfma_f32_32x32x16_bf16 v[64:79], v[100:103], a[60:63], v[64:79]
    v_cvt_pk_bf16_f32 v82, v52, v53
    v_cvt_pk_bf16_f32 v83, v54, v55
    v_exp_f32 v56, v56
    v_exp_f32 v57, v57
    v_mfma_f32_32x32x16_bf16 a[160:175], v[120:123], v[80:83], 0
    v_exp_f32 v58, v58
    v_exp_f32 v59, v59
    v_exp_f32 v60, v60
    v_mfma_f32_16x16x32_bf16 a[216:219], v[88:91], v[80:83], 0
    v_exp_f32 v61, v61
    v_exp_f32 v62, v62
    v_exp_f32 v63, v63
    v_cvt_pk_bf16_f32 v84, v56, v57
    v_cvt_pk_bf16_f32 v85, v58, v59
    v_cvt_pk_bf16_f32 v86, v60, v61
    v_cvt_pk_bf16_f32 v87, v62, v63
    s_waitcnt vmcnt(14)
    v_exp_f32 v64, v64
    v_exp_f32 v65, v65
    v_mfma_f32_32x32x16_bf16 a[160:175], v[124:127], v[84:87], a[160:175]
    v_exp_f32 v66, v66
    v_exp_f32 v67, v67
    v_exp_f32 v68, v68
    v_mfma_f32_16x16x32_bf16 a[216:219], v[88:91], v[84:87], a[216:219]
    v_exp_f32 v69, v69
    v_mfma_f32_32x32x16_bf16 v[48:63], v[104:107], a[0:3], 0
    v_exp_f32 v70, v70
    v_exp_f32 v71, v71
    v_cvt_pk_bf16_f32 v80, v64, v65
    v_cvt_pk_bf16_f32 v81, v66, v67
    v_mfma_f32_32x32x16_bf16 v[48:63], v[108:111], a[4:7], v[48:63]
    v_cvt_pk_bf16_f32 v82, v68, v69
    v_cvt_pk_bf16_f32 v83, v70, v71
    v_exp_f32 v72, v72
    v_exp_f32 v73, v73
    v_mfma_f32_32x32x16_bf16 a[176:191], v[120:123], v[80:83], 0
    v_exp_f32 v74, v74
    v_exp_f32 v75, v75
    v_exp_f32 v76, v76
    v_mfma_f32_16x16x32_bf16 a[220:223], v[88:91], v[80:83], 0
    v_exp_f32 v77, v77
    v_exp_f32 v78, v78
    v_exp_f32 v79, v79
    v_cvt_pk_bf16_f32 v84, v72, v73
    v_cvt_pk_bf16_f32 v85, v74, v75
    v_cvt_pk_bf16_f32 v86, v76, v77
    v_cvt_pk_bf16_f32 v87, v78, v79
    v_exp_f32 v48, v48
    v_exp_f32 v49, v49
    v_mfma_f32_32x32x16_bf16 a[176:191], v[124:127], v[84:87], a[176:191]
    v_exp_f32 v50, v50
    v_exp_f32 v51, v51
    v_exp_f32 v52, v52
    v_mfma_f32_16x16x32_bf16 a[220:223], v[88:91], v[84:87], a[220:223]
    v_exp_f32 v53, v53
    v_mfma_f32_32x32x16_bf16 v[64:79], v[104:107], a[8:11], 0
    v_exp_f32 v54, v54
    v_exp_f32 v55, v55
    v_cvt_pk_bf16_f32 v80, v48, v49
    v_cvt_pk_bf16_f32 v81, v50, v51
    v_mfma_f32_32x32x16_bf16 v[64:79], v[108:111], a[12:15], v[64:79]
    v_cvt_pk_bf16_f32 v82, v52, v53
    v_cvt_pk_bf16_f32 v83, v54, v55
    v_exp_f32 v56, v56
    v_exp_f32 v57, v57
    v_mfma_f32_32x32x16_bf16 a[64:79], v[128:131], v[80:83], a[64:79]
    v_exp_f32 v58, v58
    v_exp_f32 v59, v59
    v_exp_f32 v60, v60
    v_mfma_f32_16x16x32_bf16 a[192:195], v[88:91], v[80:83], a[192:195]
    v_exp_f32 v61, v61
    v_exp_f32 v62, v62
    v_exp_f32 v63, v63
    v_cvt_pk_bf16_f32 v84, v56, v57
    v_cvt_pk_bf16_f32 v85, v58, v59
    v_cvt_pk_bf16_f32 v86, v60, v61
    v_cvt_pk_bf16_f32 v87, v62, v63
    v_exp_f32 v64, v64
    v_exp_f32 v65, v65
    v_mfma_f32_32x32x16_bf16 a[64:79], v[132:135], v[84:87], a[64:79]
    v_exp_f32 v66, v66
    v_exp_f32 v67, v67
    v_exp_f32 v68, v68
    v_mfma_f32_16x16x32_bf16 a[192:195], v[88:91], v[84:87], a[192:195]
    v_exp_f32 v69, v69
    v_mfma_f32_32x32x16_bf16 v[48:63], v[104:107], a[16:19], 0
    v_exp_f32 v70, v70
    v_exp_f32 v71, v71
    v_cvt_pk_bf16_f32 v80, v64, v65
    v_cvt_pk_bf16_f32 v81, v66, v67
    v_mfma_f32_32x32x16_bf16 v[48:63], v[108:111], a[20:23], v[48:63]
    v_cvt_pk_bf16_f32 v82, v68, v69
    v_cvt_pk_bf16_f32 v83, v70, v71
    v_exp_f32 v72, v72
    v_exp_f32 v73, v73
    v_mfma_f32_32x32x16_bf16 a[80:95], v[128:131], v[80:83], a[80:95]
    v_exp_f32 v74, v74
    v_exp_f32 v75, v75
    v_exp_f32 v76, v76
    v_mfma_f32_16x16x32_bf16 a[196:199], v[88:91], v[80:83], a[196:199]
    buffer_load_dwordx4 v[96:99], v2, s[8:11], s30 offen offset:2048 sc1
    buffer_load_dwordx4 v[100:103], v2, s[8:11], s30 offen offset:3072 sc1
    v_exp_f32 v77, v77
    v_exp_f32 v78, v78
    v_exp_f32 v79, v79
    s_add_u32 s30, s30, 4096
    buffer_load_dwordx4 v[120:123], v2, s[8:11], s31 offen offset:2048 sc1
    v_cvt_pk_bf16_f32 v84, v72, v73
    v_cvt_pk_bf16_f32 v85, v74, v75
    buffer_load_dwordx4 v[124:127], v2, s[8:11], s31 offen offset:3072 sc1
    s_add_u32 s31, s31, 4096
    v_cvt_pk_bf16_f32 v86, v76, v77
    v_cvt_pk_bf16_f32 v87, v78, v79
    v_exp_f32 v48, v48
    v_exp_f32 v49, v49
    v_mfma_f32_32x32x16_bf16 a[80:95], v[132:135], v[84:87], a[80:95]
    v_exp_f32 v50, v50
    v_exp_f32 v51, v51
    v_exp_f32 v52, v52
    v_mfma_f32_16x16x32_bf16 a[196:199], v[88:91], v[84:87], a[196:199]
    v_exp_f32 v53, v53
    v_mfma_f32_32x32x16_bf16 v[64:79], v[104:107], a[24:27], 0
    v_exp_f32 v54, v54
    v_exp_f32 v55, v55
    v_cvt_pk_bf16_f32 v80, v48, v49
    v_cvt_pk_bf16_f32 v81, v50, v51
    v_mfma_f32_32x32x16_bf16 v[64:79], v[108:111], a[28:31], v[64:79]
    v_cvt_pk_bf16_f32 v82, v52, v53
    v_cvt_pk_bf16_f32 v83, v54, v55
    v_exp_f32 v56, v56
    v_exp_f32 v57, v57
    v_mfma_f32_32x32x16_bf16 a[96:111], v[128:131], v[80:83], a[96:111]
    v_exp_f32 v58, v58
    v_exp_f32 v59, v59
    v_exp_f32 v60, v60
    v_mfma_f32_16x16x32_bf16 a[200:203], v[88:91], v[80:83], a[200:203]
    v_exp_f32 v61, v61
    v_exp_f32 v62, v62
    v_exp_f32 v63, v63
    v_cvt_pk_bf16_f32 v84, v56, v57
    v_cvt_pk_bf16_f32 v85, v58, v59
    v_cvt_pk_bf16_f32 v86, v60, v61
    v_cvt_pk_bf16_f32 v87, v62, v63
    v_exp_f32 v64, v64
    v_exp_f32 v65, v65
    v_mfma_f32_32x32x16_bf16 a[96:111], v[132:135], v[84:87], a[96:111]
    v_exp_f32 v66, v66
    v_exp_f32 v67, v67
    v_exp_f32 v68, v68
    v_mfma_f32_16x16x32_bf16 a[200:203], v[88:91], v[84:87], a[200:203]
    v_exp_f32 v69, v69
    v_mfma_f32_32x32x16_bf16 v[48:63], v[104:107], a[32:35], 0
    v_exp_f32 v70, v70
    v_exp_f32 v71, v71
    v_cvt_pk_bf16_f32 v80, v64, v65
    v_cvt_pk_bf16_f32 v81, v66, v67
    v_mfma_f32_32x32x16_bf16 v[48:63], v[108:111], a[36:39], v[48:63]
    v_cvt_pk_bf16_f32 v82, v68, v69
    v_cvt_pk_bf16_f32 v83, v70, v71
    v_exp_f32 v72, v72
    v_exp_f32 v73, v73
    v_mfma_f32_32x32x16_bf16 a[112:127], v[128:131], v[80:83], a[112:127]
    v_exp_f32 v74, v74
    v_exp_f32 v75, v75
    v_exp_f32 v76, v76
    v_mfma_f32_16x16x32_bf16 a[204:207], v[88:91], v[80:83], a[204:207]
    buffer_store_dwordx4 v[160:163], v2, s[8:11], s67 offen offset:0 sc1
    buffer_store_dwordx4 v[164:167], v2, s[8:11], s67 offen offset:1024 sc1
    v_exp_f32 v77, v77
    v_exp_f32 v78, v78
    v_exp_f32 v79, v79
    v_cvt_pk_bf16_f32 v84, v72, v73
    v_cvt_pk_bf16_f32 v85, v74, v75
    v_cvt_pk_bf16_f32 v86, v76, v77
    v_cvt_pk_bf16_f32 v87, v78, v79
    v_exp_f32 v48, v48
    v_exp_f32 v49, v49
    v_mfma_f32_32x32x16_bf16 a[112:127], v[132:135], v[84:87], a[112:127]
    v_exp_f32 v50, v50
    v_exp_f32 v51, v51
    v_exp_f32 v52, v52
    v_mfma_f32_16x16x32_bf16 a[204:207], v[88:91], v[84:87], a[204:207]
    v_exp_f32 v53, v53
    v_mfma_f32_32x32x16_bf16 v[64:79], v[104:107], a[40:43], 0
    v_exp_f32 v54, v54
    v_exp_f32 v55, v55
    v_cvt_pk_bf16_f32 v80, v48, v49
    v_cvt_pk_bf16_f32 v81, v50, v51
    v_mfma_f32_32x32x16_bf16 v[64:79], v[108:111], a[44:47], v[64:79]
    v_cvt_pk_bf16_f32 v82, v52, v53
    v_cvt_pk_bf16_f32 v83, v54, v55
    v_exp_f32 v56, v56
    v_exp_f32 v57, v57
    v_mfma_f32_32x32x16_bf16 a[128:143], v[128:131], v[80:83], a[128:143]
    v_exp_f32 v58, v58
    v_exp_f32 v59, v59
    v_exp_f32 v60, v60
    v_mfma_f32_16x16x32_bf16 a[208:211], v[88:91], v[80:83], a[208:211]
    v_exp_f32 v61, v61
    v_exp_f32 v62, v62
    v_exp_f32 v63, v63
    v_cvt_pk_bf16_f32 v84, v56, v57
    v_cvt_pk_bf16_f32 v85, v58, v59
    v_cvt_pk_bf16_f32 v86, v60, v61
    v_cvt_pk_bf16_f32 v87, v62, v63
    v_exp_f32 v64, v64
    v_exp_f32 v65, v65
    v_mfma_f32_32x32x16_bf16 a[128:143], v[132:135], v[84:87], a[128:143]
    v_exp_f32 v66, v66
    v_exp_f32 v67, v67
    v_exp_f32 v68, v68
    v_mfma_f32_16x16x32_bf16 a[208:211], v[88:91], v[84:87], a[208:211]
    v_exp_f32 v69, v69
    v_mfma_f32_32x32x16_bf16 v[48:63], v[104:107], a[48:51], 0
    v_exp_f32 v70, v70
    v_exp_f32 v71, v71
    v_cvt_pk_bf16_f32 v80, v64, v65
    v_cvt_pk_bf16_f32 v81, v66, v67
    v_mfma_f32_32x32x16_bf16 v[48:63], v[108:111], a[52:55], v[48:63]
    v_cvt_pk_bf16_f32 v82, v68, v69
    v_cvt_pk_bf16_f32 v83, v70, v71
    v_exp_f32 v72, v72
    v_exp_f32 v73, v73
    v_mfma_f32_32x32x16_bf16 a[144:159], v[128:131], v[80:83], a[144:159]
    v_exp_f32 v74, v74
    v_exp_f32 v75, v75
    v_exp_f32 v76, v76
    v_mfma_f32_16x16x32_bf16 a[212:215], v[88:91], v[80:83], a[212:215]
    v_exp_f32 v77, v77
    v_exp_f32 v78, v78
    v_exp_f32 v79, v79
    v_cvt_pk_bf16_f32 v84, v72, v73
    v_cvt_pk_bf16_f32 v85, v74, v75
    v_cvt_pk_bf16_f32 v86, v76, v77
    v_cvt_pk_bf16_f32 v87, v78, v79
    v_exp_f32 v48, v48
    v_exp_f32 v49, v49
    v_mfma_f32_32x32x16_bf16 a[144:159], v[132:135], v[84:87], a[144:159]
    v_exp_f32 v50, v50
    v_exp_f32 v51, v51
    v_exp_f32 v52, v52
    v_mfma_f32_16x16x32_bf16 a[212:215], v[88:91], v[84:87], a[212:215]
    v_exp_f32 v53, v53
    v_mfma_f32_32x32x16_bf16 v[64:79], v[104:107], a[56:59], 0
    v_exp_f32 v54, v54
    v_exp_f32 v55, v55
    v_cvt_pk_bf16_f32 v80, v48, v49
    v_cvt_pk_bf16_f32 v81, v50, v51
    v_mfma_f32_32x32x16_bf16 v[64:79], v[108:111], a[60:63], v[64:79]
    v_cvt_pk_bf16_f32 v82, v52, v53
    v_cvt_pk_bf16_f32 v83, v54, v55
    v_exp_f32 v56, v56
    v_exp_f32 v57, v57
    v_mfma_f32_32x32x16_bf16 a[160:175], v[128:131], v[80:83], a[160:175]
    v_exp_f32 v58, v58
    v_exp_f32 v59, v59
    v_exp_f32 v60, v60
    v_mfma_f32_16x16x32_bf16 a[216:219], v[88:91], v[80:83], a[216:219]
    v_exp_f32 v61, v61
    v_exp_f32 v62, v62
    v_exp_f32 v63, v63
    v_cvt_pk_bf16_f32 v84, v56, v57
    v_cvt_pk_bf16_f32 v85, v58, v59
    v_cvt_pk_bf16_f32 v86, v60, v61
    v_cvt_pk_bf16_f32 v87, v62, v63
    s_waitcnt vmcnt(16)
    v_exp_f32 v64, v64
    v_exp_f32 v65, v65
    v_mfma_f32_32x32x16_bf16 a[160:175], v[132:135], v[84:87], a[160:175]
    v_exp_f32 v66, v66
    v_exp_f32 v67, v67
    v_exp_f32 v68, v68
    v_mfma_f32_16x16x32_bf16 a[216:219], v[88:91], v[84:87], a[216:219]
    v_exp_f32 v69, v69
    v_mfma_f32_32x32x16_bf16 v[48:63], v[112:115], a[0:3], 0
    v_exp_f32 v70, v70
    v_exp_f32 v71, v71
    v_cvt_pk_bf16_f32 v80, v64, v65
    v_cvt_pk_bf16_f32 v81, v66, v67
    v_mfma_f32_32x32x16_bf16 v[48:63], v[116:119], a[4:7], v[48:63]
    v_cvt_pk_bf16_f32 v82, v68, v69
    v_cvt_pk_bf16_f32 v83, v70, v71
    v_exp_f32 v72, v72
    v_exp_f32 v73, v73
    v_mfma_f32_32x32x16_bf16 a[176:191], v[128:131], v[80:83], a[176:191]
    v_exp_f32 v74, v74
    v_exp_f32 v75, v75
    v_exp_f32 v76, v76
    v_mfma_f32_16x16x32_bf16 a[220:223], v[88:91], v[80:83], a[220:223]
    v_exp_f32 v77, v77
    v_exp_f32 v78, v78
    v_exp_f32 v79, v79
    v_cvt_pk_bf16_f32 v84, v72, v73
    v_cvt_pk_bf16_f32 v85, v74, v75
    v_cvt_pk_bf16_f32 v86, v76, v77
    v_cvt_pk_bf16_f32 v87, v78, v79
    v_exp_f32 v48, v48
    v_exp_f32 v49, v49
    v_mfma_f32_32x32x16_bf16 a[176:191], v[132:135], v[84:87], a[176:191]
    v_exp_f32 v50, v50
    v_exp_f32 v51, v51
    v_exp_f32 v52, v52
    v_mfma_f32_16x16x32_bf16 a[220:223], v[88:91], v[84:87], a[220:223]
    v_exp_f32 v53, v53
    v_mfma_f32_32x32x16_bf16 v[64:79], v[112:115], a[8:11], 0
    v_exp_f32 v54, v54
    v_exp_f32 v55, v55
    v_cvt_pk_bf16_f32 v80, v48, v49
    v_cvt_pk_bf16_f32 v81, v50, v51
    v_mfma_f32_32x32x16_bf16 v[64:79], v[116:119], a[12:15], v[64:79]
    v_cvt_pk_bf16_f32 v82, v52, v53
    v_cvt_pk_bf16_f32 v83, v54, v55
    v_exp_f32 v56, v56
    v_exp_f32 v57, v57
    v_mfma_f32_32x32x16_bf16 a[64:79], v[136:139], v[80:83], a[64:79]
    v_exp_f32 v58, v58
    v_exp_f32 v59, v59
    v_exp_f32 v60, v60
    v_mfma_f32_16x16x32_bf16 a[192:195], v[88:91], v[80:83], a[192:195]
    v_exp_f32 v61, v61
    v_exp_f32 v62, v62
    v_exp_f32 v63, v63
    v_cvt_pk_bf16_f32 v84, v56, v57
    v_cvt_pk_bf16_f32 v85, v58, v59
    v_cvt_pk_bf16_f32 v86, v60, v61
    v_cvt_pk_bf16_f32 v87, v62, v63
    v_exp_f32 v64, v64
    v_exp_f32 v65, v65
    v_mfma_f32_32x32x16_bf16 a[64:79], v[140:143], v[84:87], a[64:79]
    v_exp_f32 v66, v66
    v_exp_f32 v67, v67
    v_exp_f32 v68, v68
    v_mfma_f32_16x16x32_bf16 a[192:195], v[88:91], v[84:87], a[192:195]
    v_exp_f32 v69, v69
    v_mfma_f32_32x32x16_bf16 v[48:63], v[112:115], a[16:19], 0
    v_exp_f32 v70, v70
    v_exp_f32 v71, v71
    v_cvt_pk_bf16_f32 v80, v64, v65
    v_cvt_pk_bf16_f32 v81, v66, v67
    v_mfma_f32_32x32x16_bf16 v[48:63], v[116:119], a[20:23], v[48:63]
    v_cvt_pk_bf16_f32 v82, v68, v69
    v_cvt_pk_bf16_f32 v83, v70, v71
    v_exp_f32 v72, v72
    v_exp_f32 v73, v73
    v_mfma_f32_32x32x16_bf16 a[80:95], v[136:139], v[80:83], a[80:95]
    v_exp_f32 v74, v74
    v_exp_f32 v75, v75
    v_exp_f32 v76, v76
    v_mfma_f32_16x16x32_bf16 a[196:199], v[88:91], v[80:83], a[196:199]
    buffer_load_dwordx4 v[104:107], v2, s[8:11], s30 offen offset:0 sc1
    buffer_load_dwordx4 v[108:111], v2, s[8:11], s30 offen offset:1024 sc1
    v_exp_f32 v77, v77
    v_exp_f32 v78, v78
    v_exp_f32 v79, v79
    buffer_load_dwordx4 v[128:131], v2, s[8:11], s31 offen offset:0 sc1
    buffer_load_dwordx4 v[132:135], v2, s[8:11], s31 offen offset:1024 sc1
    v_cvt_pk_bf16_f32 v84, v72, v73
    v_cvt_pk_bf16_f32 v85, v74, v75
    v_cvt_pk_bf16_f32 v86, v76, v77
    v_cvt_pk_bf16_f32 v87, v78, v79
    v_exp_f32 v48, v48
    v_exp_f32 v49, v49
    v_mfma_f32_32x32x16_bf16 a[80:95], v[140:143], v[84:87], a[80:95]
    v_exp_f32 v50, v50
    v_exp_f32 v51, v51
    v_exp_f32 v52, v52
    v_mfma_f32_16x16x32_bf16 a[196:199], v[88:91], v[84:87], a[196:199]
    v_exp_f32 v53, v53
    v_mfma_f32_32x32x16_bf16 v[64:79], v[112:115], a[24:27], 0
    v_exp_f32 v54, v54
    v_exp_f32 v55, v55
    v_cvt_pk_bf16_f32 v80, v48, v49
    v_cvt_pk_bf16_f32 v81, v50, v51
    v_mfma_f32_32x32x16_bf16 v[64:79], v[116:119], a[28:31], v[64:79]
    v_cvt_pk_bf16_f32 v82, v52, v53
    v_cvt_pk_bf16_f32 v83, v54, v55
    v_exp_f32 v56, v56
    v_exp_f32 v57, v57
    v_mfma_f32_32x32x16_bf16 a[96:111], v[136:139], v[80:83], a[96:111]
    v_exp_f32 v58, v58
    v_exp_f32 v59, v59
    v_exp_f32 v60, v60
    v_mfma_f32_16x16x32_bf16 a[200:203], v[88:91], v[80:83], a[200:203]
    v_exp_f32 v61, v61
    v_exp_f32 v62, v62
    v_exp_f32 v63, v63
    v_cvt_pk_bf16_f32 v84, v56, v57
    v_cvt_pk_bf16_f32 v85, v58, v59
    v_cvt_pk_bf16_f32 v86, v60, v61
    v_cvt_pk_bf16_f32 v87, v62, v63
    v_exp_f32 v64, v64
    v_exp_f32 v65, v65
    v_mfma_f32_32x32x16_bf16 a[96:111], v[140:143], v[84:87], a[96:111]
    v_exp_f32 v66, v66
    v_exp_f32 v67, v67
    v_exp_f32 v68, v68
    v_mfma_f32_16x16x32_bf16 a[200:203], v[88:91], v[84:87], a[200:203]
    v_exp_f32 v69, v69
    v_mfma_f32_32x32x16_bf16 v[48:63], v[112:115], a[32:35], 0
    v_exp_f32 v70, v70
    v_exp_f32 v71, v71
    v_cvt_pk_bf16_f32 v80, v64, v65
    v_cvt_pk_bf16_f32 v81, v66, v67
    v_mfma_f32_32x32x16_bf16 v[48:63], v[116:119], a[36:39], v[48:63]
    v_cvt_pk_bf16_f32 v82, v68, v69
    v_cvt_pk_bf16_f32 v83, v70, v71
    v_exp_f32 v72, v72
    v_exp_f32 v73, v73
    v_mfma_f32_32x32x16_bf16 a[112:127], v[136:139], v[80:83], a[112:127]
    v_exp_f32 v74, v74
    v_exp_f32 v75, v75
    v_exp_f32 v76, v76
    v_mfma_f32_16x16x32_bf16 a[204:207], v[88:91], v[80:83], a[204:207]
    buffer_store_dwordx4 v[176:179], v2, s[8:11], s66 offen offset:2048 sc1
    buffer_store_dwordx4 v[180:183], v2, s[8:11], s66 offen offset:3072 sc1
    v_exp_f32 v77, v77
    v_exp_f32 v78, v78
    v_exp_f32 v79, v79
    v_cvt_pk_bf16_f32 v84, v72, v73
    v_cvt_pk_bf16_f32 v85, v74, v75
    v_cvt_pk_bf16_f32 v86, v76, v77
    v_cvt_pk_bf16_f32 v87, v78, v79
    v_exp_f32 v48, v48
    v_exp_f32 v49, v49
    v_mfma_f32_32x32x16_bf16 a[112:127], v[140:143], v[84:87], a[112:127]
    v_exp_f32 v50, v50
    v_exp_f32 v51, v51
    v_exp_f32 v52, v52
    v_mfma_f32_16x16x32_bf16 a[204:207], v[88:91], v[84:87], a[204:207]
    v_exp_f32 v53, v53
    v_mfma_f32_32x32x16_bf16 v[64:79], v[112:115], a[40:43], 0
    v_exp_f32 v54, v54
    v_exp_f32 v55, v55
    v_cvt_pk_bf16_f32 v80, v48, v49
    v_cvt_pk_bf16_f32 v81, v50, v51
    v_mfma_f32_32x32x16_bf16 v[64:79], v[116:119], a[44:47], v[64:79]
    v_cvt_pk_bf16_f32 v82, v52, v53
    v_cvt_pk_bf16_f32 v83, v54, v55
    v_exp_f32 v56, v56
    v_exp_f32 v57, v57
    v_mfma_f32_32x32x16_bf16 a[128:143], v[136:139], v[80:83], a[128:143]
    v_exp_f32 v58, v58
    v_exp_f32 v59, v59
    v_exp_f32 v60, v60
    v_mfma_f32_16x16x32_bf16 a[208:211], v[88:91], v[80:83], a[208:211]
    v_exp_f32 v61, v61
    v_exp_f32 v62, v62
    v_exp_f32 v63, v63
    v_cvt_pk_bf16_f32 v84, v56, v57
    v_cvt_pk_bf16_f32 v85, v58, v59
    v_cvt_pk_bf16_f32 v86, v60, v61
    v_cvt_pk_bf16_f32 v87, v62, v63
    v_exp_f32 v64, v64
    v_exp_f32 v65, v65
    v_mfma_f32_32x32x16_bf16 a[128:143], v[140:143], v[84:87], a[128:143]
    v_exp_f32 v66, v66
    v_exp_f32 v67, v67
    v_exp_f32 v68, v68
    v_mfma_f32_16x16x32_bf16 a[208:211], v[88:91], v[84:87], a[208:211]
    v_exp_f32 v69, v69
    v_mfma_f32_32x32x16_bf16 v[48:63], v[112:115], a[48:51], 0
    v_exp_f32 v70, v70
    v_exp_f32 v71, v71
    v_cvt_pk_bf16_f32 v80, v64, v65
    v_cvt_pk_bf16_f32 v81, v66, v67
    v_mfma_f32_32x32x16_bf16 v[48:63], v[116:119], a[52:55], v[48:63]
    v_cvt_pk_bf16_f32 v82, v68, v69
    v_cvt_pk_bf16_f32 v83, v70, v71
    v_exp_f32 v72, v72
    v_exp_f32 v73, v73
    v_mfma_f32_32x32x16_bf16 a[144:159], v[136:139], v[80:83], a[144:159]
    v_exp_f32 v74, v74
    v_exp_f32 v75, v75
    v_exp_f32 v76, v76
    v_mfma_f32_16x16x32_bf16 a[212:215], v[88:91], v[80:83], a[212:215]
    v_exp_f32 v77, v77
    v_exp_f32 v78, v78
    v_exp_f32 v79, v79
    v_cvt_pk_bf16_f32 v84, v72, v73
    v_cvt_pk_bf16_f32 v85, v74, v75
    v_cvt_pk_bf16_f32 v86, v76, v77
    v_cvt_pk_bf16_f32 v87, v78, v79
    v_exp_f32 v48, v48
    v_exp_f32 v49, v49
    v_mfma_f32_32x32x16_bf16 a[144:159], v[140:143], v[84:87], a[144:159]
    v_exp_f32 v50, v50
    v_exp_f32 v51, v51
    v_exp_f32 v52, v52
    v_mfma_f32_16x16x32_bf16 a[212:215], v[88:91], v[84:87], a[212:215]
    v_exp_f32 v53, v53
    v_mfma_f32_32x32x16_bf16 v[64:79], v[112:115], a[56:59], 0
    v_exp_f32 v54, v54
    v_exp_f32 v55, v55
    v_cvt_pk_bf16_f32 v80, v48, v49
    v_cvt_pk_bf16_f32 v81, v50, v51
    v_mfma_f32_32x32x16_bf16 v[64:79], v[116:119], a[60:63], v[64:79]
    v_cvt_pk_bf16_f32 v82, v52, v53
    v_cvt_pk_bf16_f32 v83, v54, v55
    v_exp_f32 v56, v56
    v_exp_f32 v57, v57
    v_mfma_f32_32x32x16_bf16 a[160:175], v[136:139], v[80:83], a[160:175]
    v_exp_f32 v58, v58
    v_exp_f32 v59, v59
    v_exp_f32 v60, v60
    v_mfma_f32_16x16x32_bf16 a[216:219], v[88:91], v[80:83], a[216:219]
    v_exp_f32 v61, v61
    v_exp_f32 v62, v62
    v_exp_f32 v63, v63
    v_cvt_pk_bf16_f32 v84, v56, v57
    v_cvt_pk_bf16_f32 v85, v58, v59
    v_cvt_pk_bf16_f32 v86, v60, v61
    v_cvt_pk_bf16_f32 v87, v62, v63
    s_waitcnt vmcnt(18)
    v_exp_f32 v64, v64
    v_exp_f32 v65, v65
    v_mfma_f32_32x32x16_bf16 a[160:175], v[140:143], v[84:87], a[160:175]
    v_exp_f32 v66, v66
    v_exp_f32 v67, v67
    v_exp_f32 v68, v68
    v_mfma_f32_16x16x32_bf16 a[216:219], v[88:91], v[84:87], a[216:219]
    v_exp_f32 v69, v69
    v_mfma_f32_32x32x16_bf16 v[48:63], v[152:155], a[0:3], 0
    v_exp_f32 v70, v70
    v_exp_f32 v71, v71
    v_cvt_pk_bf16_f32 v80, v64, v65
    v_cvt_pk_bf16_f32 v81, v66, v67
    v_mfma_f32_32x32x16_bf16 v[48:63], v[156:159], a[4:7], v[48:63]
    v_cvt_pk_bf16_f32 v82, v68, v69
    v_cvt_pk_bf16_f32 v83, v70, v71
    v_exp_f32 v72, v72
    v_exp_f32 v73, v73
    v_mfma_f32_32x32x16_bf16 a[176:191], v[136:139], v[80:83], a[176:191]
    v_exp_f32 v74, v74
    v_exp_f32 v75, v75
    v_exp_f32 v76, v76
    v_mfma_f32_16x16x32_bf16 a[220:223], v[88:91], v[80:83], a[220:223]
    v_exp_f32 v77, v77
    v_exp_f32 v78, v78
    v_exp_f32 v79, v79
    v_cvt_pk_bf16_f32 v84, v72, v73
    v_cvt_pk_bf16_f32 v85, v74, v75
    v_cvt_pk_bf16_f32 v86, v76, v77
    v_cvt_pk_bf16_f32 v87, v78, v79
    v_exp_f32 v48, v48
    v_exp_f32 v49, v49
    v_mfma_f32_32x32x16_bf16 a[176:191], v[140:143], v[84:87], a[176:191]
    v_exp_f32 v50, v50
    v_exp_f32 v51, v51
    v_exp_f32 v52, v52
    v_mfma_f32_16x16x32_bf16 a[220:223], v[88:91], v[84:87], a[220:223]
    v_exp_f32 v53, v53
    v_mfma_f32_32x32x16_bf16 v[64:79], v[152:155], a[8:11], 0
    v_exp_f32 v54, v54
    v_exp_f32 v55, v55
    v_cvt_pk_bf16_f32 v80, v48, v49
    v_cvt_pk_bf16_f32 v81, v50, v51
    v_mfma_f32_32x32x16_bf16 v[64:79], v[156:159], a[12:15], v[64:79]
    v_cvt_pk_bf16_f32 v82, v52, v53
    v_cvt_pk_bf16_f32 v83, v54, v55
    v_exp_f32 v56, v56
    v_exp_f32 v57, v57
    v_mfma_f32_32x32x16_bf16 a[64:79], v[168:171], v[80:83], a[64:79]
    v_exp_f32 v58, v58
    v_exp_f32 v59, v59
    v_exp_f32 v60, v60
    v_mfma_f32_16x16x32_bf16 a[192:195], v[88:91], v[80:83], a[192:195]
    v_exp_f32 v61, v61
    v_exp_f32 v62, v62
    v_exp_f32 v63, v63
    v_cvt_pk_bf16_f32 v84, v56, v57
    v_cvt_pk_bf16_f32 v85, v58, v59
    v_cvt_pk_bf16_f32 v86, v60, v61
    v_cvt_pk_bf16_f32 v87, v62, v63
    v_exp_f32 v64, v64
    v_exp_f32 v65, v65
    v_mfma_f32_32x32x16_bf16 a[64:79], v[172:175], v[84:87], a[64:79]
    v_exp_f32 v66, v66
    v_exp_f32 v67, v67
    v_exp_f32 v68, v68
    v_mfma_f32_16x16x32_bf16 a[192:195], v[88:91], v[84:87], a[192:195]
    v_exp_f32 v69, v69
    v_mfma_f32_32x32x16_bf16 v[48:63], v[152:155], a[16:19], 0
    v_exp_f32 v70, v70
    v_exp_f32 v71, v71
    v_cvt_pk_bf16_f32 v80, v64, v65
    v_cvt_pk_bf16_f32 v81, v66, v67
    v_mfma_f32_32x32x16_bf16 v[48:63], v[156:159], a[20:23], v[48:63]
    v_cvt_pk_bf16_f32 v82, v68, v69
    v_cvt_pk_bf16_f32 v83, v70, v71
    v_exp_f32 v72, v72
    v_exp_f32 v73, v73
    v_mfma_f32_32x32x16_bf16 a[80:95], v[168:171], v[80:83], a[80:95]
    v_exp_f32 v74, v74
    v_exp_f32 v75, v75
    v_exp_f32 v76, v76
    v_mfma_f32_16x16x32_bf16 a[196:199], v[88:91], v[80:83], a[196:199]
    buffer_load_dwordx4 v[112:115], v2, s[8:11], s30 offen offset:2048 sc1
    buffer_load_dwordx4 v[116:119], v2, s[8:11], s30 offen offset:3072 sc1
    v_exp_f32 v77, v77
    v_exp_f32 v78, v78
    v_exp_f32 v79, v79
    s_add_u32 s30, s30, 4096
    buffer_load_dwordx4 v[136:139], v2, s[8:11], s31 offen offset:2048 sc1
    v_cvt_pk_bf16_f32 v84, v72, v73
    v_cvt_pk_bf16_f32 v85, v74, v75
    buffer_load_dwordx4 v[140:143], v2, s[8:11], s31 offen offset:3072 sc1
    s_add_u32 s31, s31, 4096
    v_cvt_pk_bf16_f32 v86, v76, v77
    v_cvt_pk_bf16_f32 v87, v78, v79
    v_exp_f32 v48, v48
    v_exp_f32 v49, v49
    v_mfma_f32_32x32x16_bf16 a[80:95], v[172:175], v[84:87], a[80:95]
    v_exp_f32 v50, v50
    v_exp_f32 v51, v51
    v_exp_f32 v52, v52
    v_mfma_f32_16x16x32_bf16 a[196:199], v[88:91], v[84:87], a[196:199]
    v_exp_f32 v53, v53
    v_mfma_f32_32x32x16_bf16 v[64:79], v[152:155], a[24:27], 0
    v_exp_f32 v54, v54
    v_exp_f32 v55, v55
    v_cvt_pk_bf16_f32 v80, v48, v49
    v_cvt_pk_bf16_f32 v81, v50, v51
    v_mfma_f32_32x32x16_bf16 v[64:79], v[156:159], a[28:31], v[64:79]
    v_cvt_pk_bf16_f32 v82, v52, v53
    v_cvt_pk_bf16_f32 v83, v54, v55
    v_exp_f32 v56, v56
    v_exp_f32 v57, v57
    v_mfma_f32_32x32x16_bf16 a[96:111], v[168:171], v[80:83], a[96:111]
    v_exp_f32 v58, v58
    v_exp_f32 v59, v59
    v_exp_f32 v60, v60
    v_mfma_f32_16x16x32_bf16 a[200:203], v[88:91], v[80:83], a[200:203]
    v_exp_f32 v61, v61
    v_exp_f32 v62, v62
    v_exp_f32 v63, v63
    v_cvt_pk_bf16_f32 v84, v56, v57
    v_cvt_pk_bf16_f32 v85, v58, v59
    v_cvt_pk_bf16_f32 v86, v60, v61
    v_cvt_pk_bf16_f32 v87, v62, v63
    v_exp_f32 v64, v64
    v_exp_f32 v65, v65
    v_mfma_f32_32x32x16_bf16 a[96:111], v[172:175], v[84:87], a[96:111]
    v_exp_f32 v66, v66
    v_exp_f32 v67, v67
    v_exp_f32 v68, v68
    v_mfma_f32_16x16x32_bf16 a[200:203], v[88:91], v[84:87], a[200:203]
    v_exp_f32 v69, v69
    v_mfma_f32_32x32x16_bf16 v[48:63], v[152:155], a[32:35], 0
    v_exp_f32 v70, v70
    v_exp_f32 v71, v71
    v_cvt_pk_bf16_f32 v80, v64, v65
    v_cvt_pk_bf16_f32 v81, v66, v67
    v_mfma_f32_32x32x16_bf16 v[48:63], v[156:159], a[36:39], v[48:63]
    v_cvt_pk_bf16_f32 v82, v68, v69
    v_cvt_pk_bf16_f32 v83, v70, v71
    v_exp_f32 v72, v72
    v_exp_f32 v73, v73
    v_mfma_f32_32x32x16_bf16 a[112:127], v[168:171], v[80:83], a[112:127]
    v_exp_f32 v74, v74
    v_exp_f32 v75, v75
    v_exp_f32 v76, v76
    v_mfma_f32_16x16x32_bf16 a[204:207], v[88:91], v[80:83], a[204:207]
    buffer_store_dwordx4 v[192:195], v2, s[8:11], s67 offen offset:2048 sc1
    buffer_store_dwordx4 v[196:199], v2, s[8:11], s67 offen offset:3072 sc1
    v_exp_f32 v77, v77
    v_exp_f32 v78, v78
    v_exp_f32 v79, v79
    v_cvt_pk_bf16_f32 v84, v72, v73
    v_cvt_pk_bf16_f32 v85, v74, v75
    v_cvt_pk_bf16_f32 v86, v76, v77
    v_cvt_pk_bf16_f32 v87, v78, v79
    v_exp_f32 v48, v48
    v_exp_f32 v49, v49
    v_mfma_f32_32x32x16_bf16 a[112:127], v[172:175], v[84:87], a[112:127]
    v_exp_f32 v50, v50
    v_exp_f32 v51, v51
    v_exp_f32 v52, v52
    v_mfma_f32_16x16x32_bf16 a[204:207], v[88:91], v[84:87], a[204:207]
    v_exp_f32 v53, v53
    v_mfma_f32_32x32x16_bf16 v[64:79], v[152:155], a[40:43], 0
    v_exp_f32 v54, v54
    v_exp_f32 v55, v55
    v_cvt_pk_bf16_f32 v80, v48, v49
    v_cvt_pk_bf16_f32 v81, v50, v51
    v_mfma_f32_32x32x16_bf16 v[64:79], v[156:159], a[44:47], v[64:79]
    v_cvt_pk_bf16_f32 v82, v52, v53
    v_cvt_pk_bf16_f32 v83, v54, v55
    v_exp_f32 v56, v56
    v_exp_f32 v57, v57
    v_mfma_f32_32x32x16_bf16 a[128:143], v[168:171], v[80:83], a[128:143]
    v_exp_f32 v58, v58
    v_exp_f32 v59, v59
    v_exp_f32 v60, v60
    v_mfma_f32_16x16x32_bf16 a[208:211], v[88:91], v[80:83], a[208:211]
    v_exp_f32 v61, v61
    v_exp_f32 v62, v62
    v_exp_f32 v63, v63
    v_cvt_pk_bf16_f32 v84, v56, v57
    v_cvt_pk_bf16_f32 v85, v58, v59
    v_cvt_pk_bf16_f32 v86, v60, v61
    v_cvt_pk_bf16_f32 v87, v62, v63
    v_exp_f32 v64, v64
    v_exp_f32 v65, v65
    v_mfma_f32_32x32x16_bf16 a[128:143], v[172:175], v[84:87], a[128:143]
    v_exp_f32 v66, v66
    v_exp_f32 v67, v67
    v_exp_f32 v68, v68
    v_mfma_f32_16x16x32_bf16 a[208:211], v[88:91], v[84:87], a[208:211]
    v_exp_f32 v69, v69
    v_mfma_f32_32x32x16_bf16 v[48:63], v[152:155], a[48:51], 0
    v_exp_f32 v70, v70
    v_exp_f32 v71, v71
    v_cvt_pk_bf16_f32 v80, v64, v65
    v_cvt_pk_bf16_f32 v81, v66, v67
    v_mfma_f32_32x32x16_bf16 v[48:63], v[156:159], a[52:55], v[48:63]
    v_cvt_pk_bf16_f32 v82, v68, v69
    v_cvt_pk_bf16_f32 v83, v70, v71
    v_exp_f32 v72, v72
    v_exp_f32 v73, v73
    v_mfma_f32_32x32x16_bf16 a[144:159], v[168:171], v[80:83], a[144:159]
    v_exp_f32 v74, v74
    v_exp_f32 v75, v75
    v_exp_f32 v76, v76
    v_mfma_f32_16x16x32_bf16 a[212:215], v[88:91], v[80:83], a[212:215]
    v_exp_f32 v77, v77
    v_exp_f32 v78, v78
    v_exp_f32 v79, v79
    v_cvt_pk_bf16_f32 v84, v72, v73
    v_cvt_pk_bf16_f32 v85, v74, v75
    v_cvt_pk_bf16_f32 v86, v76, v77
    v_cvt_pk_bf16_f32 v87, v78, v79
    v_exp_f32 v48, v48
    v_exp_f32 v49, v49
    v_mfma_f32_32x32x16_bf16 a[144:159], v[172:175], v[84:87], a[144:159]
    v_exp_f32 v50, v50
    v_exp_f32 v51, v51
    v_exp_f32 v52, v52
    v_mfma_f32_16x16x32_bf16 a[212:215], v[88:91], v[84:87], a[212:215]
    v_exp_f32 v53, v53
    v_mfma_f32_32x32x16_bf16 v[64:79], v[152:155], a[56:59], 0
    v_exp_f32 v54, v54
    v_exp_f32 v55, v55
    v_cvt_pk_bf16_f32 v80, v48, v49
    v_cvt_pk_bf16_f32 v81, v50, v51
    v_mfma_f32_32x32x16_bf16 v[64:79], v[156:159], a[60:63], v[64:79]
    v_cvt_pk_bf16_f32 v82, v52, v53
    v_cvt_pk_bf16_f32 v83, v54, v55
    v_exp_f32 v56, v56
    v_exp_f32 v57, v57
    v_mfma_f32_32x32x16_bf16 a[160:175], v[168:171], v[80:83], a[160:175]
    v_exp_f32 v58, v58
    v_exp_f32 v59, v59
    v_exp_f32 v60, v60
    v_mfma_f32_16x16x32_bf16 a[216:219], v[88:91], v[80:83], a[216:219]
    v_exp_f32 v61, v61
    v_exp_f32 v62, v62
    v_exp_f32 v63, v63
    v_cvt_pk_bf16_f32 v84, v56, v57
    v_cvt_pk_bf16_f32 v85, v58, v59
    v_cvt_pk_bf16_f32 v86, v60, v61
    v_cvt_pk_bf16_f32 v87, v62, v63
    s_waitcnt vmcnt(20)
    v_exp_f32 v64, v64
    v_exp_f32 v65, v65
    v_mfma_f32_32x32x16_bf16 a[160:175], v[172:175], v[84:87], a[160:175]
    v_exp_f32 v66, v66
    v_exp_f32 v67, v67
    v_exp_f32 v68, v68
    v_mfma_f32_16x16x32_bf16 a[216:219], v[88:91], v[84:87], a[216:219]
    v_exp_f32 v69, v69
    v_mfma_f32_32x32x16_bf16 v[48:63], v[184:187], a[0:3], 0
    v_exp_f32 v70, v70
    v_exp_f32 v71, v71
    v_cvt_pk_bf16_f32 v80, v64, v65
    v_cvt_pk_bf16_f32 v81, v66, v67
    v_mfma_f32_32x32x16_bf16 v[48:63], v[188:191], a[4:7], v[48:63]
    v_cvt_pk_bf16_f32 v82, v68, v69
    v_cvt_pk_bf16_f32 v83, v70, v71
    v_exp_f32 v72, v72
    v_exp_f32 v73, v73
    v_mfma_f32_32x32x16_bf16 a[176:191], v[168:171], v[80:83], a[176:191]
    v_exp_f32 v74, v74
    v_exp_f32 v75, v75
    v_exp_f32 v76, v76
    v_mfma_f32_16x16x32_bf16 a[220:223], v[88:91], v[80:83], a[220:223]
    v_exp_f32 v77, v77
    v_exp_f32 v78, v78
    v_exp_f32 v79, v79
    v_cvt_pk_bf16_f32 v84, v72, v73
    v_cvt_pk_bf16_f32 v85, v74, v75
    v_cvt_pk_bf16_f32 v86, v76, v77
    v_cvt_pk_bf16_f32 v87, v78, v79
    v_exp_f32 v48, v48
    v_exp_f32 v49, v49
    v_mfma_f32_32x32x16_bf16 a[176:191], v[172:175], v[84:87], a[176:191]
    v_exp_f32 v50, v50
    v_exp_f32 v51, v51
    v_exp_f32 v52, v52
    v_mfma_f32_16x16x32_bf16 a[220:223], v[88:91], v[84:87], a[220:223]
    v_exp_f32 v53, v53
    v_mfma_f32_32x32x16_bf16 v[64:79], v[184:187], a[8:11], 0
    v_exp_f32 v54, v54
    v_exp_f32 v55, v55
    v_cvt_pk_bf16_f32 v80, v48, v49
    v_cvt_pk_bf16_f32 v81, v50, v51
    v_mfma_f32_32x32x16_bf16 v[64:79], v[188:191], a[12:15], v[64:79]
    v_cvt_pk_bf16_f32 v82, v52, v53
    v_cvt_pk_bf16_f32 v83, v54, v55
    v_exp_f32 v56, v56
    v_exp_f32 v57, v57
    v_mfma_f32_32x32x16_bf16 a[64:79], v[200:203], v[80:83], a[64:79]
    v_exp_f32 v58, v58
    v_exp_f32 v59, v59
    v_exp_f32 v60, v60
    v_mfma_f32_16x16x32_bf16 a[192:195], v[88:91], v[80:83], a[192:195]
    v_exp_f32 v61, v61
    v_exp_f32 v62, v62
    v_exp_f32 v63, v63
    v_cvt_pk_bf16_f32 v84, v56, v57
    v_cvt_pk_bf16_f32 v85, v58, v59
    v_cvt_pk_bf16_f32 v86, v60, v61
    v_cvt_pk_bf16_f32 v87, v62, v63
    v_exp_f32 v64, v64
    v_exp_f32 v65, v65
    v_mfma_f32_32x32x16_bf16 a[64:79], v[204:207], v[84:87], a[64:79]
    v_exp_f32 v66, v66
    v_exp_f32 v67, v67
    v_exp_f32 v68, v68
    v_mfma_f32_16x16x32_bf16 a[192:195], v[88:91], v[84:87], a[192:195]
    v_exp_f32 v69, v69
    v_mfma_f32_32x32x16_bf16 v[48:63], v[184:187], a[16:19], 0
    v_exp_f32 v70, v70
    v_exp_f32 v71, v71
    v_cvt_pk_bf16_f32 v80, v64, v65
    v_cvt_pk_bf16_f32 v81, v66, v67
    v_mfma_f32_32x32x16_bf16 v[48:63], v[188:191], a[20:23], v[48:63]
    v_cvt_pk_bf16_f32 v82, v68, v69
    v_cvt_pk_bf16_f32 v83, v70, v71
    v_exp_f32 v72, v72
    v_exp_f32 v73, v73
    v_mfma_f32_32x32x16_bf16 a[80:95], v[200:203], v[80:83], a[80:95]
    v_exp_f32 v74, v74
    v_exp_f32 v75, v75
    v_exp_f32 v76, v76
    v_mfma_f32_16x16x32_bf16 a[196:199], v[88:91], v[80:83], a[196:199]
    buffer_load_dwordx4 v[152:155], v2, s[8:11], s30 offen offset:0 sc1
    buffer_load_dwordx4 v[156:159], v2, s[8:11], s30 offen offset:1024 sc1
    v_exp_f32 v77, v77
    v_exp_f32 v78, v78
    v_exp_f32 v79, v79
    buffer_load_dwordx4 v[168:171], v2, s[8:11], s31 offen offset:0 sc1
    buffer_load_dwordx4 v[172:175], v2, s[8:11], s31 offen offset:1024 sc1
    v_cvt_pk_bf16_f32 v84, v72, v73
    v_cvt_pk_bf16_f32 v85, v74, v75
    v_cvt_pk_bf16_f32 v86, v76, v77
    v_cvt_pk_bf16_f32 v87, v78, v79
    v_exp_f32 v48, v48
    v_exp_f32 v49, v49
    v_mfma_f32_32x32x16_bf16 a[80:95], v[204:207], v[84:87], a[80:95]
    v_exp_f32 v50, v50
    v_exp_f32 v51, v51
    v_exp_f32 v52, v52
    v_mfma_f32_16x16x32_bf16 a[196:199], v[88:91], v[84:87], a[196:199]
    v_exp_f32 v53, v53
    v_mfma_f32_32x32x16_bf16 v[64:79], v[184:187], a[24:27], 0
    v_exp_f32 v54, v54
    v_exp_f32 v55, v55
    v_cvt_pk_bf16_f32 v80, v48, v49
    v_cvt_pk_bf16_f32 v81, v50, v51
    v_mfma_f32_32x32x16_bf16 v[64:79], v[188:191], a[28:31], v[64:79]
    v_cvt_pk_bf16_f32 v82, v52, v53
    v_cvt_pk_bf16_f32 v83, v54, v55
    v_exp_f32 v56, v56
    v_exp_f32 v57, v57
    v_mfma_f32_32x32x16_bf16 a[96:111], v[200:203], v[80:83], a[96:111]
    v_exp_f32 v58, v58
    v_exp_f32 v59, v59
    v_exp_f32 v60, v60
    v_mfma_f32_16x16x32_bf16 a[200:203], v[88:91], v[80:83], a[200:203]
    v_exp_f32 v61, v61
    v_exp_f32 v62, v62
    v_exp_f32 v63, v63
    v_cvt_pk_bf16_f32 v84, v56, v57
    v_cvt_pk_bf16_f32 v85, v58, v59
    v_cvt_pk_bf16_f32 v86, v60, v61
    v_cvt_pk_bf16_f32 v87, v62, v63
    v_exp_f32 v64, v64
    v_exp_f32 v65, v65
    v_mfma_f32_32x32x16_bf16 a[96:111], v[204:207], v[84:87], a[96:111]
    v_exp_f32 v66, v66
    v_exp_f32 v67, v67
    v_exp_f32 v68, v68
    v_mfma_f32_16x16x32_bf16 a[200:203], v[88:91], v[84:87], a[200:203]
    v_exp_f32 v69, v69
    v_mfma_f32_32x32x16_bf16 v[48:63], v[184:187], a[32:35], 0
    v_exp_f32 v70, v70
    v_exp_f32 v71, v71
    v_cvt_pk_bf16_f32 v80, v64, v65
    v_cvt_pk_bf16_f32 v81, v66, v67
    v_mfma_f32_32x32x16_bf16 v[48:63], v[188:191], a[36:39], v[48:63]
    v_cvt_pk_bf16_f32 v82, v68, v69
    v_cvt_pk_bf16_f32 v83, v70, v71
    v_exp_f32 v72, v72
    v_exp_f32 v73, v73
    v_mfma_f32_32x32x16_bf16 a[112:127], v[200:203], v[80:83], a[112:127]
    v_exp_f32 v74, v74
    v_exp_f32 v75, v75
    v_exp_f32 v76, v76
    v_mfma_f32_16x16x32_bf16 a[204:207], v[88:91], v[80:83], a[204:207]
    s_add_u32 s66, s66, 4096
    buffer_store_dwordx4 v[208:211], v2, s[8:11], s66 offen offset:0 sc1
    v_exp_f32 v77, v77
    v_exp_f32 v78, v78
    v_exp_f32 v79, v79
    buffer_store_dwordx4 v[212:215], v2, s[8:11], s66 offen offset:1024 sc1
    v_cvt_pk_bf16_f32 v84, v72, v73
    v_cvt_pk_bf16_f32 v85, v74, v75
    v_cvt_pk_bf16_f32 v86, v76, v77
    v_cvt_pk_bf16_f32 v87, v78, v79
    v_exp_f32 v48, v48
    v_exp_f32 v49, v49
    v_mfma_f32_32x32x16_bf16 a[112:127], v[204:207], v[84:87], a[112:127]
    v_exp_f32 v50, v50
    v_exp_f32 v51, v51
    v_exp_f32 v52, v52
    v_mfma_f32_16x16x32_bf16 a[204:207], v[88:91], v[84:87], a[204:207]
    v_exp_f32 v53, v53
    v_mfma_f32_32x32x16_bf16 v[64:79], v[184:187], a[40:43], 0
    v_exp_f32 v54, v54
    v_exp_f32 v55, v55
    v_cvt_pk_bf16_f32 v80, v48, v49
    v_cvt_pk_bf16_f32 v81, v50, v51
    v_mfma_f32_32x32x16_bf16 v[64:79], v[188:191], a[44:47], v[64:79]
    v_cvt_pk_bf16_f32 v82, v52, v53
    v_cvt_pk_bf16_f32 v83, v54, v55
    v_exp_f32 v56, v56
    v_exp_f32 v57, v57
    v_mfma_f32_32x32x16_bf16 a[128:143], v[200:203], v[80:83], a[128:143]
    v_exp_f32 v58, v58
    v_exp_f32 v59, v59
    v_exp_f32 v60, v60
    v_mfma_f32_16x16x32_bf16 a[208:211], v[88:91], v[80:83], a[208:211]
    v_exp_f32 v61, v61
    v_exp_f32 v62, v62
    v_exp_f32 v63, v63
    v_cvt_pk_bf16_f32 v84, v56, v57
    v_cvt_pk_bf16_f32 v85, v58, v59
    v_cvt_pk_bf16_f32 v86, v60, v61
    v_cvt_pk_bf16_f32 v87, v62, v63
    v_exp_f32 v64, v64
    v_exp_f32 v65, v65
    v_mfma_f32_32x32x16_bf16 a[128:143], v[204:207], v[84:87], a[128:143]
    v_exp_f32 v66, v66
    v_exp_f32 v67, v67
    v_exp_f32 v68, v68
    v_mfma_f32_16x16x32_bf16 a[208:211], v[88:91], v[84:87], a[208:211]
    v_exp_f32 v69, v69
    v_mfma_f32_32x32x16_bf16 v[48:63], v[184:187], a[48:51], 0
    v_exp_f32 v70, v70
    v_exp_f32 v71, v71
    v_cvt_pk_bf16_f32 v80, v64, v65
    v_cvt_pk_bf16_f32 v81, v66, v67
    v_mfma_f32_32x32x16_bf16 v[48:63], v[188:191], a[52:55], v[48:63]
    v_cvt_pk_bf16_f32 v82, v68, v69
    v_cvt_pk_bf16_f32 v83, v70, v71
    v_exp_f32 v72, v72
    v_exp_f32 v73, v73
    v_mfma_f32_32x32x16_bf16 a[144:159], v[200:203], v[80:83], a[144:159]
    v_exp_f32 v74, v74
    v_exp_f32 v75, v75
    v_exp_f32 v76, v76
    v_mfma_f32_16x16x32_bf16 a[212:215], v[88:91], v[80:83], a[212:215]
    v_exp_f32 v77, v77
    v_exp_f32 v78, v78
    v_exp_f32 v79, v79
    v_cvt_pk_bf16_f32 v84, v72, v73
    v_cvt_pk_bf16_f32 v85, v74, v75
    v_cvt_pk_bf16_f32 v86, v76, v77
    v_cvt_pk_bf16_f32 v87, v78, v79
    v_exp_f32 v48, v48
    v_exp_f32 v49, v49
    v_mfma_f32_32x32x16_bf16 a[144:159], v[204:207], v[84:87], a[144:159]
    v_exp_f32 v50, v50
    v_exp_f32 v51, v51
    v_exp_f32 v52, v52
    v_mfma_f32_16x16x32_bf16 a[212:215], v[88:91], v[84:87], a[212:215]
    v_exp_f32 v53, v53
    v_mfma_f32_32x32x16_bf16 v[64:79], v[184:187], a[56:59], 0
    v_exp_f32 v54, v54
    v_exp_f32 v55, v55
    v_cvt_pk_bf16_f32 v80, v48, v49
    v_cvt_pk_bf16_f32 v81, v50, v51
    v_mfma_f32_32x32x16_bf16 v[64:79], v[188:191], a[60:63], v[64:79]
    v_cvt_pk_bf16_f32 v82, v52, v53
    v_cvt_pk_bf16_f32 v83, v54, v55
    v_exp_f32 v56, v56
    v_exp_f32 v57, v57
    v_mfma_f32_32x32x16_bf16 a[160:175], v[200:203], v[80:83], a[160:175]
    v_exp_f32 v58, v58
    v_exp_f32 v59, v59
    v_exp_f32 v60, v60
    v_mfma_f32_16x16x32_bf16 a[216:219], v[88:91], v[80:83], a[216:219]
    v_exp_f32 v61, v61
    v_exp_f32 v62, v62
    v_exp_f32 v63, v63
    v_cvt_pk_bf16_f32 v84, v56, v57
    v_cvt_pk_bf16_f32 v85, v58, v59
    v_cvt_pk_bf16_f32 v86, v60, v61
    v_cvt_pk_bf16_f32 v87, v62, v63
    s_waitcnt vmcnt(20)
    v_exp_f32 v64, v64
    v_exp_f32 v65, v65
    v_mfma_f32_32x32x16_bf16 a[160:175], v[204:207], v[84:87], a[160:175]
    v_exp_f32 v66, v66
    v_exp_f32 v67, v67
    v_exp_f32 v68, v68
    v_mfma_f32_16x16x32_bf16 a[216:219], v[88:91], v[84:87], a[216:219]
    v_exp_f32 v69, v69
    v_mfma_f32_32x32x16_bf16 v[48:63], v[96:99], a[0:3], 0
    v_exp_f32 v70, v70
    v_exp_f32 v71, v71
    v_cvt_pk_bf16_f32 v80, v64, v65
    v_cvt_pk_bf16_f32 v81, v66, v67
    v_mfma_f32_32x32x16_bf16 v[48:63], v[100:103], a[4:7], v[48:63]
    v_cvt_pk_bf16_f32 v82, v68, v69
    v_cvt_pk_bf16_f32 v83, v70, v71
    v_exp_f32 v72, v72
    v_exp_f32 v73, v73
    v_mfma_f32_32x32x16_bf16 a[176:191], v[200:203], v[80:83], a[176:191]
    v_exp_f32 v74, v74
    v_exp_f32 v75, v75
    v_exp_f32 v76, v76
    v_mfma_f32_16x16x32_bf16 a[220:223], v[88:91], v[80:83], a[220:223]
    v_exp_f32 v77, v77
    v_exp_f32 v78, v78
    v_exp_f32 v79, v79
    v_cvt_pk_bf16_f32 v84, v72, v73
    v_cvt_pk_bf16_f32 v85, v74, v75
    v_cvt_pk_bf16_f32 v86, v76, v77
    v_cvt_pk_bf16_f32 v87, v78, v79
    v_exp_f32 v48, v48
    v_exp_f32 v49, v49
    v_mfma_f32_32x32x16_bf16 a[176:191], v[204:207], v[84:87], a[176:191]
    v_exp_f32 v50, v50
    v_exp_f32 v51, v51
    v_exp_f32 v52, v52
    v_mfma_f32_16x16x32_bf16 a[220:223], v[88:91], v[84:87], a[220:223]
    v_exp_f32 v53, v53
    v_mfma_f32_32x32x16_bf16 v[64:79], v[96:99], a[8:11], 0
    v_exp_f32 v54, v54
    v_exp_f32 v55, v55
    v_cvt_pk_bf16_f32 v80, v48, v49
    v_cvt_pk_bf16_f32 v81, v50, v51
    v_mfma_f32_32x32x16_bf16 v[64:79], v[100:103], a[12:15], v[64:79]
    v_cvt_pk_bf16_f32 v82, v52, v53
    v_cvt_pk_bf16_f32 v83, v54, v55
    v_exp_f32 v56, v56
    v_exp_f32 v57, v57
    v_mfma_f32_32x32x16_bf16 a[64:79], v[120:123], v[80:83], a[64:79]
    v_exp_f32 v58, v58
    v_exp_f32 v59, v59
    v_exp_f32 v60, v60
    v_mfma_f32_16x16x32_bf16 a[192:195], v[88:91], v[80:83], a[192:195]
    v_exp_f32 v61, v61
    v_exp_f32 v62, v62
    v_exp_f32 v63, v63
    v_cvt_pk_bf16_f32 v84, v56, v57
    v_cvt_pk_bf16_f32 v85, v58, v59
    v_cvt_pk_bf16_f32 v86, v60, v61
    v_cvt_pk_bf16_f32 v87, v62, v63
    v_exp_f32 v64, v64
    v_exp_f32 v65, v65
    v_mfma_f32_32x32x16_bf16 a[64:79], v[124:127], v[84:87], a[64:79]
    v_exp_f32 v66, v66
    v_exp_f32 v67, v67
    v_exp_f32 v68, v68
    v_mfma_f32_16x16x32_bf16 a[192:195], v[88:91], v[84:87], a[192:195]
    v_exp_f32 v69, v69
    v_mfma_f32_32x32x16_bf16 v[48:63], v[96:99], a[16:19], 0
    v_exp_f32 v70, v70
    v_exp_f32 v71, v71
    v_cvt_pk_bf16_f32 v80, v64, v65
    v_cvt_pk_bf16_f32 v81, v66, v67
    v_mfma_f32_32x32x16_bf16 v[48:63], v[100:103], a[20:23], v[48:63]
    v_cvt_pk_bf16_f32 v82, v68, v69
    v_cvt_pk_bf16_f32 v83, v70, v71
    v_exp_f32 v72, v72
    v_exp_f32 v73, v73
    v_mfma_f32_32x32x16_bf16 a[80:95], v[120:123], v[80:83], a[80:95]
    v_exp_f32 v74, v74
    v_exp_f32 v75, v75
    v_exp_f32 v76, v76
    v_mfma_f32_16x16x32_bf16 a[196:199], v[88:91], v[80:83], a[196:199]
    buffer_load_dwordx4 v[184:187], v2, s[8:11], s30 offen offset:2048 sc1
    buffer_load_dwordx4 v[188:191], v2, s[8:11], s30 offen offset:3072 sc1
    v_exp_f32 v77, v77
    v_exp_f32 v78, v78
    v_exp_f32 v79, v79
    s_add_u32 s30, s30, 4096
    buffer_load_dwordx4 v[200:203], v2, s[8:11], s31 offen offset:2048 sc1
    v_cvt_pk_bf16_f32 v84, v72, v73
    v_cvt_pk_bf16_f32 v85, v74, v75
    buffer_load_dwordx4 v[204:207], v2, s[8:11], s31 offen offset:3072 sc1
    s_add_u32 s31, s31, 4096
    v_cvt_pk_bf16_f32 v86, v76, v77
    v_cvt_pk_bf16_f32 v87, v78, v79
    v_exp_f32 v48, v48
    v_exp_f32 v49, v49
    v_mfma_f32_32x32x16_bf16 a[80:95], v[124:127], v[84:87], a[80:95]
    v_exp_f32 v50, v50
    v_exp_f32 v51, v51
    v_exp_f32 v52, v52
    v_mfma_f32_16x16x32_bf16 a[196:199], v[88:91], v[84:87], a[196:199]
    v_exp_f32 v53, v53
    v_mfma_f32_32x32x16_bf16 v[64:79], v[96:99], a[24:27], 0
    v_exp_f32 v54, v54
    v_exp_f32 v55, v55
    v_cvt_pk_bf16_f32 v80, v48, v49
    v_cvt_pk_bf16_f32 v81, v50, v51
    v_mfma_f32_32x32x16_bf16 v[64:79], v[100:103], a[28:31], v[64:79]
    v_cvt_pk_bf16_f32 v82, v52, v53
    v_cvt_pk_bf16_f32 v83, v54, v55
    v_exp_f32 v56, v56
    v_exp_f32 v57, v57
    v_mfma_f32_32x32x16_bf16 a[96:111], v[120:123], v[80:83], a[96:111]
    v_exp_f32 v58, v58
    v_exp_f32 v59, v59
    v_exp_f32 v60, v60
    v_mfma_f32_16x16x32_bf16 a[200:203], v[88:91], v[80:83], a[200:203]
    v_exp_f32 v61, v61
    v_exp_f32 v62, v62
    v_exp_f32 v63, v63
    v_cvt_pk_bf16_f32 v84, v56, v57
    v_cvt_pk_bf16_f32 v85, v58, v59
    v_cvt_pk_bf16_f32 v86, v60, v61
    v_cvt_pk_bf16_f32 v87, v62, v63
    v_exp_f32 v64, v64
    v_exp_f32 v65, v65
    v_mfma_f32_32x32x16_bf16 a[96:111], v[124:127], v[84:87], a[96:111]
    v_exp_f32 v66, v66
    v_exp_f32 v67, v67
    v_exp_f32 v68, v68
    v_mfma_f32_16x16x32_bf16 a[200:203], v[88:91], v[84:87], a[200:203]
    v_exp_f32 v69, v69
    v_mfma_f32_32x32x16_bf16 v[48:63], v[96:99], a[32:35], 0
    v_exp_f32 v70, v70
    v_exp_f32 v71, v71
    v_cvt_pk_bf16_f32 v80, v64, v65
    v_cvt_pk_bf16_f32 v81, v66, v67
    v_mfma_f32_32x32x16_bf16 v[48:63], v[100:103], a[36:39], v[48:63]
    v_cvt_pk_bf16_f32 v82, v68, v69
    v_cvt_pk_bf16_f32 v83, v70, v71
    v_exp_f32 v72, v72
    v_exp_f32 v73, v73
    v_mfma_f32_32x32x16_bf16 a[112:127], v[120:123], v[80:83], a[112:127]
    v_exp_f32 v74, v74
    v_exp_f32 v75, v75
    v_exp_f32 v76, v76
    v_mfma_f32_16x16x32_bf16 a[204:207], v[88:91], v[80:83], a[204:207]
    s_add_u32 s67, s67, 4096
    buffer_store_dwordx4 v[224:227], v2, s[8:11], s67 offen offset:0 sc1
    v_exp_f32 v77, v77
    v_exp_f32 v78, v78
    v_exp_f32 v79, v79
    buffer_store_dwordx4 v[228:231], v2, s[8:11], s67 offen offset:1024 sc1
    v_cvt_pk_bf16_f32 v84, v72, v73
    v_cvt_pk_bf16_f32 v85, v74, v75
    v_cvt_pk_bf16_f32 v86, v76, v77
    v_cvt_pk_bf16_f32 v87, v78, v79
    v_exp_f32 v48, v48
    v_exp_f32 v49, v49
    v_mfma_f32_32x32x16_bf16 a[112:127], v[124:127], v[84:87], a[112:127]
    v_exp_f32 v50, v50
    v_exp_f32 v51, v51
    v_exp_f32 v52, v52
    v_mfma_f32_16x16x32_bf16 a[204:207], v[88:91], v[84:87], a[204:207]
    v_exp_f32 v53, v53
    v_mfma_f32_32x32x16_bf16 v[64:79], v[96:99], a[40:43], 0
    v_exp_f32 v54, v54
    v_exp_f32 v55, v55
    v_cvt_pk_bf16_f32 v80, v48, v49
    v_cvt_pk_bf16_f32 v81, v50, v51
    v_mfma_f32_32x32x16_bf16 v[64:79], v[100:103], a[44:47], v[64:79]
    v_cvt_pk_bf16_f32 v82, v52, v53
    v_cvt_pk_bf16_f32 v83, v54, v55
    v_exp_f32 v56, v56
    v_exp_f32 v57, v57
    v_mfma_f32_32x32x16_bf16 a[128:143], v[120:123], v[80:83], a[128:143]
    v_exp_f32 v58, v58
    v_exp_f32 v59, v59
    v_exp_f32 v60, v60
    v_mfma_f32_16x16x32_bf16 a[208:211], v[88:91], v[80:83], a[208:211]
    v_exp_f32 v61, v61
    v_exp_f32 v62, v62
    v_exp_f32 v63, v63
    v_cvt_pk_bf16_f32 v84, v56, v57
    v_cvt_pk_bf16_f32 v85, v58, v59
    v_cvt_pk_bf16_f32 v86, v60, v61
    v_cvt_pk_bf16_f32 v87, v62, v63
    v_exp_f32 v64, v64
    v_exp_f32 v65, v65
    v_mfma_f32_32x32x16_bf16 a[128:143], v[124:127], v[84:87], a[128:143]
    v_exp_f32 v66, v66
    v_exp_f32 v67, v67
    v_exp_f32 v68, v68
    v_mfma_f32_16x16x32_bf16 a[208:211], v[88:91], v[84:87], a[208:211]
    v_exp_f32 v69, v69
    v_mfma_f32_32x32x16_bf16 v[48:63], v[96:99], a[48:51], 0
    v_exp_f32 v70, v70
    v_exp_f32 v71, v71
    v_cvt_pk_bf16_f32 v80, v64, v65
    v_cvt_pk_bf16_f32 v81, v66, v67
    v_mfma_f32_32x32x16_bf16 v[48:63], v[100:103], a[52:55], v[48:63]
    v_cvt_pk_bf16_f32 v82, v68, v69
    v_cvt_pk_bf16_f32 v83, v70, v71
    v_exp_f32 v72, v72
    v_exp_f32 v73, v73
    v_mfma_f32_32x32x16_bf16 a[144:159], v[120:123], v[80:83], a[144:159]
    v_exp_f32 v74, v74
    v_exp_f32 v75, v75
    v_exp_f32 v76, v76
    v_mfma_f32_16x16x32_bf16 a[212:215], v[88:91], v[80:83], a[212:215]
    v_exp_f32 v77, v77
    v_exp_f32 v78, v78
    v_exp_f32 v79, v79
    v_cvt_pk_bf16_f32 v84, v72, v73
    v_cvt_pk_bf16_f32 v85, v74, v75
    v_cvt_pk_bf16_f32 v86, v76, v77
    v_cvt_pk_bf16_f32 v87, v78, v79
    v_exp_f32 v48, v48
    v_exp_f32 v49, v49
    v_mfma_f32_32x32x16_bf16 a[144:159], v[124:127], v[84:87], a[144:159]
    v_exp_f32 v50, v50
    v_exp_f32 v51, v51
    v_exp_f32 v52, v52
    v_mfma_f32_16x16x32_bf16 a[212:215], v[88:91], v[84:87], a[212:215]
    v_exp_f32 v53, v53
    v_mfma_f32_32x32x16_bf16 v[64:79], v[96:99], a[56:59], 0
    v_exp_f32 v54, v54
    v_exp_f32 v55, v55
    v_cvt_pk_bf16_f32 v80, v48, v49
    v_cvt_pk_bf16_f32 v81, v50, v51
    v_mfma_f32_32x32x16_bf16 v[64:79], v[100:103], a[60:63], v[64:79]
    v_cvt_pk_bf16_f32 v82, v52, v53
    v_cvt_pk_bf16_f32 v83, v54, v55
    v_exp_f32 v56, v56
    v_exp_f32 v57, v57
    v_mfma_f32_32x32x16_bf16 a[160:175], v[120:123], v[80:83], a[160:175]
    v_exp_f32 v58, v58
    v_exp_f32 v59, v59
    v_exp_f32 v60, v60
    v_mfma_f32_16x16x32_bf16 a[216:219], v[88:91], v[80:83], a[216:219]
    v_exp_f32 v61, v61
    v_exp_f32 v62, v62
    v_exp_f32 v63, v63
    v_cvt_pk_bf16_f32 v84, v56, v57
    v_cvt_pk_bf16_f32 v85, v58, v59
    v_cvt_pk_bf16_f32 v86, v60, v61
    v_cvt_pk_bf16_f32 v87, v62, v63
    s_waitcnt vmcnt(20)
    v_exp_f32 v64, v64
    v_exp_f32 v65, v65
    v_mfma_f32_32x32x16_bf16 a[160:175], v[124:127], v[84:87], a[160:175]
    v_exp_f32 v66, v66
    v_exp_f32 v67, v67
    v_exp_f32 v68, v68
    v_mfma_f32_16x16x32_bf16 a[216:219], v[88:91], v[84:87], a[216:219]
    v_exp_f32 v69, v69
    v_mfma_f32_32x32x16_bf16 v[48:63], v[104:107], a[0:3], 0
    v_exp_f32 v70, v70
    v_exp_f32 v71, v71
    v_cvt_pk_bf16_f32 v80, v64, v65
    v_cvt_pk_bf16_f32 v81, v66, v67
    v_mfma_f32_32x32x16_bf16 v[48:63], v[108:111], a[4:7], v[48:63]
    v_cvt_pk_bf16_f32 v82, v68, v69
    v_cvt_pk_bf16_f32 v83, v70, v71
    v_exp_f32 v72, v72
    v_exp_f32 v73, v73
    v_mfma_f32_32x32x16_bf16 a[176:191], v[120:123], v[80:83], a[176:191]
    v_exp_f32 v74, v74
    v_exp_f32 v75, v75
    v_exp_f32 v76, v76
    v_mfma_f32_16x16x32_bf16 a[220:223], v[88:91], v[80:83], a[220:223]
    v_exp_f32 v77, v77
    v_exp_f32 v78, v78
    v_exp_f32 v79, v79
    v_cvt_pk_bf16_f32 v84, v72, v73
    v_cvt_pk_bf16_f32 v85, v74, v75
    v_cvt_pk_bf16_f32 v86, v76, v77
    v_cvt_pk_bf16_f32 v87, v78, v79
    v_exp_f32 v48, v48
    v_exp_f32 v49, v49
    v_mfma_f32_32x32x16_bf16 a[176:191], v[124:127], v[84:87], a[176:191]
    v_exp_f32 v50, v50
    v_exp_f32 v51, v51
    v_exp_f32 v52, v52
    v_mfma_f32_16x16x32_bf16 a[220:223], v[88:91], v[84:87], a[220:223]
    v_exp_f32 v53, v53
    v_mfma_f32_32x32x16_bf16 v[64:79], v[104:107], a[8:11], 0
    v_exp_f32 v54, v54
    v_exp_f32 v55, v55
    v_cvt_pk_bf16_f32 v80, v48, v49
    v_cvt_pk_bf16_f32 v81, v50, v51
    v_mfma_f32_32x32x16_bf16 v[64:79], v[108:111], a[12:15], v[64:79]
    v_cvt_pk_bf16_f32 v82, v52, v53
    v_cvt_pk_bf16_f32 v83, v54, v55
    v_exp_f32 v56, v56
    v_exp_f32 v57, v57
    v_mfma_f32_32x32x16_bf16 a[64:79], v[128:131], v[80:83], a[64:79]
    v_exp_f32 v58, v58
    v_exp_f32 v59, v59
    v_exp_f32 v60, v60
    v_mfma_f32_16x16x32_bf16 a[192:195], v[88:91], v[80:83], a[192:195]
    v_exp_f32 v61, v61
    v_exp_f32 v62, v62
    v_exp_f32 v63, v63
    v_cvt_pk_bf16_f32 v84, v56, v57
    v_cvt_pk_bf16_f32 v85, v58, v59
    v_cvt_pk_bf16_f32 v86, v60, v61
    v_cvt_pk_bf16_f32 v87, v62, v63
    v_exp_f32 v64, v64
    v_exp_f32 v65, v65
    v_mfma_f32_32x32x16_bf16 a[64:79], v[132:135], v[84:87], a[64:79]
    v_exp_f32 v66, v66
    v_exp_f32 v67, v67
    v_exp_f32 v68, v68
    v_mfma_f32_16x16x32_bf16 a[192:195], v[88:91], v[84:87], a[192:195]
    v_exp_f32 v69, v69
    v_mfma_f32_32x32x16_bf16 v[48:63], v[104:107], a[16:19], 0
    v_exp_f32 v70, v70
    v_exp_f32 v71, v71
    v_cvt_pk_bf16_f32 v80, v64, v65
    v_cvt_pk_bf16_f32 v81, v66, v67
    v_mfma_f32_32x32x16_bf16 v[48:63], v[108:111], a[20:23], v[48:63]
    v_cvt_pk_bf16_f32 v82, v68, v69
    v_cvt_pk_bf16_f32 v83, v70, v71
    v_exp_f32 v72, v72
    v_exp_f32 v73, v73
    v_mfma_f32_32x32x16_bf16 a[80:95], v[128:131], v[80:83], a[80:95]
    v_exp_f32 v74, v74
    v_exp_f32 v75, v75
    v_exp_f32 v76, v76
    v_mfma_f32_16x16x32_bf16 a[196:199], v[88:91], v[80:83], a[196:199]
    buffer_load_dwordx4 v[96:99], v2, s[8:11], s30 offen offset:0 sc1
    buffer_load_dwordx4 v[100:103], v2, s[8:11], s30 offen offset:1024 sc1
    v_exp_f32 v77, v77
    v_exp_f32 v78, v78
    v_exp_f32 v79, v79
    buffer_load_dwordx4 v[120:123], v2, s[8:11], s31 offen offset:0 sc1
    buffer_load_dwordx4 v[124:127], v2, s[8:11], s31 offen offset:1024 sc1
    v_cvt_pk_bf16_f32 v84, v72, v73
    v_cvt_pk_bf16_f32 v85, v74, v75
    v_cvt_pk_bf16_f32 v86, v76, v77
    v_cvt_pk_bf16_f32 v87, v78, v79
    v_exp_f32 v48, v48
    v_exp_f32 v49, v49
    v_mfma_f32_32x32x16_bf16 a[80:95], v[132:135], v[84:87], a[80:95]
    v_exp_f32 v50, v50
    v_exp_f32 v51, v51
    v_exp_f32 v52, v52
    v_mfma_f32_16x16x32_bf16 a[196:199], v[88:91], v[84:87], a[196:199]
    v_exp_f32 v53, v53
    v_mfma_f32_32x32x16_bf16 v[64:79], v[104:107], a[24:27], 0
    v_exp_f32 v54, v54
    v_exp_f32 v55, v55
    v_cvt_pk_bf16_f32 v80, v48, v49
    v_cvt_pk_bf16_f32 v81, v50, v51
    v_mfma_f32_32x32x16_bf16 v[64:79], v[108:111], a[28:31], v[64:79]
    v_cvt_pk_bf16_f32 v82, v52, v53
    v_cvt_pk_bf16_f32 v83, v54, v55
    v_exp_f32 v56, v56
    v_exp_f32 v57, v57
    v_mfma_f32_32x32x16_bf16 a[96:111], v[128:131], v[80:83], a[96:111]
    v_exp_f32 v58, v58
    v_exp_f32 v59, v59
    v_exp_f32 v60, v60
    v_mfma_f32_16x16x32_bf16 a[200:203], v[88:91], v[80:83], a[200:203]
    v_exp_f32 v61, v61
    v_exp_f32 v62, v62
    v_exp_f32 v63, v63
    v_cvt_pk_bf16_f32 v84, v56, v57
    v_cvt_pk_bf16_f32 v85, v58, v59
    v_cvt_pk_bf16_f32 v86, v60, v61
    v_cvt_pk_bf16_f32 v87, v62, v63
    v_exp_f32 v64, v64
    v_exp_f32 v65, v65
    v_mfma_f32_32x32x16_bf16 a[96:111], v[132:135], v[84:87], a[96:111]
    v_exp_f32 v66, v66
    v_exp_f32 v67, v67
    v_exp_f32 v68, v68
    v_mfma_f32_16x16x32_bf16 a[200:203], v[88:91], v[84:87], a[200:203]
    v_exp_f32 v69, v69
    v_mfma_f32_32x32x16_bf16 v[48:63], v[104:107], a[32:35], 0
    v_exp_f32 v70, v70
    v_exp_f32 v71, v71
    v_cvt_pk_bf16_f32 v80, v64, v65
    v_cvt_pk_bf16_f32 v81, v66, v67
    v_mfma_f32_32x32x16_bf16 v[48:63], v[108:111], a[36:39], v[48:63]
    v_cvt_pk_bf16_f32 v82, v68, v69
    v_cvt_pk_bf16_f32 v83, v70, v71
    v_exp_f32 v72, v72
    v_exp_f32 v73, v73
    v_mfma_f32_32x32x16_bf16 a[112:127], v[128:131], v[80:83], a[112:127]
    v_exp_f32 v74, v74
    v_exp_f32 v75, v75
    v_exp_f32 v76, v76
    v_mfma_f32_16x16x32_bf16 a[204:207], v[88:91], v[80:83], a[204:207]
    buffer_store_dwordx4 v[240:243], v2, s[8:11], s68 offen offset:0 sc1
    buffer_store_dwordx4 v[244:247], v2, s[8:11], s68 offen offset:1024 sc1
    v_exp_f32 v77, v77
    v_exp_f32 v78, v78
    v_exp_f32 v79, v79
    v_cvt_pk_bf16_f32 v84, v72, v73
    v_cvt_pk_bf16_f32 v85, v74, v75
    v_cvt_pk_bf16_f32 v86, v76, v77
    v_cvt_pk_bf16_f32 v87, v78, v79
    v_exp_f32 v48, v48
    v_exp_f32 v49, v49
    v_mfma_f32_32x32x16_bf16 a[112:127], v[132:135], v[84:87], a[112:127]
    v_exp_f32 v50, v50
    v_exp_f32 v51, v51
    v_exp_f32 v52, v52
    v_mfma_f32_16x16x32_bf16 a[204:207], v[88:91], v[84:87], a[204:207]
    v_exp_f32 v53, v53
    v_mfma_f32_32x32x16_bf16 v[64:79], v[104:107], a[40:43], 0
    v_exp_f32 v54, v54
    v_exp_f32 v55, v55
    v_cvt_pk_bf16_f32 v80, v48, v49
    v_cvt_pk_bf16_f32 v81, v50, v51
    v_mfma_f32_32x32x16_bf16 v[64:79], v[108:111], a[44:47], v[64:79]
    v_cvt_pk_bf16_f32 v82, v52, v53
    v_cvt_pk_bf16_f32 v83, v54, v55
    v_exp_f32 v56, v56
    v_exp_f32 v57, v57
    v_mfma_f32_32x32x16_bf16 a[128:143], v[128:131], v[80:83], a[128:143]
    v_exp_f32 v58, v58
    v_exp_f32 v59, v59
    v_exp_f32 v60, v60
    v_mfma_f32_16x16x32_bf16 a[208:211], v[88:91], v[80:83], a[208:211]
    v_exp_f32 v61, v61
    v_exp_f32 v62, v62
    v_exp_f32 v63, v63
    v_cvt_pk_bf16_f32 v84, v56, v57
    v_cvt_pk_bf16_f32 v85, v58, v59
    v_cvt_pk_bf16_f32 v86, v60, v61
    v_cvt_pk_bf16_f32 v87, v62, v63
    v_exp_f32 v64, v64
    v_exp_f32 v65, v65
    v_mfma_f32_32x32x16_bf16 a[128:143], v[132:135], v[84:87], a[128:143]
    v_exp_f32 v66, v66
    v_exp_f32 v67, v67
    v_exp_f32 v68, v68
    v_mfma_f32_16x16x32_bf16 a[208:211], v[88:91], v[84:87], a[208:211]
    v_exp_f32 v69, v69
    v_mfma_f32_32x32x16_bf16 v[48:63], v[104:107], a[48:51], 0
    v_exp_f32 v70, v70
    v_exp_f32 v71, v71
    v_cvt_pk_bf16_f32 v80, v64, v65
    v_cvt_pk_bf16_f32 v81, v66, v67
    v_mfma_f32_32x32x16_bf16 v[48:63], v[108:111], a[52:55], v[48:63]
    v_cvt_pk_bf16_f32 v82, v68, v69
    v_cvt_pk_bf16_f32 v83, v70, v71
    v_exp_f32 v72, v72
    v_exp_f32 v73, v73
    v_mfma_f32_32x32x16_bf16 a[144:159], v[128:131], v[80:83], a[144:159]
    v_exp_f32 v74, v74
    v_exp_f32 v75, v75
    v_exp_f32 v76, v76
    v_mfma_f32_16x16x32_bf16 a[212:215], v[88:91], v[80:83], a[212:215]
    v_exp_f32 v77, v77
    v_exp_f32 v78, v78
    v_exp_f32 v79, v79
    v_cvt_pk_bf16_f32 v84, v72, v73
    v_cvt_pk_bf16_f32 v85, v74, v75
    v_cvt_pk_bf16_f32 v86, v76, v77
    v_cvt_pk_bf16_f32 v87, v78, v79
    v_exp_f32 v48, v48
    v_exp_f32 v49, v49
    v_mfma_f32_32x32x16_bf16 a[144:159], v[132:135], v[84:87], a[144:159]
    v_exp_f32 v50, v50
    v_exp_f32 v51, v51
    v_exp_f32 v52, v52
    v_mfma_f32_16x16x32_bf16 a[212:215], v[88:91], v[84:87], a[212:215]
    v_exp_f32 v53, v53
    v_mfma_f32_32x32x16_bf16 v[64:79], v[104:107], a[56:59], 0
    v_exp_f32 v54, v54
    v_exp_f32 v55, v55
    v_cvt_pk_bf16_f32 v80, v48, v49
    v_cvt_pk_bf16_f32 v81, v50, v51
    v_mfma_f32_32x32x16_bf16 v[64:79], v[108:111], a[60:63], v[64:79]
    v_cvt_pk_bf16_f32 v82, v52, v53
    v_cvt_pk_bf16_f32 v83, v54, v55
    v_exp_f32 v56, v56
    v_exp_f32 v57, v57
    v_mfma_f32_32x32x16_bf16 a[160:175], v[128:131], v[80:83], a[160:175]
    v_exp_f32 v58, v58
    v_exp_f32 v59, v59
    v_exp_f32 v60, v60
    v_mfma_f32_16x16x32_bf16 a[216:219], v[88:91], v[80:83], a[216:219]
    v_exp_f32 v61, v61
    v_exp_f32 v62, v62
    v_exp_f32 v63, v63
    v_cvt_pk_bf16_f32 v84, v56, v57
    v_cvt_pk_bf16_f32 v85, v58, v59
    v_cvt_pk_bf16_f32 v86, v60, v61
    v_cvt_pk_bf16_f32 v87, v62, v63
    s_waitcnt vmcnt(20)
    v_exp_f32 v64, v64
    v_exp_f32 v65, v65
    v_mfma_f32_32x32x16_bf16 a[160:175], v[132:135], v[84:87], a[160:175]
    v_exp_f32 v66, v66
    v_exp_f32 v67, v67
    v_exp_f32 v68, v68
    v_mfma_f32_16x16x32_bf16 a[216:219], v[88:91], v[84:87], a[216:219]
    v_exp_f32 v69, v69
    v_mfma_f32_32x32x16_bf16 v[48:63], v[112:115], a[0:3], 0
    v_exp_f32 v70, v70
    v_exp_f32 v71, v71
    v_cvt_pk_bf16_f32 v80, v64, v65
    v_cvt_pk_bf16_f32 v81, v66, v67
    v_mfma_f32_32x32x16_bf16 v[48:63], v[116:119], a[4:7], v[48:63]
    v_cvt_pk_bf16_f32 v82, v68, v69
    v_cvt_pk_bf16_f32 v83, v70, v71
    v_exp_f32 v72, v72
    v_exp_f32 v73, v73
    v_mfma_f32_32x32x16_bf16 a[176:191], v[128:131], v[80:83], a[176:191]
    v_exp_f32 v74, v74
    v_exp_f32 v75, v75
    v_exp_f32 v76, v76
    v_mfma_f32_16x16x32_bf16 a[220:223], v[88:91], v[80:83], a[220:223]
    v_exp_f32 v77, v77
    v_exp_f32 v78, v78
    v_exp_f32 v79, v79
    v_cvt_pk_bf16_f32 v84, v72, v73
    v_cvt_pk_bf16_f32 v85, v74, v75
    v_cvt_pk_bf16_f32 v86, v76, v77
    v_cvt_pk_bf16_f32 v87, v78, v79
    v_exp_f32 v48, v48
    v_exp_f32 v49, v49
    v_mfma_f32_32x32x16_bf16 a[176:191], v[132:135], v[84:87], a[176:191]
    v_exp_f32 v50, v50
    v_exp_f32 v51, v51
    v_exp_f32 v52, v52
    v_mfma_f32_16x16x32_bf16 a[220:223], v[88:91], v[84:87], a[220:223]
    v_exp_f32 v53, v53
    v_mfma_f32_32x32x16_bf16 v[64:79], v[112:115], a[8:11], 0
    v_exp_f32 v54, v54
    v_exp_f32 v55, v55
    v_cvt_pk_bf16_f32 v80, v48, v49
    v_cvt_pk_bf16_f32 v81, v50, v51
    v_mfma_f32_32x32x16_bf16 v[64:79], v[116:119], a[12:15], v[64:79]
    v_cvt_pk_bf16_f32 v82, v52, v53
    v_cvt_pk_bf16_f32 v83, v54, v55
    v_exp_f32 v56, v56
    v_exp_f32 v57, v57
    v_mfma_f32_32x32x16_bf16 a[64:79], v[136:139], v[80:83], a[64:79]
    v_exp_f32 v58, v58
    v_exp_f32 v59, v59
    v_exp_f32 v60, v60
    v_mfma_f32_16x16x32_bf16 a[192:195], v[88:91], v[80:83], a[192:195]
    v_exp_f32 v61, v61
    v_exp_f32 v62, v62
    v_exp_f32 v63, v63
    v_cvt_pk_bf16_f32 v84, v56, v57
    v_cvt_pk_bf16_f32 v85, v58, v59
    v_cvt_pk_bf16_f32 v86, v60, v61
    v_cvt_pk_bf16_f32 v87, v62, v63
    v_exp_f32 v64, v64
    v_exp_f32 v65, v65
    v_mfma_f32_32x32x16_bf16 a[64:79], v[140:143], v[84:87], a[64:79]
    v_exp_f32 v66, v66
    v_exp_f32 v67, v67
    v_exp_f32 v68, v68
    v_mfma_f32_16x16x32_bf16 a[192:195], v[88:91], v[84:87], a[192:195]
    v_exp_f32 v69, v69
    v_mfma_f32_32x32x16_bf16 v[48:63], v[112:115], a[16:19], 0
    v_exp_f32 v70, v70
    v_exp_f32 v71, v71
    v_cvt_pk_bf16_f32 v80, v64, v65
    v_cvt_pk_bf16_f32 v81, v66, v67
    v_mfma_f32_32x32x16_bf16 v[48:63], v[116:119], a[20:23], v[48:63]
    v_cvt_pk_bf16_f32 v82, v68, v69
    v_cvt_pk_bf16_f32 v83, v70, v71
    v_exp_f32 v72, v72
    v_exp_f32 v73, v73
    v_mfma_f32_32x32x16_bf16 a[80:95], v[136:139], v[80:83], a[80:95]
    v_exp_f32 v74, v74
    v_exp_f32 v75, v75
    v_exp_f32 v76, v76
    v_mfma_f32_16x16x32_bf16 a[196:199], v[88:91], v[80:83], a[196:199]
    buffer_load_dwordx4 v[104:107], v2, s[8:11], s30 offen offset:2048 sc1
    buffer_load_dwordx4 v[108:111], v2, s[8:11], s30 offen offset:3072 sc1
    v_exp_f32 v77, v77
    v_exp_f32 v78, v78
    v_exp_f32 v79, v79
    s_add_u32 s30, s30, 4096
    buffer_load_dwordx4 v[128:131], v2, s[8:11], s31 offen offset:2048 sc1
    v_cvt_pk_bf16_f32 v84, v72, v73
    v_cvt_pk_bf16_f32 v85, v74, v75
    buffer_load_dwordx4 v[132:135], v2, s[8:11], s31 offen offset:3072 sc1
    s_add_u32 s31, s31, 4096
    v_cvt_pk_bf16_f32 v86, v76, v77
    v_cvt_pk_bf16_f32 v87, v78, v79
    v_exp_f32 v48, v48
    v_exp_f32 v49, v49
    v_mfma_f32_32x32x16_bf16 a[80:95], v[140:143], v[84:87], a[80:95]
    v_exp_f32 v50, v50
    v_exp_f32 v51, v51
    v_exp_f32 v52, v52
    v_mfma_f32_16x16x32_bf16 a[196:199], v[88:91], v[84:87], a[196:199]
    v_exp_f32 v53, v53
    v_mfma_f32_32x32x16_bf16 v[64:79], v[112:115], a[24:27], 0
    v_exp_f32 v54, v54
    v_exp_f32 v55, v55
    v_cvt_pk_bf16_f32 v80, v48, v49
    v_cvt_pk_bf16_f32 v81, v50, v51
    v_mfma_f32_32x32x16_bf16 v[64:79], v[116:119], a[28:31], v[64:79]
    v_cvt_pk_bf16_f32 v82, v52, v53
    v_cvt_pk_bf16_f32 v83, v54, v55
    v_exp_f32 v56, v56
    v_exp_f32 v57, v57
    v_mfma_f32_32x32x16_bf16 a[96:111], v[136:139], v[80:83], a[96:111]
    v_exp_f32 v58, v58
    v_exp_f32 v59, v59
    v_exp_f32 v60, v60
    v_mfma_f32_16x16x32_bf16 a[200:203], v[88:91], v[80:83], a[200:203]
    v_exp_f32 v61, v61
    v_exp_f32 v62, v62
    v_exp_f32 v63, v63
    v_cvt_pk_bf16_f32 v84, v56, v57
    v_cvt_pk_bf16_f32 v85, v58, v59
    v_cvt_pk_bf16_f32 v86, v60, v61
    v_cvt_pk_bf16_f32 v87, v62, v63
    v_exp_f32 v64, v64
    v_exp_f32 v65, v65
    v_mfma_f32_32x32x16_bf16 a[96:111], v[140:143], v[84:87], a[96:111]
    v_exp_f32 v66, v66
    v_exp_f32 v67, v67
    v_exp_f32 v68, v68
    v_mfma_f32_16x16x32_bf16 a[200:203], v[88:91], v[84:87], a[200:203]
    v_exp_f32 v69, v69
    v_mfma_f32_32x32x16_bf16 v[48:63], v[112:115], a[32:35], 0
    v_exp_f32 v70, v70
    v_exp_f32 v71, v71
    v_cvt_pk_bf16_f32 v80, v64, v65
    v_cvt_pk_bf16_f32 v81, v66, v67
    v_mfma_f32_32x32x16_bf16 v[48:63], v[116:119], a[36:39], v[48:63]
    v_cvt_pk_bf16_f32 v82, v68, v69
    v_cvt_pk_bf16_f32 v83, v70, v71
    v_exp_f32 v72, v72
    v_exp_f32 v73, v73
    v_mfma_f32_32x32x16_bf16 a[112:127], v[136:139], v[80:83], a[112:127]
    v_exp_f32 v74, v74
    v_exp_f32 v75, v75
    v_exp_f32 v76, v76
    v_mfma_f32_16x16x32_bf16 a[204:207], v[88:91], v[80:83], a[204:207]
    v_exp_f32 v77, v77
    v_exp_f32 v78, v78
    v_exp_f32 v79, v79
    v_cvt_pk_bf16_f32 v84, v72, v73
    v_cvt_pk_bf16_f32 v85, v74, v75
    v_cvt_pk_bf16_f32 v86, v76, v77
    v_cvt_pk_bf16_f32 v87, v78, v79
    v_exp_f32 v48, v48
    v_exp_f32 v49, v49
    v_mfma_f32_32x32x16_bf16 a[112:127], v[140:143], v[84:87], a[112:127]
    v_exp_f32 v50, v50
    v_exp_f32 v51, v51
    v_exp_f32 v52, v52
    v_mfma_f32_16x16x32_bf16 a[204:207], v[88:91], v[84:87], a[204:207]
    v_exp_f32 v53, v53
    v_mfma_f32_32x32x16_bf16 v[64:79], v[112:115], a[40:43], 0
    v_exp_f32 v54, v54
    v_exp_f32 v55, v55
    v_cvt_pk_bf16_f32 v80, v48, v49
    v_cvt_pk_bf16_f32 v81, v50, v51
    v_mfma_f32_32x32x16_bf16 v[64:79], v[116:119], a[44:47], v[64:79]
    v_cvt_pk_bf16_f32 v82, v52, v53
    v_cvt_pk_bf16_f32 v83, v54, v55
    v_exp_f32 v56, v56
    v_exp_f32 v57, v57
    v_mfma_f32_32x32x16_bf16 a[128:143], v[136:139], v[80:83], a[128:143]
    v_exp_f32 v58, v58
    v_exp_f32 v59, v59
    v_exp_f32 v60, v60
    v_mfma_f32_16x16x32_bf16 a[208:211], v[88:91], v[80:83], a[208:211]
    v_exp_f32 v61, v61
    v_exp_f32 v62, v62
    v_exp_f32 v63, v63
    v_cvt_pk_bf16_f32 v84, v56, v57
    v_cvt_pk_bf16_f32 v85, v58, v59
    v_cvt_pk_bf16_f32 v86, v60, v61
    v_cvt_pk_bf16_f32 v87, v62, v63
    v_exp_f32 v64, v64
    v_exp_f32 v65, v65
    v_mfma_f32_32x32x16_bf16 a[128:143], v[140:143], v[84:87], a[128:143]
    v_exp_f32 v66, v66
    v_exp_f32 v67, v67
    v_exp_f32 v68, v68
    v_mfma_f32_16x16x32_bf16 a[208:211], v[88:91], v[84:87], a[208:211]
    v_exp_f32 v69, v69
    v_mfma_f32_32x32x16_bf16 v[48:63], v[112:115], a[48:51], 0
    v_exp_f32 v70, v70
    v_exp_f32 v71, v71
    v_cvt_pk_bf16_f32 v80, v64, v65
    v_cvt_pk_bf16_f32 v81, v66, v67
    v_mfma_f32_32x32x16_bf16 v[48:63], v[116:119], a[52:55], v[48:63]
    v_cvt_pk_bf16_f32 v82, v68, v69
    v_cvt_pk_bf16_f32 v83, v70, v71
    v_exp_f32 v72, v72
    v_exp_f32 v73, v73
    v_mfma_f32_32x32x16_bf16 a[144:159], v[136:139], v[80:83], a[144:159]
    v_exp_f32 v74, v74
    v_exp_f32 v75, v75
    v_exp_f32 v76, v76
    v_mfma_f32_16x16x32_bf16 a[212:215], v[88:91], v[80:83], a[212:215]
    v_exp_f32 v77, v77
    v_exp_f32 v78, v78
    v_exp_f32 v79, v79
    v_cvt_pk_bf16_f32 v84, v72, v73
    v_cvt_pk_bf16_f32 v85, v74, v75
    v_cvt_pk_bf16_f32 v86, v76, v77
    v_cvt_pk_bf16_f32 v87, v78, v79
    v_exp_f32 v48, v48
    v_exp_f32 v49, v49
    v_mfma_f32_32x32x16_bf16 a[144:159], v[140:143], v[84:87], a[144:159]
    v_exp_f32 v50, v50
    v_exp_f32 v51, v51
    v_exp_f32 v52, v52
    v_mfma_f32_16x16x32_bf16 a[212:215], v[88:91], v[84:87], a[212:215]
    v_exp_f32 v53, v53
    v_mfma_f32_32x32x16_bf16 v[64:79], v[112:115], a[56:59], 0
    v_exp_f32 v54, v54
    v_exp_f32 v55, v55
    v_cvt_pk_bf16_f32 v80, v48, v49
    v_cvt_pk_bf16_f32 v81, v50, v51
    v_mfma_f32_32x32x16_bf16 v[64:79], v[116:119], a[60:63], v[64:79]
    v_cvt_pk_bf16_f32 v82, v52, v53
    v_cvt_pk_bf16_f32 v83, v54, v55
    v_exp_f32 v56, v56
    v_exp_f32 v57, v57
    v_mfma_f32_32x32x16_bf16 a[160:175], v[136:139], v[80:83], a[160:175]
    v_exp_f32 v58, v58
    v_exp_f32 v59, v59
    v_exp_f32 v60, v60
    v_mfma_f32_16x16x32_bf16 a[216:219], v[88:91], v[80:83], a[216:219]
    v_exp_f32 v61, v61
    v_exp_f32 v62, v62
    v_exp_f32 v63, v63
    v_cvt_pk_bf16_f32 v84, v56, v57
    v_cvt_pk_bf16_f32 v85, v58, v59
    v_cvt_pk_bf16_f32 v86, v60, v61
    v_cvt_pk_bf16_f32 v87, v62, v63
    s_waitcnt vmcnt(18)
    v_exp_f32 v64, v64
    v_exp_f32 v65, v65
    v_mfma_f32_32x32x16_bf16 a[160:175], v[140:143], v[84:87], a[160:175]
    v_exp_f32 v66, v66
    v_exp_f32 v67, v67
    v_exp_f32 v68, v68
    v_mfma_f32_16x16x32_bf16 a[216:219], v[88:91], v[84:87], a[216:219]
    v_exp_f32 v69, v69
    v_mfma_f32_32x32x16_bf16 v[48:63], v[152:155], a[0:3], 0
    v_exp_f32 v70, v70
    v_exp_f32 v71, v71
    v_cvt_pk_bf16_f32 v80, v64, v65
    v_cvt_pk_bf16_f32 v81, v66, v67
    v_mfma_f32_32x32x16_bf16 v[48:63], v[156:159], a[4:7], v[48:63]
    v_cvt_pk_bf16_f32 v82, v68, v69
    v_cvt_pk_bf16_f32 v83, v70, v71
    v_exp_f32 v72, v72
    v_exp_f32 v73, v73
    v_mfma_f32_32x32x16_bf16 a[176:191], v[136:139], v[80:83], a[176:191]
    v_exp_f32 v74, v74
    v_exp_f32 v75, v75
    v_exp_f32 v76, v76
    v_mfma_f32_16x16x32_bf16 a[220:223], v[88:91], v[80:83], a[220:223]
    v_exp_f32 v77, v77
    v_exp_f32 v78, v78
    v_exp_f32 v79, v79
    v_cvt_pk_bf16_f32 v84, v72, v73
    v_cvt_pk_bf16_f32 v85, v74, v75
    v_cvt_pk_bf16_f32 v86, v76, v77
    v_cvt_pk_bf16_f32 v87, v78, v79
    v_exp_f32 v48, v48
    v_exp_f32 v49, v49
    v_mfma_f32_32x32x16_bf16 a[176:191], v[140:143], v[84:87], a[176:191]
    v_exp_f32 v50, v50
    v_exp_f32 v51, v51
    v_exp_f32 v52, v52
    v_mfma_f32_16x16x32_bf16 a[220:223], v[88:91], v[84:87], a[220:223]
    v_exp_f32 v53, v53
    v_mfma_f32_32x32x16_bf16 v[64:79], v[152:155], a[8:11], 0
    v_exp_f32 v54, v54
    v_exp_f32 v55, v55
    v_cvt_pk_bf16_f32 v80, v48, v49
    v_cvt_pk_bf16_f32 v81, v50, v51
    v_mfma_f32_32x32x16_bf16 v[64:79], v[156:159], a[12:15], v[64:79]
    v_cvt_pk_bf16_f32 v82, v52, v53
    v_cvt_pk_bf16_f32 v83, v54, v55
    v_exp_f32 v56, v56
    v_exp_f32 v57, v57
    v_mfma_f32_32x32x16_bf16 a[64:79], v[168:171], v[80:83], a[64:79]
    v_exp_f32 v58, v58
    v_exp_f32 v59, v59
    v_exp_f32 v60, v60
    v_mfma_f32_16x16x32_bf16 a[192:195], v[88:91], v[80:83], a[192:195]
    v_exp_f32 v61, v61
    v_exp_f32 v62, v62
    v_exp_f32 v63, v63
    v_cvt_pk_bf16_f32 v84, v56, v57
    v_cvt_pk_bf16_f32 v85, v58, v59
    v_cvt_pk_bf16_f32 v86, v60, v61
    v_cvt_pk_bf16_f32 v87, v62, v63
    v_exp_f32 v64, v64
    v_exp_f32 v65, v65
    v_mfma_f32_32x32x16_bf16 a[64:79], v[172:175], v[84:87], a[64:79]
    v_exp_f32 v66, v66
    v_exp_f32 v67, v67
    v_exp_f32 v68, v68
    v_mfma_f32_16x16x32_bf16 a[192:195], v[88:91], v[84:87], a[192:195]
    v_exp_f32 v69, v69
    v_mfma_f32_32x32x16_bf16 v[48:63], v[152:155], a[16:19], 0
    v_exp_f32 v70, v70
    v_exp_f32 v71, v71
    v_cvt_pk_bf16_f32 v80, v64, v65
    v_cvt_pk_bf16_f32 v81, v66, v67
    v_mfma_f32_32x32x16_bf16 v[48:63], v[156:159], a[20:23], v[48:63]
    v_cvt_pk_bf16_f32 v82, v68, v69
    v_cvt_pk_bf16_f32 v83, v70, v71
    v_exp_f32 v72, v72
    v_exp_f32 v73, v73
    v_mfma_f32_32x32x16_bf16 a[80:95], v[168:171], v[80:83], a[80:95]
    v_exp_f32 v74, v74
    v_exp_f32 v75, v75
    v_exp_f32 v76, v76
    v_mfma_f32_16x16x32_bf16 a[196:199], v[88:91], v[80:83], a[196:199]
    buffer_load_dwordx4 v[112:115], v2, s[8:11], s30 offen offset:0 sc1
    buffer_load_dwordx4 v[116:119], v2, s[8:11], s30 offen offset:1024 sc1
    v_exp_f32 v77, v77
    v_exp_f32 v78, v78
    v_exp_f32 v79, v79
    buffer_load_dwordx4 v[136:139], v2, s[8:11], s31 offen offset:0 sc1
    buffer_load_dwordx4 v[140:143], v2, s[8:11], s31 offen offset:1024 sc1
    v_cvt_pk_bf16_f32 v84, v72, v73
    v_cvt_pk_bf16_f32 v85, v74, v75
    v_cvt_pk_bf16_f32 v86, v76, v77
    v_cvt_pk_bf16_f32 v87, v78, v79
    v_exp_f32 v48, v48
    v_exp_f32 v49, v49
    v_mfma_f32_32x32x16_bf16 a[80:95], v[172:175], v[84:87], a[80:95]
    v_exp_f32 v50, v50
    v_exp_f32 v51, v51
    v_exp_f32 v52, v52
    v_mfma_f32_16x16x32_bf16 a[196:199], v[88:91], v[84:87], a[196:199]
    v_exp_f32 v53, v53
    v_mfma_f32_32x32x16_bf16 v[64:79], v[152:155], a[24:27], 0
    v_exp_f32 v54, v54
    v_exp_f32 v55, v55
    v_cvt_pk_bf16_f32 v80, v48, v49
    v_cvt_pk_bf16_f32 v81, v50, v51
    v_mfma_f32_32x32x16_bf16 v[64:79], v[156:159], a[28:31], v[64:79]
    v_cvt_pk_bf16_f32 v82, v52, v53
    v_cvt_pk_bf16_f32 v83, v54, v55
    v_exp_f32 v56, v56
    v_exp_f32 v57, v57
    v_mfma_f32_32x32x16_bf16 a[96:111], v[168:171], v[80:83], a[96:111]
    v_exp_f32 v58, v58
    v_exp_f32 v59, v59
    v_exp_f32 v60, v60
    v_mfma_f32_16x16x32_bf16 a[200:203], v[88:91], v[80:83], a[200:203]
    v_exp_f32 v61, v61
    v_exp_f32 v62, v62
    v_exp_f32 v63, v63
    v_cvt_pk_bf16_f32 v84, v56, v57
    v_cvt_pk_bf16_f32 v85, v58, v59
    v_cvt_pk_bf16_f32 v86, v60, v61
    v_cvt_pk_bf16_f32 v87, v62, v63
    v_exp_f32 v64, v64
    v_exp_f32 v65, v65
    v_mfma_f32_32x32x16_bf16 a[96:111], v[172:175], v[84:87], a[96:111]
    v_exp_f32 v66, v66
    v_exp_f32 v67, v67
    v_exp_f32 v68, v68
    v_mfma_f32_16x16x32_bf16 a[200:203], v[88:91], v[84:87], a[200:203]
    v_exp_f32 v69, v69
    v_mfma_f32_32x32x16_bf16 v[48:63], v[152:155], a[32:35], 0
    v_exp_f32 v70, v70
    v_exp_f32 v71, v71
    v_cvt_pk_bf16_f32 v80, v64, v65
    v_cvt_pk_bf16_f32 v81, v66, v67
    v_mfma_f32_32x32x16_bf16 v[48:63], v[156:159], a[36:39], v[48:63]
    v_cvt_pk_bf16_f32 v82, v68, v69
    v_cvt_pk_bf16_f32 v83, v70, v71
    v_exp_f32 v72, v72
    v_exp_f32 v73, v73
    v_mfma_f32_32x32x16_bf16 a[112:127], v[168:171], v[80:83], a[112:127]
    v_exp_f32 v74, v74
    v_exp_f32 v75, v75
    v_exp_f32 v76, v76
    v_mfma_f32_16x16x32_bf16 a[204:207], v[88:91], v[80:83], a[204:207]
    v_exp_f32 v77, v77
    v_exp_f32 v78, v78
    v_exp_f32 v79, v79
    v_cvt_pk_bf16_f32 v84, v72, v73
    v_cvt_pk_bf16_f32 v85, v74, v75
    v_cvt_pk_bf16_f32 v86, v76, v77
    v_cvt_pk_bf16_f32 v87, v78, v79
    v_exp_f32 v48, v48
    v_exp_f32 v49, v49
    v_mfma_f32_32x32x16_bf16 a[112:127], v[172:175], v[84:87], a[112:127]
    v_exp_f32 v50, v50
    v_exp_f32 v51, v51
    v_exp_f32 v52, v52
    v_mfma_f32_16x16x32_bf16 a[204:207], v[88:91], v[84:87], a[204:207]
    v_exp_f32 v53, v53
    v_mfma_f32_32x32x16_bf16 v[64:79], v[152:155], a[40:43], 0
    v_exp_f32 v54, v54
    v_exp_f32 v55, v55
    v_cvt_pk_bf16_f32 v80, v48, v49
    v_cvt_pk_bf16_f32 v81, v50, v51
    v_mfma_f32_32x32x16_bf16 v[64:79], v[156:159], a[44:47], v[64:79]
    v_cvt_pk_bf16_f32 v82, v52, v53
    v_cvt_pk_bf16_f32 v83, v54, v55
    v_exp_f32 v56, v56
    v_exp_f32 v57, v57
    v_mfma_f32_32x32x16_bf16 a[128:143], v[168:171], v[80:83], a[128:143]
    v_exp_f32 v58, v58
    v_exp_f32 v59, v59
    v_exp_f32 v60, v60
    v_mfma_f32_16x16x32_bf16 a[208:211], v[88:91], v[80:83], a[208:211]
    v_exp_f32 v61, v61
    v_exp_f32 v62, v62
    v_exp_f32 v63, v63
    v_cvt_pk_bf16_f32 v84, v56, v57
    v_cvt_pk_bf16_f32 v85, v58, v59
    v_cvt_pk_bf16_f32 v86, v60, v61
    v_cvt_pk_bf16_f32 v87, v62, v63
    v_exp_f32 v64, v64
    v_exp_f32 v65, v65
    v_mfma_f32_32x32x16_bf16 a[128:143], v[172:175], v[84:87], a[128:143]
    v_exp_f32 v66, v66
    v_exp_f32 v67, v67
    v_exp_f32 v68, v68
    v_mfma_f32_16x16x32_bf16 a[208:211], v[88:91], v[84:87], a[208:211]
    v_exp_f32 v69, v69
    v_mfma_f32_32x32x16_bf16 v[48:63], v[152:155], a[48:51], 0
    v_exp_f32 v70, v70
    v_exp_f32 v71, v71
    v_cvt_pk_bf16_f32 v80, v64, v65
    v_cvt_pk_bf16_f32 v81, v66, v67
    v_mfma_f32_32x32x16_bf16 v[48:63], v[156:159], a[52:55], v[48:63]
    v_cvt_pk_bf16_f32 v82, v68, v69
    v_cvt_pk_bf16_f32 v83, v70, v71
    v_exp_f32 v72, v72
    v_exp_f32 v73, v73
    v_mfma_f32_32x32x16_bf16 a[144:159], v[168:171], v[80:83], a[144:159]
    v_exp_f32 v74, v74
    v_exp_f32 v75, v75
    v_exp_f32 v76, v76
    v_mfma_f32_16x16x32_bf16 a[212:215], v[88:91], v[80:83], a[212:215]
    v_exp_f32 v77, v77
    v_exp_f32 v78, v78
    v_exp_f32 v79, v79
    v_cvt_pk_bf16_f32 v84, v72, v73
    v_cvt_pk_bf16_f32 v85, v74, v75
    v_cvt_pk_bf16_f32 v86, v76, v77
    v_cvt_pk_bf16_f32 v87, v78, v79
    v_exp_f32 v48, v48
    v_exp_f32 v49, v49
    v_mfma_f32_32x32x16_bf16 a[144:159], v[172:175], v[84:87], a[144:159]
    v_exp_f32 v50, v50
    v_exp_f32 v51, v51
    v_exp_f32 v52, v52
    v_mfma_f32_16x16x32_bf16 a[212:215], v[88:91], v[84:87], a[212:215]
    v_exp_f32 v53, v53
    v_mfma_f32_32x32x16_bf16 v[64:79], v[152:155], a[56:59], 0
    v_exp_f32 v54, v54
    v_exp_f32 v55, v55
    v_cvt_pk_bf16_f32 v80, v48, v49
    v_cvt_pk_bf16_f32 v81, v50, v51
    v_mfma_f32_32x32x16_bf16 v[64:79], v[156:159], a[60:63], v[64:79]
    v_cvt_pk_bf16_f32 v82, v52, v53
    v_cvt_pk_bf16_f32 v83, v54, v55
    v_exp_f32 v56, v56
    v_exp_f32 v57, v57
    v_mfma_f32_32x32x16_bf16 a[160:175], v[168:171], v[80:83], a[160:175]
    v_exp_f32 v58, v58
    v_exp_f32 v59, v59
    v_exp_f32 v60, v60
    v_mfma_f32_16x16x32_bf16 a[216:219], v[88:91], v[80:83], a[216:219]
    v_exp_f32 v61, v61
    v_exp_f32 v62, v62
    v_exp_f32 v63, v63
    v_cvt_pk_bf16_f32 v84, v56, v57
    v_cvt_pk_bf16_f32 v85, v58, v59
    v_cvt_pk_bf16_f32 v86, v60, v61
    v_cvt_pk_bf16_f32 v87, v62, v63
    s_waitcnt vmcnt(16)
    v_exp_f32 v64, v64
    v_exp_f32 v65, v65
    v_mfma_f32_32x32x16_bf16 a[160:175], v[172:175], v[84:87], a[160:175]
    v_exp_f32 v66, v66
    v_exp_f32 v67, v67
    v_exp_f32 v68, v68
    v_mfma_f32_16x16x32_bf16 a[216:219], v[88:91], v[84:87], a[216:219]
    v_exp_f32 v69, v69
    v_mfma_f32_32x32x16_bf16 v[48:63], v[184:187], a[0:3], 0
    v_exp_f32 v70, v70
    v_exp_f32 v71, v71
    v_cvt_pk_bf16_f32 v80, v64, v65
    v_cvt_pk_bf16_f32 v81, v66, v67
    v_mfma_f32_32x32x16_bf16 v[48:63], v[188:191], a[4:7], v[48:63]
    v_cvt_pk_bf16_f32 v82, v68, v69
    v_cvt_pk_bf16_f32 v83, v70, v71
    v_exp_f32 v72, v72
    v_exp_f32 v73, v73
    v_mfma_f32_32x32x16_bf16 a[176:191], v[168:171], v[80:83], a[176:191]
    v_exp_f32 v74, v74
    v_exp_f32 v75, v75
    v_exp_f32 v76, v76
    v_mfma_f32_16x16x32_bf16 a[220:223], v[88:91], v[80:83], a[220:223]
    v_exp_f32 v77, v77
    v_exp_f32 v78, v78
    v_exp_f32 v79, v79
    v_cvt_pk_bf16_f32 v84, v72, v73
    v_cvt_pk_bf16_f32 v85, v74, v75
    v_cvt_pk_bf16_f32 v86, v76, v77
    v_cvt_pk_bf16_f32 v87, v78, v79
    v_exp_f32 v48, v48
    v_exp_f32 v49, v49
    v_mfma_f32_32x32x16_bf16 a[176:191], v[172:175], v[84:87], a[176:191]
    v_exp_f32 v50, v50
    v_exp_f32 v51, v51
    v_exp_f32 v52, v52
    v_mfma_f32_16x16x32_bf16 a[220:223], v[88:91], v[84:87], a[220:223]
    v_exp_f32 v53, v53
    v_mfma_f32_32x32x16_bf16 v[64:79], v[184:187], a[8:11], 0
    v_exp_f32 v54, v54
    v_exp_f32 v55, v55
    v_cvt_pk_bf16_f32 v80, v48, v49
    v_cvt_pk_bf16_f32 v81, v50, v51
    v_mfma_f32_32x32x16_bf16 v[64:79], v[188:191], a[12:15], v[64:79]
    v_cvt_pk_bf16_f32 v82, v52, v53
    v_cvt_pk_bf16_f32 v83, v54, v55
    v_exp_f32 v56, v56
    v_exp_f32 v57, v57
    v_mfma_f32_32x32x16_bf16 a[64:79], v[200:203], v[80:83], a[64:79]
    v_exp_f32 v58, v58
    v_exp_f32 v59, v59
    v_exp_f32 v60, v60
    v_mfma_f32_16x16x32_bf16 a[192:195], v[88:91], v[80:83], a[192:195]
    v_exp_f32 v61, v61
    v_exp_f32 v62, v62
    v_exp_f32 v63, v63
    v_cvt_pk_bf16_f32 v84, v56, v57
    v_cvt_pk_bf16_f32 v85, v58, v59
    v_cvt_pk_bf16_f32 v86, v60, v61
    v_cvt_pk_bf16_f32 v87, v62, v63
    v_exp_f32 v64, v64
    v_exp_f32 v65, v65
    v_mfma_f32_32x32x16_bf16 a[64:79], v[204:207], v[84:87], a[64:79]
    v_exp_f32 v66, v66
    v_exp_f32 v67, v67
    v_exp_f32 v68, v68
    v_mfma_f32_16x16x32_bf16 a[192:195], v[88:91], v[84:87], a[192:195]
    v_exp_f32 v69, v69
    v_mfma_f32_32x32x16_bf16 v[48:63], v[184:187], a[16:19], 0
    v_exp_f32 v70, v70
    v_exp_f32 v71, v71
    v_cvt_pk_bf16_f32 v80, v64, v65
    v_cvt_pk_bf16_f32 v81, v66, v67
    v_mfma_f32_32x32x16_bf16 v[48:63], v[188:191], a[20:23], v[48:63]
    v_cvt_pk_bf16_f32 v82, v68, v69
    v_cvt_pk_bf16_f32 v83, v70, v71
    v_exp_f32 v72, v72
    v_exp_f32 v73, v73
    v_mfma_f32_32x32x16_bf16 a[80:95], v[200:203], v[80:83], a[80:95]
    v_exp_f32 v74, v74
    v_exp_f32 v75, v75
    v_exp_f32 v76, v76
    v_mfma_f32_16x16x32_bf16 a[196:199], v[88:91], v[80:83], a[196:199]
    buffer_load_dwordx4 v[152:155], v2, s[8:11], s30 offen offset:2048 sc1
    buffer_load_dwordx4 v[156:159], v2, s[8:11], s30 offen offset:3072 sc1
    v_exp_f32 v77, v77
    v_exp_f32 v78, v78
    v_exp_f32 v79, v79
    s_add_u32 s30, s30, 4096
    buffer_load_dwordx4 v[168:171], v2, s[8:11], s31 offen offset:2048 sc1
    v_cvt_pk_bf16_f32 v84, v72, v73
    v_cvt_pk_bf16_f32 v85, v74, v75
    buffer_load_dwordx4 v[172:175], v2, s[8:11], s31 offen offset:3072 sc1
    s_add_u32 s31, s31, 4096
    v_cvt_pk_bf16_f32 v86, v76, v77
    v_cvt_pk_bf16_f32 v87, v78, v79
    v_exp_f32 v48, v48
    v_exp_f32 v49, v49
    v_mfma_f32_32x32x16_bf16 a[80:95], v[204:207], v[84:87], a[80:95]
    v_exp_f32 v50, v50
    v_exp_f32 v51, v51
    v_exp_f32 v52, v52
    v_mfma_f32_16x16x32_bf16 a[196:199], v[88:91], v[84:87], a[196:199]
    v_exp_f32 v53, v53
    v_mfma_f32_32x32x16_bf16 v[64:79], v[184:187], a[24:27], 0
    v_exp_f32 v54, v54
    v_exp_f32 v55, v55
    v_cvt_pk_bf16_f32 v80, v48, v49
    v_cvt_pk_bf16_f32 v81, v50, v51
    v_mfma_f32_32x32x16_bf16 v[64:79], v[188:191], a[28:31], v[64:79]
    v_cvt_pk_bf16_f32 v82, v52, v53
    v_cvt_pk_bf16_f32 v83, v54, v55
    v_exp_f32 v56, v56
    v_exp_f32 v57, v57
    v_mfma_f32_32x32x16_bf16 a[96:111], v[200:203], v[80:83], a[96:111]
    v_exp_f32 v58, v58
    v_exp_f32 v59, v59
    v_exp_f32 v60, v60
    v_mfma_f32_16x16x32_bf16 a[200:203], v[88:91], v[80:83], a[200:203]
    v_exp_f32 v61, v61
    v_exp_f32 v62, v62
    v_exp_f32 v63, v63
    v_cvt_pk_bf16_f32 v84, v56, v57
    v_cvt_pk_bf16_f32 v85, v58, v59
    v_cvt_pk_bf16_f32 v86, v60, v61
    v_cvt_pk_bf16_f32 v87, v62, v63
    v_exp_f32 v64, v64
    v_exp_f32 v65, v65
    v_mfma_f32_32x32x16_bf16 a[96:111], v[204:207], v[84:87], a[96:111]
    v_exp_f32 v66, v66
    v_exp_f32 v67, v67
    v_exp_f32 v68, v68
    v_mfma_f32_16x16x32_bf16 a[200:203], v[88:91], v[84:87], a[200:203]
    v_exp_f32 v69, v69
    v_mfma_f32_32x32x16_bf16 v[48:63], v[184:187], a[32:35], 0
    v_exp_f32 v70, v70
    v_exp_f32 v71, v71
    v_cvt_pk_bf16_f32 v80, v64, v65
    v_cvt_pk_bf16_f32 v81, v66, v67
    v_mfma_f32_32x32x16_bf16 v[48:63], v[188:191], a[36:39], v[48:63]
    v_cvt_pk_bf16_f32 v82, v68, v69
    v_cvt_pk_bf16_f32 v83, v70, v71
    v_exp_f32 v72, v72
    v_exp_f32 v73, v73
    v_mfma_f32_32x32x16_bf16 a[112:127], v[200:203], v[80:83], a[112:127]
    v_exp_f32 v74, v74
    v_exp_f32 v75, v75
    v_exp_f32 v76, v76
    v_mfma_f32_16x16x32_bf16 a[204:207], v[88:91], v[80:83], a[204:207]
    s_mov_b32 s3, 0
    buffer_load_dword v25, v24, s[16:19], s3 offen
    v_exp_f32 v77, v77
    v_exp_f32 v78, v78
    v_exp_f32 v79, v79
    v_cvt_pk_bf16_f32 v84, v72, v73
    v_cvt_pk_bf16_f32 v85, v74, v75
    v_cvt_pk_bf16_f32 v86, v76, v77
    v_cvt_pk_bf16_f32 v87, v78, v79
    v_exp_f32 v48, v48
    v_exp_f32 v49, v49
    v_mfma_f32_32x32x16_bf16 a[112:127], v[204:207], v[84:87], a[112:127]
    v_exp_f32 v50, v50
    v_exp_f32 v51, v51
    v_exp_f32 v52, v52
    v_mfma_f32_16x16x32_bf16 a[204:207], v[88:91], v[84:87], a[204:207]
    v_exp_f32 v53, v53
    v_mfma_f32_32x32x16_bf16 v[64:79], v[184:187], a[40:43], 0
    v_exp_f32 v54, v54
    v_exp_f32 v55, v55
    v_cvt_pk_bf16_f32 v80, v48, v49
    v_cvt_pk_bf16_f32 v81, v50, v51
    v_mfma_f32_32x32x16_bf16 v[64:79], v[188:191], a[44:47], v[64:79]
    v_cvt_pk_bf16_f32 v82, v52, v53
    v_cvt_pk_bf16_f32 v83, v54, v55
    v_exp_f32 v56, v56
    v_exp_f32 v57, v57
    v_mfma_f32_32x32x16_bf16 a[128:143], v[200:203], v[80:83], a[128:143]
    v_exp_f32 v58, v58
    v_exp_f32 v59, v59
    v_exp_f32 v60, v60
    v_mfma_f32_16x16x32_bf16 a[208:211], v[88:91], v[80:83], a[208:211]
    v_exp_f32 v61, v61
    v_exp_f32 v62, v62
    v_exp_f32 v63, v63
    v_cvt_pk_bf16_f32 v84, v56, v57
    v_cvt_pk_bf16_f32 v85, v58, v59
    v_cvt_pk_bf16_f32 v86, v60, v61
    v_cvt_pk_bf16_f32 v87, v62, v63
    v_exp_f32 v64, v64
    v_exp_f32 v65, v65
    v_mfma_f32_32x32x16_bf16 a[128:143], v[204:207], v[84:87], a[128:143]
    v_exp_f32 v66, v66
    v_exp_f32 v67, v67
    v_exp_f32 v68, v68
    v_mfma_f32_16x16x32_bf16 a[208:211], v[88:91], v[84:87], a[208:211]
    v_exp_f32 v69, v69
    v_mfma_f32_32x32x16_bf16 v[48:63], v[184:187], a[48:51], 0
    v_exp_f32 v70, v70
    v_exp_f32 v71, v71
    v_cvt_pk_bf16_f32 v80, v64, v65
    v_cvt_pk_bf16_f32 v81, v66, v67
    v_mfma_f32_32x32x16_bf16 v[48:63], v[188:191], a[52:55], v[48:63]
    v_cvt_pk_bf16_f32 v82, v68, v69
    v_cvt_pk_bf16_f32 v83, v70, v71
    v_exp_f32 v72, v72
    v_exp_f32 v73, v73
    v_mfma_f32_32x32x16_bf16 a[144:159], v[200:203], v[80:83], a[144:159]
    v_exp_f32 v74, v74
    v_exp_f32 v75, v75
    v_exp_f32 v76, v76
    v_mfma_f32_16x16x32_bf16 a[212:215], v[88:91], v[80:83], a[212:215]
    v_exp_f32 v77, v77
    v_exp_f32 v78, v78
    v_exp_f32 v79, v79
    v_cvt_pk_bf16_f32 v84, v72, v73
    v_cvt_pk_bf16_f32 v85, v74, v75
    v_cvt_pk_bf16_f32 v86, v76, v77
    v_cvt_pk_bf16_f32 v87, v78, v79
    v_exp_f32 v48, v48
    v_exp_f32 v49, v49
    v_mfma_f32_32x32x16_bf16 a[144:159], v[204:207], v[84:87], a[144:159]
    v_exp_f32 v50, v50
    v_exp_f32 v51, v51
    v_exp_f32 v52, v52
    v_mfma_f32_16x16x32_bf16 a[212:215], v[88:91], v[84:87], a[212:215]
    v_exp_f32 v53, v53
    v_mfma_f32_32x32x16_bf16 v[64:79], v[184:187], a[56:59], 0
    v_exp_f32 v54, v54
    v_exp_f32 v55, v55
    v_cvt_pk_bf16_f32 v80, v48, v49
    v_cvt_pk_bf16_f32 v81, v50, v51
    v_mfma_f32_32x32x16_bf16 v[64:79], v[188:191], a[60:63], v[64:79]
    v_cvt_pk_bf16_f32 v82, v52, v53
    v_cvt_pk_bf16_f32 v83, v54, v55
    v_exp_f32 v56, v56
    v_exp_f32 v57, v57
    v_mfma_f32_32x32x16_bf16 a[160:175], v[200:203], v[80:83], a[160:175]
    v_exp_f32 v58, v58
    v_exp_f32 v59, v59
    v_exp_f32 v60, v60
    v_mfma_f32_16x16x32_bf16 a[216:219], v[88:91], v[80:83], a[216:219]
    v_exp_f32 v61, v61
    v_exp_f32 v62, v62
    v_exp_f32 v63, v63
    v_cvt_pk_bf16_f32 v84, v56, v57
    v_cvt_pk_bf16_f32 v85, v58, v59
    v_cvt_pk_bf16_f32 v86, v60, v61
    v_cvt_pk_bf16_f32 v87, v62, v63
    s_waitcnt vmcnt(13)
    v_exp_f32 v64, v64
    v_exp_f32 v65, v65
    v_mfma_f32_32x32x16_bf16 a[160:175], v[204:207], v[84:87], a[160:175]
    v_exp_f32 v66, v66
    v_exp_f32 v67, v67
    v_exp_f32 v68, v68
    v_mfma_f32_16x16x32_bf16 a[216:219], v[88:91], v[84:87], a[216:219]
    v_exp_f32 v69, v69
    v_mfma_f32_32x32x16_bf16 v[48:63], v[96:99], a[0:3], 0
    v_exp_f32 v70, v70
    v_exp_f32 v71, v71
    v_cvt_pk_bf16_f32 v80, v64, v65
    v_cvt_pk_bf16_f32 v81, v66, v67
    v_mfma_f32_32x32x16_bf16 v[48:63], v[100:103], a[4:7], v[48:63]
    v_cvt_pk_bf16_f32 v82, v68, v69
    v_cvt_pk_bf16_f32 v83, v70, v71
    v_exp_f32 v72, v72
    v_exp_f32 v73, v73
    v_mfma_f32_32x32x16_bf16 a[176:191], v[200:203], v[80:83], a[176:191]
    v_exp_f32 v74, v74
    v_exp_f32 v75, v75
    v_exp_f32 v76, v76
    v_mfma_f32_16x16x32_bf16 a[220:223], v[88:91], v[80:83], a[220:223]
    v_exp_f32 v77, v77
    v_exp_f32 v78, v78
    v_exp_f32 v79, v79
    v_cvt_pk_bf16_f32 v84, v72, v73
    v_cvt_pk_bf16_f32 v85, v74, v75
    v_cvt_pk_bf16_f32 v86, v76, v77
    v_cvt_pk_bf16_f32 v87, v78, v79
    v_exp_f32 v48, v48
    v_exp_f32 v49, v49
    v_mfma_f32_32x32x16_bf16 a[176:191], v[204:207], v[84:87], a[176:191]
    v_exp_f32 v50, v50
    v_exp_f32 v51, v51
    v_exp_f32 v52, v52
    v_mfma_f32_16x16x32_bf16 a[220:223], v[88:91], v[84:87], a[220:223]
    v_exp_f32 v53, v53
    v_mfma_f32_32x32x16_bf16 v[64:79], v[96:99], a[8:11], 0
    v_exp_f32 v54, v54
    v_exp_f32 v55, v55
    v_cvt_pk_bf16_f32 v80, v48, v49
    v_cvt_pk_bf16_f32 v81, v50, v51
    v_mfma_f32_32x32x16_bf16 v[64:79], v[100:103], a[12:15], v[64:79]
    v_cvt_pk_bf16_f32 v82, v52, v53
    v_cvt_pk_bf16_f32 v83, v54, v55
    v_exp_f32 v56, v56
    v_exp_f32 v57, v57
    v_mfma_f32_32x32x16_bf16 a[64:79], v[120:123], v[80:83], a[64:79]
    v_exp_f32 v58, v58
    v_exp_f32 v59, v59
    v_exp_f32 v60, v60
    v_mfma_f32_16x16x32_bf16 a[192:195], v[88:91], v[80:83], a[192:195]
    v_exp_f32 v61, v61
    v_exp_f32 v62, v62
    v_exp_f32 v63, v63
    v_cvt_pk_bf16_f32 v84, v56, v57
    v_cvt_pk_bf16_f32 v85, v58, v59
    v_cvt_pk_bf16_f32 v86, v60, v61
    v_cvt_pk_bf16_f32 v87, v62, v63
    v_exp_f32 v64, v64
    v_exp_f32 v65, v65
    v_mfma_f32_32x32x16_bf16 a[64:79], v[124:127], v[84:87], a[64:79]
    v_exp_f32 v66, v66
    v_exp_f32 v67, v67
    v_exp_f32 v68, v68
    v_mfma_f32_16x16x32_bf16 a[192:195], v[88:91], v[84:87], a[192:195]
    v_exp_f32 v69, v69
    v_mfma_f32_32x32x16_bf16 v[48:63], v[96:99], a[16:19], 0
    v_exp_f32 v70, v70
    v_exp_f32 v71, v71
    v_cvt_pk_bf16_f32 v80, v64, v65
    v_cvt_pk_bf16_f32 v81, v66, v67
    v_mfma_f32_32x32x16_bf16 v[48:63], v[100:103], a[20:23], v[48:63]
    v_cvt_pk_bf16_f32 v82, v68, v69
    v_cvt_pk_bf16_f32 v83, v70, v71
    v_exp_f32 v72, v72
    v_exp_f32 v73, v73
    v_mfma_f32_32x32x16_bf16 a[80:95], v[120:123], v[80:83], a[80:95]
    v_exp_f32 v74, v74
    v_exp_f32 v75, v75
    v_exp_f32 v76, v76
    v_mfma_f32_16x16x32_bf16 a[196:199], v[88:91], v[80:83], a[196:199]
    buffer_load_dwordx4 v[184:187], v2, s[8:11], s30 offen offset:0 sc1
    buffer_load_dwordx4 v[188:191], v2, s[8:11], s30 offen offset:1024 sc1
    v_exp_f32 v77, v77
    v_exp_f32 v78, v78
    v_exp_f32 v79, v79
    buffer_load_dwordx4 v[200:203], v2, s[8:11], s31 offen offset:0 sc1
    buffer_load_dwordx4 v[204:207], v2, s[8:11], s31 offen offset:1024 sc1
    v_cvt_pk_bf16_f32 v84, v72, v73
    v_cvt_pk_bf16_f32 v85, v74, v75
    v_cvt_pk_bf16_f32 v86, v76, v77
    v_cvt_pk_bf16_f32 v87, v78, v79
    v_exp_f32 v48, v48
    v_exp_f32 v49, v49
    v_mfma_f32_32x32x16_bf16 a[80:95], v[124:127], v[84:87], a[80:95]
    v_exp_f32 v50, v50
    v_exp_f32 v51, v51
    v_exp_f32 v52, v52
    v_mfma_f32_16x16x32_bf16 a[196:199], v[88:91], v[84:87], a[196:199]
    v_exp_f32 v53, v53
    v_mfma_f32_32x32x16_bf16 v[64:79], v[96:99], a[24:27], 0
    v_exp_f32 v54, v54
    v_exp_f32 v55, v55
    v_cvt_pk_bf16_f32 v80, v48, v49
    v_cvt_pk_bf16_f32 v81, v50, v51
    v_mfma_f32_32x32x16_bf16 v[64:79], v[100:103], a[28:31], v[64:79]
    v_cvt_pk_bf16_f32 v82, v52, v53
    v_cvt_pk_bf16_f32 v83, v54, v55
    v_exp_f32 v56, v56
    v_exp_f32 v57, v57
    v_mfma_f32_32x32x16_bf16 a[96:111], v[120:123], v[80:83], a[96:111]
    v_exp_f32 v58, v58
    v_exp_f32 v59, v59
    v_exp_f32 v60, v60
    v_mfma_f32_16x16x32_bf16 a[200:203], v[88:91], v[80:83], a[200:203]
    v_exp_f32 v61, v61
    v_exp_f32 v62, v62
    v_exp_f32 v63, v63
    v_cvt_pk_bf16_f32 v84, v56, v57
    v_cvt_pk_bf16_f32 v85, v58, v59
    v_cvt_pk_bf16_f32 v86, v60, v61
    v_cvt_pk_bf16_f32 v87, v62, v63
    v_exp_f32 v64, v64
    v_exp_f32 v65, v65
    v_mfma_f32_32x32x16_bf16 a[96:111], v[124:127], v[84:87], a[96:111]
    v_exp_f32 v66, v66
    v_exp_f32 v67, v67
    v_exp_f32 v68, v68
    v_mfma_f32_16x16x32_bf16 a[200:203], v[88:91], v[84:87], a[200:203]
    v_exp_f32 v69, v69
    v_mfma_f32_32x32x16_bf16 v[48:63], v[96:99], a[32:35], 0
    v_exp_f32 v70, v70
    v_exp_f32 v71, v71
    v_cvt_pk_bf16_f32 v80, v64, v65
    v_cvt_pk_bf16_f32 v81, v66, v67
    v_mfma_f32_32x32x16_bf16 v[48:63], v[100:103], a[36:39], v[48:63]
    v_cvt_pk_bf16_f32 v82, v68, v69
    v_cvt_pk_bf16_f32 v83, v70, v71
    v_exp_f32 v72, v72
    v_exp_f32 v73, v73
    v_mfma_f32_32x32x16_bf16 a[112:127], v[120:123], v[80:83], a[112:127]
    v_exp_f32 v74, v74
    v_exp_f32 v75, v75
    v_exp_f32 v76, v76
    v_mfma_f32_16x16x32_bf16 a[204:207], v[88:91], v[80:83], a[204:207]
    s_mov_b64 exec, 1
    v_mov_b32 v3, 1
    buffer_atomic_add v3, off, s[8:11], s36 sc1
    s_mov_b64 exec, -1
    s_mov_b32 s3, 3145728
    v_exp_f32 v77, v77
    v_exp_f32 v78, v78
    v_exp_f32 v79, v79
    buffer_load_dword v25, v24, s[16:19], s3 offen
    v_cvt_pk_bf16_f32 v84, v72, v73
    v_cvt_pk_bf16_f32 v85, v74, v75
    v_cvt_pk_bf16_f32 v86, v76, v77
    v_cvt_pk_bf16_f32 v87, v78, v79
    v_exp_f32 v48, v48
    v_exp_f32 v49, v49
    v_mfma_f32_32x32x16_bf16 a[112:127], v[124:127], v[84:87], a[112:127]
    v_exp_f32 v50, v50
    v_exp_f32 v51, v51
    v_exp_f32 v52, v52
    v_mfma_f32_16x16x32_bf16 a[204:207], v[88:91], v[84:87], a[204:207]
    v_exp_f32 v53, v53
    v_mfma_f32_32x32x16_bf16 v[64:79], v[96:99], a[40:43], 0
    v_exp_f32 v54, v54
    v_exp_f32 v55, v55
    v_cvt_pk_bf16_f32 v80, v48, v49
    v_cvt_pk_bf16_f32 v81, v50, v51
    v_mfma_f32_32x32x16_bf16 v[64:79], v[100:103], a[44:47], v[64:79]
    v_cvt_pk_bf16_f32 v82, v52, v53
    v_cvt_pk_bf16_f32 v83, v54, v55
    v_exp_f32 v56, v56
    v_exp_f32 v57, v57
    v_mfma_f32_32x32x16_bf16 a[128:143], v[120:123], v[80:83], a[128:143]
    v_exp_f32 v58, v58
    v_exp_f32 v59, v59
    v_exp_f32 v60, v60
    v_mfma_f32_16x16x32_bf16 a[208:211], v[88:91], v[80:83], a[208:211]
    v_exp_f32 v61, v61
    v_exp_f32 v62, v62
    v_exp_f32 v63, v63
    v_cvt_pk_bf16_f32 v84, v56, v57
    v_cvt_pk_bf16_f32 v85, v58, v59
    v_cvt_pk_bf16_f32 v86, v60, v61
    v_cvt_pk_bf16_f32 v87, v62, v63
    v_exp_f32 v64, v64
    v_exp_f32 v65, v65
    v_mfma_f32_32x32x16_bf16 a[128:143], v[124:127], v[84:87], a[128:143]
    v_exp_f32 v66, v66
    v_exp_f32 v67, v67
    v_exp_f32 v68, v68
    v_mfma_f32_16x16x32_bf16 a[208:211], v[88:91], v[84:87], a[208:211]
    v_exp_f32 v69, v69
    v_mfma_f32_32x32x16_bf16 v[48:63], v[96:99], a[48:51], 0
    v_exp_f32 v70, v70
    v_exp_f32 v71, v71
    v_cvt_pk_bf16_f32 v80, v64, v65
    v_cvt_pk_bf16_f32 v81, v66, v67
    v_mfma_f32_32x32x16_bf16 v[48:63], v[100:103], a[52:55], v[48:63]
    v_cvt_pk_bf16_f32 v82, v68, v69
    v_cvt_pk_bf16_f32 v83, v70, v71
    v_exp_f32 v72, v72
    v_exp_f32 v73, v73
    v_mfma_f32_32x32x16_bf16 a[144:159], v[120:123], v[80:83], a[144:159]
    v_exp_f32 v74, v74
    v_exp_f32 v75, v75
    v_exp_f32 v76, v76
    v_mfma_f32_16x16x32_bf16 a[212:215], v[88:91], v[80:83], a[212:215]
    v_exp_f32 v77, v77
    v_exp_f32 v78, v78
    v_exp_f32 v79, v79
    v_cvt_pk_bf16_f32 v84, v72, v73
    v_cvt_pk_bf16_f32 v85, v74, v75
    v_cvt_pk_bf16_f32 v86, v76, v77
    v_cvt_pk_bf16_f32 v87, v78, v79
    v_exp_f32 v48, v48
    v_exp_f32 v49, v49
    v_mfma_f32_32x32x16_bf16 a[144:159], v[124:127], v[84:87], a[144:159]
    v_exp_f32 v50, v50
    v_exp_f32 v51, v51
    v_exp_f32 v52, v52
    v_mfma_f32_16x16x32_bf16 a[212:215], v[88:91], v[84:87], a[212:215]
    v_exp_f32 v53, v53
    v_mfma_f32_32x32x16_bf16 v[64:79], v[96:99], a[56:59], 0
    v_exp_f32 v54, v54
    v_exp_f32 v55, v55
    v_cvt_pk_bf16_f32 v80, v48, v49
    v_cvt_pk_bf16_f32 v81, v50, v51
    v_mfma_f32_32x32x16_bf16 v[64:79], v[100:103], a[60:63], v[64:79]
    v_cvt_pk_bf16_f32 v82, v52, v53
    v_cvt_pk_bf16_f32 v83, v54, v55
    v_exp_f32 v56, v56
    v_exp_f32 v57, v57
    v_mfma_f32_32x32x16_bf16 a[160:175], v[120:123], v[80:83], a[160:175]
    v_exp_f32 v58, v58
    v_exp_f32 v59, v59
    v_exp_f32 v60, v60
    v_mfma_f32_16x16x32_bf16 a[216:219], v[88:91], v[80:83], a[216:219]
    v_exp_f32 v61, v61
    v_exp_f32 v62, v62
    v_exp_f32 v63, v63
    v_cvt_pk_bf16_f32 v84, v56, v57
    v_cvt_pk_bf16_f32 v85, v58, v59
    v_cvt_pk_bf16_f32 v86, v60, v61
    v_cvt_pk_bf16_f32 v87, v62, v63
    s_waitcnt vmcnt(15)
    v_exp_f32 v64, v64
    v_exp_f32 v65, v65
    v_mfma_f32_32x32x16_bf16 a[160:175], v[124:127], v[84:87], a[160:175]
    v_exp_f32 v66, v66
    v_exp_f32 v67, v67
    v_exp_f32 v68, v68
    v_mfma_f32_16x16x32_bf16 a[216:219], v[88:91], v[84:87], a[216:219]
    v_exp_f32 v69, v69
    v_mfma_f32_32x32x16_bf16 v[48:63], v[104:107], a[0:3], 0
    v_exp_f32 v70, v70
    v_exp_f32 v71, v71
    v_cvt_pk_bf16_f32 v80, v64, v65
    v_cvt_pk_bf16_f32 v81, v66, v67
    v_mfma_f32_32x32x16_bf16 v[48:63], v[108:111], a[4:7], v[48:63]
    v_cvt_pk_bf16_f32 v82, v68, v69
    v_cvt_pk_bf16_f32 v83, v70, v71
    v_exp_f32 v72, v72
    v_exp_f32 v73, v73
    v_mfma_f32_32x32x16_bf16 a[176:191], v[120:123], v[80:83], a[176:191]
    v_exp_f32 v74, v74
    v_exp_f32 v75, v75
    v_exp_f32 v76, v76
    v_mfma_f32_16x16x32_bf16 a[220:223], v[88:91], v[80:83], a[220:223]
    v_exp_f32 v77, v77
    v_exp_f32 v78, v78
    v_exp_f32 v79, v79
    v_cvt_pk_bf16_f32 v84, v72, v73
    v_cvt_pk_bf16_f32 v85, v74, v75
    v_cvt_pk_bf16_f32 v86, v76, v77
    v_cvt_pk_bf16_f32 v87, v78, v79
    v_exp_f32 v48, v48
    v_exp_f32 v49, v49
    v_mfma_f32_32x32x16_bf16 a[176:191], v[124:127], v[84:87], a[176:191]
    v_exp_f32 v50, v50
    v_exp_f32 v51, v51
    v_exp_f32 v52, v52
    v_mfma_f32_16x16x32_bf16 a[220:223], v[88:91], v[84:87], a[220:223]
    v_exp_f32 v53, v53
    v_mfma_f32_32x32x16_bf16 v[64:79], v[104:107], a[8:11], 0
    v_exp_f32 v54, v54
    v_exp_f32 v55, v55
    v_cvt_pk_bf16_f32 v80, v48, v49
    v_cvt_pk_bf16_f32 v81, v50, v51
    v_mfma_f32_32x32x16_bf16 v[64:79], v[108:111], a[12:15], v[64:79]
    v_cvt_pk_bf16_f32 v82, v52, v53
    v_cvt_pk_bf16_f32 v83, v54, v55
    v_exp_f32 v56, v56
    v_exp_f32 v57, v57
    v_mfma_f32_32x32x16_bf16 a[64:79], v[128:131], v[80:83], a[64:79]
    v_exp_f32 v58, v58
    v_exp_f32 v59, v59
    v_exp_f32 v60, v60
    v_mfma_f32_16x16x32_bf16 a[192:195], v[88:91], v[80:83], a[192:195]
    v_exp_f32 v61, v61
    v_exp_f32 v62, v62
    v_exp_f32 v63, v63
    v_cvt_pk_bf16_f32 v84, v56, v57
    v_cvt_pk_bf16_f32 v85, v58, v59
    v_cvt_pk_bf16_f32 v86, v60, v61
    v_cvt_pk_bf16_f32 v87, v62, v63
    v_exp_f32 v64, v64
    v_exp_f32 v65, v65
    v_mfma_f32_32x32x16_bf16 a[64:79], v[132:135], v[84:87], a[64:79]
    v_exp_f32 v66, v66
    v_exp_f32 v67, v67
    v_exp_f32 v68, v68
    v_mfma_f32_16x16x32_bf16 a[192:195], v[88:91], v[84:87], a[192:195]
    v_exp_f32 v69, v69
    v_mfma_f32_32x32x16_bf16 v[48:63], v[104:107], a[16:19], 0
    v_exp_f32 v70, v70
    v_exp_f32 v71, v71
    v_cvt_pk_bf16_f32 v80, v64, v65
    v_cvt_pk_bf16_f32 v81, v66, v67
    v_mfma_f32_32x32x16_bf16 v[48:63], v[108:111], a[20:23], v[48:63]
    v_cvt_pk_bf16_f32 v82, v68, v69
    v_cvt_pk_bf16_f32 v83, v70, v71
    v_exp_f32 v72, v72
    v_exp_f32 v73, v73
    v_mfma_f32_32x32x16_bf16 a[80:95], v[128:131], v[80:83], a[80:95]
    v_exp_f32 v74, v74
    v_exp_f32 v75, v75
    v_exp_f32 v76, v76
    v_mfma_f32_16x16x32_bf16 a[196:199], v[88:91], v[80:83], a[196:199]
    buffer_load_dwordx4 v[96:99], v2, s[8:11], s30 offen offset:2048 sc1
    buffer_load_dwordx4 v[100:103], v2, s[8:11], s30 offen offset:3072 sc1
    v_exp_f32 v77, v77
    v_exp_f32 v78, v78
    v_exp_f32 v79, v79
    s_add_u32 s30, s30, 4096
    buffer_load_dwordx4 v[120:123], v2, s[8:11], s31 offen offset:2048 sc1
    v_cvt_pk_bf16_f32 v84, v72, v73
    v_cvt_pk_bf16_f32 v85, v74, v75
    buffer_load_dwordx4 v[124:127], v2, s[8:11], s31 offen offset:3072 sc1
    s_add_u32 s31, s31, 4096
    v_cvt_pk_bf16_f32 v86, v76, v77
    v_cvt_pk_bf16_f32 v87, v78, v79
    v_exp_f32 v48, v48
    v_exp_f32 v49, v49
    v_mfma_f32_32x32x16_bf16 a[80:95], v[132:135], v[84:87], a[80:95]
    v_exp_f32 v50, v50
    v_exp_f32 v51, v51
    v_exp_f32 v52, v52
    v_mfma_f32_16x16x32_bf16 a[196:199], v[88:91], v[84:87], a[196:199]
    v_exp_f32 v53, v53
    v_mfma_f32_32x32x16_bf16 v[64:79], v[104:107], a[24:27], 0
    v_exp_f32 v54, v54
    v_exp_f32 v55, v55
    v_cvt_pk_bf16_f32 v80, v48, v49
    v_cvt_pk_bf16_f32 v81, v50, v51
    v_mfma_f32_32x32x16_bf16 v[64:79], v[108:111], a[28:31], v[64:79]
    v_cvt_pk_bf16_f32 v82, v52, v53
    v_cvt_pk_bf16_f32 v83, v54, v55
    v_exp_f32 v56, v56
    v_exp_f32 v57, v57
    v_mfma_f32_32x32x16_bf16 a[96:111], v[128:131], v[80:83], a[96:111]
    v_exp_f32 v58, v58
    v_exp_f32 v59, v59
    v_exp_f32 v60, v60
    v_mfma_f32_16x16x32_bf16 a[200:203], v[88:91], v[80:83], a[200:203]
    v_exp_f32 v61, v61
    v_exp_f32 v62, v62
    v_exp_f32 v63, v63
    v_cvt_pk_bf16_f32 v84, v56, v57
    v_cvt_pk_bf16_f32 v85, v58, v59
    v_cvt_pk_bf16_f32 v86, v60, v61
    v_cvt_pk_bf16_f32 v87, v62, v63
    v_exp_f32 v64, v64
    v_exp_f32 v65, v65
    v_mfma_f32_32x32x16_bf16 a[96:111], v[132:135], v[84:87], a[96:111]
    v_exp_f32 v66, v66
    v_exp_f32 v67, v67
    v_exp_f32 v68, v68
    v_mfma_f32_16x16x32_bf16 a[200:203], v[88:91], v[84:87], a[200:203]
    v_exp_f32 v69, v69
    v_mfma_f32_32x32x16_bf16 v[48:63], v[104:107], a[32:35], 0
    v_exp_f32 v70, v70
    v_exp_f32 v71, v71
    v_cvt_pk_bf16_f32 v80, v64, v65
    v_cvt_pk_bf16_f32 v81, v66, v67
    v_mfma_f32_32x32x16_bf16 v[48:63], v[108:111], a[36:39], v[48:63]
    v_cvt_pk_bf16_f32 v82, v68, v69
    v_cvt_pk_bf16_f32 v83, v70, v71
    v_exp_f32 v72, v72
    v_exp_f32 v73, v73
    v_mfma_f32_32x32x16_bf16 a[112:127], v[128:131], v[80:83], a[112:127]
    v_exp_f32 v74, v74
    v_exp_f32 v75, v75
    v_exp_f32 v76, v76
    v_mfma_f32_16x16x32_bf16 a[204:207], v[88:91], v[80:83], a[204:207]
    s_mov_b32 s3, 0
    buffer_load_dword v25, v24, s[12:15], s3 offen
    v_exp_f32 v77, v77
    v_exp_f32 v78, v78
    v_exp_f32 v79, v79
    v_cvt_pk_bf16_f32 v84, v72, v73
    v_cvt_pk_bf16_f32 v85, v74, v75
    v_cvt_pk_bf16_f32 v86, v76, v77
    v_cvt_pk_bf16_f32 v87, v78, v79
    v_exp_f32 v48, v48
    v_exp_f32 v49, v49
    v_mfma_f32_32x32x16_bf16 a[112:127], v[132:135], v[84:87], a[112:127]
    v_exp_f32 v50, v50
    v_exp_f32 v51, v51
    v_exp_f32 v52, v52
    v_mfma_f32_16x16x32_bf16 a[204:207], v[88:91], v[84:87], a[204:207]
    v_exp_f32 v53, v53
    v_mfma_f32_32x32x16_bf16 v[64:79], v[104:107], a[40:43], 0
    v_exp_f32 v54, v54
    v_exp_f32 v55, v55
    v_cvt_pk_bf16_f32 v80, v48, v49
    v_cvt_pk_bf16_f32 v81, v50, v51
    v_mfma_f32_32x32x16_bf16 v[64:79], v[108:111], a[44:47], v[64:79]
    v_cvt_pk_bf16_f32 v82, v52, v53
    v_cvt_pk_bf16_f32 v83, v54, v55
    v_exp_f32 v56, v56
    v_exp_f32 v57, v57
    v_mfma_f32_32x32x16_bf16 a[128:143], v[128:131], v[80:83], a[128:143]
    v_exp_f32 v58, v58
    v_exp_f32 v59, v59
    v_exp_f32 v60, v60
    v_mfma_f32_16x16x32_bf16 a[208:211], v[88:91], v[80:83], a[208:211]
    v_exp_f32 v61, v61
    v_exp_f32 v62, v62
    v_exp_f32 v63, v63
    v_cvt_pk_bf16_f32 v84, v56, v57
    v_cvt_pk_bf16_f32 v85, v58, v59
    v_cvt_pk_bf16_f32 v86, v60, v61
    v_cvt_pk_bf16_f32 v87, v62, v63
    v_exp_f32 v64, v64
    v_exp_f32 v65, v65
    v_mfma_f32_32x32x16_bf16 a[128:143], v[132:135], v[84:87], a[128:143]
    v_exp_f32 v66, v66
    v_exp_f32 v67, v67
    v_exp_f32 v68, v68
    v_mfma_f32_16x16x32_bf16 a[208:211], v[88:91], v[84:87], a[208:211]
    v_exp_f32 v69, v69
    v_mfma_f32_32x32x16_bf16 v[48:63], v[104:107], a[48:51], 0
    v_exp_f32 v70, v70
    v_exp_f32 v71, v71
    v_cvt_pk_bf16_f32 v80, v64, v65
    v_cvt_pk_bf16_f32 v81, v66, v67
    v_mfma_f32_32x32x16_bf16 v[48:63], v[108:111], a[52:55], v[48:63]
    v_cvt_pk_bf16_f32 v82, v68, v69
    v_cvt_pk_bf16_f32 v83, v70, v71
    v_exp_f32 v72, v72
    v_exp_f32 v73, v73
    v_mfma_f32_32x32x16_bf16 a[144:159], v[128:131], v[80:83], a[144:159]
    v_exp_f32 v74, v74
    v_exp_f32 v75, v75
    v_exp_f32 v76, v76
    v_mfma_f32_16x16x32_bf16 a[212:215], v[88:91], v[80:83], a[212:215]
    v_exp_f32 v77, v77
    v_exp_f32 v78, v78
    v_exp_f32 v79, v79
    v_cvt_pk_bf16_f32 v84, v72, v73
    v_cvt_pk_bf16_f32 v85, v74, v75
    v_cvt_pk_bf16_f32 v86, v76, v77
    v_cvt_pk_bf16_f32 v87, v78, v79
    v_exp_f32 v48, v48
    v_exp_f32 v49, v49
    v_mfma_f32_32x32x16_bf16 a[144:159], v[132:135], v[84:87], a[144:159]
    v_exp_f32 v50, v50
    v_exp_f32 v51, v51
    v_exp_f32 v52, v52
    v_mfma_f32_16x16x32_bf16 a[212:215], v[88:91], v[84:87], a[212:215]
    v_exp_f32 v53, v53
    v_mfma_f32_32x32x16_bf16 v[64:79], v[104:107], a[56:59], 0
    v_exp_f32 v54, v54
    v_exp_f32 v55, v55
    v_cvt_pk_bf16_f32 v80, v48, v49
    v_cvt_pk_bf16_f32 v81, v50, v51
    v_mfma_f32_32x32x16_bf16 v[64:79], v[108:111], a[60:63], v[64:79]
    v_cvt_pk_bf16_f32 v82, v52, v53
    v_cvt_pk_bf16_f32 v83, v54, v55
    v_exp_f32 v56, v56
    v_exp_f32 v57, v57
    v_mfma_f32_32x32x16_bf16 a[160:175], v[128:131], v[80:83], a[160:175]
    v_exp_f32 v58, v58
    v_exp_f32 v59, v59
    v_exp_f32 v60, v60
    v_mfma_f32_16x16x32_bf16 a[216:219], v[88:91], v[80:83], a[216:219]
    v_exp_f32 v61, v61
    v_exp_f32 v62, v62
    v_exp_f32 v63, v63
    v_cvt_pk_bf16_f32 v84, v56, v57
    v_cvt_pk_bf16_f32 v85, v58, v59
    v_cvt_pk_bf16_f32 v86, v60, v61
    v_cvt_pk_bf16_f32 v87, v62, v63
    s_waitcnt vmcnt(16)
    v_exp_f32 v64, v64
    v_exp_f32 v65, v65
    v_mfma_f32_32x32x16_bf16 a[160:175], v[132:135], v[84:87], a[160:175]
    v_exp_f32 v66, v66
    v_exp_f32 v67, v67
    v_exp_f32 v68, v68
    v_mfma_f32_16x16x32_bf16 a[216:219], v[88:91], v[84:87], a[216:219]
    v_exp_f32 v69, v69
    v_mfma_f32_32x32x16_bf16 v[48:63], v[112:115], a[0:3], 0
    v_exp_f32 v70, v70
    v_exp_f32 v71, v71
    v_cvt_pk_bf16_f32 v80, v64, v65
    v_cvt_pk_bf16_f32 v81, v66, v67
    v_mfma_f32_32x32x16_bf16 v[48:63], v[116:119], a[4:7], v[48:63]
    v_cvt_pk_bf16_f32 v82, v68, v69
    v_cvt_pk_bf16_f32 v83, v70, v71
    v_exp_f32 v72, v72
    v_exp_f32 v73, v73
    v_mfma_f32_32x32x16_bf16 a[176:191], v[128:131], v[80:83], a[176:191]
    v_exp_f32 v74, v74
    v_exp_f32 v75, v75
    v_exp_f32 v76, v76
    v_mfma_f32_16x16x32_bf16 a[220:223], v[88:91], v[80:83], a[220:223]
    v_exp_f32 v77, v77
    v_exp_f32 v78, v78
    v_exp_f32 v79, v79
    v_cvt_pk_bf16_f32 v84, v72, v73
    v_cvt_pk_bf16_f32 v85, v74, v75
    v_cvt_pk_bf16_f32 v86, v76, v77
    v_cvt_pk_bf16_f32 v87, v78, v79
    v_exp_f32 v48, v48
    v_exp_f32 v49, v49
    v_mfma_f32_32x32x16_bf16 a[176:191], v[132:135], v[84:87], a[176:191]
    v_exp_f32 v50, v50
    v_exp_f32 v51, v51
    v_exp_f32 v52, v52
    v_mfma_f32_16x16x32_bf16 a[220:223], v[88:91], v[84:87], a[220:223]
    v_exp_f32 v53, v53
    v_mfma_f32_32x32x16_bf16 v[64:79], v[112:115], a[8:11], 0
    v_exp_f32 v54, v54
    v_exp_f32 v55, v55
    v_cvt_pk_bf16_f32 v80, v48, v49
    v_cvt_pk_bf16_f32 v81, v50, v51
    v_mfma_f32_32x32x16_bf16 v[64:79], v[116:119], a[12:15], v[64:79]
    v_cvt_pk_bf16_f32 v82, v52, v53
    v_cvt_pk_bf16_f32 v83, v54, v55
    v_exp_f32 v56, v56
    v_exp_f32 v57, v57
    v_mfma_f32_32x32x16_bf16 a[64:79], v[136:139], v[80:83], a[64:79]
    v_exp_f32 v58, v58
    v_exp_f32 v59, v59
    v_exp_f32 v60, v60
    v_mfma_f32_16x16x32_bf16 a[192:195], v[88:91], v[80:83], a[192:195]
    v_exp_f32 v61, v61
    v_exp_f32 v62, v62
    v_exp_f32 v63, v63
    v_cvt_pk_bf16_f32 v84, v56, v57
    v_cvt_pk_bf16_f32 v85, v58, v59
    v_cvt_pk_bf16_f32 v86, v60, v61
    v_cvt_pk_bf16_f32 v87, v62, v63
    v_exp_f32 v64, v64
    v_exp_f32 v65, v65
    v_mfma_f32_32x32x16_bf16 a[64:79], v[140:143], v[84:87], a[64:79]
    v_exp_f32 v66, v66
    v_exp_f32 v67, v67
    v_exp_f32 v68, v68
    v_mfma_f32_16x16x32_bf16 a[192:195], v[88:91], v[84:87], a[192:195]
    v_exp_f32 v69, v69
    v_mfma_f32_32x32x16_bf16 v[48:63], v[112:115], a[16:19], 0
    v_exp_f32 v70, v70
    v_exp_f32 v71, v71
    v_cvt_pk_bf16_f32 v80, v64, v65
    v_cvt_pk_bf16_f32 v81, v66, v67
    v_mfma_f32_32x32x16_bf16 v[48:63], v[116:119], a[20:23], v[48:63]
    v_cvt_pk_bf16_f32 v82, v68, v69
    v_cvt_pk_bf16_f32 v83, v70, v71
    v_exp_f32 v72, v72
    v_exp_f32 v73, v73
    v_mfma_f32_32x32x16_bf16 a[80:95], v[136:139], v[80:83], a[80:95]
    v_exp_f32 v74, v74
    v_exp_f32 v75, v75
    v_exp_f32 v76, v76
    v_mfma_f32_16x16x32_bf16 a[196:199], v[88:91], v[80:83], a[196:199]
    v_exp_f32 v77, v77
    v_exp_f32 v78, v78
    v_exp_f32 v79, v79
    v_cvt_pk_bf16_f32 v84, v72, v73
    v_cvt_pk_bf16_f32 v85, v74, v75
    v_cvt_pk_bf16_f32 v86, v76, v77
    v_cvt_pk_bf16_f32 v87, v78, v79
    v_exp_f32 v48, v48
    v_exp_f32 v49, v49
    v_mfma_f32_32x32x16_bf16 a[80:95], v[140:143], v[84:87], a[80:95]
    v_exp_f32 v50, v50
    v_exp_f32 v51, v51
    v_exp_f32 v52, v52
    v_mfma_f32_16x16x32_bf16 a[196:199], v[88:91], v[84:87], a[196:199]
    v_exp_f32 v53, v53
    v_mfma_f32_32x32x16_bf16 v[64:79], v[112:115], a[24:27], 0
    v_exp_f32 v54, v54
    v_exp_f32 v55, v55
    v_cvt_pk_bf16_f32 v80, v48, v49
    v_cvt_pk_bf16_f32 v81, v50, v51
    v_mfma_f32_32x32x16_bf16 v[64:79], v[116:119], a[28:31], v[64:79]
    v_cvt_pk_bf16_f32 v82, v52, v53
    v_cvt_pk_bf16_f32 v83, v54, v55
    v_exp_f32 v56, v56
    v_exp_f32 v57, v57
    v_mfma_f32_32x32x16_bf16 a[96:111], v[136:139], v[80:83], a[96:111]
    v_exp_f32 v58, v58
    v_exp_f32 v59, v59
    v_exp_f32 v60, v60
    v_mfma_f32_16x16x32_bf16 a[200:203], v[88:91], v[80:83], a[200:203]
    v_exp_f32 v61, v61
    v_exp_f32 v62, v62
    v_exp_f32 v63, v63
    v_cvt_pk_bf16_f32 v84, v56, v57
    v_cvt_pk_bf16_f32 v85, v58, v59
    v_cvt_pk_bf16_f32 v86, v60, v61
    v_cvt_pk_bf16_f32 v87, v62, v63
    v_exp_f32 v64, v64
    v_exp_f32 v65, v65
    v_mfma_f32_32x32x16_bf16 a[96:111], v[140:143], v[84:87], a[96:111]
    v_exp_f32 v66, v66
    v_exp_f32 v67, v67
    v_exp_f32 v68, v68
    v_mfma_f32_16x16x32_bf16 a[200:203], v[88:91], v[84:87], a[200:203]
    v_exp_f32 v69, v69
    v_mfma_f32_32x32x16_bf16 v[48:63], v[112:115], a[32:35], 0
    v_exp_f32 v70, v70
    v_exp_f32 v71, v71
    v_cvt_pk_bf16_f32 v80, v64, v65
    v_cvt_pk_bf16_f32 v81, v66, v67
    v_mfma_f32_32x32x16_bf16 v[48:63], v[116:119], a[36:39], v[48:63]
    v_cvt_pk_bf16_f32 v82, v68, v69
    v_cvt_pk_bf16_f32 v83, v70, v71
    v_exp_f32 v72, v72
    v_exp_f32 v73, v73
    v_mfma_f32_32x32x16_bf16 a[112:127], v[136:139], v[80:83], a[112:127]
    v_exp_f32 v74, v74
    v_exp_f32 v75, v75
    v_exp_f32 v76, v76
    v_mfma_f32_16x16x32_bf16 a[204:207], v[88:91], v[80:83], a[204:207]
    s_mov_b32 s3, 6291456
    buffer_load_dword v25, v24, s[16:19], s3 offen
    v_exp_f32 v77, v77
    v_exp_f32 v78, v78
    v_exp_f32 v79, v79
    v_cvt_pk_bf16_f32 v84, v72, v73
    v_cvt_pk_bf16_f32 v85, v74, v75
    v_cvt_pk_bf16_f32 v86, v76, v77
    v_cvt_pk_bf16_f32 v87, v78, v79
    v_exp_f32 v48, v48
    v_exp_f32 v49, v49
    v_mfma_f32_32x32x16_bf16 a[112:127], v[140:143], v[84:87], a[112:127]
    v_exp_f32 v50, v50
    v_exp_f32 v51, v51
    v_exp_f32 v52, v52
    v_mfma_f32_16x16x32_bf16 a[204:207], v[88:91], v[84:87], a[204:207]
    v_exp_f32 v53, v53
    v_mfma_f32_32x32x16_bf16 v[64:79], v[112:115], a[40:43], 0
    v_exp_f32 v54, v54
    v_exp_f32 v55, v55
    v_cvt_pk_bf16_f32 v80, v48, v49
    v_cvt_pk_bf16_f32 v81, v50, v51
    v_mfma_f32_32x32x16_bf16 v[64:79], v[116:119], a[44:47], v[64:79]
    v_cvt_pk_bf16_f32 v82, v52, v53
    v_cvt_pk_bf16_f32 v83, v54, v55
    v_exp_f32 v56, v56
    v_exp_f32 v57, v57
    v_mfma_f32_32x32x16_bf16 a[128:143], v[136:139], v[80:83], a[128:143]
    v_exp_f32 v58, v58
    v_exp_f32 v59, v59
    v_exp_f32 v60, v60
    v_mfma_f32_16x16x32_bf16 a[208:211], v[88:91], v[80:83], a[208:211]
    v_exp_f32 v61, v61
    v_exp_f32 v62, v62
    v_exp_f32 v63, v63
    v_cvt_pk_bf16_f32 v84, v56, v57
    v_cvt_pk_bf16_f32 v85, v58, v59
    v_cvt_pk_bf16_f32 v86, v60, v61
    v_cvt_pk_bf16_f32 v87, v62, v63
    v_exp_f32 v64, v64
    v_exp_f32 v65, v65
    v_mfma_f32_32x32x16_bf16 a[128:143], v[140:143], v[84:87], a[128:143]
    v_exp_f32 v66, v66
    v_exp_f32 v67, v67
    v_exp_f32 v68, v68
    v_mfma_f32_16x16x32_bf16 a[208:211], v[88:91], v[84:87], a[208:211]
    v_exp_f32 v69, v69
    v_mfma_f32_32x32x16_bf16 v[48:63], v[112:115], a[48:51], 0
    v_exp_f32 v70, v70
    v_exp_f32 v71, v71
    v_cvt_pk_bf16_f32 v80, v64, v65
    v_cvt_pk_bf16_f32 v81, v66, v67
    v_mfma_f32_32x32x16_bf16 v[48:63], v[116:119], a[52:55], v[48:63]
    v_cvt_pk_bf16_f32 v82, v68, v69
    v_cvt_pk_bf16_f32 v83, v70, v71
    v_exp_f32 v72, v72
    v_exp_f32 v73, v73
    v_mfma_f32_32x32x16_bf16 a[144:159], v[136:139], v[80:83], a[144:159]
    v_exp_f32 v74, v74
    v_exp_f32 v75, v75
    v_exp_f32 v76, v76
    v_mfma_f32_16x16x32_bf16 a[212:215], v[88:91], v[80:83], a[212:215]
    v_exp_f32 v77, v77
    v_exp_f32 v78, v78
    v_exp_f32 v79, v79
    v_cvt_pk_bf16_f32 v84, v72, v73
    v_cvt_pk_bf16_f32 v85, v74, v75
    v_cvt_pk_bf16_f32 v86, v76, v77
    v_cvt_pk_bf16_f32 v87, v78, v79
    v_exp_f32 v48, v48
    v_exp_f32 v49, v49
    v_mfma_f32_32x32x16_bf16 a[144:159], v[140:143], v[84:87], a[144:159]
    v_exp_f32 v50, v50
    v_exp_f32 v51, v51
    v_exp_f32 v52, v52
    v_mfma_f32_16x16x32_bf16 a[212:215], v[88:91], v[84:87], a[212:215]
    v_exp_f32 v53, v53
    v_mfma_f32_32x32x16_bf16 v[64:79], v[112:115], a[56:59], 0
    v_exp_f32 v54, v54
    v_exp_f32 v55, v55
    v_cvt_pk_bf16_f32 v80, v48, v49
    v_cvt_pk_bf16_f32 v81, v50, v51
    v_mfma_f32_32x32x16_bf16 v[64:79], v[116:119], a[60:63], v[64:79]
    v_cvt_pk_bf16_f32 v82, v52, v53
    v_cvt_pk_bf16_f32 v83, v54, v55
    v_exp_f32 v56, v56
    v_exp_f32 v57, v57
    v_mfma_f32_32x32x16_bf16 a[160:175], v[136:139], v[80:83], a[160:175]
    v_exp_f32 v58, v58
    v_exp_f32 v59, v59
    v_exp_f32 v60, v60
    v_mfma_f32_16x16x32_bf16 a[216:219], v[88:91], v[80:83], a[216:219]
    v_exp_f32 v61, v61
    v_exp_f32 v62, v62
    v_exp_f32 v63, v63
    v_cvt_pk_bf16_f32 v84, v56, v57
    v_cvt_pk_bf16_f32 v85, v58, v59
    v_cvt_pk_bf16_f32 v86, v60, v61
    v_cvt_pk_bf16_f32 v87, v62, v63
    s_waitcnt vmcnt(13)
    v_exp_f32 v64, v64
    v_exp_f32 v65, v65
    v_mfma_f32_32x32x16_bf16 a[160:175], v[140:143], v[84:87], a[160:175]
    v_exp_f32 v66, v66
    v_exp_f32 v67, v67
    v_exp_f32 v68, v68
    v_mfma_f32_16x16x32_bf16 a[216:219], v[88:91], v[84:87], a[216:219]
    v_exp_f32 v69, v69
    v_mfma_f32_32x32x16_bf16 v[48:63], v[152:155], a[0:3], 0
    v_exp_f32 v70, v70
    v_exp_f32 v71, v71
    v_cvt_pk_bf16_f32 v80, v64, v65
    v_cvt_pk_bf16_f32 v81, v66, v67
    v_mfma_f32_32x32x16_bf16 v[48:63], v[156:159], a[4:7], v[48:63]
    v_cvt_pk_bf16_f32 v82, v68, v69
    v_cvt_pk_bf16_f32 v83, v70, v71
    v_exp_f32 v72, v72
    v_exp_f32 v73, v73
    v_mfma_f32_32x32x16_bf16 a[176:191], v[136:139], v[80:83], a[176:191]
    v_exp_f32 v74, v74
    v_exp_f32 v75, v75
    v_exp_f32 v76, v76
    v_mfma_f32_16x16x32_bf16 a[220:223], v[88:91], v[80:83], a[220:223]
    v_exp_f32 v77, v77
    v_exp_f32 v78, v78
    v_exp_f32 v79, v79
    v_cvt_pk_bf16_f32 v84, v72, v73
    v_cvt_pk_bf16_f32 v85, v74, v75
    v_cvt_pk_bf16_f32 v86, v76, v77
    v_cvt_pk_bf16_f32 v87, v78, v79
    v_exp_f32 v48, v48
    v_exp_f32 v49, v49
    v_mfma_f32_32x32x16_bf16 a[176:191], v[140:143], v[84:87], a[176:191]
    v_exp_f32 v50, v50
    v_exp_f32 v51, v51
    v_exp_f32 v52, v52
    v_mfma_f32_16x16x32_bf16 a[220:223], v[88:91], v[84:87], a[220:223]
    v_exp_f32 v53, v53
    v_mfma_f32_32x32x16_bf16 v[64:79], v[152:155], a[8:11], 0
    v_exp_f32 v54, v54
    v_exp_f32 v55, v55
    v_cvt_pk_bf16_f32 v80, v48, v49
    v_cvt_pk_bf16_f32 v81, v50, v51
    v_mfma_f32_32x32x16_bf16 v[64:79], v[156:159], a[12:15], v[64:79]
    v_cvt_pk_bf16_f32 v82, v52, v53
    v_cvt_pk_bf16_f32 v83, v54, v55
    v_exp_f32 v56, v56
    v_exp_f32 v57, v57
    v_mfma_f32_32x32x16_bf16 a[64:79], v[168:171], v[80:83], a[64:79]
    v_exp_f32 v58, v58
    v_exp_f32 v59, v59
    v_exp_f32 v60, v60
    v_mfma_f32_16x16x32_bf16 a[192:195], v[88:91], v[80:83], a[192:195]
    v_exp_f32 v61, v61
    v_exp_f32 v62, v62
    v_exp_f32 v63, v63
    v_cvt_pk_bf16_f32 v84, v56, v57
    v_cvt_pk_bf16_f32 v85, v58, v59
    v_cvt_pk_bf16_f32 v86, v60, v61
    v_cvt_pk_bf16_f32 v87, v62, v63
    v_exp_f32 v64, v64
    v_exp_f32 v65, v65
    v_mfma_f32_32x32x16_bf16 a[64:79], v[172:175], v[84:87], a[64:79]
    v_exp_f32 v66, v66
    v_exp_f32 v67, v67
    v_exp_f32 v68, v68
    v_mfma_f32_16x16x32_bf16 a[192:195], v[88:91], v[84:87], a[192:195]
    v_exp_f32 v69, v69
    v_mfma_f32_32x32x16_bf16 v[48:63], v[152:155], a[16:19], 0
    v_exp_f32 v70, v70
    v_exp_f32 v71, v71
    v_cvt_pk_bf16_f32 v80, v64, v65
    v_cvt_pk_bf16_f32 v81, v66, v67
    v_mfma_f32_32x32x16_bf16 v[48:63], v[156:159], a[20:23], v[48:63]
    v_cvt_pk_bf16_f32 v82, v68, v69
    v_cvt_pk_bf16_f32 v83, v70, v71
    v_exp_f32 v72, v72
    v_exp_f32 v73, v73
    v_mfma_f32_32x32x16_bf16 a[80:95], v[168:171], v[80:83], a[80:95]
    v_exp_f32 v74, v74
    v_exp_f32 v75, v75
    v_exp_f32 v76, v76
    v_mfma_f32_16x16x32_bf16 a[196:199], v[88:91], v[80:83], a[196:199]
    v_exp_f32 v77, v77
    v_exp_f32 v78, v78
    v_exp_f32 v79, v79
    v_cvt_pk_bf16_f32 v84, v72, v73
    v_cvt_pk_bf16_f32 v85, v74, v75
    v_cvt_pk_bf16_f32 v86, v76, v77
    v_cvt_pk_bf16_f32 v87, v78, v79
    v_exp_f32 v48, v48
    v_exp_f32 v49, v49
    v_mfma_f32_32x32x16_bf16 a[80:95], v[172:175], v[84:87], a[80:95]
    v_exp_f32 v50, v50
    v_exp_f32 v51, v51
    v_exp_f32 v52, v52
    v_mfma_f32_16x16x32_bf16 a[196:199], v[88:91], v[84:87], a[196:199]
    v_exp_f32 v53, v53
    v_mfma_f32_32x32x16_bf16 v[64:79], v[152:155], a[24:27], 0
    v_exp_f32 v54, v54
    v_exp_f32 v55, v55
    v_cvt_pk_bf16_f32 v80, v48, v49
    v_cvt_pk_bf16_f32 v81, v50, v51
    v_mfma_f32_32x32x16_bf16 v[64:79], v[156:159], a[28:31], v[64:79]
    v_cvt_pk_bf16_f32 v82, v52, v53
    v_cvt_pk_bf16_f32 v83, v54, v55
    v_exp_f32 v56, v56
    v_exp_f32 v57, v57
    v_mfma_f32_32x32x16_bf16 a[96:111], v[168:171], v[80:83], a[96:111]
    v_exp_f32 v58, v58
    v_exp_f32 v59, v59
    v_exp_f32 v60, v60
    v_mfma_f32_16x16x32_bf16 a[200:203], v[88:91], v[80:83], a[200:203]
    v_exp_f32 v61, v61
    v_exp_f32 v62, v62
    v_exp_f32 v63, v63
    v_cvt_pk_bf16_f32 v84, v56, v57
    v_cvt_pk_bf16_f32 v85, v58, v59
    v_cvt_pk_bf16_f32 v86, v60, v61
    v_cvt_pk_bf16_f32 v87, v62, v63
    v_exp_f32 v64, v64
    v_exp_f32 v65, v65
    v_mfma_f32_32x32x16_bf16 a[96:111], v[172:175], v[84:87], a[96:111]
    v_exp_f32 v66, v66
    v_exp_f32 v67, v67
    v_exp_f32 v68, v68
    v_mfma_f32_16x16x32_bf16 a[200:203], v[88:91], v[84:87], a[200:203]
    v_exp_f32 v69, v69
    v_mfma_f32_32x32x16_bf16 v[48:63], v[152:155], a[32:35], 0
    v_exp_f32 v70, v70
    v_exp_f32 v71, v71
    v_cvt_pk_bf16_f32 v80, v64, v65
    v_cvt_pk_bf16_f32 v81, v66, v67
    v_mfma_f32_32x32x16_bf16 v[48:63], v[156:159], a[36:39], v[48:63]
    v_cvt_pk_bf16_f32 v82, v68, v69
    v_cvt_pk_bf16_f32 v83, v70, v71
    v_exp_f32 v72, v72
    v_exp_f32 v73, v73
    v_mfma_f32_32x32x16_bf16 a[112:127], v[168:171], v[80:83], a[112:127]
    v_exp_f32 v74, v74
    v_exp_f32 v75, v75
    v_exp_f32 v76, v76
    v_mfma_f32_16x16x32_bf16 a[204:207], v[88:91], v[80:83], a[204:207]
    v_mov_b32 v23, s60
    global_load_dword v23, v23, s[6:7] sc1
    v_exp_f32 v77, v77
    v_exp_f32 v78, v78
    v_exp_f32 v79, v79
    v_cvt_pk_bf16_f32 v84, v72, v73
    v_cvt_pk_bf16_f32 v85, v74, v75
    v_cvt_pk_bf16_f32 v86, v76, v77
    v_cvt_pk_bf16_f32 v87, v78, v79
    v_exp_f32 v48, v48
    v_exp_f32 v49, v49
    v_mfma_f32_32x32x16_bf16 a[112:127], v[172:175], v[84:87], a[112:127]
    v_exp_f32 v50, v50
    v_exp_f32 v51, v51
    v_exp_f32 v52, v52
    v_mfma_f32_16x16x32_bf16 a[204:207], v[88:91], v[84:87], a[204:207]
    v_exp_f32 v53, v53
    v_mfma_f32_32x32x16_bf16 v[64:79], v[152:155], a[40:43], 0
    v_exp_f32 v54, v54
    v_exp_f32 v55, v55
    v_cvt_pk_bf16_f32 v80, v48, v49
    v_cvt_pk_bf16_f32 v81, v50, v51
    v_mfma_f32_32x32x16_bf16 v[64:79], v[156:159], a[44:47], v[64:79]
    v_cvt_pk_bf16_f32 v82, v52, v53
    v_cvt_pk_bf16_f32 v83, v54, v55
    v_exp_f32 v56, v56
    v_exp_f32 v57, v57
    v_mfma_f32_32x32x16_bf16 a[128:143], v[168:171], v[80:83], a[128:143]
    v_exp_f32 v58, v58
    v_exp_f32 v59, v59
    v_exp_f32 v60, v60
    v_mfma_f32_16x16x32_bf16 a[208:211], v[88:91], v[80:83], a[208:211]
    v_exp_f32 v61, v61
    v_exp_f32 v62, v62
    v_exp_f32 v63, v63
    v_cvt_pk_bf16_f32 v84, v56, v57
    v_cvt_pk_bf16_f32 v85, v58, v59
    v_cvt_pk_bf16_f32 v86, v60, v61
    v_cvt_pk_bf16_f32 v87, v62, v63
    v_exp_f32 v64, v64
    v_exp_f32 v65, v65
    v_mfma_f32_32x32x16_bf16 a[128:143], v[172:175], v[84:87], a[128:143]
    v_exp_f32 v66, v66
    v_exp_f32 v67, v67
    v_exp_f32 v68, v68
    v_mfma_f32_16x16x32_bf16 a[208:211], v[88:91], v[84:87], a[208:211]
    v_exp_f32 v69, v69
    v_mfma_f32_32x32x16_bf16 v[48:63], v[152:155], a[48:51], 0
    v_exp_f32 v70, v70
    v_exp_f32 v71, v71
    v_cvt_pk_bf16_f32 v80, v64, v65
    v_cvt_pk_bf16_f32 v81, v66, v67
    v_mfma_f32_32x32x16_bf16 v[48:63], v[156:159], a[52:55], v[48:63]
    v_cvt_pk_bf16_f32 v82, v68, v69
    v_cvt_pk_bf16_f32 v83, v70, v71
    v_exp_f32 v72, v72
    v_exp_f32 v73, v73
    v_mfma_f32_32x32x16_bf16 a[144:159], v[168:171], v[80:83], a[144:159]
    v_exp_f32 v74, v74
    v_exp_f32 v75, v75
    v_exp_f32 v76, v76
    v_mfma_f32_16x16x32_bf16 a[212:215], v[88:91], v[80:83], a[212:215]
    v_exp_f32 v77, v77
    v_exp_f32 v78, v78
    v_exp_f32 v79, v79
    v_cvt_pk_bf16_f32 v84, v72, v73
    v_cvt_pk_bf16_f32 v85, v74, v75
    v_cvt_pk_bf16_f32 v86, v76, v77
    v_cvt_pk_bf16_f32 v87, v78, v79
    v_exp_f32 v48, v48
    v_exp_f32 v49, v49
    v_mfma_f32_32x32x16_bf16 a[144:159], v[172:175], v[84:87], a[144:159]
    v_exp_f32 v50, v50
    v_exp_f32 v51, v51
    v_exp_f32 v52, v52
    v_mfma_f32_16x16x32_bf16 a[212:215], v[88:91], v[84:87], a[212:215]
    v_exp_f32 v53, v53
    v_mfma_f32_32x32x16_bf16 v[64:79], v[152:155], a[56:59], 0
    v_exp_f32 v54, v54
    v_exp_f32 v55, v55
    v_cvt_pk_bf16_f32 v80, v48, v49
    v_cvt_pk_bf16_f32 v81, v50, v51
    v_mfma_f32_32x32x16_bf16 v[64:79], v[156:159], a[60:63], v[64:79]
    v_cvt_pk_bf16_f32 v82, v52, v53
    v_cvt_pk_bf16_f32 v83, v54, v55
    v_exp_f32 v56, v56
    v_exp_f32 v57, v57
    v_mfma_f32_32x32x16_bf16 a[160:175], v[168:171], v[80:83], a[160:175]
    v_exp_f32 v58, v58
    v_exp_f32 v59, v59
    v_exp_f32 v60, v60
    v_mfma_f32_16x16x32_bf16 a[216:219], v[88:91], v[80:83], a[216:219]
    v_exp_f32 v61, v61
    v_exp_f32 v62, v62
    v_exp_f32 v63, v63
    v_cvt_pk_bf16_f32 v84, v56, v57
    v_cvt_pk_bf16_f32 v85, v58, v59
    v_cvt_pk_bf16_f32 v86, v60, v61
    v_cvt_pk_bf16_f32 v87, v62, v63
    s_waitcnt vmcnt(9)
    v_exp_f32 v64, v64
    v_exp_f32 v65, v65
    v_mfma_f32_32x32x16_bf16 a[160:175], v[172:175], v[84:87], a[160:175]
    v_exp_f32 v66, v66
    v_exp_f32 v67, v67
    v_exp_f32 v68, v68
    v_mfma_f32_16x16x32_bf16 a[216:219], v[88:91], v[84:87], a[216:219]
    v_exp_f32 v69, v69
    v_mfma_f32_32x32x16_bf16 v[48:63], v[184:187], a[0:3], 0
    v_exp_f32 v70, v70
    v_exp_f32 v71, v71
    v_cvt_pk_bf16_f32 v80, v64, v65
    v_cvt_pk_bf16_f32 v81, v66, v67
    v_mfma_f32_32x32x16_bf16 v[48:63], v[188:191], a[4:7], v[48:63]
    v_cvt_pk_bf16_f32 v82, v68, v69
    v_cvt_pk_bf16_f32 v83, v70, v71
    v_exp_f32 v72, v72
    v_exp_f32 v73, v73
    v_mfma_f32_32x32x16_bf16 a[176:191], v[168:171], v[80:83], a[176:191]
    v_exp_f32 v74, v74
    v_exp_f32 v75, v75
    v_exp_f32 v76, v76
    v_mfma_f32_16x16x32_bf16 a[220:223], v[88:91], v[80:83], a[220:223]
    v_exp_f32 v77, v77
    v_exp_f32 v78, v78
    v_exp_f32 v79, v79
    v_cvt_pk_bf16_f32 v84, v72, v73
    v_cvt_pk_bf16_f32 v85, v74, v75
    v_cvt_pk_bf16_f32 v86, v76, v77
    v_cvt_pk_bf16_f32 v87, v78, v79
    v_exp_f32 v48, v48
    v_exp_f32 v49, v49
    v_mfma_f32_32x32x16_bf16 a[176:191], v[172:175], v[84:87], a[176:191]
    v_exp_f32 v50, v50
    v_exp_f32 v51, v51
    v_exp_f32 v52, v52
    v_mfma_f32_16x16x32_bf16 a[220:223], v[88:91], v[84:87], a[220:223]
    v_exp_f32 v53, v53
    v_mfma_f32_32x32x16_bf16 v[64:79], v[184:187], a[8:11], 0
    v_exp_f32 v54, v54
    v_exp_f32 v55, v55
    v_cvt_pk_bf16_f32 v80, v48, v49
    v_cvt_pk_bf16_f32 v81, v50, v51
    v_mfma_f32_32x32x16_bf16 v[64:79], v[188:191], a[12:15], v[64:79]
    v_cvt_pk_bf16_f32 v82, v52, v53
    v_cvt_pk_bf16_f32 v83, v54, v55
    v_exp_f32 v56, v56
    v_exp_f32 v57, v57
    v_mfma_f32_32x32x16_bf16 a[64:79], v[200:203], v[80:83], a[64:79]
    v_exp_f32 v58, v58
    v_exp_f32 v59, v59
    v_exp_f32 v60, v60
    v_mfma_f32_16x16x32_bf16 a[192:195], v[88:91], v[80:83], a[192:195]
    v_exp_f32 v61, v61
    v_exp_f32 v62, v62
    v_exp_f32 v63, v63
    v_cvt_pk_bf16_f32 v84, v56, v57
    v_cvt_pk_bf16_f32 v85, v58, v59
    v_cvt_pk_bf16_f32 v86, v60, v61
    v_cvt_pk_bf16_f32 v87, v62, v63
    v_exp_f32 v64, v64
    v_exp_f32 v65, v65
    v_mfma_f32_32x32x16_bf16 a[64:79], v[204:207], v[84:87], a[64:79]
    v_exp_f32 v66, v66
    v_exp_f32 v67, v67
    v_exp_f32 v68, v68
    v_mfma_f32_16x16x32_bf16 a[192:195], v[88:91], v[84:87], a[192:195]
    v_exp_f32 v69, v69
    v_mfma_f32_32x32x16_bf16 v[48:63], v[184:187], a[16:19], 0
    v_exp_f32 v70, v70
    v_exp_f32 v71, v71
    v_cvt_pk_bf16_f32 v80, v64, v65
    v_cvt_pk_bf16_f32 v81, v66, v67
    v_mfma_f32_32x32x16_bf16 v[48:63], v[188:191], a[20:23], v[48:63]
    v_cvt_pk_bf16_f32 v82, v68, v69
    v_cvt_pk_bf16_f32 v83, v70, v71
    v_exp_f32 v72, v72
    v_exp_f32 v73, v73
    v_mfma_f32_32x32x16_bf16 a[80:95], v[200:203], v[80:83], a[80:95]
    v_exp_f32 v74, v74
    v_exp_f32 v75, v75
    v_exp_f32 v76, v76
    v_mfma_f32_16x16x32_bf16 a[196:199], v[88:91], v[80:83], a[196:199]
    v_exp_f32 v77, v77
    v_exp_f32 v78, v78
    v_exp_f32 v79, v79
    v_cvt_pk_bf16_f32 v84, v72, v73
    v_cvt_pk_bf16_f32 v85, v74, v75
    v_cvt_pk_bf16_f32 v86, v76, v77
    v_cvt_pk_bf16_f32 v87, v78, v79
    v_exp_f32 v48, v48
    v_exp_f32 v49, v49
    v_mfma_f32_32x32x16_bf16 a[80:95], v[204:207], v[84:87], a[80:95]
    v_exp_f32 v50, v50
    v_exp_f32 v51, v51
    v_exp_f32 v52, v52
    v_mfma_f32_16x16x32_bf16 a[196:199], v[88:91], v[84:87], a[196:199]
    v_exp_f32 v53, v53
    v_mfma_f32_32x32x16_bf16 v[64:79], v[184:187], a[24:27], 0
    v_exp_f32 v54, v54
    v_exp_f32 v55, v55
    v_cvt_pk_bf16_f32 v80, v48, v49
    v_cvt_pk_bf16_f32 v81, v50, v51
    v_mfma_f32_32x32x16_bf16 v[64:79], v[188:191], a[28:31], v[64:79]
    v_cvt_pk_bf16_f32 v82, v52, v53
    v_cvt_pk_bf16_f32 v83, v54, v55
    v_exp_f32 v56, v56
    v_exp_f32 v57, v57
    v_mfma_f32_32x32x16_bf16 a[96:111], v[200:203], v[80:83], a[96:111]
    v_exp_f32 v58, v58
    v_exp_f32 v59, v59
    v_exp_f32 v60, v60
    v_mfma_f32_16x16x32_bf16 a[200:203], v[88:91], v[80:83], a[200:203]
    v_exp_f32 v61, v61
    v_exp_f32 v62, v62
    v_exp_f32 v63, v63
    v_cvt_pk_bf16_f32 v84, v56, v57
    v_cvt_pk_bf16_f32 v85, v58, v59
    v_cvt_pk_bf16_f32 v86, v60, v61
    v_cvt_pk_bf16_f32 v87, v62, v63
    v_exp_f32 v64, v64
    v_exp_f32 v65, v65
    v_mfma_f32_32x32x16_bf16 a[96:111], v[204:207], v[84:87], a[96:111]
    v_exp_f32 v66, v66
    v_exp_f32 v67, v67
    v_exp_f32 v68, v68
    v_mfma_f32_16x16x32_bf16 a[200:203], v[88:91], v[84:87], a[200:203]
    v_exp_f32 v69, v69
    v_mfma_f32_32x32x16_bf16 v[48:63], v[184:187], a[32:35], 0
    v_exp_f32 v70, v70
    v_exp_f32 v71, v71
    v_cvt_pk_bf16_f32 v80, v64, v65
    v_cvt_pk_bf16_f32 v81, v66, v67
    v_mfma_f32_32x32x16_bf16 v[48:63], v[188:191], a[36:39], v[48:63]
    v_cvt_pk_bf16_f32 v82, v68, v69
    v_cvt_pk_bf16_f32 v83, v70, v71
    v_exp_f32 v72, v72
    v_exp_f32 v73, v73
    v_mfma_f32_32x32x16_bf16 a[112:127], v[200:203], v[80:83], a[112:127]
    v_exp_f32 v74, v74
    v_exp_f32 v75, v75
    v_exp_f32 v76, v76
    v_mfma_f32_16x16x32_bf16 a[204:207], v[88:91], v[80:83], a[204:207]
    v_exp_f32 v77, v77
    v_exp_f32 v78, v78
    v_exp_f32 v79, v79
    v_cvt_pk_bf16_f32 v84, v72, v73
    v_cvt_pk_bf16_f32 v85, v74, v75
    v_cvt_pk_bf16_f32 v86, v76, v77
    v_cvt_pk_bf16_f32 v87, v78, v79
    v_exp_f32 v48, v48
    v_exp_f32 v49, v49
    v_mfma_f32_32x32x16_bf16 a[112:127], v[204:207], v[84:87], a[112:127]
    v_exp_f32 v50, v50
    v_exp_f32 v51, v51
    v_exp_f32 v52, v52
    v_mfma_f32_16x16x32_bf16 a[204:207], v[88:91], v[84:87], a[204:207]
    v_exp_f32 v53, v53
    v_mfma_f32_32x32x16_bf16 v[64:79], v[184:187], a[40:43], 0
    v_exp_f32 v54, v54
    v_exp_f32 v55, v55
    v_cvt_pk_bf16_f32 v80, v48, v49
    v_cvt_pk_bf16_f32 v81, v50, v51
    v_mfma_f32_32x32x16_bf16 v[64:79], v[188:191], a[44:47], v[64:79]
    v_cvt_pk_bf16_f32 v82, v52, v53
    v_cvt_pk_bf16_f32 v83, v54, v55
    v_exp_f32 v56, v56
    v_exp_f32 v57, v57
    v_mfma_f32_32x32x16_bf16 a[128:143], v[200:203], v[80:83], a[128:143]
    v_exp_f32 v58, v58
    v_exp_f32 v59, v59
    v_exp_f32 v60, v60
    v_mfma_f32_16x16x32_bf16 a[208:211], v[88:91], v[80:83], a[208:211]
    v_exp_f32 v61, v61
    v_exp_f32 v62, v62
    v_exp_f32 v63, v63
    v_cvt_pk_bf16_f32 v84, v56, v57
    v_cvt_pk_bf16_f32 v85, v58, v59
    v_cvt_pk_bf16_f32 v86, v60, v61
    v_cvt_pk_bf16_f32 v87, v62, v63
    v_exp_f32 v64, v64
    v_exp_f32 v65, v65
    v_mfma_f32_32x32x16_bf16 a[128:143], v[204:207], v[84:87], a[128:143]
    v_exp_f32 v66, v66
    v_exp_f32 v67, v67
    v_exp_f32 v68, v68
    v_mfma_f32_16x16x32_bf16 a[208:211], v[88:91], v[84:87], a[208:211]
    v_exp_f32 v69, v69
    v_mfma_f32_32x32x16_bf16 v[48:63], v[184:187], a[48:51], 0
    v_exp_f32 v70, v70
    v_exp_f32 v71, v71
    v_cvt_pk_bf16_f32 v80, v64, v65
    v_cvt_pk_bf16_f32 v81, v66, v67
    v_mfma_f32_32x32x16_bf16 v[48:63], v[188:191], a[52:55], v[48:63]
    v_cvt_pk_bf16_f32 v82, v68, v69
    v_cvt_pk_bf16_f32 v83, v70, v71
    v_exp_f32 v72, v72
    v_exp_f32 v73, v73
    v_mfma_f32_32x32x16_bf16 a[144:159], v[200:203], v[80:83], a[144:159]
    v_exp_f32 v74, v74
    v_exp_f32 v75, v75
    v_exp_f32 v76, v76
    v_mfma_f32_16x16x32_bf16 a[212:215], v[88:91], v[80:83], a[212:215]
    v_exp_f32 v77, v77
    v_exp_f32 v78, v78
    v_exp_f32 v79, v79
    v_cvt_pk_bf16_f32 v84, v72, v73
    v_cvt_pk_bf16_f32 v85, v74, v75
    v_cvt_pk_bf16_f32 v86, v76, v77
    v_cvt_pk_bf16_f32 v87, v78, v79
    v_exp_f32 v48, v48
    v_exp_f32 v49, v49
    v_mfma_f32_32x32x16_bf16 a[144:159], v[204:207], v[84:87], a[144:159]
    v_exp_f32 v50, v50
    v_exp_f32 v51, v51
    v_exp_f32 v52, v52
    v_mfma_f32_16x16x32_bf16 a[212:215], v[88:91], v[84:87], a[212:215]
    v_exp_f32 v53, v53
    v_mfma_f32_32x32x16_bf16 v[64:79], v[184:187], a[56:59], 0
    v_exp_f32 v54, v54
    v_exp_f32 v55, v55
    v_cvt_pk_bf16_f32 v80, v48, v49
    v_cvt_pk_bf16_f32 v81, v50, v51
    v_mfma_f32_32x32x16_bf16 v[64:79], v[188:191], a[60:63], v[64:79]
    v_cvt_pk_bf16_f32 v82, v52, v53
    v_cvt_pk_bf16_f32 v83, v54, v55
    v_exp_f32 v56, v56
    v_exp_f32 v57, v57
    v_mfma_f32_32x32x16_bf16 a[160:175], v[200:203], v[80:83], a[160:175]
    v_exp_f32 v58, v58
    v_exp_f32 v59, v59
    v_exp_f32 v60, v60
    v_mfma_f32_16x16x32_bf16 a[216:219], v[88:91], v[80:83], a[216:219]
    v_exp_f32 v61, v61
    v_exp_f32 v62, v62
    v_exp_f32 v63, v63
    v_cvt_pk_bf16_f32 v84, v56, v57
    v_cvt_pk_bf16_f32 v85, v58, v59
    v_cvt_pk_bf16_f32 v86, v60, v61
    v_cvt_pk_bf16_f32 v87, v62, v63
    s_waitcnt vmcnt(0)
    v_readfirstlane_b32 s3, v23
    s_cmp_ge_u32 s3, s64
    s_cbranch_scc0 L_ghw
L_ghb:
    s_barrier
    v_exp_f32 v64, v64
    v_exp_f32 v65, v65
    v_mfma_f32_32x32x16_bf16 a[160:175], v[204:207], v[84:87], a[160:175]
    v_exp_f32 v66, v66
    v_exp_f32 v67, v67
    v_exp_f32 v68, v68
    v_mfma_f32_16x16x32_bf16 a[216:219], v[88:91], v[84:87], a[216:219]
    v_exp_f32 v69, v69
    v_mfma_f32_32x32x16_bf16 v[48:63], v[96:99], a[16:19], 0
    v_exp_f32 v70, v70
    v_exp_f32 v71, v71
    v_cvt_pk_bf16_f32 v80, v64, v65
    v_cvt_pk_bf16_f32 v81, v66, v67
    v_mfma_f32_32x32x16_bf16 v[48:63], v[100:103], a[20:23], v[48:63]
    v_cvt_pk_bf16_f32 v82, v68, v69
    v_cvt_pk_bf16_f32 v83, v70, v71
    v_exp_f32 v72, v72
    v_exp_f32 v73, v73
    v_mfma_f32_32x32x16_bf16 a[176:191], v[200:203], v[80:83], a[176:191]
    v_exp_f32 v74, v74
    v_exp_f32 v75, v75
    v_exp_f32 v76, v76
    v_mfma_f32_16x16x32_bf16 a[220:223], v[88:91], v[80:83], a[220:223]
    v_exp_f32 v77, v77
    v_exp_f32 v78, v78
    v_exp_f32 v79, v79
    v_cvt_pk_bf16_f32 v84, v72, v73
    v_cvt_pk_bf16_f32 v85, v74, v75
    v_cvt_pk_bf16_f32 v86, v76, v77
    v_cvt_pk_bf16_f32 v87, v78, v79
    v_exp_f32 v48, v48
    v_exp_f32 v49, v49
    v_mfma_f32_32x32x16_bf16 a[176:191], v[204:207], v[84:87], a[176:191]
    v_exp_f32 v50, v50
    v_exp_f32 v51, v51
    v_exp_f32 v52, v52
    v_mfma_f32_16x16x32_bf16 a[220:223], v[88:91], v[84:87], a[220:223]
    v_exp_f32 v53, v53
    v_mfma_f32_32x32x16_bf16 v[64:79], v[96:99], a[24:27], 0
    v_exp_f32 v54, v54
    v_exp_f32 v55, v55
    v_cvt_pk_bf16_f32 v80, v48, v49
    v_cvt_pk_bf16_f32 v81, v50, v51
    v_mfma_f32_32x32x16_bf16 v[64:79], v[100:103], a[28:31], v[64:79]
    v_cvt_pk_bf16_f32 v82, v52, v53
    v_cvt_pk_bf16_f32 v83, v54, v55
    v_exp_f32 v56, v56
    v_exp_f32 v57, v57
    v_mfma_f32_32x32x16_bf16 a[96:111], v[120:123], v[80:83], a[96:111]
    v_exp_f32 v58, v58
    v_exp_f32 v59, v59
    v_exp_f32 v60, v60
    v_mfma_f32_16x16x32_bf16 a[200:203], v[88:91], v[80:83], a[200:203]
    s_add_u32 m0, s34, 98304
    s_add_u32 s35, s32, 0
    v_exp_f32 v61, v61
    v_exp_f32 v62, v62
    v_exp_f32 v63, v63
    buffer_load_dwordx4 v8, s[16:19], s35 offen offset:0 lds
    buffer_load_dwordx4 a[224:227], v2, s[8:11], s37 offen offset:0 sc1
    v_cvt_pk_bf16_f32 v84, v56, v57
    v_cvt_pk_bf16_f32 v85, v58, v59
    v_cvt_pk_bf16_f32 v86, v60, v61
    v_cvt_pk_bf16_f32 v87, v62, v63
    v_exp_f32 v64, v64
    v_exp_f32 v65, v65
    v_mfma_f32_32x32x16_bf16 a[96:111], v[124:127], v[84:87], a[96:111]
    v_exp_f32 v66, v66
    v_exp_f32 v67, v67
    v_exp_f32 v68, v68
    v_mfma_f32_16x16x32_bf16 a[200:203], v[88:91], v[84:87], a[200:203]
    v_exp_f32 v69, v69
    v_mfma_f32_32x32x16_bf16 v[48:63], v[96:99], a[32:35], 0
    v_exp_f32 v70, v70
    v_exp_f32 v71, v71
    v_cvt_pk_bf16_f32 v80, v64, v65
    v_cvt_pk_bf16_f32 v81, v66, v67
    v_mfma_f32_32x32x16_bf16 v[48:63], v[100:103], a[36:39], v[48:63]
    v_cvt_pk_bf16_f32 v82, v68, v69
    v_cvt_pk_bf16_f32 v83, v70, v71
    v_exp_f32 v72, v72
    v_exp_f32 v73, v73
    v_mfma_f32_32x32x16_bf16 a[112:127], v[120:123], v[80:83], a[112:127]
    v_exp_f32 v74, v74
    v_exp_f32 v75, v75
    v_exp_f32 v76, v76
    v_mfma_f32_16x16x32_bf16 a[204:207], v[88:91], v[80:83], a[204:207]
    buffer_load_dwordx4 v9, s[16:19], s35 offen offset:1024 lds
    buffer_load_dwordx4 a[228:231], v2, s[8:11], s37 offen offset:1024 sc1
    v_exp_f32 v77, v77
    v_exp_f32 v78, v78
    v_exp_f32 v79, v79
    v_cvt_pk_bf16_f32 v84, v72, v73
    v_cvt_pk_bf16_f32 v85, v74, v75
    v_cvt_pk_bf16_f32 v86, v76, v77
    v_cvt_pk_bf16_f32 v87, v78, v79
    v_exp_f32 v48, v48
    v_exp_f32 v49, v49
    v_mfma_f32_32x32x16_bf16 a[112:127], v[124:127], v[84:87], a[112:127]
    v_exp_f32 v50, v50
    v_exp_f32 v51, v51
    v_exp_f32 v52, v52
    v_mfma_f32_16x16x32_bf16 a[204:207], v[88:91], v[84:87], a[204:207]
    v_exp_f32 v53, v53
    v_mfma_f32_32x32x16_bf16 v[64:79], v[96:99], a[40:43], 0
    v_exp_f32 v54, v54
    v_exp_f32 v55, v55
    v_cvt_pk_bf16_f32 v80, v48, v49
    v_cvt_pk_bf16_f32 v81, v50, v51
    v_mfma_f32_32x32x16_bf16 v[64:79], v[100:103], a[44:47], v[64:79]
    v_cvt_pk_bf16_f32 v82, v52, v53
    v_cvt_pk_bf16_f32 v83, v54, v55
    v_exp_f32 v56, v56
    v_exp_f32 v57, v57
    v_mfma_f32_32x32x16_bf16 a[128:143], v[120:123], v[80:83], a[128:143]
    v_exp_f32 v58, v58
    v_exp_f32 v59, v59
    v_exp_f32 v60, v60
    v_mfma_f32_16x16x32_bf16 a[208:211], v[88:91], v[80:83], a[208:211]
    buffer_load_dwordx4 v10, s[16:19], s35 offen offset:2048 lds
    buffer_load_dwordx4 a[232:235], v2, s[8:11], s37 offen offset:2048 sc1
    v_exp_f32 v61, v61
    v_exp_f32 v62, v62
    v_exp_f32 v63, v63
    ds_write_b128 v37, a[96:99] offset:0
    ds_write_b128 v37, a[100:103] offset:1024
    v_cvt_pk_bf16_f32 v84, v56, v57
    v_cvt_pk_bf16_f32 v85, v58, v59
    ds_write_b128 v37, a[104:107] offset:2048
    ds_write_b128 v37, a[108:111] offset:3072
    ds_write_b32 v33, a200 offset:4096
    v_cvt_pk_bf16_f32 v86, v60, v61
    v_cvt_pk_bf16_f32 v87, v62, v63
    v_exp_f32 v64, v64
    v_exp_f32 v65, v65
    v_mfma_f32_32x32x16_bf16 a[128:143], v[124:127], v[84:87], a[128:143]
    v_exp_f32 v66, v66
    v_exp_f32 v67, v67
    v_exp_f32 v68, v68
    v_mfma_f32_16x16x32_bf16 a[208:211], v[88:91], v[84:87], a[208:211]
    v_exp_f32 v69, v69
    v_mfma_f32_32x32x16_bf16 v[48:63], v[96:99], a[48:51], 0
    v_exp_f32 v70, v70
    v_exp_f32 v71, v71
    v_cvt_pk_bf16_f32 v80, v64, v65
    v_cvt_pk_bf16_f32 v81, v66, v67
    v_mfma_f32_32x32x16_bf16 v[48:63], v[100:103], a[52:55], v[48:63]
    v_cvt_pk_bf16_f32 v82, v68, v69
    v_cvt_pk_bf16_f32 v83, v70, v71
    v_exp_f32 v72, v72
    v_exp_f32 v73, v73
    v_mfma_f32_32x32x16_bf16 a[144:159], v[120:123], v[80:83], a[144:159]
    v_exp_f32 v74, v74
    v_exp_f32 v75, v75
    v_exp_f32 v76, v76
    v_mfma_f32_16x16x32_bf16 a[212:215], v[88:91], v[80:83], a[212:215]
    buffer_load_dwordx4 v11, s[16:19], s35 offen offset:3072 lds
    buffer_load_dwordx4 a[236:239], v2, s[8:11], s37 offen offset:3072 sc1
    v_exp_f32 v77, v77
    v_exp_f32 v78, v78
    v_exp_f32 v79, v79
    s_add_u32 s37, s37, 4096
    ds_write_b128 v37, a[112:115] offset:4352
    v_cvt_pk_bf16_f32 v84, v72, v73
    v_cvt_pk_bf16_f32 v85, v74, v75
    ds_write_b128 v37, a[116:119] offset:5376
    ds_write_b128 v37, a[120:123] offset:6400
    ds_write_b128 v37, a[124:127] offset:7424
    ds_write_b32 v33, a204 offset:8448
    v_cvt_pk_bf16_f32 v86, v76, v77
    v_cvt_pk_bf16_f32 v87, v78, v79
    v_exp_f32 v48, v48
    v_exp_f32 v49, v49
    v_mfma_f32_32x32x16_bf16 a[144:159], v[124:127], v[84:87], a[144:159]
    v_exp_f32 v50, v50
    v_exp_f32 v51, v51
    v_exp_f32 v52, v52
    v_mfma_f32_16x16x32_bf16 a[212:215], v[88:91], v[84:87], a[212:215]
    v_exp_f32 v53, v53
    v_mfma_f32_32x32x16_bf16 v[64:79], v[96:99], a[56:59], 0
    v_exp_f32 v54, v54
    v_exp_f32 v55, v55
    v_cvt_pk_bf16_f32 v80, v48, v49
    v_cvt_pk_bf16_f32 v81, v50, v51
    v_mfma_f32_32x32x16_bf16 v[64:79], v[100:103], a[60:63], v[64:79]
    v_cvt_pk_bf16_f32 v82, v52, v53
    v_cvt_pk_bf16_f32 v83, v54, v55
    v_exp_f32 v56, v56
    v_exp_f32 v57, v57
    v_mfma_f32_32x32x16_bf16 a[160:175], v[120:123], v[80:83], a[160:175]
    v_exp_f32 v58, v58
    v_exp_f32 v59, v59
    v_exp_f32 v60, v60
    v_mfma_f32_16x16x32_bf16 a[216:219], v[88:91], v[80:83], a[216:219]
    s_add_u32 m0, s34, 102400
    s_add_u32 s35, s32, 32768
    v_exp_f32 v61, v61
    v_exp_f32 v62, v62
    v_exp_f32 v63, v63
    buffer_load_dwordx4 v8, s[16:19], s35 offen offset:0 lds
    buffer_load_dwordx4 a[240:243], v2, s[8:11], s37 offen offset:0 sc1
    v_cvt_pk_bf16_f32 v84, v56, v57
    v_cvt_pk_bf16_f32 v85, v58, v59
    ds_write_b128 v38, a[128:131] offset:0
    ds_write_b128 v38, a[132:135] offset:1024
    ds_write_b128 v38, a[136:139] offset:2048
    ds_write_b128 v38, a[140:143] offset:3072
    ds_write_b32 v34, a208 offset:4096
    v_cvt_pk_bf16_f32 v86, v60, v61
    v_cvt_pk_bf16_f32 v87, v62, v63
    v_exp_f32 v64, v64
    v_exp_f32 v65, v65
    v_mfma_f32_32x32x16_bf16 a[160:175], v[124:127], v[84:87], a[160:175]
    v_exp_f32 v66, v66
    v_exp_f32 v67, v67
    v_exp_f32 v68, v68
    v_mfma_f32_16x16x32_bf16 a[216:219], v[88:91], v[84:87], a[216:219]
    v_exp_f32 v69, v69
    v_mfma_f32_32x32x16_bf16 v[48:63], v[96:99], a[0:3], 0
    v_exp_f32 v70, v70
    v_exp_f32 v71, v71
    v_cvt_pk_bf16_f32 v80, v64, v65
    v_cvt_pk_bf16_f32 v81, v66, v67
    v_mfma_f32_32x32x16_bf16 v[48:63], v[100:103], a[4:7], v[48:63]
    v_cvt_pk_bf16_f32 v82, v68, v69
    v_cvt_pk_bf16_f32 v83, v70, v71
    v_exp_f32 v72, v72
    v_exp_f32 v73, v73
    v_mfma_f32_32x32x16_bf16 a[176:191], v[120:123], v[80:83], a[176:191]
    v_exp_f32 v74, v74
    v_exp_f32 v75, v75
    v_exp_f32 v76, v76
    v_mfma_f32_16x16x32_bf16 a[220:223], v[88:91], v[80:83], a[220:223]
    buffer_load_dwordx4 v9, s[16:19], s35 offen offset:1024 lds
    buffer_load_dwordx4 a[244:247], v2, s[8:11], s37 offen offset:1024 sc1
    v_exp_f32 v77, v77
    v_exp_f32 v78, v78
    v_exp_f32 v79, v79
    ds_write_b128 v38, a[144:147] offset:4352
    ds_write_b128 v38, a[148:151] offset:5376
    v_cvt_pk_bf16_f32 v84, v72, v73
    v_cvt_pk_bf16_f32 v85, v74, v75
    ds_write_b128 v38, a[152:155] offset:6400
    ds_write_b128 v38, a[156:159] offset:7424
    ds_write_b32 v34, a212 offset:8448
    v_cvt_pk_bf16_f32 v86, v76, v77
    v_cvt_pk_bf16_f32 v87, v78, v79
    v_exp_f32 v48, v48
    v_exp_f32 v49, v49
    v_mfma_f32_32x32x16_bf16 a[176:191], v[124:127], v[84:87], a[176:191]
    v_exp_f32 v50, v50
    v_exp_f32 v51, v51
    v_exp_f32 v52, v52
    v_mfma_f32_16x16x32_bf16 a[220:223], v[88:91], v[84:87], a[220:223]
    v_exp_f32 v53, v53
    v_mfma_f32_32x32x16_bf16 v[64:79], v[96:99], a[8:11], 0
    v_exp_f32 v54, v54
    v_exp_f32 v55, v55
    v_cvt_pk_bf16_f32 v80, v48, v49
    v_cvt_pk_bf16_f32 v81, v50, v51
    v_mfma_f32_32x32x16_bf16 v[64:79], v[100:103], a[12:15], v[64:79]
    v_cvt_pk_bf16_f32 v82, v52, v53
    v_cvt_pk_bf16_f32 v83, v54, v55
    v_exp_f32 v56, v56
    v_exp_f32 v57, v57
    v_mfma_f32_32x32x16_bf16 a[64:79], v[120:123], v[80:83], a[64:79]
    v_exp_f32 v58, v58
    v_exp_f32 v59, v59
    v_exp_f32 v60, v60
    v_mfma_f32_16x16x32_bf16 a[192:195], v[88:91], v[80:83], a[192:195]
    buffer_load_dwordx4 v10, s[16:19], s35 offen offset:2048 lds
    buffer_load_dwordx4 a[248:251], v2, s[8:11], s37 offen offset:2048 sc1
    v_exp_f32 v61, v61
    v_exp_f32 v62, v62
    v_exp_f32 v63, v63
    ds_write_b128 v39, a[160:163] offset:0
    ds_write_b128 v39, a[164:167] offset:1024
    v_cvt_pk_bf16_f32 v84, v56, v57
    v_cvt_pk_bf16_f32 v85, v58, v59
    ds_write_b128 v39, a[168:171] offset:2048
    ds_write_b128 v39, a[172:175] offset:3072
    ds_write_b32 v35, a216 offset:4096
    v_cvt_pk_bf16_f32 v86, v60, v61
    v_cvt_pk_bf16_f32 v87, v62, v63
    v_exp_f32 v64, v64
    v_exp_f32 v65, v65
    v_mfma_f32_32x32x16_bf16 a[64:79], v[124:127], v[84:87], a[64:79]
    v_exp_f32 v66, v66
    v_exp_f32 v67, v67
    v_exp_f32 v68, v68
    v_mfma_f32_16x16x32_bf16 a[192:195], v[88:91], v[84:87], a[192:195]
    v_exp_f32 v69, v69
    v_exp_f32 v70, v70
    v_exp_f32 v71, v71
    v_cvt_pk_bf16_f32 v80, v64, v65
    v_cvt_pk_bf16_f32 v81, v66, v67
    v_cvt_pk_bf16_f32 v82, v68, v69
    v_cvt_pk_bf16_f32 v83, v70, v71
    v_exp_f32 v72, v72
    v_exp_f32 v73, v73
    v_mfma_f32_32x32x16_bf16 a[80:95], v[120:123], v[80:83], a[80:95]
    v_exp_f32 v74, v74
    v_exp_f32 v75, v75
    v_exp_f32 v76, v76
    v_mfma_f32_16x16x32_bf16 a[196:199], v[88:91], v[80:83], a[196:199]
    buffer_load_dwordx4 v11, s[16:19], s35 offen offset:3072 lds
    s_add_u32 s32, s32, 262144
    v_exp_f32 v77, v77
    v_exp_f32 v78, v78
    v_exp_f32 v79, v79
    buffer_load_dwordx4 a[252:255], v2, s[8:11], s37 offen offset:3072 sc1
    s_add_u32 s37, s37, 4096
    v_cvt_pk_bf16_f32 v84, v72, v73
    v_cvt_pk_bf16_f32 v85, v74, v75
    ds_write_b128 v39, a[176:179] offset:4352
    ds_write_b128 v39, a[180:183] offset:5376
    ds_write_b128 v39, a[184:187] offset:6400
    ds_write_b128 v39, a[188:191] offset:7424
    ds_write_b32 v35, a220 offset:8448
    v_cvt_pk_bf16_f32 v86, v76, v77
    v_cvt_pk_bf16_f32 v87, v78, v79
    s_nop 1
    v_mfma_f32_32x32x16_bf16 a[80:95], v[124:127], v[84:87], a[80:95]
    v_mfma_f32_16x16x32_bf16 a[196:199], v[88:91], v[84:87], a[196:199]
    s_waitcnt lgkmcnt(0)
    s_barrier
    ds_read_b128 v[144:147], v36 offset:0
    ds_read_b128 v[148:151], v36 offset:1024
    ds_read_b128 v[152:155], v36 offset:2048
    ds_read_b128 v[156:159], v36 offset:3072
    ds_read_b32 v240, v32 offset:4096
    ds_read_b128 v[160:163], v36 offset:4352
    ds_read_b128 v[164:167], v36 offset:5376
    ds_read_b128 v[168:171], v36 offset:6400
    ds_read_b128 v[172:175], v36 offset:7424
    ds_read_b32 v241, v32 offset:8448
    ds_read_b128 v[176:179], v36 offset:8704
    ds_read_b128 v[180:183], v36 offset:9728
    ds_read_b128 v[184:187], v36 offset:10752
    ds_read_b128 v[188:191], v36 offset:11776
    ds_read_b32 v242, v32 offset:12800
    v_accvgpr_read_b32 v48, a64
    v_accvgpr_read_b32 v49, a65
    v_accvgpr_read_b32 v50, a66
    v_accvgpr_read_b32 v51, a67
    v_accvgpr_read_b32 v52, a68
    v_accvgpr_read_b32 v53, a69
    v_accvgpr_read_b32 v54, a70
    v_accvgpr_read_b32 v55, a71
    v_accvgpr_read_b32 v56, a72
    v_accvgpr_read_b32 v57, a73
    v_accvgpr_read_b32 v58, a74
    v_accvgpr_read_b32 v59, a75
    v_accvgpr_read_b32 v60, a76
    v_accvgpr_read_b32 v61, a77
    v_accvgpr_read_b32 v62, a78
    v_accvgpr_read_b32 v63, a79
    v_accvgpr_read_b32 v80, a192
    v_accvgpr_read_b32 v64, a80
    v_accvgpr_read_b32 v65, a81
    v_accvgpr_read_b32 v66, a82
    v_accvgpr_read_b32 v67, a83
    v_accvgpr_read_b32 v68, a84
    v_accvgpr_read_b32 v69, a85
    v_accvgpr_read_b32 v70, a86
    v_accvgpr_read_b32 v71, a87
    v_accvgpr_read_b32 v72, a88
    v_accvgpr_read_b32 v73, a89
    v_accvgpr_read_b32 v74, a90
    v_accvgpr_read_b32 v75, a91
    v_accvgpr_read_b32 v76, a92
    v_accvgpr_read_b32 v77, a93
    v_accvgpr_read_b32 v78, a94
    v_accvgpr_read_b32 v79, a95
    v_accvgpr_read_b32 v81, a196
    s_mul_i32 s3, s44, 294912
    s_lshl_b32 s33, s26, 11
    s_add_u32 s3, s3, s33
    s_add_u32 s52, s3, 0x1100000
    s_add_u32 s53, s52, 294912
    s_waitcnt lgkmcnt(10)
    ds_read_b128 v[192:195], v36 offset:13056
    ds_read_b128 v[196:199], v36 offset:14080
    ds_read_b128 v[200:203], v36 offset:15104
    ds_read_b128 v[204:207], v36 offset:16128
    ds_read_b32 v243, v32 offset:17152
    v_pk_add_f32 v[48:49], v[48:49], v[144:145]
    v_pk_add_f32 v[50:51], v[50:51], v[146:147]
    v_pk_add_f32 v[52:53], v[52:53], v[148:149]
    v_pk_add_f32 v[54:55], v[54:55], v[150:151]
    v_pk_add_f32 v[56:57], v[56:57], v[152:153]
    v_pk_add_f32 v[58:59], v[58:59], v[154:155]
    v_pk_add_f32 v[60:61], v[60:61], v[156:157]
    v_pk_add_f32 v[62:63], v[62:63], v[158:159]
    v_add_f32 v80, v80, v240
    buffer_load_dwordx4 a[64:67], v2, s[8:11], s37 offen offset:0 sc1
    buffer_load_dwordx4 a[68:71], v2, s[8:11], s37 offen offset:1024 sc1
    buffer_load_dwordx4 a[72:75], v2, s[8:11], s37 offen offset:2048 sc1
    buffer_load_dwordx4 a[76:79], v2, s[8:11], s37 offen offset:3072 sc1
    s_add_u32 s37, s37, 4096
    s_waitcnt lgkmcnt(10)
    ds_read_b128 v[208:211], v36 offset:17408
    ds_read_b128 v[212:215], v36 offset:18432
    ds_read_b128 v[216:219], v36 offset:19456
    ds_read_b128 v[220:223], v36 offset:20480
    ds_read_b32 v244, v32 offset:21504
    v_pk_add_f32 v[64:65], v[64:65], v[160:161]
    v_pk_add_f32 v[66:67], v[66:67], v[162:163]
    v_pk_add_f32 v[68:69], v[68:69], v[164:165]
    v_pk_add_f32 v[70:71], v[70:71], v[166:167]
    v_pk_add_f32 v[72:73], v[72:73], v[168:169]
    v_pk_add_f32 v[74:75], v[74:75], v[170:171]
    v_pk_add_f32 v[76:77], v[76:77], v[172:173]
    v_pk_add_f32 v[78:79], v[78:79], v[174:175]
    v_add_f32 v81, v81, v241
    buffer_load_dwordx4 a[80:83], v2, s[8:11], s37 offen offset:0 sc1
    buffer_load_dwordx4 a[84:87], v2, s[8:11], s37 offen offset:1024 sc1
    buffer_load_dwordx4 a[88:91], v2, s[8:11], s37 offen offset:2048 sc1
    buffer_load_dwordx4 a[92:95], v2, s[8:11], s37 offen offset:3072 sc1
    s_add_u32 s37, s37, 4096
    s_waitcnt lgkmcnt(10)
    ds_read_b128 v[224:227], v36 offset:21760
    ds_read_b128 v[228:231], v36 offset:22784
    ds_read_b128 v[232:235], v36 offset:23808
    ds_read_b128 v[236:239], v36 offset:24832
    ds_read_b32 v245, v32 offset:25856
    v_pk_add_f32 v[48:49], v[48:49], v[176:177]
    v_pk_add_f32 v[50:51], v[50:51], v[178:179]
    v_pk_add_f32 v[52:53], v[52:53], v[180:181]
    v_pk_add_f32 v[54:55], v[54:55], v[182:183]
    v_pk_add_f32 v[56:57], v[56:57], v[184:185]
    v_pk_add_f32 v[58:59], v[58:59], v[186:187]
    v_pk_add_f32 v[60:61], v[60:61], v[188:189]
    v_pk_add_f32 v[62:63], v[62:63], v[190:191]
    v_add_f32 v80, v80, v242
    buffer_load_dwordx4 a[96:99], v2, s[8:11], s37 offen offset:0 sc1
    buffer_load_dwordx4 a[100:103], v2, s[8:11], s37 offen offset:1024 sc1
    buffer_load_dwordx4 a[104:107], v2, s[8:11], s37 offen offset:2048 sc1
    buffer_load_dwordx4 a[108:111], v2, s[8:11], s37 offen offset:3072 sc1
    s_add_u32 s37, s37, 4096
    s_waitcnt lgkmcnt(10)
    v_pk_add_f32 v[64:65], v[64:65], v[192:193]
    v_pk_add_f32 v[66:67], v[66:67], v[194:195]
    v_pk_add_f32 v[68:69], v[68:69], v[196:197]
    v_pk_add_f32 v[70:71], v[70:71], v[198:199]
    v_pk_add_f32 v[72:73], v[72:73], v[200:201]
    v_pk_add_f32 v[74:75], v[74:75], v[202:203]
    v_pk_add_f32 v[76:77], v[76:77], v[204:205]
    v_pk_add_f32 v[78:79], v[78:79], v[206:207]
    v_add_f32 v81, v81, v243
    buffer_load_dwordx4 a[112:115], v2, s[8:11], s37 offen offset:0 sc1
    buffer_load_dwordx4 a[116:119], v2, s[8:11], s37 offen offset:1024 sc1
    buffer_load_dwordx4 a[120:123], v2, s[8:11], s37 offen offset:2048 sc1
    buffer_load_dwordx4 a[124:127], v2, s[8:11], s37 offen offset:3072 sc1
    s_add_u32 s37, s37, 4096
    s_waitcnt lgkmcnt(5)
    v_pk_add_f32 v[48:49], v[48:49], v[208:209]
    v_pk_add_f32 v[50:51], v[50:51], v[210:211]
    v_pk_add_f32 v[52:53], v[52:53], v[212:213]
    v_pk_add_f32 v[54:55], v[54:55], v[214:215]
    v_pk_add_f32 v[56:57], v[56:57], v[216:217]
    v_pk_add_f32 v[58:59], v[58:59], v[218:219]
    v_pk_add_f32 v[60:61], v[60:61], v[220:221]
    v_pk_add_f32 v[62:63], v[62:63], v[222:223]
    v_add_f32 v80, v80, v244
    s_waitcnt lgkmcnt(0)
    s_barrier
    s_add_u32 m0, s34, 0
    s_add_u32 s35, s32, 0
    buffer_load_dwordx4 v8, s[16:19], s35 offen offset:0 lds
    buffer_load_dwordx4 v9, s[16:19], s35 offen offset:1024 lds
    buffer_load_dwordx4 v10, s[16:19], s35 offen offset:2048 lds
    buffer_load_dwordx4 v11, s[16:19], s35 offen offset:3072 lds
    s_add_u32 m0, s34, 4096
    s_add_u32 s35, s32, 32768
    buffer_load_dwordx4 v8, s[16:19], s35 offen offset:0 lds
    buffer_load_dwordx4 v9, s[16:19], s35 offen offset:1024 lds
    buffer_load_dwordx4 v10, s[16:19], s35 offen offset:2048 lds
    buffer_load_dwordx4 v11, s[16:19], s35 offen offset:3072 lds
    s_add_u32 s32, s32, 262144
    s_add_u32 m0, s34, 32768
    s_add_u32 s35, s32, 0
    buffer_load_dwordx4 v8, s[16:19], s35 offen offset:0 lds
    buffer_load_dwordx4 v9, s[16:19], s35 offen offset:1024 lds
    buffer_load_dwordx4 v10, s[16:19], s35 offen offset:2048 lds
    buffer_load_dwordx4 v11, s[16:19], s35 offen offset:3072 lds
    s_add_u32 m0, s34, 36864
    s_add_u32 s35, s32, 32768
    buffer_load_dwordx4 v8, s[16:19], s35 offen offset:0 lds
    buffer_load_dwordx4 v9, s[16:19], s35 offen offset:1024 lds
    buffer_load_dwordx4 v10, s[16:19], s35 offen offset:2048 lds
    buffer_load_dwordx4 v11, s[16:19], s35 offen offset:3072 lds
    s_add_u32 s32, s32, 262144
    v_pk_add_f32 v[64:65], v[64:65], v[224:225]
    v_pk_add_f32 v[66:67], v[66:67], v[226:227]
    v_pk_add_f32 v[68:69], v[68:69], v[228:229]
    v_pk_add_f32 v[70:71], v[70:71], v[230:231]
    v_pk_add_f32 v[72:73], v[72:73], v[232:233]
    v_pk_add_f32 v[74:75], v[74:75], v[234:235]
    v_pk_add_f32 v[76:77], v[76:77], v[236:237]
    v_pk_add_f32 v[78:79], v[78:79], v[238:239]
    v_add_f32 v81, v81, v245
    v_mul_f32 v40, 0, v80
    v_mov_b32 v41, 0
    v_pk_fma_f32 v[40:41], v[48:49], 0, v[40:41] op_sel_hi:[1,0,1]
    v_pk_fma_f32 v[40:41], v[50:51], 0, v[40:41] op_sel_hi:[1,0,1]
    v_pk_fma_f32 v[40:41], v[52:53], 0, v[40:41] op_sel_hi:[1,0,1]
    v_pk_fma_f32 v[40:41], v[54:55], 0, v[40:41] op_sel_hi:[1,0,1]
    v_pk_fma_f32 v[40:41], v[56:57], 0, v[40:41] op_sel_hi:[1,0,1]
    v_pk_fma_f32 v[40:41], v[58:59], 0, v[40:41] op_sel_hi:[1,0,1]
    v_pk_fma_f32 v[40:41], v[60:61], 0, v[40:41] op_sel_hi:[1,0,1]
    v_pk_fma_f32 v[40:41], v[62:63], 0, v[40:41] op_sel_hi:[1,0,1]
    v_add_f32 v41, v41, v40
    v_mov_b32 v42, 0x21800000
    v_cmp_neq_f32 s[54:55], 0, v41
    v_cmp_nle_f32 vcc, v42, v80
    s_or_b64 vcc, vcc, s[54:55]
    s_cbranch_vccnz L_slow0
L_fin0:
    v_rcp_f32 v40, v80
    s_nop 0
    v_pk_mul_f32 v[48:49], v[48:49], v[40:41] op_sel_hi:[1,0]
    v_pk_mul_f32 v[50:51], v[50:51], v[40:41] op_sel_hi:[1,0]
    v_pk_mul_f32 v[52:53], v[52:53], v[40:41] op_sel_hi:[1,0]
    v_pk_mul_f32 v[54:55], v[54:55], v[40:41] op_sel_hi:[1,0]
    v_pk_mul_f32 v[56:57], v[56:57], v[40:41] op_sel_hi:[1,0]
    v_pk_mul_f32 v[58:59], v[58:59], v[40:41] op_sel_hi:[1,0]
    v_pk_mul_f32 v[60:61], v[60:61], v[40:41] op_sel_hi:[1,0]
    v_pk_mul_f32 v[62:63], v[62:63], v[40:41] op_sel_hi:[1,0]
    v_cvt_pk_bf16_f32 v48, v48, v49
    v_cvt_pk_bf16_f32 v49, v50, v51
    v_cvt_pk_bf16_f32 v50, v52, v53
    v_cvt_pk_bf16_f32 v51, v54, v55
    v_cvt_pk_bf16_f32 v52, v56, v57
    v_cvt_pk_bf16_f32 v53, v58, v59
    v_cvt_pk_bf16_f32 v54, v60, v61
    v_cvt_pk_bf16_f32 v55, v62, v63
    buffer_store_dwordx4 v[48:51], v2, s[8:11], s52 offen offset:0 sc1
    buffer_store_dwordx4 v[52:55], v2, s[8:11], s52 offen offset:1024 sc1
    v_mul_f32 v40, 0, v81
    v_mov_b32 v41, 0
    v_pk_fma_f32 v[40:41], v[64:65], 0, v[40:41] op_sel_hi:[1,0,1]
    v_pk_fma_f32 v[40:41], v[66:67], 0, v[40:41] op_sel_hi:[1,0,1]
    v_pk_fma_f32 v[40:41], v[68:69], 0, v[40:41] op_sel_hi:[1,0,1]
    v_pk_fma_f32 v[40:41], v[70:71], 0, v[40:41] op_sel_hi:[1,0,1]
    v_pk_fma_f32 v[40:41], v[72:73], 0, v[40:41] op_sel_hi:[1,0,1]
    v_pk_fma_f32 v[40:41], v[74:75], 0, v[40:41] op_sel_hi:[1,0,1]
    v_pk_fma_f32 v[40:41], v[76:77], 0, v[40:41] op_sel_hi:[1,0,1]
    v_pk_fma_f32 v[40:41], v[78:79], 0, v[40:41] op_sel_hi:[1,0,1]
    v_add_f32 v41, v41, v40
    v_mov_b32 v42, 0x21800000
    v_cmp_neq_f32 s[54:55], 0, v41
    v_cmp_nle_f32 vcc, v42, v81
    s_or_b64 vcc, vcc, s[54:55]
    s_cbranch_vccnz L_slow1
L_fin1:
    v_rcp_f32 v40, v81
    s_nop 0
    v_pk_mul_f32 v[64:65], v[64:65], v[40:41] op_sel_hi:[1,0]
    v_pk_mul_f32 v[66:67], v[66:67], v[40:41] op_sel_hi:[1,0]
    v_pk_mul_f32 v[68:69], v[68:69], v[40:41] op_sel_hi:[1,0]
    v_pk_mul_f32 v[70:71], v[70:71], v[40:41] op_sel_hi:[1,0]
    v_pk_mul_f32 v[72:73], v[72:73], v[40:41] op_sel_hi:[1,0]
    v_pk_mul_f32 v[74:75], v[74:75], v[40:41] op_sel_hi:[1,0]
    v_pk_mul_f32 v[76:77], v[76:77], v[40:41] op_sel_hi:[1,0]
    v_pk_mul_f32 v[78:79], v[78:79], v[40:41] op_sel_hi:[1,0]
    v_cvt_pk_bf16_f32 v64, v64, v65
    v_cvt_pk_bf16_f32 v65, v66, v67
    v_cvt_pk_bf16_f32 v66, v68, v69
    v_cvt_pk_bf16_f32 v67, v70, v71
    v_cvt_pk_bf16_f32 v68, v72, v73
    v_cvt_pk_bf16_f32 v69, v74, v75
    v_cvt_pk_bf16_f32 v70, v76, v77
    v_cvt_pk_bf16_f32 v71, v78, v79
    buffer_store_dwordx4 v[64:67], v2, s[8:11], s53 offen offset:0 sc1
    buffer_store_dwordx4 v[68:71], v2, s[8:11], s53 offen offset:1024 sc1
    s_lshl_b32 s69, s27, 7
    s_add_u32 s69, s69, 0x411000
    s_bitcmp1_b32 s2, 5
    s_cbranch_scc1 L_help
    s_mov_b32 s20, s100
    s_mov_b32 s21, s101
    s_mov_b32 s22, 0x400000
    s_mov_b32 s23, 0x20000
    s_waitcnt vmcnt(36)
    s_barrier
    ds_read_b64_tr_b16 a[0:1], v16 offset:32768
    ds_read_b64_tr_b16 a[2:3], v16 offset:34816
    ds_read_b64_tr_b16 a[4:5], v17 offset:32768
    ds_read_b64_tr_b16 a[6:7], v17 offset:34816
    ds_read_b64_tr_b16 a[8:9], v18 offset:32768
    ds_read_b64_tr_b16 a[10:11], v18 offset:34816
    ds_read_b64_tr_b16 a[12:13], v19 offset:32768
    ds_read_b64_tr_b16 a[14:15], v19 offset:34816
    ds_read_b64_tr_b16 a[16:17], v16 offset:36864
    ds_read_b64_tr_b16 a[18:19], v16 offset:38912
    ds_read_b64_tr_b16 a[20:21], v17 offset:36864
    ds_read_b64_tr_b16 a[22:23], v17 offset:38912
    ds_read_b64_tr_b16 a[24:25], v18 offset:36864
    ds_read_b64_tr_b16 a[26:27], v18 offset:38912
    s_add_u32 m0, s34, 65536
    s_add_u32 s35, s32, 0
    buffer_load_dwordx4 v8, s[16:19], s35 offen offset:0 lds
    s_waitcnt lgkmcnt(12)
    v_mfma_f32_32x32x16_bf16 v[128:143], a[0:3], a[224:227], 0
    ds_read_b64_tr_b16 a[28:29], v19 offset:36864
    ds_read_b64_tr_b16 a[30:31], v19 offset:38912
    buffer_load_dwordx4 a[128:131], v2, s[8:11], s37 offen offset:0 sc1
    s_waitcnt lgkmcnt(12)
    v_mfma_f32_32x32x16_bf16 v[144:159], a[4:7], a[224:227], 0
    ds_read_b64_tr_b16 a[32:33], v16 offset:40960
    ds_read_b64_tr_b16 a[34:35], v16 offset:43008
    s_waitcnt lgkmcnt(12)
    v_mfma_f32_32x32x16_bf16 v[160:175], a[8:11], a[224:227], 0
    ds_read_b64_tr_b16 a[36:37], v17 offset:40960
    ds_read_b64_tr_b16 a[38:39], v17 offset:43008
    buffer_load_dwordx4 v9, s[16:19], s35 offen offset:1024 lds
    s_waitcnt lgkmcnt(12)
    v_mfma_f32_32x32x16_bf16 v[176:191], a[12:15], a[224:227], 0
    ds_read_b64_tr_b16 a[40:41], v18 offset:40960
    ds_read_b64_tr_b16 a[42:43], v18 offset:43008
    buffer_load_dwordx4 a[132:135], v2, s[8:11], s37 offen offset:1024 sc1
    s_waitcnt lgkmcnt(12)
    v_mfma_f32_32x32x16_bf16 v[128:143], a[16:19], a[228:231], v[128:143]
    ds_read_b64_tr_b16 a[44:45], v19 offset:40960
    ds_read_b64_tr_b16 a[46:47], v19 offset:43008
    s_waitcnt lgkmcnt(12)
    v_mfma_f32_32x32x16_bf16 v[144:159], a[20:23], a[228:231], v[144:159]
    ds_read_b64_tr_b16 a[48:49], v16 offset:45056
    ds_read_b64_tr_b16 a[50:51], v16 offset:47104
    buffer_load_dwordx4 v10, s[16:19], s35 offen offset:2048 lds
    s_waitcnt lgkmcnt(12)
    v_mfma_f32_32x32x16_bf16 v[160:175], a[24:27], a[228:231], v[160:175]
    ds_read_b64_tr_b16 a[52:53], v17 offset:45056
    ds_read_b64_tr_b16 a[54:55], v17 offset:47104
    s_waitcnt lgkmcnt(12)
    v_mfma_f32_32x32x16_bf16 v[176:191], a[28:31], a[228:231], v[176:191]
    ds_read_b64_tr_b16 a[56:57], v18 offset:45056
    ds_read_b64_tr_b16 a[58:59], v18 offset:47104
    buffer_load_dwordx4 a[136:139], v2, s[8:11], s37 offen offset:2048 sc1
    s_waitcnt lgkmcnt(12)
    v_mfma_f32_32x32x16_bf16 v[128:143], a[32:35], a[232:235], v[128:143]
    ds_read_b64_tr_b16 a[60:61], v19 offset:45056
    ds_read_b64_tr_b16 a[62:63], v19 offset:47104
    buffer_load_dwordx4 v11, s[16:19], s35 offen offset:3072 lds
    s_waitcnt lgkmcnt(12)
    v_mfma_f32_32x32x16_bf16 v[144:159], a[36:39], a[232:235], v[144:159]
    ds_read_b64_tr_b16 a[0:1], v16 offset:49152
    ds_read_b64_tr_b16 a[2:3], v16 offset:51200
    s_waitcnt lgkmcnt(12)
    v_mfma_f32_32x32x16_bf16 v[160:175], a[40:43], a[232:235], v[160:175]
    ds_read_b64_tr_b16 a[4:5], v17 offset:49152
    ds_read_b64_tr_b16 a[6:7], v17 offset:51200
    buffer_load_dwordx4 a[140:143], v2, s[8:11], s37 offen offset:3072 sc1
    s_add_u32 s37, s37, 4096
    s_waitcnt lgkmcnt(12)
    v_mfma_f32_32x32x16_bf16 v[176:191], a[44:47], a[232:235], v[176:191]
    ds_read_b64_tr_b16 a[8:9], v18 offset:49152
    ds_read_b64_tr_b16 a[10:11], v18 offset:51200
    s_add_u32 m0, s34, 69632
    s_add_u32 s35, s32, 32768
    buffer_load_dwordx4 v8, s[16:19], s35 offen offset:0 lds
    s_waitcnt lgkmcnt(12)
    v_mfma_f32_32x32x16_bf16 v[128:143], a[48:51], a[236:239], v[128:143]
    ds_read_b64_tr_b16 a[12:13], v19 offset:49152
    ds_read_b64_tr_b16 a[14:15], v19 offset:51200
    s_waitcnt lgkmcnt(12)
    v_mfma_f32_32x32x16_bf16 v[144:159], a[52:55], a[236:239], v[144:159]
    ds_read_b64_tr_b16 a[16:17], v16 offset:53248
    ds_read_b64_tr_b16 a[18:19], v16 offset:55296
    buffer_load_dwordx4 a[144:147], v2, s[8:11], s37 offen offset:0 sc1
    s_waitcnt lgkmcnt(12)
    v_mfma_f32_32x32x16_bf16 v[160:175], a[56:59], a[236:239], v[160:175]
    ds_read_b64_tr_b16 a[20:21], v17 offset:53248
    ds_read_b64_tr_b16 a[22:23], v17 offset:55296
    s_waitcnt lgkmcnt(12)
    v_mfma_f32_32x32x16_bf16 v[176:191], a[60:63], a[236:239], v[176:191]
    ds_read_b64_tr_b16 a[24:25], v18 offset:53248
    ds_read_b64_tr_b16 a[26:27], v18 offset:55296
    buffer_load_dwordx4 v9, s[16:19], s35 offen offset:1024 lds
    s_waitcnt lgkmcnt(12)
    v_mfma_f32_32x32x16_bf16 v[128:143], a[0:3], a[240:243], v[128:143]
    ds_read_b64_tr_b16 a[28:29], v19 offset:53248
    ds_read_b64_tr_b16 a[30:31], v19 offset:55296
    buffer_load_dwordx4 a[148:151], v2, s[8:11], s37 offen offset:1024 sc1
    s_waitcnt lgkmcnt(12)
    v_mfma_f32_32x32x16_bf16 v[144:159], a[4:7], a[240:243], v[144:159]
    ds_read_b64_tr_b16 a[32:33], v16 offset:57344
    ds_read_b64_tr_b16 a[34:35], v16 offset:59392
    s_waitcnt lgkmcnt(12)
    v_mfma_f32_32x32x16_bf16 v[160:175], a[8:11], a[240:243], v[160:175]
    ds_read_b64_tr_b16 a[36:37], v17 offset:57344
    ds_read_b64_tr_b16 a[38:39], v17 offset:59392
    buffer_load_dwordx4 v10, s[16:19], s35 offen offset:2048 lds
    s_waitcnt lgkmcnt(12)
    v_mfma_f32_32x32x16_bf16 v[176:191], a[12:15], a[240:243], v[176:191]
    ds_read_b64_tr_b16 a[40:41], v18 offset:57344
    ds_read_b64_tr_b16 a[42:43], v18 offset:59392
    buffer_load_dwordx4 a[152:155], v2, s[8:11], s37 offen offset:2048 sc1
    s_waitcnt lgkmcnt(12)
    v_mfma_f32_32x32x16_bf16 v[128:143], a[16:19], a[244:247], v[128:143]
    ds_read_b64_tr_b16 a[44:45], v19 offset:57344
    ds_read_b64_tr_b16 a[46:47], v19 offset:59392
    s_waitcnt lgkmcnt(12)
    v_mfma_f32_32x32x16_bf16 v[144:159], a[20:23], a[244:247], v[144:159]
    ds_read_b64_tr_b16 a[48:49], v16 offset:61440
    ds_read_b64_tr_b16 a[50:51], v16 offset:63488
    buffer_load_dwordx4 v11, s[16:19], s35 offen offset:3072 lds
    s_add_u32 s32, s32, 262144
    s_waitcnt lgkmcnt(12)
    v_mfma_f32_32x32x16_bf16 v[160:175], a[24:27], a[244:247], v[160:175]
    ds_read_b64_tr_b16 a[52:53], v17 offset:61440
    ds_read_b64_tr_b16 a[54:55], v17 offset:63488
    s_waitcnt lgkmcnt(12)
    v_mfma_f32_32x32x16_bf16 v[176:191], a[28:31], a[244:247], v[176:191]
    ds_read_b64_tr_b16 a[56:57], v18 offset:61440
    ds_read_b64_tr_b16 a[58:59], v18 offset:63488
    buffer_load_dwordx4 a[156:159], v2, s[8:11], s37 offen offset:3072 sc1
    s_add_u32 s37, s37, 4096
    s_waitcnt lgkmcnt(12)
    v_mfma_f32_32x32x16_bf16 v[128:143], a[32:35], a[248:251], v[128:143]
    ds_read_b64_tr_b16 a[60:61], v19 offset:61440
    ds_read_b64_tr_b16 a[62:63], v19 offset:63488
    s_waitcnt lgkmcnt(12)
    v_mfma_f32_32x32x16_bf16 v[144:159], a[36:39], a[248:251], v[144:159]
    s_waitcnt lgkmcnt(10)
    v_mfma_f32_32x32x16_bf16 v[160:175], a[40:43], a[248:251], v[160:175]
    s_waitcnt lgkmcnt(8)
    v_mfma_f32_32x32x16_bf16 v[176:191], a[44:47], a[248:251], v[176:191]
    s_waitcnt vmcnt(28) lgkmcnt(0)
    s_barrier
    ds_read_b64_tr_b16 a[0:1], v12 offset:0
    ds_read_b64_tr_b16 a[2:3], v12 offset:2048
    ds_read_b64_tr_b16 a[4:5], v13 offset:0
    ds_read_b64_tr_b16 a[6:7], v13 offset:2048
    ds_read_b64_tr_b16 a[8:9], v14 offset:0
    ds_read_b64_tr_b16 a[10:11], v14 offset:2048
    v_mfma_f32_32x32x16_bf16 v[128:143], a[48:51], a[252:255], v[128:143]
    ds_read_b64_tr_b16 a[12:13], v15 offset:0
    ds_read_b64_tr_b16 a[14:15], v15 offset:2048
    v_mfma_f32_32x32x16_bf16 v[144:159], a[52:55], a[252:255], v[144:159]
    ds_read_b64_tr_b16 a[16:17], v12 offset:4096
    ds_read_b64_tr_b16 a[18:19], v12 offset:6144
    v_mfma_f32_32x32x16_bf16 v[160:175], a[56:59], a[252:255], v[160:175]
    ds_read_b64_tr_b16 a[20:21], v13 offset:4096
    ds_read_b64_tr_b16 a[22:23], v13 offset:6144
    v_mfma_f32_32x32x16_bf16 v[176:191], a[60:63], a[252:255], v[176:191]
    ds_read_b64_tr_b16 a[24:25], v14 offset:4096
    ds_read_b64_tr_b16 a[26:27], v14 offset:6144
    s_add_u32 m0, s34, 98304
    s_add_u32 s35, s32, 0
    buffer_load_dwordx4 v8, s[16:19], s35 offen offset:0 lds
    s_waitcnt lgkmcnt(12)
    v_mfma_f32_32x32x16_bf16 v[128:143], a[0:3], a[64:67], v[128:143]
    ds_read_b64_tr_b16 a[28:29], v15 offset:4096
    ds_read_b64_tr_b16 a[30:31], v15 offset:6144
    buffer_load_dwordx4 a[224:227], v2, s[8:11], s37 offen offset:0 sc1
    s_waitcnt lgkmcnt(12)
    v_mfma_f32_32x32x16_bf16 v[144:159], a[4:7], a[64:67], v[144:159]
    ds_read_b64_tr_b16 a[32:33], v12 offset:8192
    ds_read_b64_tr_b16 a[34:35], v12 offset:10240
    s_waitcnt lgkmcnt(12)
    v_mfma_f32_32x32x16_bf16 v[160:175], a[8:11], a[64:67], v[160:175]
    ds_read_b64_tr_b16 a[36:37], v13 offset:8192
    ds_read_b64_tr_b16 a[38:39], v13 offset:10240
    buffer_load_dwordx4 v9, s[16:19], s35 offen offset:1024 lds
    s_waitcnt lgkmcnt(12)
    v_mfma_f32_32x32x16_bf16 v[176:191], a[12:15], a[64:67], v[176:191]
    ds_read_b64_tr_b16 a[40:41], v14 offset:8192
    ds_read_b64_tr_b16 a[42:43], v14 offset:10240
    buffer_load_dwordx4 a[228:231], v2, s[8:11], s37 offen offset:1024 sc1
    s_waitcnt lgkmcnt(12)
    v_mfma_f32_32x32x16_bf16 v[128:143], a[16:19], a[68:71], v[128:143]
    ds_read_b64_tr_b16 a[44:45], v15 offset:8192
    ds_read_b64_tr_b16 a[46:47], v15 offset:10240
    s_waitcnt lgkmcnt(12)
    v_mfma_f32_32x32x16_bf16 v[144:159], a[20:23], a[68:71], v[144:159]
    ds_read_b64_tr_b16 a[48:49], v12 offset:12288
    ds_read_b64_tr_b16 a[50:51], v12 offset:14336
    buffer_load_dwordx4 v10, s[16:19], s35 offen offset:2048 lds
    s_waitcnt lgkmcnt(12)
    v_mfma_f32_32x32x16_bf16 v[160:175], a[24:27], a[68:71], v[160:175]
    ds_read_b64_tr_b16 a[52:53], v13 offset:12288
    ds_read_b64_tr_b16 a[54:55], v13 offset:14336
    s_waitcnt lgkmcnt(12)
    v_mfma_f32_32x32x16_bf16 v[176:191], a[28:31], a[68:71], v[176:191]
    ds_read_b64_tr_b16 a[56:57], v14 offset:12288
    ds_read_b64_tr_b16 a[58:59], v14 offset:14336
    buffer_load_dwordx4 a[232:235], v2, s[8:11], s37 offen offset:2048 sc1
    s_waitcnt lgkmcnt(12)
    v_mfma_f32_32x32x16_bf16 v[128:143], a[32:35], a[72:75], v[128:143]
    ds_read_b64_tr_b16 a[60:61], v15 offset:12288
    ds_read_b64_tr_b16 a[62:63], v15 offset:14336
    buffer_load_dwordx4 v11, s[16:19], s35 offen offset:3072 lds
    s_waitcnt lgkmcnt(12)
    v_mfma_f32_32x32x16_bf16 v[144:159], a[36:39], a[72:75], v[144:159]
    ds_read_b64_tr_b16 a[0:1], v12 offset:16384
    ds_read_b64_tr_b16 a[2:3], v12 offset:18432
    s_waitcnt lgkmcnt(12)
    v_mfma_f32_32x32x16_bf16 v[160:175], a[40:43], a[72:75], v[160:175]
    ds_read_b64_tr_b16 a[4:5], v13 offset:16384
    ds_read_b64_tr_b16 a[6:7], v13 offset:18432
    buffer_load_dwordx4 a[236:239], v2, s[8:11], s37 offen offset:3072 sc1
    s_add_u32 s37, s37, 4096
    s_waitcnt lgkmcnt(12)
    v_mfma_f32_32x32x16_bf16 v[176:191], a[44:47], a[72:75], v[176:191]
    ds_read_b64_tr_b16 a[8:9], v14 offset:16384
    ds_read_b64_tr_b16 a[10:11], v14 offset:18432
    s_add_u32 m0, s34, 102400
    s_add_u32 s35, s32, 32768
    buffer_load_dwordx4 v8, s[16:19], s35 offen offset:0 lds
    s_waitcnt lgkmcnt(12)
    v_mfma_f32_32x32x16_bf16 v[128:143], a[48:51], a[76:79], v[128:143]
    ds_read_b64_tr_b16 a[12:13], v15 offset:16384
    ds_read_b64_tr_b16 a[14:15], v15 offset:18432
    s_waitcnt lgkmcnt(12)
    v_mfma_f32_32x32x16_bf16 v[144:159], a[52:55], a[76:79], v[144:159]
    ds_read_b64_tr_b16 a[16:17], v12 offset:20480
    ds_read_b64_tr_b16 a[18:19], v12 offset:22528
    buffer_load_dwordx4 a[240:243], v2, s[8:11], s37 offen offset:0 sc1
    s_waitcnt lgkmcnt(12)
    v_mfma_f32_32x32x16_bf16 v[160:175], a[56:59], a[76:79], v[160:175]
    ds_read_b64_tr_b16 a[20:21], v13 offset:20480
    ds_read_b64_tr_b16 a[22:23], v13 offset:22528
    s_waitcnt lgkmcnt(12)
    v_mfma_f32_32x32x16_bf16 v[176:191], a[60:63], a[76:79], v[176:191]
    ds_read_b64_tr_b16 a[24:25], v14 offset:20480
    ds_read_b64_tr_b16 a[26:27], v14 offset:22528
    buffer_load_dwordx4 v9, s[16:19], s35 offen offset:1024 lds
    s_waitcnt lgkmcnt(12)
    v_mfma_f32_32x32x16_bf16 v[128:143], a[0:3], a[80:83], v[128:143]
    ds_read_b64_tr_b16 a[28:29], v15 offset:20480
    ds_read_b64_tr_b16 a[30:31], v15 offset:22528
    buffer_load_dwordx4 a[244:247], v2, s[8:11], s37 offen offset:1024 sc1
    s_waitcnt lgkmcnt(12)
    v_mfma_f32_32x32x16_bf16 v[144:159], a[4:7], a[80:83], v[144:159]
    ds_read_b64_tr_b16 a[32:33], v12 offset:24576
    ds_read_b64_tr_b16 a[34:35], v12 offset:26624
    s_waitcnt lgkmcnt(12)
    v_mfma_f32_32x32x16_bf16 v[160:175], a[8:11], a[80:83], v[160:175]
    ds_read_b64_tr_b16 a[36:37], v13 offset:24576
    ds_read_b64_tr_b16 a[38:39], v13 offset:26624
    buffer_load_dwordx4 v10, s[16:19], s35 offen offset:2048 lds
    s_waitcnt lgkmcnt(12)
    v_mfma_f32_32x32x16_bf16 v[176:191], a[12:15], a[80:83], v[176:191]
    ds_read_b64_tr_b16 a[40:41], v14 offset:24576
    ds_read_b64_tr_b16 a[42:43], v14 offset:26624
    buffer_load_dwordx4 a[248:251], v2, s[8:11], s37 offen offset:2048 sc1
    s_waitcnt lgkmcnt(12)
    v_mfma_f32_32x32x16_bf16 v[128:143], a[16:19], a[84:87], v[128:143]
    ds_read_b64_tr_b16 a[44:45], v15 offset:24576
    ds_read_b64_tr_b16 a[46:47], v15 offset:26624
    s_waitcnt lgkmcnt(12)
    v_mfma_f32_32x32x16_bf16 v[144:159], a[20:23], a[84:87], v[144:159]
    ds_read_b64_tr_b16 a[48:49], v12 offset:28672
    ds_read_b64_tr_b16 a[50:51], v12 offset:30720
    buffer_load_dwordx4 v11, s[16:19], s35 offen offset:3072 lds
    s_add_u32 s32, s32, 262144
    s_waitcnt lgkmcnt(12)
    v_mfma_f32_32x32x16_bf16 v[160:175], a[24:27], a[84:87], v[160:175]
    ds_read_b64_tr_b16 a[52:53], v13 offset:28672
    ds_read_b64_tr_b16 a[54:55], v13 offset:30720
    s_waitcnt lgkmcnt(12)
    v_mfma_f32_32x32x16_bf16 v[176:191], a[28:31], a[84:87], v[176:191]
    ds_read_b64_tr_b16 a[56:57], v14 offset:28672
    ds_read_b64_tr_b16 a[58:59], v14 offset:30720
    buffer_load_dwordx4 a[252:255], v2, s[8:11], s37 offen offset:3072 sc1
    s_add_u32 s37, s37, 4096
    s_waitcnt lgkmcnt(12)
    v_mfma_f32_32x32x16_bf16 v[128:143], a[32:35], a[88:91], v[128:143]
    ds_read_b64_tr_b16 a[60:61], v15 offset:28672
    ds_read_b64_tr_b16 a[62:63], v15 offset:30720
    s_waitcnt lgkmcnt(12)
    v_mfma_f32_32x32x16_bf16 v[144:159], a[36:39], a[88:91], v[144:159]
    s_waitcnt lgkmcnt(10)
    v_mfma_f32_32x32x16_bf16 v[160:175], a[40:43], a[88:91], v[160:175]
    s_waitcnt lgkmcnt(8)
    v_mfma_f32_32x32x16_bf16 v[176:191], a[44:47], a[88:91], v[176:191]
    s_waitcnt vmcnt(32) lgkmcnt(0)
    s_barrier
    ds_read_b64_tr_b16 a[0:1], v12 offset:32768
    ds_read_b64_tr_b16 a[2:3], v12 offset:34816
    ds_read_b64_tr_b16 a[4:5], v13 offset:32768
    ds_read_b64_tr_b16 a[6:7], v13 offset:34816
    ds_read_b64_tr_b16 a[8:9], v14 offset:32768
    ds_read_b64_tr_b16 a[10:11], v14 offset:34816
    v_mfma_f32_32x32x16_bf16 v[128:143], a[48:51], a[92:95], v[128:143]
    ds_read_b64_tr_b16 a[12:13], v15 offset:32768
    ds_read_b64_tr_b16 a[14:15], v15 offset:34816
    v_mfma_f32_32x32x16_bf16 v[144:159], a[52:55], a[92:95], v[144:159]
    ds_read_b64_tr_b16 a[16:17], v12 offset:36864
    ds_read_b64_tr_b16 a[18:19], v12 offset:38912
    v_mfma_f32_32x32x16_bf16 v[160:175], a[56:59], a[92:95], v[160:175]
    ds_read_b64_tr_b16 a[20:21], v13 offset:36864
    ds_read_b64_tr_b16 a[22:23], v13 offset:38912
    v_mfma_f32_32x32x16_bf16 v[176:191], a[60:63], a[92:95], v[176:191]
    ds_read_b64_tr_b16 a[24:25], v14 offset:36864
    ds_read_b64_tr_b16 a[26:27], v14 offset:38912
    s_mov_b64 exec, 1
    v_mov_b32 v3, 1
    buffer_atomic_add v3, off, s[8:11], s69 sc1
    s_mov_b64 exec, -1
    s_add_u32 m0, s34, 0
    s_add_u32 s35, s32, 0
    buffer_load_dwordx4 v8, s[16:19], s35 offen offset:0 lds
    s_waitcnt lgkmcnt(12)
    v_mfma_f32_32x32x16_bf16 v[128:143], a[0:3], a[96:99], v[128:143]
    ds_read_b64_tr_b16 a[28:29], v15 offset:36864
    ds_read_b64_tr_b16 a[30:31], v15 offset:38912
    buffer_load_dwordx4 a[64:67], v2, s[8:11], s37 offen offset:0 sc1
    s_waitcnt lgkmcnt(12)
    v_mfma_f32_32x32x16_bf16 v[144:159], a[4:7], a[96:99], v[144:159]
    ds_read_b64_tr_b16 a[32:33], v12 offset:40960
    ds_read_b64_tr_b16 a[34:35], v12 offset:43008
    s_waitcnt lgkmcnt(12)
    v_mfma_f32_32x32x16_bf16 v[160:175], a[8:11], a[96:99], v[160:175]
    ds_read_b64_tr_b16 a[36:37], v13 offset:40960
    ds_read_b64_tr_b16 a[38:39], v13 offset:43008
    buffer_load_dwordx4 v9, s[16:19], s35 offen offset:1024 lds
    s_waitcnt lgkmcnt(12)
    v_mfma_f32_32x32x16_bf16 v[176:191], a[12:15], a[96:99], v[176:191]
    ds_read_b64_tr_b16 a[40:41], v14 offset:40960
    ds_read_b64_tr_b16 a[42:43], v14 offset:43008
    buffer_load_dwordx4 a[68:71], v2, s[8:11], s37 offen offset:1024 sc1
    s_waitcnt lgkmcnt(12)
    v_mfma_f32_32x32x16_bf16 v[128:143], a[16:19], a[100:103], v[128:143]
    ds_read_b64_tr_b16 a[44:45], v15 offset:40960
    ds_read_b64_tr_b16 a[46:47], v15 offset:43008
    s_waitcnt lgkmcnt(12)
    v_mfma_f32_32x32x16_bf16 v[144:159], a[20:23], a[100:103], v[144:159]
    ds_read_b64_tr_b16 a[48:49], v12 offset:45056
    ds_read_b64_tr_b16 a[50:51], v12 offset:47104
    buffer_load_dwordx4 v10, s[16:19], s35 offen offset:2048 lds
    s_waitcnt lgkmcnt(12)
    v_mfma_f32_32x32x16_bf16 v[160:175], a[24:27], a[100:103], v[160:175]
    ds_read_b64_tr_b16 a[52:53], v13 offset:45056
    ds_read_b64_tr_b16 a[54:55], v13 offset:47104
    s_waitcnt lgkmcnt(12)
    v_mfma_f32_32x32x16_bf16 v[176:191], a[28:31], a[100:103], v[176:191]
    ds_read_b64_tr_b16 a[56:57], v14 offset:45056
    ds_read_b64_tr_b16 a[58:59], v14 offset:47104
    buffer_load_dwordx4 a[72:75], v2, s[8:11], s37 offen offset:2048 sc1
    s_waitcnt lgkmcnt(12)
    v_mfma_f32_32x32x16_bf16 v[128:143], a[32:35], a[104:107], v[128:143]
    ds_read_b64_tr_b16 a[60:61], v15 offset:45056
    ds_read_b64_tr_b16 a[62:63], v15 offset:47104
    buffer_load_dwordx4 v11, s[16:19], s35 offen offset:3072 lds
    s_waitcnt lgkmcnt(12)
    v_mfma_f32_32x32x16_bf16 v[144:159], a[36:39], a[104:107], v[144:159]
    ds_read_b64_tr_b16 a[0:1], v12 offset:49152
    ds_read_b64_tr_b16 a[2:3], v12 offset:51200
    s_waitcnt lgkmcnt(12)
    v_mfma_f32_32x32x16_bf16 v[160:175], a[40:43], a[104:107], v[160:175]
    ds_read_b64_tr_b16 a[4:5], v13 offset:49152
    ds_read_b64_tr_b16 a[6:7], v13 offset:51200
    buffer_load_dwordx4 a[76:79], v2, s[8:11], s37 offen offset:3072 sc1
    s_add_u32 s37, s37, 4096
    s_waitcnt lgkmcnt(12)
    v_mfma_f32_32x32x16_bf16 v[176:191], a[44:47], a[104:107], v[176:191]
    ds_read_b64_tr_b16 a[8:9], v14 offset:49152
    ds_read_b64_tr_b16 a[10:11], v14 offset:51200
    s_add_u32 m0, s34, 4096
    s_add_u32 s35, s32, 32768
    buffer_load_dwordx4 v8, s[16:19], s35 offen offset:0 lds
    s_waitcnt lgkmcnt(12)
    v_mfma_f32_32x32x16_bf16 v[128:143], a[48:51], a[108:111], v[128:143]
    ds_read_b64_tr_b16 a[12:13], v15 offset:49152
    ds_read_b64_tr_b16 a[14:15], v15 offset:51200
    s_waitcnt lgkmcnt(12)
    v_mfma_f32_32x32x16_bf16 v[144:159], a[52:55], a[108:111], v[144:159]
    ds_read_b64_tr_b16 a[16:17], v12 offset:53248
    ds_read_b64_tr_b16 a[18:19], v12 offset:55296
    buffer_load_dwordx4 a[80:83], v2, s[8:11], s37 offen offset:0 sc1
    s_waitcnt lgkmcnt(12)
    v_mfma_f32_32x32x16_bf16 v[160:175], a[56:59], a[108:111], v[160:175]
    ds_read_b64_tr_b16 a[20:21], v13 offset:53248
    ds_read_b64_tr_b16 a[22:23], v13 offset:55296
    s_waitcnt lgkmcnt(12)
    v_mfma_f32_32x32x16_bf16 v[176:191], a[60:63], a[108:111], v[176:191]
    ds_read_b64_tr_b16 a[24:25], v14 offset:53248
    ds_read_b64_tr_b16 a[26:27], v14 offset:55296
    buffer_load_dwordx4 v9, s[16:19], s35 offen offset:1024 lds
    s_waitcnt lgkmcnt(12)
    v_mfma_f32_32x32x16_bf16 v[128:143], a[0:3], a[112:115], v[128:143]
    ds_read_b64_tr_b16 a[28:29], v15 offset:53248
    ds_read_b64_tr_b16 a[30:31], v15 offset:55296
    buffer_load_dwordx4 a[84:87], v2, s[8:11], s37 offen offset:1024 sc1
    s_waitcnt lgkmcnt(12)
    v_mfma_f32_32x32x16_bf16 v[144:159], a[4:7], a[112:115], v[144:159]
    ds_read_b64_tr_b16 a[32:33], v12 offset:57344
    ds_read_b64_tr_b16 a[34:35], v12 offset:59392
    s_waitcnt lgkmcnt(12)
    v_mfma_f32_32x32x16_bf16 v[160:175], a[8:11], a[112:115], v[160:175]
    ds_read_b64_tr_b16 a[36:37], v13 offset:57344
    ds_read_b64_tr_b16 a[38:39], v13 offset:59392
    buffer_load_dwordx4 v10, s[16:19], s35 offen offset:2048 lds
    s_waitcnt lgkmcnt(12)
    v_mfma_f32_32x32x16_bf16 v[176:191], a[12:15], a[112:115], v[176:191]
    ds_read_b64_tr_b16 a[40:41], v14 offset:57344
    ds_read_b64_tr_b16 a[42:43], v14 offset:59392
    buffer_load_dwordx4 a[88:91], v2, s[8:11], s37 offen offset:2048 sc1
    s_waitcnt lgkmcnt(12)
    v_mfma_f32_32x32x16_bf16 v[128:143], a[16:19], a[116:119], v[128:143]
    ds_read_b64_tr_b16 a[44:45], v15 offset:57344
    ds_read_b64_tr_b16 a[46:47], v15 offset:59392
    s_waitcnt lgkmcnt(12)
    v_mfma_f32_32x32x16_bf16 v[144:159], a[20:23], a[116:119], v[144:159]
    ds_read_b64_tr_b16 a[48:49], v12 offset:61440
    ds_read_b64_tr_b16 a[50:51], v12 offset:63488
    buffer_load_dwordx4 v11, s[16:19], s35 offen offset:3072 lds
    s_add_u32 s32, s32, 262144
    s_waitcnt lgkmcnt(12)
    v_mfma_f32_32x32x16_bf16 v[160:175], a[24:27], a[116:119], v[160:175]
    ds_read_b64_tr_b16 a[52:53], v13 offset:61440
    ds_read_b64_tr_b16 a[54:55], v13 offset:63488
    s_waitcnt lgkmcnt(12)
    v_mfma_f32_32x32x16_bf16 v[176:191], a[28:31], a[116:119], v[176:191]
    ds_read_b64_tr_b16 a[56:57], v14 offset:61440
    ds_read_b64_tr_b16 a[58:59], v14 offset:63488
    buffer_load_dwordx4 a[92:95], v2, s[8:11], s37 offen offset:3072 sc1
    s_add_u32 s37, s37, 4096
    s_waitcnt lgkmcnt(12)
    v_mfma_f32_32x32x16_bf16 v[128:143], a[32:35], a[120:123], v[128:143]
    ds_read_b64_tr_b16 a[60:61], v15 offset:61440
    ds_read_b64_tr_b16 a[62:63], v15 offset:63488
    s_waitcnt lgkmcnt(12)
    v_mfma_f32_32x32x16_bf16 v[144:159], a[36:39], a[120:123], v[144:159]
    s_waitcnt lgkmcnt(10)
    v_mfma_f32_32x32x16_bf16 v[160:175], a[40:43], a[120:123], v[160:175]
    s_waitcnt lgkmcnt(8)
    v_mfma_f32_32x32x16_bf16 v[176:191], a[44:47], a[120:123], v[176:191]
    s_waitcnt vmcnt(33) lgkmcnt(0)
    s_barrier
    ds_read_b64_tr_b16 a[0:1], v16 offset:0
    ds_read_b64_tr_b16 a[2:3], v16 offset:2048
    ds_read_b64_tr_b16 a[4:5], v17 offset:0
    ds_read_b64_tr_b16 a[6:7], v17 offset:2048
    ds_read_b64_tr_b16 a[8:9], v18 offset:0
    ds_read_b64_tr_b16 a[10:11], v18 offset:2048
    v_mfma_f32_32x32x16_bf16 v[128:143], a[48:51], a[124:127], v[128:143]
    ds_read_b64_tr_b16 a[12:13], v19 offset:0
    ds_read_b64_tr_b16 a[14:15], v19 offset:2048
    v_mfma_f32_32x32x16_bf16 v[144:159], a[52:55], a[124:127], v[144:159]
    ds_read_b64_tr_b16 a[16:17], v16 offset:4096
    ds_read_b64_tr_b16 a[18:19], v16 offset:6144
    v_mfma_f32_32x32x16_bf16 v[160:175], a[56:59], a[124:127], v[160:175]
    ds_read_b64_tr_b16 a[20:21], v17 offset:4096
    ds_read_b64_tr_b16 a[22:23], v17 offset:6144
    v_mfma_f32_32x32x16_bf16 v[176:191], a[60:63], a[124:127], v[176:191]
    ds_read_b64_tr_b16 a[24:25], v18 offset:4096
    ds_read_b64_tr_b16 a[26:27], v18 offset:6144
    s_add_u32 m0, s34, 32768
    s_add_u32 s35, s32, 0
    buffer_load_dwordx4 v8, s[16:19], s35 offen offset:0 lds
    s_waitcnt lgkmcnt(12)
    v_mfma_f32_32x32x16_bf16 v[128:143], a[0:3], a[128:131], v[128:143]
    ds_read_b64_tr_b16 a[28:29], v19 offset:4096
    ds_read_b64_tr_b16 a[30:31], v19 offset:6144
    buffer_load_dwordx4 a[96:99], v2, s[8:11], s37 offen offset:0 sc1
    s_waitcnt lgkmcnt(12)
    v_mfma_f32_32x32x16_bf16 v[144:159], a[4:7], a[128:131], v[144:159]
    ds_read_b64_tr_b16 a[32:33], v16 offset:8192
    ds_read_b64_tr_b16 a[34:35], v16 offset:10240
    s_waitcnt lgkmcnt(12)
    v_mfma_f32_32x32x16_bf16 v[160:175], a[8:11], a[128:131], v[160:175]
    ds_read_b64_tr_b16 a[36:37], v17 offset:8192
    ds_read_b64_tr_b16 a[38:39], v17 offset:10240
    buffer_load_dwordx4 v9, s[16:19], s35 offen offset:1024 lds
    s_waitcnt lgkmcnt(12)
    v_mfma_f32_32x32x16_bf16 v[176:191], a[12:15], a[128:131], v[176:191]
    ds_read_b64_tr_b16 a[40:41], v18 offset:8192
    ds_read_b64_tr_b16 a[42:43], v18 offset:10240
    buffer_load_dwordx4 a[100:103], v2, s[8:11], s37 offen offset:1024 sc1
    s_waitcnt lgkmcnt(12)
    v_mfma_f32_32x32x16_bf16 v[128:143], a[16:19], a[132:135], v[128:143]
    ds_read_b64_tr_b16 a[44:45], v19 offset:8192
    ds_read_b64_tr_b16 a[46:47], v19 offset:10240
    s_waitcnt lgkmcnt(12)
    v_mfma_f32_32x32x16_bf16 v[144:159], a[20:23], a[132:135], v[144:159]
    ds_read_b64_tr_b16 a[48:49], v16 offset:12288
    ds_read_b64_tr_b16 a[50:51], v16 offset:14336
    buffer_load_dwordx4 v10, s[16:19], s35 offen offset:2048 lds
    s_waitcnt lgkmcnt(12)
    v_mfma_f32_32x32x16_bf16 v[160:175], a[24:27], a[132:135], v[160:175]
    ds_read_b64_tr_b16 a[52:53], v17 offset:12288
    ds_read_b64_tr_b16 a[54:55], v17 offset:14336
    s_waitcnt lgkmcnt(12)
    v_mfma_f32_32x32x16_bf16 v[176:191], a[28:31], a[132:135], v[176:191]
    ds_read_b64_tr_b16 a[56:57], v18 offset:12288
    ds_read_b64_tr_b16 a[58:59], v18 offset:14336
    buffer_load_dwordx4 a[104:107], v2, s[8:11], s37 offen offset:2048 sc1
    s_waitcnt lgkmcnt(12)
    v_mfma_f32_32x32x16_bf16 v[128:143], a[32:35], a[136:139], v[128:143]
    ds_read_b64_tr_b16 a[60:61], v19 offset:12288
    ds_read_b64_tr_b16 a[62:63], v19 offset:14336
    buffer_load_dwordx4 v11, s[16:19], s35 offen offset:3072 lds
    s_waitcnt lgkmcnt(12)
    v_mfma_f32_32x32x16_bf16 v[144:159], a[36:39], a[136:139], v[144:159]
    ds_read_b64_tr_b16 a[0:1], v16 offset:16384
    ds_read_b64_tr_b16 a[2:3], v16 offset:18432
    s_waitcnt lgkmcnt(12)
    v_mfma_f32_32x32x16_bf16 v[160:175], a[40:43], a[136:139], v[160:175]
    ds_read_b64_tr_b16 a[4:5], v17 offset:16384
    ds_read_b64_tr_b16 a[6:7], v17 offset:18432
    buffer_load_dwordx4 a[108:111], v2, s[8:11], s37 offen offset:3072 sc1
    s_add_u32 s37, s37, 4096
    s_waitcnt lgkmcnt(12)
    v_mfma_f32_32x32x16_bf16 v[176:191], a[44:47], a[136:139], v[176:191]
    ds_read_b64_tr_b16 a[8:9], v18 offset:16384
    ds_read_b64_tr_b16 a[10:11], v18 offset:18432
    s_add_u32 m0, s34, 36864
    s_add_u32 s35, s32, 32768
    buffer_load_dwordx4 v8, s[16:19], s35 offen offset:0 lds
    s_waitcnt lgkmcnt(12)
    v_mfma_f32_32x32x16_bf16 v[128:143], a[48:51], a[140:143], v[128:143]
    ds_read_b64_tr_b16 a[12:13], v19 offset:16384
    ds_read_b64_tr_b16 a[14:15], v19 offset:18432
    s_waitcnt lgkmcnt(12)
    v_mfma_f32_32x32x16_bf16 v[144:159], a[52:55], a[140:143], v[144:159]
    ds_read_b64_tr_b16 a[16:17], v16 offset:20480
    ds_read_b64_tr_b16 a[18:19], v16 offset:22528
    buffer_load_dwordx4 a[112:115], v2, s[8:11], s37 offen offset:0 sc1
    s_waitcnt lgkmcnt(12)
    v_mfma_f32_32x32x16_bf16 v[160:175], a[56:59], a[140:143], v[160:175]
    ds_read_b64_tr_b16 a[20:21], v17 offset:20480
    ds_read_b64_tr_b16 a[22:23], v17 offset:22528
    s_waitcnt lgkmcnt(12)
    v_mfma_f32_32x32x16_bf16 v[176:191], a[60:63], a[140:143], v[176:191]
    ds_read_b64_tr_b16 a[24:25], v18 offset:20480
    ds_read_b64_tr_b16 a[26:27], v18 offset:22528
    buffer_load_dwordx4 v9, s[16:19], s35 offen offset:1024 lds
    s_waitcnt lgkmcnt(12)
    v_mfma_f32_32x32x16_bf16 v[128:143], a[0:3], a[144:147], v[128:143]
    ds_read_b64_tr_b16 a[28:29], v19 offset:20480
    ds_read_b64_tr_b16 a[30:31], v19 offset:22528
    buffer_load_dwordx4 a[116:119], v2, s[8:11], s37 offen offset:1024 sc1
    s_waitcnt lgkmcnt(12)
    v_mfma_f32_32x32x16_bf16 v[144:159], a[4:7], a[144:147], v[144:159]
    ds_read_b64_tr_b16 a[32:33], v16 offset:24576
    ds_read_b64_tr_b16 a[34:35], v16 offset:26624
    s_waitcnt lgkmcnt(12)
    v_mfma_f32_32x32x16_bf16 v[160:175], a[8:11], a[144:147], v[160:175]
    ds_read_b64_tr_b16 a[36:37], v17 offset:24576
    ds_read_b64_tr_b16 a[38:39], v17 offset:26624
    buffer_load_dwordx4 v10, s[16:19], s35 offen offset:2048 lds
    s_waitcnt lgkmcnt(12)
    v_mfma_f32_32x32x16_bf16 v[176:191], a[12:15], a[144:147], v[176:191]
    ds_read_b64_tr_b16 a[40:41], v18 offset:24576
    ds_read_b64_tr_b16 a[42:43], v18 offset:26624
    buffer_load_dwordx4 a[120:123], v2, s[8:11], s37 offen offset:2048 sc1
    s_waitcnt lgkmcnt(12)
    v_mfma_f32_32x32x16_bf16 v[128:143], a[16:19], a[148:151], v[128:143]
    ds_read_b64_tr_b16 a[44:45], v19 offset:24576
    ds_read_b64_tr_b16 a[46:47], v19 offset:26624
    s_waitcnt lgkmcnt(12)
    v_mfma_f32_32x32x16_bf16 v[144:159], a[20:23], a[148:151], v[144:159]
    ds_read_b64_tr_b16 a[48:49], v16 offset:28672
    ds_read_b64_tr_b16 a[50:51], v16 offset:30720
    buffer_load_dwordx4 v11, s[16:19], s35 offen offset:3072 lds
    s_add_u32 s32, s32, 262144
    s_waitcnt lgkmcnt(12)
    v_mfma_f32_32x32x16_bf16 v[160:175], a[24:27], a[148:151], v[160:175]
    ds_read_b64_tr_b16 a[52:53], v17 offset:28672
    ds_read_b64_tr_b16 a[54:55], v17 offset:30720
    s_waitcnt lgkmcnt(12)
    v_mfma_f32_32x32x16_bf16 v[176:191], a[28:31], a[148:151], v[176:191]
    ds_read_b64_tr_b16 a[56:57], v18 offset:28672
    ds_read_b64_tr_b16 a[58:59], v18 offset:30720
    buffer_load_dwordx4 a[124:127], v2, s[8:11], s37 offen offset:3072 sc1
    s_add_u32 s37, s37, 4096
    s_waitcnt lgkmcnt(12)
    v_mfma_f32_32x32x16_bf16 v[128:143], a[32:35], a[152:155], v[128:143]
    ds_read_b64_tr_b16 a[60:61], v19 offset:28672
    ds_read_b64_tr_b16 a[62:63], v19 offset:30720
    s_waitcnt lgkmcnt(12)
    v_mfma_f32_32x32x16_bf16 v[144:159], a[36:39], a[152:155], v[144:159]
    s_waitcnt lgkmcnt(10)
    v_mfma_f32_32x32x16_bf16 v[160:175], a[40:43], a[152:155], v[160:175]
    s_waitcnt lgkmcnt(8)
    v_mfma_f32_32x32x16_bf16 v[176:191], a[44:47], a[152:155], v[176:191]
    s_waitcnt vmcnt(33) lgkmcnt(0)
    s_barrier
    ds_read_b64_tr_b16 a[0:1], v16 offset:32768
    ds_read_b64_tr_b16 a[2:3], v16 offset:34816
    ds_read_b64_tr_b16 a[4:5], v17 offset:32768
    ds_read_b64_tr_b16 a[6:7], v17 offset:34816
    ds_read_b64_tr_b16 a[8:9], v18 offset:32768
    ds_read_b64_tr_b16 a[10:11], v18 offset:34816
    v_mfma_f32_32x32x16_bf16 v[128:143], a[48:51], a[156:159], v[128:143]
    ds_read_b64_tr_b16 a[12:13], v19 offset:32768
    ds_read_b64_tr_b16 a[14:15], v19 offset:34816
    v_mfma_f32_32x32x16_bf16 v[144:159], a[52:55], a[156:159], v[144:159]
    ds_read_b64_tr_b16 a[16:17], v16 offset:36864
    ds_read_b64_tr_b16 a[18:19], v16 offset:38912
    v_mfma_f32_32x32x16_bf16 v[160:175], a[56:59], a[156:159], v[160:175]
    ds_read_b64_tr_b16 a[20:21], v17 offset:36864
    ds_read_b64_tr_b16 a[22:23], v17 offset:38912
    v_mfma_f32_32x32x16_bf16 v[176:191], a[60:63], a[156:159], v[176:191]
    ds_read_b64_tr_b16 a[24:25], v18 offset:36864
    ds_read_b64_tr_b16 a[26:27], v18 offset:38912
    s_add_u32 m0, s34, 65536
    s_add_u32 s35, s32, 0
    buffer_load_dwordx4 v8, s[16:19], s35 offen offset:0 lds
    s_waitcnt lgkmcnt(12)
    v_mfma_f32_32x32x16_bf16 v[128:143], a[0:3], a[224:227], v[128:143]
    ds_read_b64_tr_b16 a[28:29], v19 offset:36864
    ds_read_b64_tr_b16 a[30:31], v19 offset:38912
    buffer_load_dwordx4 a[128:131], v2, s[8:11], s37 offen offset:0 sc1
    s_waitcnt lgkmcnt(12)
    v_mfma_f32_32x32x16_bf16 v[144:159], a[4:7], a[224:227], v[144:159]
    ds_read_b64_tr_b16 a[32:33], v16 offset:40960
    ds_read_b64_tr_b16 a[34:35], v16 offset:43008
    s_waitcnt lgkmcnt(12)
    v_mfma_f32_32x32x16_bf16 v[160:175], a[8:11], a[224:227], v[160:175]
    ds_read_b64_tr_b16 a[36:37], v17 offset:40960
    ds_read_b64_tr_b16 a[38:39], v17 offset:43008
    buffer_load_dwordx4 v9, s[16:19], s35 offen offset:1024 lds
    s_waitcnt lgkmcnt(12)
    v_mfma_f32_32x32x16_bf16 v[176:191], a[12:15], a[224:227], v[176:191]
    ds_read_b64_tr_b16 a[40:41], v18 offset:40960
    ds_read_b64_tr_b16 a[42:43], v18 offset:43008
    buffer_load_dwordx4 a[132:135], v2, s[8:11], s37 offen offset:1024 sc1
    s_waitcnt lgkmcnt(12)
    v_mfma_f32_32x32x16_bf16 v[128:143], a[16:19], a[228:231], v[128:143]
    ds_read_b64_tr_b16 a[44:45], v19 offset:40960
    ds_read_b64_tr_b16 a[46:47], v19 offset:43008
    s_waitcnt lgkmcnt(12)
    v_mfma_f32_32x32x16_bf16 v[144:159], a[20:23], a[228:231], v[144:159]
    ds_read_b64_tr_b16 a[48:49], v16 offset:45056
    ds_read_b64_tr_b16 a[50:51], v16 offset:47104
    buffer_load_dwordx4 v10, s[16:19], s35 offen offset:2048 lds
    s_waitcnt lgkmcnt(12)
    v_mfma_f32_32x32x16_bf16 v[160:175], a[24:27], a[228:231], v[160:175]
    ds_read_b64_tr_b16 a[52:53], v17 offset:45056
    ds_read_b64_tr_b16 a[54:55], v17 offset:47104
    s_waitcnt lgkmcnt(12)
    v_mfma_f32_32x32x16_bf16 v[176:191], a[28:31], a[228:231], v[176:191]
    ds_read_b64_tr_b16 a[56:57], v18 offset:45056
    ds_read_b64_tr_b16 a[58:59], v18 offset:47104
    buffer_load_dwordx4 a[136:139], v2, s[8:11], s37 offen offset:2048 sc1
    s_waitcnt lgkmcnt(12)
    v_mfma_f32_32x32x16_bf16 v[128:143], a[32:35], a[232:235], v[128:143]
    ds_read_b64_tr_b16 a[60:61], v19 offset:45056
    ds_read_b64_tr_b16 a[62:63], v19 offset:47104
    buffer_load_dwordx4 v11, s[16:19], s35 offen offset:3072 lds
    s_waitcnt lgkmcnt(12)
    v_mfma_f32_32x32x16_bf16 v[144:159], a[36:39], a[232:235], v[144:159]
    ds_read_b64_tr_b16 a[0:1], v16 offset:49152
    ds_read_b64_tr_b16 a[2:3], v16 offset:51200
    s_waitcnt lgkmcnt(12)
    v_mfma_f32_32x32x16_bf16 v[160:175], a[40:43], a[232:235], v[160:175]
    ds_read_b64_tr_b16 a[4:5], v17 offset:49152
    ds_read_b64_tr_b16 a[6:7], v17 offset:51200
    buffer_load_dwordx4 a[140:143], v2, s[8:11], s37 offen offset:3072 sc1
    s_add_u32 s37, s37, 4096
    s_waitcnt lgkmcnt(12)
    v_mfma_f32_32x32x16_bf16 v[176:191], a[44:47], a[232:235], v[176:191]
    ds_read_b64_tr_b16 a[8:9], v18 offset:49152
    ds_read_b64_tr_b16 a[10:11], v18 offset:51200
    s_add_u32 m0, s34, 69632
    s_add_u32 s35, s32, 32768
    buffer_load_dwordx4 v8, s[16:19], s35 offen offset:0 lds
    s_waitcnt lgkmcnt(12)
    v_mfma_f32_32x32x16_bf16 v[128:143], a[48:51], a[236:239], v[128:143]
    ds_read_b64_tr_b16 a[12:13], v19 offset:49152
    ds_read_b64_tr_b16 a[14:15], v19 offset:51200
    s_waitcnt lgkmcnt(12)
    v_mfma_f32_32x32x16_bf16 v[144:159], a[52:55], a[236:239], v[144:159]
    ds_read_b64_tr_b16 a[16:17], v16 offset:53248
    ds_read_b64_tr_b16 a[18:19], v16 offset:55296
    buffer_load_dwordx4 a[144:147], v2, s[8:11], s37 offen offset:0 sc1
    s_waitcnt lgkmcnt(12)
    v_mfma_f32_32x32x16_bf16 v[160:175], a[56:59], a[236:239], v[160:175]
    ds_read_b64_tr_b16 a[20:21], v17 offset:53248
    ds_read_b64_tr_b16 a[22:23], v17 offset:55296
    s_waitcnt lgkmcnt(12)
    v_mfma_f32_32x32x16_bf16 v[176:191], a[60:63], a[236:239], v[176:191]
    ds_read_b64_tr_b16 a[24:25], v18 offset:53248
    ds_read_b64_tr_b16 a[26:27], v18 offset:55296
    buffer_load_dwordx4 v9, s[16:19], s35 offen offset:1024 lds
    s_waitcnt lgkmcnt(12)
    v_mfma_f32_32x32x16_bf16 v[128:143], a[0:3], a[240:243], v[128:143]
    ds_read_b64_tr_b16 a[28:29], v19 offset:53248
    ds_read_b64_tr_b16 a[30:31], v19 offset:55296
    buffer_load_dwordx4 a[148:151], v2, s[8:11], s37 offen offset:1024 sc1
    s_waitcnt lgkmcnt(12)
    v_mfma_f32_32x32x16_bf16 v[144:159], a[4:7], a[240:243], v[144:159]
    ds_read_b64_tr_b16 a[32:33], v16 offset:57344
    ds_read_b64_tr_b16 a[34:35], v16 offset:59392
    s_waitcnt lgkmcnt(12)
    v_mfma_f32_32x32x16_bf16 v[160:175], a[8:11], a[240:243], v[160:175]
    ds_read_b64_tr_b16 a[36:37], v17 offset:57344
    ds_read_b64_tr_b16 a[38:39], v17 offset:59392
    buffer_load_dwordx4 v10, s[16:19], s35 offen offset:2048 lds
    s_waitcnt lgkmcnt(12)
    v_mfma_f32_32x32x16_bf16 v[176:191], a[12:15], a[240:243], v[176:191]
    ds_read_b64_tr_b16 a[40:41], v18 offset:57344
    ds_read_b64_tr_b16 a[42:43], v18 offset:59392
    buffer_load_dwordx4 a[152:155], v2, s[8:11], s37 offen offset:2048 sc1
    s_waitcnt lgkmcnt(12)
    v_mfma_f32_32x32x16_bf16 v[128:143], a[16:19], a[244:247], v[128:143]
    ds_read_b64_tr_b16 a[44:45], v19 offset:57344
    ds_read_b64_tr_b16 a[46:47], v19 offset:59392
    s_waitcnt lgkmcnt(12)
    v_mfma_f32_32x32x16_bf16 v[144:159], a[20:23], a[244:247], v[144:159]
    ds_read_b64_tr_b16 a[48:49], v16 offset:61440
    ds_read_b64_tr_b16 a[50:51], v16 offset:63488
    buffer_load_dwordx4 v11, s[16:19], s35 offen offset:3072 lds
    s_add_u32 s32, s32, 262144
    s_waitcnt lgkmcnt(12)
    v_mfma_f32_32x32x16_bf16 v[160:175], a[24:27], a[244:247], v[160:175]
    ds_read_b64_tr_b16 a[52:53], v17 offset:61440
    ds_read_b64_tr_b16 a[54:55], v17 offset:63488
    s_waitcnt lgkmcnt(12)
    v_mfma_f32_32x32x16_bf16 v[176:191], a[28:31], a[244:247], v[176:191]
    ds_read_b64_tr_b16 a[56:57], v18 offset:61440
    ds_read_b64_tr_b16 a[58:59], v18 offset:63488
    buffer_load_dwordx4 a[156:159], v2, s[8:11], s37 offen offset:3072 sc1
    s_add_u32 s37, s37, 4096
    s_waitcnt lgkmcnt(12)
    v_mfma_f32_32x32x16_bf16 v[128:143], a[32:35], a[248:251], v[128:143]
    ds_read_b64_tr_b16 a[60:61], v19 offset:61440
    ds_read_b64_tr_b16 a[62:63], v19 offset:63488
    s_waitcnt lgkmcnt(12)
    v_mfma_f32_32x32x16_bf16 v[144:159], a[36:39], a[248:251], v[144:159]
    s_waitcnt lgkmcnt(10)
    v_mfma_f32_32x32x16_bf16 v[160:175], a[40:43], a[248:251], v[160:175]
    s_waitcnt lgkmcnt(8)
    v_mfma_f32_32x32x16_bf16 v[176:191], a[44:47], a[248:251], v[176:191]
    s_waitcnt vmcnt(32) lgkmcnt(0)
    s_barrier
    ds_read_b64_tr_b16 a[0:1], v12 offset:0
    ds_read_b64_tr_b16 a[2:3], v12 offset:2048
    ds_read_b64_tr_b16 a[4:5], v13 offset:0
    ds_read_b64_tr_b16 a[6:7], v13 offset:2048
    ds_read_b64_tr_b16 a[8:9], v14 offset:0
    ds_read_b64_tr_b16 a[10:11], v14 offset:2048
    v_mfma_f32_32x32x16_bf16 v[128:143], a[48:51], a[252:255], v[128:143]
    ds_read_b64_tr_b16 a[12:13], v15 offset:0
    ds_read_b64_tr_b16 a[14:15], v15 offset:2048
    v_mfma_f32_32x32x16_bf16 v[144:159], a[52:55], a[252:255], v[144:159]
    ds_read_b64_tr_b16 a[16:17], v12 offset:4096
    ds_read_b64_tr_b16 a[18:19], v12 offset:6144
    v_mfma_f32_32x32x16_bf16 v[160:175], a[56:59], a[252:255], v[160:175]
    ds_read_b64_tr_b16 a[20:21], v13 offset:4096
    ds_read_b64_tr_b16 a[22:23], v13 offset:6144
    v_mfma_f32_32x32x16_bf16 v[176:191], a[60:63], a[252:255], v[176:191]
    ds_read_b64_tr_b16 a[24:25], v14 offset:4096
    ds_read_b64_tr_b16 a[26:27], v14 offset:6144
    s_add_u32 m0, s34, 98304
    s_add_u32 s35, s32, 0
    buffer_load_dwordx4 v8, s[16:19], s35 offen offset:0 lds
    s_waitcnt lgkmcnt(12)
    v_mfma_f32_32x32x16_bf16 v[128:143], a[0:3], a[64:67], v[128:143]
    ds_read_b64_tr_b16 a[28:29], v15 offset:4096
    ds_read_b64_tr_b16 a[30:31], v15 offset:6144
    buffer_load_dwordx4 a[224:227], v2, s[8:11], s37 offen offset:0 sc1
    s_waitcnt lgkmcnt(12)
    v_mfma_f32_32x32x16_bf16 v[144:159], a[4:7], a[64:67], v[144:159]
    ds_read_b64_tr_b16 a[32:33], v12 offset:8192
    ds_read_b64_tr_b16 a[34:35], v12 offset:10240
    s_waitcnt lgkmcnt(12)
    v_mfma_f32_32x32x16_bf16 v[160:175], a[8:11], a[64:67], v[160:175]
    ds_read_b64_tr_b16 a[36:37], v13 offset:8192
    ds_read_b64_tr_b16 a[38:39], v13 offset:10240
    buffer_load_dwordx4 v9, s[16:19], s35 offen offset:1024 lds
    s_waitcnt lgkmcnt(12)
    v_mfma_f32_32x32x16_bf16 v[176:191], a[12:15], a[64:67], v[176:191]
    ds_read_b64_tr_b16 a[40:41], v14 offset:8192
    ds_read_b64_tr_b16 a[42:43], v14 offset:10240
    buffer_load_dwordx4 a[228:231], v2, s[8:11], s37 offen offset:1024 sc1
    s_waitcnt lgkmcnt(12)
    v_mfma_f32_32x32x16_bf16 v[128:143], a[16:19], a[68:71], v[128:143]
    ds_read_b64_tr_b16 a[44:45], v15 offset:8192
    ds_read_b64_tr_b16 a[46:47], v15 offset:10240
    s_waitcnt lgkmcnt(12)
    v_mfma_f32_32x32x16_bf16 v[144:159], a[20:23], a[68:71], v[144:159]
    ds_read_b64_tr_b16 a[48:49], v12 offset:12288
    ds_read_b64_tr_b16 a[50:51], v12 offset:14336
    buffer_load_dwordx4 v10, s[16:19], s35 offen offset:2048 lds
    s_waitcnt lgkmcnt(12)
    v_mfma_f32_32x32x16_bf16 v[160:175], a[24:27], a[68:71], v[160:175]
    ds_read_b64_tr_b16 a[52:53], v13 offset:12288
    ds_read_b64_tr_b16 a[54:55], v13 offset:14336
    s_waitcnt lgkmcnt(12)
    v_mfma_f32_32x32x16_bf16 v[176:191], a[28:31], a[68:71], v[176:191]
    ds_read_b64_tr_b16 a[56:57], v14 offset:12288
    ds_read_b64_tr_b16 a[58:59], v14 offset:14336
    buffer_load_dwordx4 a[232:235], v2, s[8:11], s37 offen offset:2048 sc1
    s_waitcnt lgkmcnt(12)
    v_mfma_f32_32x32x16_bf16 v[128:143], a[32:35], a[72:75], v[128:143]
    ds_read_b64_tr_b16 a[60:61], v15 offset:12288
    ds_read_b64_tr_b16 a[62:63], v15 offset:14336
    buffer_load_dwordx4 v11, s[16:19], s35 offen offset:3072 lds
    s_waitcnt lgkmcnt(12)
    v_mfma_f32_32x32x16_bf16 v[144:159], a[36:39], a[72:75], v[144:159]
    ds_read_b64_tr_b16 a[0:1], v12 offset:16384
    ds_read_b64_tr_b16 a[2:3], v12 offset:18432
    s_waitcnt lgkmcnt(12)
    v_mfma_f32_32x32x16_bf16 v[160:175], a[40:43], a[72:75], v[160:175]
    ds_read_b64_tr_b16 a[4:5], v13 offset:16384
    ds_read_b64_tr_b16 a[6:7], v13 offset:18432
    buffer_load_dwordx4 a[236:239], v2, s[8:11], s37 offen offset:3072 sc1
    s_add_u32 s37, s37, 4096
    s_waitcnt lgkmcnt(12)
    v_mfma_f32_32x32x16_bf16 v[176:191], a[44:47], a[72:75], v[176:191]
    ds_read_b64_tr_b16 a[8:9], v14 offset:16384
    ds_read_b64_tr_b16 a[10:11], v14 offset:18432
    s_add_u32 m0, s34, 102400
    s_add_u32 s35, s32, 32768
    buffer_load_dwordx4 v8, s[16:19], s35 offen offset:0 lds
    s_waitcnt lgkmcnt(12)
    v_mfma_f32_32x32x16_bf16 v[128:143], a[48:51], a[76:79], v[128:143]
    ds_read_b64_tr_b16 a[12:13], v15 offset:16384
    ds_read_b64_tr_b16 a[14:15], v15 offset:18432
    s_waitcnt lgkmcnt(12)
    v_mfma_f32_32x32x16_bf16 v[144:159], a[52:55], a[76:79], v[144:159]
    ds_read_b64_tr_b16 a[16:17], v12 offset:20480
    ds_read_b64_tr_b16 a[18:19], v12 offset:22528
    buffer_load_dwordx4 a[240:243], v2, s[8:11], s37 offen offset:0 sc1
    s_waitcnt lgkmcnt(12)
    v_mfma_f32_32x32x16_bf16 v[160:175], a[56:59], a[76:79], v[160:175]
    ds_read_b64_tr_b16 a[20:21], v13 offset:20480
    ds_read_b64_tr_b16 a[22:23], v13 offset:22528
    s_waitcnt lgkmcnt(12)
    v_mfma_f32_32x32x16_bf16 v[176:191], a[60:63], a[76:79], v[176:191]
    ds_read_b64_tr_b16 a[24:25], v14 offset:20480
    ds_read_b64_tr_b16 a[26:27], v14 offset:22528
    buffer_load_dwordx4 v9, s[16:19], s35 offen offset:1024 lds
    s_waitcnt lgkmcnt(12)
    v_mfma_f32_32x32x16_bf16 v[128:143], a[0:3], a[80:83], v[128:143]
    ds_read_b64_tr_b16 a[28:29], v15 offset:20480
    ds_read_b64_tr_b16 a[30:31], v15 offset:22528
    buffer_load_dwordx4 a[244:247], v2, s[8:11], s37 offen offset:1024 sc1
    s_waitcnt lgkmcnt(12)
    v_mfma_f32_32x32x16_bf16 v[144:159], a[4:7], a[80:83], v[144:159]
    ds_read_b64_tr_b16 a[32:33], v12 offset:24576
    ds_read_b64_tr_b16 a[34:35], v12 offset:26624
    s_waitcnt lgkmcnt(12)
    v_mfma_f32_32x32x16_bf16 v[160:175], a[8:11], a[80:83], v[160:175]
    ds_read_b64_tr_b16 a[36:37], v13 offset:24576
    ds_read_b64_tr_b16 a[38:39], v13 offset:26624
    buffer_load_dwordx4 v10, s[16:19], s35 offen offset:2048 lds
    s_waitcnt lgkmcnt(12)
    v_mfma_f32_32x32x16_bf16 v[176:191], a[12:15], a[80:83], v[176:191]
    ds_read_b64_tr_b16 a[40:41], v14 offset:24576
    ds_read_b64_tr_b16 a[42:43], v14 offset:26624
    buffer_load_dwordx4 a[248:251], v2, s[8:11], s37 offen offset:2048 sc1
    s_waitcnt lgkmcnt(12)
    v_mfma_f32_32x32x16_bf16 v[128:143], a[16:19], a[84:87], v[128:143]
    ds_read_b64_tr_b16 a[44:45], v15 offset:24576
    ds_read_b64_tr_b16 a[46:47], v15 offset:26624
    s_waitcnt lgkmcnt(12)
    v_mfma_f32_32x32x16_bf16 v[144:159], a[20:23], a[84:87], v[144:159]
    ds_read_b64_tr_b16 a[48:49], v12 offset:28672
    ds_read_b64_tr_b16 a[50:51], v12 offset:30720
    buffer_load_dwordx4 v11, s[16:19], s35 offen offset:3072 lds
    s_add_u32 s32, s32, 262144
    s_waitcnt lgkmcnt(12)
    v_mfma_f32_32x32x16_bf16 v[160:175], a[24:27], a[84:87], v[160:175]
    ds_read_b64_tr_b16 a[52:53], v13 offset:28672
    ds_read_b64_tr_b16 a[54:55], v13 offset:30720
    s_waitcnt lgkmcnt(12)
    v_mfma_f32_32x32x16_bf16 v[176:191], a[28:31], a[84:87], v[176:191]
    ds_read_b64_tr_b16 a[56:57], v14 offset:28672
    ds_read_b64_tr_b16 a[58:59], v14 offset:30720
    buffer_load_dwordx4 a[252:255], v2, s[8:11], s37 offen offset:3072 sc1
    s_add_u32 s37, s37, 4096
    s_waitcnt lgkmcnt(12)
    v_mfma_f32_32x32x16_bf16 v[128:143], a[32:35], a[88:91], v[128:143]
    ds_read_b64_tr_b16 a[60:61], v15 offset:28672
    ds_read_b64_tr_b16 a[62:63], v15 offset:30720
    s_waitcnt lgkmcnt(12)
    v_mfma_f32_32x32x16_bf16 v[144:159], a[36:39], a[88:91], v[144:159]
    s_waitcnt lgkmcnt(10)
    v_mfma_f32_32x32x16_bf16 v[160:175], a[40:43], a[88:91], v[160:175]
    s_waitcnt lgkmcnt(8)
    v_mfma_f32_32x32x16_bf16 v[176:191], a[44:47], a[88:91], v[176:191]
    s_waitcnt vmcnt(32) lgkmcnt(0)
    s_barrier
    ds_read_b64_tr_b16 a[0:1], v12 offset:32768
    ds_read_b64_tr_b16 a[2:3], v12 offset:34816
    ds_read_b64_tr_b16 a[4:5], v13 offset:32768
    ds_read_b64_tr_b16 a[6:7], v13 offset:34816
    ds_read_b64_tr_b16 a[8:9], v14 offset:32768
    ds_read_b64_tr_b16 a[10:11], v14 offset:34816
    v_mfma_f32_32x32x16_bf16 v[128:143], a[48:51], a[92:95], v[128:143]
    ds_read_b64_tr_b16 a[12:13], v15 offset:32768
    ds_read_b64_tr_b16 a[14:15], v15 offset:34816
    v_mfma_f32_32x32x16_bf16 v[144:159], a[52:55], a[92:95], v[144:159]
    ds_read_b64_tr_b16 a[16:17], v12 offset:36864
    ds_read_b64_tr_b16 a[18:19], v12 offset:38912
    v_mfma_f32_32x32x16_bf16 v[160:175], a[56:59], a[92:95], v[160:175]
    ds_read_b64_tr_b16 a[20:21], v13 offset:36864
    ds_read_b64_tr_b16 a[22:23], v13 offset:38912
    v_mfma_f32_32x32x16_bf16 v[176:191], a[60:63], a[92:95], v[176:191]
    ds_read_b64_tr_b16 a[24:25], v14 offset:36864
    ds_read_b64_tr_b16 a[26:27], v14 offset:38912
    s_add_u32 m0, s34, 0
    s_add_u32 s35, s32, 0
    buffer_load_dwordx4 v8, s[16:19], s35 offen offset:0 lds
    s_waitcnt lgkmcnt(12)
    v_mfma_f32_32x32x16_bf16 v[128:143], a[0:3], a[96:99], v[128:143]
    ds_read_b64_tr_b16 a[28:29], v15 offset:36864
    ds_read_b64_tr_b16 a[30:31], v15 offset:38912
    buffer_load_dwordx4 a[64:67], v2, s[8:11], s37 offen offset:0 sc1
    s_waitcnt lgkmcnt(12)
    v_mfma_f32_32x32x16_bf16 v[144:159], a[4:7], a[96:99], v[144:159]
    ds_read_b64_tr_b16 a[32:33], v12 offset:40960
    ds_read_b64_tr_b16 a[34:35], v12 offset:43008
    s_waitcnt lgkmcnt(12)
    v_mfma_f32_32x32x16_bf16 v[160:175], a[8:11], a[96:99], v[160:175]
    ds_read_b64_tr_b16 a[36:37], v13 offset:40960
    ds_read_b64_tr_b16 a[38:39], v13 offset:43008
    buffer_load_dwordx4 v9, s[16:19], s35 offen offset:1024 lds
    s_waitcnt lgkmcnt(12)
    v_mfma_f32_32x32x16_bf16 v[176:191], a[12:15], a[96:99], v[176:191]
    ds_read_b64_tr_b16 a[40:41], v14 offset:40960
    ds_read_b64_tr_b16 a[42:43], v14 offset:43008
    buffer_load_dwordx4 a[68:71], v2, s[8:11], s37 offen offset:1024 sc1
    s_waitcnt lgkmcnt(12)
    v_mfma_f32_32x32x16_bf16 v[128:143], a[16:19], a[100:103], v[128:143]
    ds_read_b64_tr_b16 a[44:45], v15 offset:40960
    ds_read_b64_tr_b16 a[46:47], v15 offset:43008
    s_waitcnt lgkmcnt(12)
    v_mfma_f32_32x32x16_bf16 v[144:159], a[20:23], a[100:103], v[144:159]
    ds_read_b64_tr_b16 a[48:49], v12 offset:45056
    ds_read_b64_tr_b16 a[50:51], v12 offset:47104
    buffer_load_dwordx4 v10, s[16:19], s35 offen offset:2048 lds
    s_waitcnt lgkmcnt(12)
    v_mfma_f32_32x32x16_bf16 v[160:175], a[24:27], a[100:103], v[160:175]
    ds_read_b64_tr_b16 a[52:53], v13 offset:45056
    ds_read_b64_tr_b16 a[54:55], v13 offset:47104
    s_waitcnt lgkmcnt(12)
    v_mfma_f32_32x32x16_bf16 v[176:191], a[28:31], a[100:103], v[176:191]
    ds_read_b64_tr_b16 a[56:57], v14 offset:45056
    ds_read_b64_tr_b16 a[58:59], v14 offset:47104
    buffer_load_dwordx4 a[72:75], v2, s[8:11], s37 offen offset:2048 sc1
    s_waitcnt lgkmcnt(12)
    v_mfma_f32_32x32x16_bf16 v[128:143], a[32:35], a[104:107], v[128:143]
    ds_read_b64_tr_b16 a[60:61], v15 offset:45056
    ds_read_b64_tr_b16 a[62:63], v15 offset:47104
    buffer_load_dwordx4 v11, s[16:19], s35 offen offset:3072 lds
    s_waitcnt lgkmcnt(12)
    v_mfma_f32_32x32x16_bf16 v[144:159], a[36:39], a[104:107], v[144:159]
    ds_read_b64_tr_b16 a[0:1], v12 offset:49152
    ds_read_b64_tr_b16 a[2:3], v12 offset:51200
    s_waitcnt lgkmcnt(12)
    v_mfma_f32_32x32x16_bf16 v[160:175], a[40:43], a[104:107], v[160:175]
    ds_read_b64_tr_b16 a[4:5], v13 offset:49152
    ds_read_b64_tr_b16 a[6:7], v13 offset:51200
    buffer_load_dwordx4 a[76:79], v2, s[8:11], s37 offen offset:3072 sc1
    s_add_u32 s37, s37, 4096
    s_waitcnt lgkmcnt(12)
    v_mfma_f32_32x32x16_bf16 v[176:191], a[44:47], a[104:107], v[176:191]
    ds_read_b64_tr_b16 a[8:9], v14 offset:49152
    ds_read_b64_tr_b16 a[10:11], v14 offset:51200
    s_add_u32 m0, s34, 4096
    s_add_u32 s35, s32, 32768
    buffer_load_dwordx4 v8, s[16:19], s35 offen offset:0 lds
    s_waitcnt lgkmcnt(12)
    v_mfma_f32_32x32x16_bf16 v[128:143], a[48:51], a[108:111], v[128:143]
    ds_read_b64_tr_b16 a[12:13], v15 offset:49152
    ds_read_b64_tr_b16 a[14:15], v15 offset:51200
    s_waitcnt lgkmcnt(12)
    v_mfma_f32_32x32x16_bf16 v[144:159], a[52:55], a[108:111], v[144:159]
    ds_read_b64_tr_b16 a[16:17], v12 offset:53248
    ds_read_b64_tr_b16 a[18:19], v12 offset:55296
    buffer_load_dwordx4 a[80:83], v2, s[8:11], s37 offen offset:0 sc1
    s_waitcnt lgkmcnt(12)
    v_mfma_f32_32x32x16_bf16 v[160:175], a[56:59], a[108:111], v[160:175]
    ds_read_b64_tr_b16 a[20:21], v13 offset:53248
    ds_read_b64_tr_b16 a[22:23], v13 offset:55296
    s_waitcnt lgkmcnt(12)
    v_mfma_f32_32x32x16_bf16 v[176:191], a[60:63], a[108:111], v[176:191]
    ds_read_b64_tr_b16 a[24:25], v14 offset:53248
    ds_read_b64_tr_b16 a[26:27], v14 offset:55296
    buffer_load_dwordx4 v9, s[16:19], s35 offen offset:1024 lds
    s_waitcnt lgkmcnt(12)
    v_mfma_f32_32x32x16_bf16 v[128:143], a[0:3], a[112:115], v[128:143]
    ds_read_b64_tr_b16 a[28:29], v15 offset:53248
    ds_read_b64_tr_b16 a[30:31], v15 offset:55296
    buffer_load_dwordx4 a[84:87], v2, s[8:11], s37 offen offset:1024 sc1
    s_waitcnt lgkmcnt(12)
    v_mfma_f32_32x32x16_bf16 v[144:159], a[4:7], a[112:115], v[144:159]
    ds_read_b64_tr_b16 a[32:33], v12 offset:57344
    ds_read_b64_tr_b16 a[34:35], v12 offset:59392
    s_waitcnt lgkmcnt(12)
    v_mfma_f32_32x32x16_bf16 v[160:175], a[8:11], a[112:115], v[160:175]
    ds_read_b64_tr_b16 a[36:37], v13 offset:57344
    ds_read_b64_tr_b16 a[38:39], v13 offset:59392
    buffer_load_dwordx4 v10, s[16:19], s35 offen offset:2048 lds
    s_waitcnt lgkmcnt(12)
    v_mfma_f32_32x32x16_bf16 v[176:191], a[12:15], a[112:115], v[176:191]
    ds_read_b64_tr_b16 a[40:41], v14 offset:57344
    ds_read_b64_tr_b16 a[42:43], v14 offset:59392
    buffer_load_dwordx4 a[88:91], v2, s[8:11], s37 offen offset:2048 sc1
    s_waitcnt lgkmcnt(12)
    v_mfma_f32_32x32x16_bf16 v[128:143], a[16:19], a[116:119], v[128:143]
    ds_read_b64_tr_b16 a[44:45], v15 offset:57344
    ds_read_b64_tr_b16 a[46:47], v15 offset:59392
    s_waitcnt lgkmcnt(12)
    v_mfma_f32_32x32x16_bf16 v[144:159], a[20:23], a[116:119], v[144:159]
    ds_read_b64_tr_b16 a[48:49], v12 offset:61440
    ds_read_b64_tr_b16 a[50:51], v12 offset:63488
    buffer_load_dwordx4 v11, s[16:19], s35 offen offset:3072 lds
    s_add_u32 s32, s32, 262144
    s_waitcnt lgkmcnt(12)
    v_mfma_f32_32x32x16_bf16 v[160:175], a[24:27], a[116:119], v[160:175]
    ds_read_b64_tr_b16 a[52:53], v13 offset:61440
    ds_read_b64_tr_b16 a[54:55], v13 offset:63488
    s_waitcnt lgkmcnt(12)
    v_mfma_f32_32x32x16_bf16 v[176:191], a[28:31], a[116:119], v[176:191]
    ds_read_b64_tr_b16 a[56:57], v14 offset:61440
    ds_read_b64_tr_b16 a[58:59], v14 offset:63488
    buffer_load_dwordx4 a[92:95], v2, s[8:11], s37 offen offset:3072 sc1
    s_add_u32 s37, s37, 4096
    s_waitcnt lgkmcnt(12)
    v_mfma_f32_32x32x16_bf16 v[128:143], a[32:35], a[120:123], v[128:143]
    ds_read_b64_tr_b16 a[60:61], v15 offset:61440
    ds_read_b64_tr_b16 a[62:63], v15 offset:63488
    s_waitcnt lgkmcnt(12)
    v_mfma_f32_32x32x16_bf16 v[144:159], a[36:39], a[120:123], v[144:159]
    s_waitcnt lgkmcnt(10)
    v_mfma_f32_32x32x16_bf16 v[160:175], a[40:43], a[120:123], v[160:175]
    s_waitcnt lgkmcnt(8)
    v_mfma_f32_32x32x16_bf16 v[176:191], a[44:47], a[120:123], v[176:191]
    s_waitcnt vmcnt(32) lgkmcnt(0)
    s_barrier
    ds_read_b64_tr_b16 a[0:1], v16 offset:0
    ds_read_b64_tr_b16 a[2:3], v16 offset:2048
    ds_read_b64_tr_b16 a[4:5], v17 offset:0
    ds_read_b64_tr_b16 a[6:7], v17 offset:2048
    ds_read_b64_tr_b16 a[8:9], v18 offset:0
    ds_read_b64_tr_b16 a[10:11], v18 offset:2048
    v_mfma_f32_32x32x16_bf16 v[128:143], a[48:51], a[124:127], v[128:143]
    ds_read_b64_tr_b16 a[12:13], v19 offset:0
    ds_read_b64_tr_b16 a[14:15], v19 offset:2048
    v_mfma_f32_32x32x16_bf16 v[144:159], a[52:55], a[124:127], v[144:159]
    ds_read_b64_tr_b16 a[16:17], v16 offset:4096
    ds_read_b64_tr_b16 a[18:19], v16 offset:6144
    v_mfma_f32_32x32x16_bf16 v[160:175], a[56:59], a[124:127], v[160:175]
    ds_read_b64_tr_b16 a[20:21], v17 offset:4096
    ds_read_b64_tr_b16 a[22:23], v17 offset:6144
    v_mfma_f32_32x32x16_bf16 v[176:191], a[60:63], a[124:127], v[176:191]
    ds_read_b64_tr_b16 a[24:25], v18 offset:4096
    ds_read_b64_tr_b16 a[26:27], v18 offset:6144
    s_add_u32 m0, s34, 32768
    s_add_u32 s35, s32, 0
    buffer_load_dwordx4 v8, s[16:19], s35 offen offset:0 lds
    s_waitcnt lgkmcnt(12)
    v_mfma_f32_32x32x16_bf16 v[128:143], a[0:3], a[128:131], v[128:143]
    ds_read_b64_tr_b16 a[28:29], v19 offset:4096
    ds_read_b64_tr_b16 a[30:31], v19 offset:6144
    buffer_load_dwordx4 a[96:99], v2, s[8:11], s37 offen offset:0 sc1
    s_waitcnt lgkmcnt(12)
    v_mfma_f32_32x32x16_bf16 v[144:159], a[4:7], a[128:131], v[144:159]
    ds_read_b64_tr_b16 a[32:33], v16 offset:8192
    ds_read_b64_tr_b16 a[34:35], v16 offset:10240
    s_waitcnt lgkmcnt(12)
    v_mfma_f32_32x32x16_bf16 v[160:175], a[8:11], a[128:131], v[160:175]
    ds_read_b64_tr_b16 a[36:37], v17 offset:8192
    ds_read_b64_tr_b16 a[38:39], v17 offset:10240
    buffer_load_dwordx4 v9, s[16:19], s35 offen offset:1024 lds
    s_waitcnt lgkmcnt(12)
    v_mfma_f32_32x32x16_bf16 v[176:191], a[12:15], a[128:131], v[176:191]
    ds_read_b64_tr_b16 a[40:41], v18 offset:8192
    ds_read_b64_tr_b16 a[42:43], v18 offset:10240
    buffer_load_dwordx4 a[100:103], v2, s[8:11], s37 offen offset:1024 sc1
    s_waitcnt lgkmcnt(12)
    v_mfma_f32_32x32x16_bf16 v[128:143], a[16:19], a[132:135], v[128:143]
    ds_read_b64_tr_b16 a[44:45], v19 offset:8192
    ds_read_b64_tr_b16 a[46:47], v19 offset:10240
    s_waitcnt lgkmcnt(12)
    v_mfma_f32_32x32x16_bf16 v[144:159], a[20:23], a[132:135], v[144:159]
    ds_read_b64_tr_b16 a[48:49], v16 offset:12288
    ds_read_b64_tr_b16 a[50:51], v16 offset:14336
    buffer_load_dwordx4 v10, s[16:19], s35 offen offset:2048 lds
    s_waitcnt lgkmcnt(12)
    v_mfma_f32_32x32x16_bf16 v[160:175], a[24:27], a[132:135], v[160:175]
    ds_read_b64_tr_b16 a[52:53], v17 offset:12288
    ds_read_b64_tr_b16 a[54:55], v17 offset:14336
    buffer_load_dwordx4 a[104:107], v2, s[8:11], s37 offen offset:2048 sc1
    s_waitcnt lgkmcnt(12)
    v_mfma_f32_32x32x16_bf16 v[176:191], a[28:31], a[132:135], v[176:191]
    ds_read_b64_tr_b16 a[56:57], v18 offset:12288
    ds_read_b64_tr_b16 a[58:59], v18 offset:14336
    s_waitcnt lgkmcnt(12)
    v_mfma_f32_32x32x16_bf16 v[128:143], a[32:35], a[136:139], v[128:143]
    ds_read_b64_tr_b16 a[60:61], v19 offset:12288
    ds_read_b64_tr_b16 a[62:63], v19 offset:14336
    buffer_load_dwordx4 v11, s[16:19], s35 offen offset:3072 lds
    s_waitcnt lgkmcnt(12)
    v_mfma_f32_32x32x16_bf16 v[144:159], a[36:39], a[136:139], v[144:159]
    ds_read_b64_tr_b16 a[0:1], v16 offset:16384
    ds_read_b64_tr_b16 a[2:3], v16 offset:18432
    buffer_load_dwordx4 a[108:111], v2, s[8:11], s37 offen offset:3072 sc1
    s_add_u32 s37, s37, 4096
    s_waitcnt lgkmcnt(12)
    v_mfma_f32_32x32x16_bf16 v[160:175], a[40:43], a[136:139], v[160:175]
    ds_read_b64_tr_b16 a[4:5], v17 offset:16384
    ds_read_b64_tr_b16 a[6:7], v17 offset:18432
    s_waitcnt lgkmcnt(12)
    v_mfma_f32_32x32x16_bf16 v[176:191], a[44:47], a[136:139], v[176:191]
    ds_read_b64_tr_b16 a[8:9], v18 offset:16384
    ds_read_b64_tr_b16 a[10:11], v18 offset:18432
    s_add_u32 m0, s34, 36864
    s_add_u32 s35, s32, 32768
    buffer_load_dwordx4 v8, s[16:19], s35 offen offset:0 lds
    s_waitcnt lgkmcnt(12)
    v_mfma_f32_32x32x16_bf16 v[128:143], a[48:51], a[140:143], v[128:143]
    ds_read_b64_tr_b16 a[12:13], v19 offset:16384
    ds_read_b64_tr_b16 a[14:15], v19 offset:18432
    buffer_load_dwordx4 a[112:115], v2, s[8:11], s37 offen offset:0 sc1
    s_waitcnt lgkmcnt(12)
    v_mfma_f32_32x32x16_bf16 v[144:159], a[52:55], a[140:143], v[144:159]
    ds_read_b64_tr_b16 a[16:17], v16 offset:20480
    ds_read_b64_tr_b16 a[18:19], v16 offset:22528
    s_waitcnt lgkmcnt(12)
    v_mfma_f32_32x32x16_bf16 v[160:175], a[56:59], a[140:143], v[160:175]
    ds_read_b64_tr_b16 a[20:21], v17 offset:20480
    ds_read_b64_tr_b16 a[22:23], v17 offset:22528
    buffer_load_dwordx4 v9, s[16:19], s35 offen offset:1024 lds
    s_waitcnt lgkmcnt(12)
    v_mfma_f32_32x32x16_bf16 v[176:191], a[60:63], a[140:143], v[176:191]
    ds_read_b64_tr_b16 a[24:25], v18 offset:20480
    ds_read_b64_tr_b16 a[26:27], v18 offset:22528
    buffer_load_dwordx4 a[116:119], v2, s[8:11], s37 offen offset:1024 sc1
    s_waitcnt lgkmcnt(12)
    v_mfma_f32_32x32x16_bf16 v[128:143], a[0:3], a[144:147], v[128:143]
    ds_read_b64_tr_b16 a[28:29], v19 offset:20480
    ds_read_b64_tr_b16 a[30:31], v19 offset:22528
    s_waitcnt lgkmcnt(12)
    v_mfma_f32_32x32x16_bf16 v[144:159], a[4:7], a[144:147], v[144:159]
    ds_read_b64_tr_b16 a[32:33], v16 offset:24576
    ds_read_b64_tr_b16 a[34:35], v16 offset:26624
    buffer_load_dwordx4 v10, s[16:19], s35 offen offset:2048 lds
    s_waitcnt lgkmcnt(12)
    v_mfma_f32_32x32x16_bf16 v[160:175], a[8:11], a[144:147], v[160:175]
    ds_read_b64_tr_b16 a[36:37], v17 offset:24576
    ds_read_b64_tr_b16 a[38:39], v17 offset:26624
    buffer_load_dwordx4 a[120:123], v2, s[8:11], s37 offen offset:2048 sc1
    s_waitcnt lgkmcnt(12)
    v_mfma_f32_32x32x16_bf16 v[176:191], a[12:15], a[144:147], v[176:191]
    ds_read_b64_tr_b16 a[40:41], v18 offset:24576
    ds_read_b64_tr_b16 a[42:43], v18 offset:26624
    s_waitcnt lgkmcnt(12)
    v_mfma_f32_32x32x16_bf16 v[128:143], a[16:19], a[148:151], v[128:143]
    ds_read_b64_tr_b16 a[44:45], v19 offset:24576
    ds_read_b64_tr_b16 a[46:47], v19 offset:26624
    buffer_load_dwordx4 v11, s[16:19], s35 offen offset:3072 lds
    s_add_u32 s32, s32, 262144
    s_waitcnt lgkmcnt(12)
    v_mfma_f32_32x32x16_bf16 v[144:159], a[20:23], a[148:151], v[144:159]
    ds_read_b64_tr_b16 a[48:49], v16 offset:28672
    ds_read_b64_tr_b16 a[50:51], v16 offset:30720
    buffer_load_dwordx4 a[124:127], v2, s[8:11], s37 offen offset:3072 sc1
    s_add_u32 s37, s37, 4096
    s_waitcnt lgkmcnt(12)
    v_mfma_f32_32x32x16_bf16 v[160:175], a[24:27], a[148:151], v[160:175]
    ds_read_b64_tr_b16 a[52:53], v17 offset:28672
    ds_read_b64_tr_b16 a[54:55], v17 offset:30720
    s_waitcnt lgkmcnt(12)
    v_mfma_f32_32x32x16_bf16 v[176:191], a[28:31], a[148:151], v[176:191]
    ds_read_b64_tr_b16 a[56:57], v18 offset:28672
    ds_read_b64_tr_b16 a[58:59], v18 offset:30720
    v_mov_b32 v23, s61
    global_load_dword v23, v23, s[6:7] sc1
    s_waitcnt lgkmcnt(12)
    v_mfma_f32_32x32x16_bf16 v[128:143], a[32:35], a[152:155], v[128:143]
    ds_read_b64_tr_b16 a[60:61], v19 offset:28672
    ds_read_b64_tr_b16 a[62:63], v19 offset:30720
    s_waitcnt lgkmcnt(12)
    v_mfma_f32_32x32x16_bf16 v[144:159], a[36:39], a[152:155], v[144:159]
    s_waitcnt lgkmcnt(10)
    v_mfma_f32_32x32x16_bf16 v[160:175], a[40:43], a[152:155], v[160:175]
    s_waitcnt lgkmcnt(8)
    v_mfma_f32_32x32x16_bf16 v[176:191], a[44:47], a[152:155], v[176:191]
    s_waitcnt vmcnt(33) lgkmcnt(0)
    s_barrier
    ds_read_b64_tr_b16 a[0:1], v16 offset:32768
    ds_read_b64_tr_b16 a[2:3], v16 offset:34816
    ds_read_b64_tr_b16 a[4:5], v17 offset:32768
    ds_read_b64_tr_b16 a[6:7], v17 offset:34816
    ds_read_b64_tr_b16 a[8:9], v18 offset:32768
    ds_read_b64_tr_b16 a[10:11], v18 offset:34816
    v_mfma_f32_32x32x16_bf16 v[128:143], a[48:51], a[156:159], v[128:143]
    ds_read_b64_tr_b16 a[12:13], v19 offset:32768
    ds_read_b64_tr_b16 a[14:15], v19 offset:34816
    v_mfma_f32_32x32x16_bf16 v[144:159], a[52:55], a[156:159], v[144:159]
    ds_read_b64_tr_b16 a[16:17], v16 offset:36864
    ds_read_b64_tr_b16 a[18:19], v16 offset:38912
    v_mfma_f32_32x32x16_bf16 v[160:175], a[56:59], a[156:159], v[160:175]
    ds_read_b64_tr_b16 a[20:21], v17 offset:36864
    ds_read_b64_tr_b16 a[22:23], v17 offset:38912
    v_mfma_f32_32x32x16_bf16 v[176:191], a[60:63], a[156:159], v[176:191]
    ds_read_b64_tr_b16 a[24:25], v18 offset:36864
    ds_read_b64_tr_b16 a[26:27], v18 offset:38912
    s_add_u32 m0, s34, 65536
    s_add_u32 s35, s32, 0
    buffer_load_dwordx4 v8, s[16:19], s35 offen offset:0 lds
    s_waitcnt lgkmcnt(12)
    v_mfma_f32_32x32x16_bf16 v[128:143], a[0:3], a[224:227], v[128:143]
    ds_read_b64_tr_b16 a[28:29], v19 offset:36864
    ds_read_b64_tr_b16 a[30:31], v19 offset:38912
    buffer_load_dwordx4 a[128:131], v2, s[8:11], s37 offen offset:0 sc1
    s_waitcnt lgkmcnt(12)
    v_mfma_f32_32x32x16_bf16 v[144:159], a[4:7], a[224:227], v[144:159]
    ds_read_b64_tr_b16 a[32:33], v16 offset:40960
    ds_read_b64_tr_b16 a[34:35], v16 offset:43008
    s_waitcnt lgkmcnt(12)
    v_mfma_f32_32x32x16_bf16 v[160:175], a[8:11], a[224:227], v[160:175]
    ds_read_b64_tr_b16 a[36:37], v17 offset:40960
    ds_read_b64_tr_b16 a[38:39], v17 offset:43008
    buffer_load_dwordx4 v9, s[16:19], s35 offen offset:1024 lds
    s_waitcnt lgkmcnt(12)
    v_mfma_f32_32x32x16_bf16 v[176:191], a[12:15], a[224:227], v[176:191]
    ds_read_b64_tr_b16 a[40:41], v18 offset:40960
    ds_read_b64_tr_b16 a[42:43], v18 offset:43008
    buffer_load_dwordx4 a[132:135], v2, s[8:11], s37 offen offset:1024 sc1
    s_waitcnt lgkmcnt(12)
    v_mfma_f32_32x32x16_bf16 v[128:143], a[16:19], a[228:231], v[128:143]
    ds_read_b64_tr_b16 a[44:45], v19 offset:40960
    ds_read_b64_tr_b16 a[46:47], v19 offset:43008
    s_waitcnt lgkmcnt(12)
    v_mfma_f32_32x32x16_bf16 v[144:159], a[20:23], a[228:231], v[144:159]
    ds_read_b64_tr_b16 a[48:49], v16 offset:45056
    ds_read_b64_tr_b16 a[50:51], v16 offset:47104
    buffer_load_dwordx4 v10, s[16:19], s35 offen offset:2048 lds
    s_waitcnt lgkmcnt(12)
    v_mfma_f32_32x32x16_bf16 v[160:175], a[24:27], a[228:231], v[160:175]
    ds_read_b64_tr_b16 a[52:53], v17 offset:45056
    ds_read_b64_tr_b16 a[54:55], v17 offset:47104
    s_waitcnt lgkmcnt(12)
    v_mfma_f32_32x32x16_bf16 v[176:191], a[28:31], a[228:231], v[176:191]
    ds_read_b64_tr_b16 a[56:57], v18 offset:45056
    ds_read_b64_tr_b16 a[58:59], v18 offset:47104
    buffer_load_dwordx4 a[136:139], v2, s[8:11], s37 offen offset:2048 sc1
    s_waitcnt lgkmcnt(12)
    v_mfma_f32_32x32x16_bf16 v[128:143], a[32:35], a[232:235], v[128:143]
    ds_read_b64_tr_b16 a[60:61], v19 offset:45056
    ds_read_b64_tr_b16 a[62:63], v19 offset:47104
    buffer_load_dwordx4 v11, s[16:19], s35 offen offset:3072 lds
    s_waitcnt lgkmcnt(12)
    v_mfma_f32_32x32x16_bf16 v[144:159], a[36:39], a[232:235], v[144:159]
    ds_read_b64_tr_b16 a[0:1], v16 offset:49152
    ds_read_b64_tr_b16 a[2:3], v16 offset:51200
    s_waitcnt lgkmcnt(12)
    v_mfma_f32_32x32x16_bf16 v[160:175], a[40:43], a[232:235], v[160:175]
    ds_read_b64_tr_b16 a[4:5], v17 offset:49152
    ds_read_b64_tr_b16 a[6:7], v17 offset:51200
    buffer_load_dwordx4 a[140:143], v2, s[8:11], s37 offen offset:3072 sc1
    s_add_u32 s37, s37, 4096
    s_waitcnt lgkmcnt(12)
    v_mfma_f32_32x32x16_bf16 v[176:191], a[44:47], a[232:235], v[176:191]
    ds_read_b64_tr_b16 a[8:9], v18 offset:49152
    ds_read_b64_tr_b16 a[10:11], v18 offset:51200
    s_add_u32 m0, s34, 69632
    s_add_u32 s35, s32, 32768
    buffer_load_dwordx4 v8, s[16:19], s35 offen offset:0 lds
    s_waitcnt lgkmcnt(12)
    v_mfma_f32_32x32x16_bf16 v[128:143], a[48:51], a[236:239], v[128:143]
    ds_read_b64_tr_b16 a[12:13], v19 offset:49152
    ds_read_b64_tr_b16 a[14:15], v19 offset:51200
    s_waitcnt lgkmcnt(12)
    v_mfma_f32_32x32x16_bf16 v[144:159], a[52:55], a[236:239], v[144:159]
    ds_read_b64_tr_b16 a[16:17], v16 offset:53248
    ds_read_b64_tr_b16 a[18:19], v16 offset:55296
    buffer_load_dwordx4 a[144:147], v2, s[8:11], s37 offen offset:0 sc1
    s_waitcnt lgkmcnt(12)
    v_mfma_f32_32x32x16_bf16 v[160:175], a[56:59], a[236:239], v[160:175]
    ds_read_b64_tr_b16 a[20:21], v17 offset:53248
    ds_read_b64_tr_b16 a[22:23], v17 offset:55296
    s_waitcnt lgkmcnt(12)
    v_mfma_f32_32x32x16_bf16 v[176:191], a[60:63], a[236:239], v[176:191]
    ds_read_b64_tr_b16 a[24:25], v18 offset:53248
    ds_read_b64_tr_b16 a[26:27], v18 offset:55296
    buffer_load_dwordx4 v9, s[16:19], s35 offen offset:1024 lds
    s_waitcnt lgkmcnt(12)
    v_mfma_f32_32x32x16_bf16 v[128:143], a[0:3], a[240:243], v[128:143]
    ds_read_b64_tr_b16 a[28:29], v19 offset:53248
    ds_read_b64_tr_b16 a[30:31], v19 offset:55296
    buffer_load_dwordx4 a[148:151], v2, s[8:11], s37 offen offset:1024 sc1
    s_waitcnt lgkmcnt(12)
    v_mfma_f32_32x32x16_bf16 v[144:159], a[4:7], a[240:243], v[144:159]
    ds_read_b64_tr_b16 a[32:33], v16 offset:57344
    ds_read_b64_tr_b16 a[34:35], v16 offset:59392
    s_waitcnt lgkmcnt(12)
    v_mfma_f32_32x32x16_bf16 v[160:175], a[8:11], a[240:243], v[160:175]
    ds_read_b64_tr_b16 a[36:37], v17 offset:57344
    ds_read_b64_tr_b16 a[38:39], v17 offset:59392
    buffer_load_dwordx4 v10, s[16:19], s35 offen offset:2048 lds
    s_waitcnt lgkmcnt(12)
    v_mfma_f32_32x32x16_bf16 v[176:191], a[12:15], a[240:243], v[176:191]
    ds_read_b64_tr_b16 a[40:41], v18 offset:57344
    ds_read_b64_tr_b16 a[42:43], v18 offset:59392
    buffer_load_dwordx4 a[152:155], v2, s[8:11], s37 offen offset:2048 sc1
    s_waitcnt lgkmcnt(12)
    v_mfma_f32_32x32x16_bf16 v[128:143], a[16:19], a[244:247], v[128:143]
    ds_read_b64_tr_b16 a[44:45], v19 offset:57344
    ds_read_b64_tr_b16 a[46:47], v19 offset:59392
    s_waitcnt lgkmcnt(12)
    v_mfma_f32_32x32x16_bf16 v[144:159], a[20:23], a[244:247], v[144:159]
    ds_read_b64_tr_b16 a[48:49], v16 offset:61440
    ds_read_b64_tr_b16 a[50:51], v16 offset:63488
    buffer_load_dwordx4 v11, s[16:19], s35 offen offset:3072 lds
    s_add_u32 s32, s32, 262144
    s_waitcnt lgkmcnt(12)
    v_mfma_f32_32x32x16_bf16 v[160:175], a[24:27], a[244:247], v[160:175]
    ds_read_b64_tr_b16 a[52:53], v17 offset:61440
    ds_read_b64_tr_b16 a[54:55], v17 offset:63488
    s_waitcnt lgkmcnt(12)
    v_mfma_f32_32x32x16_bf16 v[176:191], a[28:31], a[244:247], v[176:191]
    ds_read_b64_tr_b16 a[56:57], v18 offset:61440
    ds_read_b64_tr_b16 a[58:59], v18 offset:63488
    buffer_load_dwordx4 a[156:159], v2, s[8:11], s37 offen offset:3072 sc1
    s_add_u32 s37, s37, 4096
    s_waitcnt lgkmcnt(12)
    v_mfma_f32_32x32x16_bf16 v[128:143], a[32:35], a[248:251], v[128:143]
    ds_read_b64_tr_b16 a[60:61], v19 offset:61440
    ds_read_b64_tr_b16 a[62:63], v19 offset:63488
    s_waitcnt lgkmcnt(12)
    v_mfma_f32_32x32x16_bf16 v[144:159], a[36:39], a[248:251], v[144:159]
    s_waitcnt lgkmcnt(10)
    v_mfma_f32_32x32x16_bf16 v[160:175], a[40:43], a[248:251], v[160:175]
    s_waitcnt lgkmcnt(8)
    v_mfma_f32_32x32x16_bf16 v[176:191], a[44:47], a[248:251], v[176:191]
    s_waitcnt vmcnt(33) lgkmcnt(0)
    s_barrier
    ds_read_b64_tr_b16 a[0:1], v12 offset:0
    ds_read_b64_tr_b16 a[2:3], v12 offset:2048
    ds_read_b64_tr_b16 a[4:5], v13 offset:0
    ds_read_b64_tr_b16 a[6:7], v13 offset:2048
    ds_read_b64_tr_b16 a[8:9], v14 offset:0
    ds_read_b64_tr_b16 a[10:11], v14 offset:2048
    v_mfma_f32_32x32x16_bf16 v[128:143], a[48:51], a[252:255], v[128:143]
    ds_read_b64_tr_b16 a[12:13], v15 offset:0
    ds_read_b64_tr_b16 a[14:15], v15 offset:2048
    v_mfma_f32_32x32x16_bf16 v[144:159], a[52:55], a[252:255], v[144:159]
    ds_read_b64_tr_b16 a[16:17], v12 offset:4096
    ds_read_b64_tr_b16 a[18:19], v12 offset:6144
    v_mfma_f32_32x32x16_bf16 v[160:175], a[56:59], a[252:255], v[160:175]
    ds_read_b64_tr_b16 a[20:21], v13 offset:4096
    ds_read_b64_tr_b16 a[22:23], v13 offset:6144
    v_mfma_f32_32x32x16_bf16 v[176:191], a[60:63], a[252:255], v[176:191]
    ds_read_b64_tr_b16 a[24:25], v14 offset:4096
    ds_read_b64_tr_b16 a[26:27], v14 offset:6144
    s_add_u32 m0, s34, 98304
    s_add_u32 s35, s32, 0
    buffer_load_dwordx4 v8, s[16:19], s35 offen offset:0 lds
    s_waitcnt lgkmcnt(12)
    v_mfma_f32_32x32x16_bf16 v[128:143], a[0:3], a[64:67], v[128:143]
    ds_read_b64_tr_b16 a[28:29], v15 offset:4096
    ds_read_b64_tr_b16 a[30:31], v15 offset:6144
    buffer_load_dwordx4 a[224:227], v2, s[8:11], s37 offen offset:0 sc1
    s_waitcnt lgkmcnt(12)
    v_mfma_f32_32x32x16_bf16 v[144:159], a[4:7], a[64:67], v[144:159]
    ds_read_b64_tr_b16 a[32:33], v12 offset:8192
    ds_read_b64_tr_b16 a[34:35], v12 offset:10240
    s_waitcnt lgkmcnt(12)
    v_mfma_f32_32x32x16_bf16 v[160:175], a[8:11], a[64:67], v[160:175]
    ds_read_b64_tr_b16 a[36:37], v13 offset:8192
    ds_read_b64_tr_b16 a[38:39], v13 offset:10240
    buffer_load_dwordx4 v9, s[16:19], s35 offen offset:1024 lds
    s_waitcnt lgkmcnt(12)
    v_mfma_f32_32x32x16_bf16 v[176:191], a[12:15], a[64:67], v[176:191]
    ds_read_b64_tr_b16 a[40:41], v14 offset:8192
    ds_read_b64_tr_b16 a[42:43], v14 offset:10240
    buffer_load_dwordx4 a[228:231], v2, s[8:11], s37 offen offset:1024 sc1
    s_waitcnt lgkmcnt(12)
    v_mfma_f32_32x32x16_bf16 v[128:143], a[16:19], a[68:71], v[128:143]
    ds_read_b64_tr_b16 a[44:45], v15 offset:8192
    ds_read_b64_tr_b16 a[46:47], v15 offset:10240
    s_waitcnt lgkmcnt(12)
    v_mfma_f32_32x32x16_bf16 v[144:159], a[20:23], a[68:71], v[144:159]
    ds_read_b64_tr_b16 a[48:49], v12 offset:12288
    ds_read_b64_tr_b16 a[50:51], v12 offset:14336
    buffer_load_dwordx4 v10, s[16:19], s35 offen offset:2048 lds
    s_waitcnt lgkmcnt(12)
    v_mfma_f32_32x32x16_bf16 v[160:175], a[24:27], a[68:71], v[160:175]
    ds_read_b64_tr_b16 a[52:53], v13 offset:12288
    ds_read_b64_tr_b16 a[54:55], v13 offset:14336
    s_waitcnt lgkmcnt(12)
    v_mfma_f32_32x32x16_bf16 v[176:191], a[28:31], a[68:71], v[176:191]
    ds_read_b64_tr_b16 a[56:57], v14 offset:12288
    ds_read_b64_tr_b16 a[58:59], v14 offset:14336
    buffer_load_dwordx4 a[232:235], v2, s[8:11], s37 offen offset:2048 sc1
    s_waitcnt lgkmcnt(12)
    v_mfma_f32_32x32x16_bf16 v[128:143], a[32:35], a[72:75], v[128:143]
    ds_read_b64_tr_b16 a[60:61], v15 offset:12288
    ds_read_b64_tr_b16 a[62:63], v15 offset:14336
    buffer_load_dwordx4 v11, s[16:19], s35 offen offset:3072 lds
    s_waitcnt lgkmcnt(12)
    v_mfma_f32_32x32x16_bf16 v[144:159], a[36:39], a[72:75], v[144:159]
    ds_read_b64_tr_b16 a[0:1], v12 offset:16384
    ds_read_b64_tr_b16 a[2:3], v12 offset:18432
    s_waitcnt lgkmcnt(12)
    v_mfma_f32_32x32x16_bf16 v[160:175], a[40:43], a[72:75], v[160:175]
    ds_read_b64_tr_b16 a[4:5], v13 offset:16384
    ds_read_b64_tr_b16 a[6:7], v13 offset:18432
    buffer_load_dwordx4 a[236:239], v2, s[8:11], s37 offen offset:3072 sc1
    s_add_u32 s37, s37, 4096
    s_waitcnt lgkmcnt(12)
    v_mfma_f32_32x32x16_bf16 v[176:191], a[44:47], a[72:75], v[176:191]
    ds_read_b64_tr_b16 a[8:9], v14 offset:16384
    ds_read_b64_tr_b16 a[10:11], v14 offset:18432
    s_add_u32 m0, s34, 102400
    s_add_u32 s35, s32, 32768
    buffer_load_dwordx4 v8, s[16:19], s35 offen offset:0 lds
    s_waitcnt lgkmcnt(12)
    v_mfma_f32_32x32x16_bf16 v[128:143], a[48:51], a[76:79], v[128:143]
    ds_read_b64_tr_b16 a[12:13], v15 offset:16384
    ds_read_b64_tr_b16 a[14:15], v15 offset:18432
    s_waitcnt lgkmcnt(12)
    v_mfma_f32_32x32x16_bf16 v[144:159], a[52:55], a[76:79], v[144:159]
    ds_read_b64_tr_b16 a[16:17], v12 offset:20480
    ds_read_b64_tr_b16 a[18:19], v12 offset:22528
    buffer_load_dwordx4 a[240:243], v2, s[8:11], s37 offen offset:0 sc1
    s_waitcnt lgkmcnt(12)
    v_mfma_f32_32x32x16_bf16 v[160:175], a[56:59], a[76:79], v[160:175]
    ds_read_b64_tr_b16 a[20:21], v13 offset:20480
    ds_read_b64_tr_b16 a[22:23], v13 offset:22528
    s_waitcnt lgkmcnt(12)
    v_mfma_f32_32x32x16_bf16 v[176:191], a[60:63], a[76:79], v[176:191]
    ds_read_b64_tr_b16 a[24:25], v14 offset:20480
    ds_read_b64_tr_b16 a[26:27], v14 offset:22528
    buffer_load_dwordx4 v9, s[16:19], s35 offen offset:1024 lds
    s_waitcnt lgkmcnt(12)
    v_mfma_f32_32x32x16_bf16 v[128:143], a[0:3], a[80:83], v[128:143]
    ds_read_b64_tr_b16 a[28:29], v15 offset:20480
    ds_read_b64_tr_b16 a[30:31], v15 offset:22528
    buffer_load_dwordx4 a[244:247], v2, s[8:11], s37 offen offset:1024 sc1
    s_waitcnt lgkmcnt(12)
    v_mfma_f32_32x32x16_bf16 v[144:159], a[4:7], a[80:83], v[144:159]
    ds_read_b64_tr_b16 a[32:33], v12 offset:24576
    ds_read_b64_tr_b16 a[34:35], v12 offset:26624
    s_waitcnt lgkmcnt(12)
    v_mfma_f32_32x32x16_bf16 v[160:175], a[8:11], a[80:83], v[160:175]
    ds_read_b64_tr_b16 a[36:37], v13 offset:24576
    ds_read_b64_tr_b16 a[38:39], v13 offset:26624
    buffer_load_dwordx4 v10, s[16:19], s35 offen offset:2048 lds
    s_waitcnt lgkmcnt(12)
    v_mfma_f32_32x32x16_bf16 v[176:191], a[12:15], a[80:83], v[176:191]
    ds_read_b64_tr_b16 a[40:41], v14 offset:24576
    ds_read_b64_tr_b16 a[42:43], v14 offset:26624
    buffer_load_dwordx4 a[248:251], v2, s[8:11], s37 offen offset:2048 sc1
    s_waitcnt lgkmcnt(12)
    v_mfma_f32_32x32x16_bf16 v[128:143], a[16:19], a[84:87], v[128:143]
    ds_read_b64_tr_b16 a[44:45], v15 offset:24576
    ds_read_b64_tr_b16 a[46:47], v15 offset:26624
    s_waitcnt lgkmcnt(12)
    v_mfma_f32_32x32x16_bf16 v[144:159], a[20:23], a[84:87], v[144:159]
    ds_read_b64_tr_b16 a[48:49], v12 offset:28672
    ds_read_b64_tr_b16 a[50:51], v12 offset:30720
    buffer_load_dwordx4 v11, s[16:19], s35 offen offset:3072 lds
    s_mov_b32 s32, 0
    s_waitcnt lgkmcnt(12)
    v_mfma_f32_32x32x16_bf16 v[160:175], a[24:27], a[84:87], v[160:175]
    ds_read_b64_tr_b16 a[52:53], v13 offset:28672
    ds_read_b64_tr_b16 a[54:55], v13 offset:30720
    s_waitcnt lgkmcnt(12)
    v_mfma_f32_32x32x16_bf16 v[176:191], a[28:31], a[84:87], v[176:191]
    ds_read_b64_tr_b16 a[56:57], v14 offset:28672
    ds_read_b64_tr_b16 a[58:59], v14 offset:30720
    buffer_load_dwordx4 a[252:255], v2, s[8:11], s37 offen offset:3072 sc1
    s_add_u32 s37, s37, 4096
    s_mov_b32 s37, s38
    s_waitcnt lgkmcnt(12)
    v_mfma_f32_32x32x16_bf16 v[128:143], a[32:35], a[88:91], v[128:143]
    ds_read_b64_tr_b16 a[60:61], v15 offset:28672
    ds_read_b64_tr_b16 a[62:63], v15 offset:30720
    s_waitcnt lgkmcnt(12)
    v_mfma_f32_32x32x16_bf16 v[144:159], a[36:39], a[88:91], v[144:159]
    s_waitcnt lgkmcnt(10)
    v_mfma_f32_32x32x16_bf16 v[160:175], a[40:43], a[88:91], v[160:175]
    s_waitcnt lgkmcnt(8)
    v_mfma_f32_32x32x16_bf16 v[176:191], a[44:47], a[88:91], v[176:191]
    s_waitcnt vmcnt(32) lgkmcnt(0)
    v_readfirstlane_b32 s3, v23
    s_cmp_ge_u32 s3, s64
    s_cbranch_scc0 L_gow
L_gob:
    s_barrier
    ds_read_b64_tr_b16 a[0:1], v12 offset:32768
    ds_read_b64_tr_b16 a[2:3], v12 offset:34816
    ds_read_b64_tr_b16 a[4:5], v13 offset:32768
    ds_read_b64_tr_b16 a[6:7], v13 offset:34816
    ds_read_b64_tr_b16 a[8:9], v14 offset:32768
    ds_read_b64_tr_b16 a[10:11], v14 offset:34816
    v_mfma_f32_32x32x16_bf16 v[128:143], a[48:51], a[92:95], v[128:143]
    ds_read_b64_tr_b16 a[12:13], v15 offset:32768
    ds_read_b64_tr_b16 a[14:15], v15 offset:34816
    v_mfma_f32_32x32x16_bf16 v[144:159], a[52:55], a[92:95], v[144:159]
    ds_read_b64_tr_b16 a[16:17], v12 offset:36864
    ds_read_b64_tr_b16 a[18:19], v12 offset:38912
    v_mfma_f32_32x32x16_bf16 v[160:175], a[56:59], a[92:95], v[160:175]
    ds_read_b64_tr_b16 a[20:21], v13 offset:36864
    ds_read_b64_tr_b16 a[22:23], v13 offset:38912
    v_mfma_f32_32x32x16_bf16 v[176:191], a[60:63], a[92:95], v[176:191]
    ds_read_b64_tr_b16 a[24:25], v14 offset:36864
    ds_read_b64_tr_b16 a[26:27], v14 offset:38912
    s_add_u32 m0, s34, 0
    s_add_u32 s35, s32, 0
    buffer_load_dwordx4 v8, s[12:15], s35 offen offset:0 lds
    s_waitcnt lgkmcnt(12)
    v_mfma_f32_32x32x16_bf16 v[128:143], a[0:3], a[96:99], v[128:143]
    ds_read_b64_tr_b16 a[28:29], v15 offset:36864
    ds_read_b64_tr_b16 a[30:31], v15 offset:38912
    buffer_load_dwordx4 a[64:67], v2, s[8:11], s37 offen offset:0 sc1
    s_waitcnt lgkmcnt(12)
    v_mfma_f32_32x32x16_bf16 v[144:159], a[4:7], a[96:99], v[144:159]
    ds_read_b64_tr_b16 a[32:33], v12 offset:40960
    ds_read_b64_tr_b16 a[34:35], v12 offset:43008
    s_waitcnt lgkmcnt(12)
    v_mfma_f32_32x32x16_bf16 v[160:175], a[8:11], a[96:99], v[160:175]
    ds_read_b64_tr_b16 a[36:37], v13 offset:40960
    ds_read_b64_tr_b16 a[38:39], v13 offset:43008
    buffer_load_dwordx4 v9, s[12:15], s35 offen offset:1024 lds
    s_waitcnt lgkmcnt(12)
    v_mfma_f32_32x32x16_bf16 v[176:191], a[12:15], a[96:99], v[176:191]
    ds_read_b64_tr_b16 a[40:41], v14 offset:40960
    ds_read_b64_tr_b16 a[42:43], v14 offset:43008
    buffer_load_dwordx4 a[68:71], v2, s[8:11], s37 offen offset:1024 sc1
    s_waitcnt lgkmcnt(12)
    v_mfma_f32_32x32x16_bf16 v[128:143], a[16:19], a[100:103], v[128:143]
    ds_read_b64_tr_b16 a[44:45], v15 offset:40960
    ds_read_b64_tr_b16 a[46:47], v15 offset:43008
    s_waitcnt lgkmcnt(12)
    v_mfma_f32_32x32x16_bf16 v[144:159], a[20:23], a[100:103], v[144:159]
    ds_read_b64_tr_b16 a[48:49], v12 offset:45056
    ds_read_b64_tr_b16 a[50:51], v12 offset:47104
    buffer_load_dwordx4 v10, s[12:15], s35 offen offset:2048 lds
    s_waitcnt lgkmcnt(12)
    v_mfma_f32_32x32x16_bf16 v[160:175], a[24:27], a[100:103], v[160:175]
    ds_read_b64_tr_b16 a[52:53], v13 offset:45056
    ds_read_b64_tr_b16 a[54:55], v13 offset:47104
    s_waitcnt lgkmcnt(12)
    v_mfma_f32_32x32x16_bf16 v[176:191], a[28:31], a[100:103], v[176:191]
    ds_read_b64_tr_b16 a[56:57], v14 offset:45056
    ds_read_b64_tr_b16 a[58:59], v14 offset:47104
    buffer_load_dwordx4 a[72:75], v2, s[8:11], s37 offen offset:2048 sc1
    s_waitcnt lgkmcnt(12)
    v_mfma_f32_32x32x16_bf16 v[128:143], a[32:35], a[104:107], v[128:143]
    ds_read_b64_tr_b16 a[60:61], v15 offset:45056
    ds_read_b64_tr_b16 a[62:63], v15 offset:47104
    buffer_load_dwordx4 v11, s[12:15], s35 offen offset:3072 lds
    s_waitcnt lgkmcnt(12)
    v_mfma_f32_32x32x16_bf16 v[144:159], a[36:39], a[104:107], v[144:159]
    ds_read_b64_tr_b16 a[0:1], v12 offset:49152
    ds_read_b64_tr_b16 a[2:3], v12 offset:51200
    s_waitcnt lgkmcnt(12)
    v_mfma_f32_32x32x16_bf16 v[160:175], a[40:43], a[104:107], v[160:175]
    ds_read_b64_tr_b16 a[4:5], v13 offset:49152
    ds_read_b64_tr_b16 a[6:7], v13 offset:51200
    buffer_load_dwordx4 a[76:79], v2, s[8:11], s37 offen offset:3072 sc1
    s_add_u32 s37, s37, 4096
    s_waitcnt lgkmcnt(12)
    v_mfma_f32_32x32x16_bf16 v[176:191], a[44:47], a[104:107], v[176:191]
    ds_read_b64_tr_b16 a[8:9], v14 offset:49152
    ds_read_b64_tr_b16 a[10:11], v14 offset:51200
    s_add_u32 m0, s34, 4096
    s_add_u32 s35, s32, 32768
    buffer_load_dwordx4 v8, s[12:15], s35 offen offset:0 lds
    s_waitcnt lgkmcnt(12)
    v_mfma_f32_32x32x16_bf16 v[128:143], a[48:51], a[108:111], v[128:143]
    ds_read_b64_tr_b16 a[12:13], v15 offset:49152
    ds_read_b64_tr_b16 a[14:15], v15 offset:51200
    s_waitcnt lgkmcnt(12)
    v_mfma_f32_32x32x16_bf16 v[144:159], a[52:55], a[108:111], v[144:159]
    ds_read_b64_tr_b16 a[16:17], v12 offset:53248
    ds_read_b64_tr_b16 a[18:19], v12 offset:55296
    buffer_load_dwordx4 a[80:83], v2, s[8:11], s37 offen offset:0 sc1
    s_waitcnt lgkmcnt(12)
    v_mfma_f32_32x32x16_bf16 v[160:175], a[56:59], a[108:111], v[160:175]
    ds_read_b64_tr_b16 a[20:21], v13 offset:53248
    ds_read_b64_tr_b16 a[22:23], v13 offset:55296
    s_waitcnt lgkmcnt(12)
    v_mfma_f32_32x32x16_bf16 v[176:191], a[60:63], a[108:111], v[176:191]
    ds_read_b64_tr_b16 a[24:25], v14 offset:53248
    ds_read_b64_tr_b16 a[26:27], v14 offset:55296
    buffer_load_dwordx4 v9, s[12:15], s35 offen offset:1024 lds
    s_waitcnt lgkmcnt(12)
    v_mfma_f32_32x32x16_bf16 v[128:143], a[0:3], a[112:115], v[128:143]
    ds_read_b64_tr_b16 a[28:29], v15 offset:53248
    ds_read_b64_tr_b16 a[30:31], v15 offset:55296
    buffer_load_dwordx4 a[84:87], v2, s[8:11], s37 offen offset:1024 sc1
    s_waitcnt lgkmcnt(12)
    v_mfma_f32_32x32x16_bf16 v[144:159], a[4:7], a[112:115], v[144:159]
    ds_read_b64_tr_b16 a[32:33], v12 offset:57344
    ds_read_b64_tr_b16 a[34:35], v12 offset:59392
    s_waitcnt lgkmcnt(12)
    v_mfma_f32_32x32x16_bf16 v[160:175], a[8:11], a[112:115], v[160:175]
    ds_read_b64_tr_b16 a[36:37], v13 offset:57344
    ds_read_b64_tr_b16 a[38:39], v13 offset:59392
    buffer_load_dwordx4 v10, s[12:15], s35 offen offset:2048 lds
    s_waitcnt lgkmcnt(12)
    v_mfma_f32_32x32x16_bf16 v[176:191], a[12:15], a[112:115], v[176:191]
    ds_read_b64_tr_b16 a[40:41], v14 offset:57344
    ds_read_b64_tr_b16 a[42:43], v14 offset:59392
    buffer_load_dwordx4 a[88:91], v2, s[8:11], s37 offen offset:2048 sc1
    s_waitcnt lgkmcnt(12)
    v_mfma_f32_32x32x16_bf16 v[128:143], a[16:19], a[116:119], v[128:143]
    ds_read_b64_tr_b16 a[44:45], v15 offset:57344
    ds_read_b64_tr_b16 a[46:47], v15 offset:59392
    s_waitcnt lgkmcnt(12)
    v_mfma_f32_32x32x16_bf16 v[144:159], a[20:23], a[116:119], v[144:159]
    ds_read_b64_tr_b16 a[48:49], v12 offset:61440
    ds_read_b64_tr_b16 a[50:51], v12 offset:63488
    buffer_load_dwordx4 v11, s[12:15], s35 offen offset:3072 lds
    s_add_u32 s32, s32, 262144
    s_waitcnt lgkmcnt(12)
    v_mfma_f32_32x32x16_bf16 v[160:175], a[24:27], a[116:119], v[160:175]
    ds_read_b64_tr_b16 a[52:53], v13 offset:61440
    ds_read_b64_tr_b16 a[54:55], v13 offset:63488
    s_waitcnt lgkmcnt(12)
    v_mfma_f32_32x32x16_bf16 v[176:191], a[28:31], a[116:119], v[176:191]
    ds_read_b64_tr_b16 a[56:57], v14 offset:61440
    ds_read_b64_tr_b16 a[58:59], v14 offset:63488
    buffer_load_dwordx4 a[92:95], v2, s[8:11], s37 offen offset:3072 sc1
    s_add_u32 s37, s37, 4096
    s_waitcnt lgkmcnt(12)
    v_mfma_f32_32x32x16_bf16 v[128:143], a[32:35], a[120:123], v[128:143]
    ds_read_b64_tr_b16 a[60:61], v15 offset:61440
    ds_read_b64_tr_b16 a[62:63], v15 offset:63488
    s_waitcnt lgkmcnt(12)
    v_mfma_f32_32x32x16_bf16 v[144:159], a[36:39], a[120:123], v[144:159]
    s_waitcnt lgkmcnt(10)
    v_mfma_f32_32x32x16_bf16 v[160:175], a[40:43], a[120:123], v[160:175]
    s_waitcnt lgkmcnt(8)
    v_mfma_f32_32x32x16_bf16 v[176:191], a[44:47], a[120:123], v[176:191]
    s_waitcnt vmcnt(32) lgkmcnt(0)
    s_barrier
    ds_read_b64_tr_b16 a[0:1], v16 offset:0
    ds_read_b64_tr_b16 a[2:3], v16 offset:2048
    ds_read_b64_tr_b16 a[4:5], v17 offset:0
    ds_read_b64_tr_b16 a[6:7], v17 offset:2048
    ds_read_b64_tr_b16 a[8:9], v18 offset:0
    ds_read_b64_tr_b16 a[10:11], v18 offset:2048
    v_mfma_f32_32x32x16_bf16 v[128:143], a[48:51], a[124:127], v[128:143]
    ds_read_b64_tr_b16 a[12:13], v19 offset:0
    ds_read_b64_tr_b16 a[14:15], v19 offset:2048
    v_mfma_f32_32x32x16_bf16 v[144:159], a[52:55], a[124:127], v[144:159]
    ds_read_b64_tr_b16 a[16:17], v16 offset:4096
    ds_read_b64_tr_b16 a[18:19], v16 offset:6144
    v_mfma_f32_32x32x16_bf16 v[160:175], a[56:59], a[124:127], v[160:175]
    ds_read_b64_tr_b16 a[20:21], v17 offset:4096
    ds_read_b64_tr_b16 a[22:23], v17 offset:6144
    v_mfma_f32_32x32x16_bf16 v[176:191], a[60:63], a[124:127], v[176:191]
    ds_read_b64_tr_b16 a[24:25], v18 offset:4096
    ds_read_b64_tr_b16 a[26:27], v18 offset:6144
    s_add_u32 m0, s34, 32768
    s_add_u32 s35, s32, 0
    buffer_load_dwordx4 v8, s[12:15], s35 offen offset:0 lds
    s_waitcnt lgkmcnt(12)
    v_mfma_f32_32x32x16_bf16 v[128:143], a[0:3], a[128:131], v[128:143]
    ds_read_b64_tr_b16 a[28:29], v19 offset:4096
    ds_read_b64_tr_b16 a[30:31], v19 offset:6144
    buffer_load_dwordx4 a[96:99], v2, s[8:11], s37 offen offset:0 sc1
    s_waitcnt lgkmcnt(12)
    v_mfma_f32_32x32x16_bf16 v[144:159], a[4:7], a[128:131], v[144:159]
    ds_read_b64_tr_b16 a[32:33], v16 offset:8192
    ds_read_b64_tr_b16 a[34:35], v16 offset:10240
    s_waitcnt lgkmcnt(12)
    v_mfma_f32_32x32x16_bf16 v[160:175], a[8:11], a[128:131], v[160:175]
    ds_read_b64_tr_b16 a[36:37], v17 offset:8192
    ds_read_b64_tr_b16 a[38:39], v17 offset:10240
    buffer_load_dwordx4 v9, s[12:15], s35 offen offset:1024 lds
    s_waitcnt lgkmcnt(12)
    v_mfma_f32_32x32x16_bf16 v[176:191], a[12:15], a[128:131], v[176:191]
    ds_read_b64_tr_b16 a[40:41], v18 offset:8192
    ds_read_b64_tr_b16 a[42:43], v18 offset:10240
    buffer_load_dwordx4 a[100:103], v2, s[8:11], s37 offen offset:1024 sc1
    s_waitcnt lgkmcnt(12)
    v_mfma_f32_32x32x16_bf16 v[128:143], a[16:19], a[132:135], v[128:143]
    ds_read_b64_tr_b16 a[44:45], v19 offset:8192
    ds_read_b64_tr_b16 a[46:47], v19 offset:10240
    s_waitcnt lgkmcnt(12)
    v_mfma_f32_32x32x16_bf16 v[144:159], a[20:23], a[132:135], v[144:159]
    ds_read_b64_tr_b16 a[48:49], v16 offset:12288
    ds_read_b64_tr_b16 a[50:51], v16 offset:14336
    buffer_load_dwordx4 v10, s[12:15], s35 offen offset:2048 lds
    s_waitcnt lgkmcnt(12)
    v_mfma_f32_32x32x16_bf16 v[160:175], a[24:27], a[132:135], v[160:175]
    ds_read_b64_tr_b16 a[52:53], v17 offset:12288
    ds_read_b64_tr_b16 a[54:55], v17 offset:14336
    s_waitcnt lgkmcnt(12)
    v_mfma_f32_32x32x16_bf16 v[176:191], a[28:31], a[132:135], v[176:191]
    ds_read_b64_tr_b16 a[56:57], v18 offset:12288
    ds_read_b64_tr_b16 a[58:59], v18 offset:14336
    buffer_load_dwordx4 a[104:107], v2, s[8:11], s37 offen offset:2048 sc1
    s_waitcnt lgkmcnt(12)
    v_mfma_f32_32x32x16_bf16 v[128:143], a[32:35], a[136:139], v[128:143]
    ds_read_b64_tr_b16 a[60:61], v19 offset:12288
    ds_read_b64_tr_b16 a[62:63], v19 offset:14336
    buffer_load_dwordx4 v11, s[12:15], s35 offen offset:3072 lds
    s_waitcnt lgkmcnt(12)
    v_mfma_f32_32x32x16_bf16 v[144:159], a[36:39], a[136:139], v[144:159]
    ds_read_b64_tr_b16 a[0:1], v16 offset:16384
    ds_read_b64_tr_b16 a[2:3], v16 offset:18432
    s_waitcnt lgkmcnt(12)
    v_mfma_f32_32x32x16_bf16 v[160:175], a[40:43], a[136:139], v[160:175]
    ds_read_b64_tr_b16 a[4:5], v17 offset:16384
    ds_read_b64_tr_b16 a[6:7], v17 offset:18432
    buffer_load_dwordx4 a[108:111], v2, s[8:11], s37 offen offset:3072 sc1
    s_add_u32 s37, s37, 4096
    s_waitcnt lgkmcnt(12)
    v_mfma_f32_32x32x16_bf16 v[176:191], a[44:47], a[136:139], v[176:191]
    ds_read_b64_tr_b16 a[8:9], v18 offset:16384
    ds_read_b64_tr_b16 a[10:11], v18 offset:18432
    s_add_u32 m0, s34, 36864
    s_add_u32 s35, s32, 32768
    buffer_load_dwordx4 v8, s[12:15], s35 offen offset:0 lds
    s_waitcnt lgkmcnt(12)
    v_mfma_f32_32x32x16_bf16 v[128:143], a[48:51], a[140:143], v[128:143]
    ds_read_b64_tr_b16 a[12:13], v19 offset:16384
    ds_read_b64_tr_b16 a[14:15], v19 offset:18432
    s_waitcnt lgkmcnt(12)
    v_mfma_f32_32x32x16_bf16 v[144:159], a[52:55], a[140:143], v[144:159]
    ds_read_b64_tr_b16 a[16:17], v16 offset:20480
    ds_read_b64_tr_b16 a[18:19], v16 offset:22528
    buffer_load_dwordx4 a[112:115], v2, s[8:11], s37 offen offset:0 sc1
    s_waitcnt lgkmcnt(12)
    v_mfma_f32_32x32x16_bf16 v[160:175], a[56:59], a[140:143], v[160:175]
    ds_read_b64_tr_b16 a[20:21], v17 offset:20480
    ds_read_b64_tr_b16 a[22:23], v17 offset:22528
    s_waitcnt lgkmcnt(12)
    v_mfma_f32_32x32x16_bf16 v[176:191], a[60:63], a[140:143], v[176:191]
    ds_read_b64_tr_b16 a[24:25], v18 offset:20480
    ds_read_b64_tr_b16 a[26:27], v18 offset:22528
    buffer_load_dwordx4 v9, s[12:15], s35 offen offset:1024 lds
    s_waitcnt lgkmcnt(12)
    v_mfma_f32_32x32x16_bf16 v[128:143], a[0:3], a[144:147], v[128:143]
    ds_read_b64_tr_b16 a[28:29], v19 offset:20480
    ds_read_b64_tr_b16 a[30:31], v19 offset:22528
    buffer_load_dwordx4 a[116:119], v2, s[8:11], s37 offen offset:1024 sc1
    s_waitcnt lgkmcnt(12)
    v_mfma_f32_32x32x16_bf16 v[144:159], a[4:7], a[144:147], v[144:159]
    ds_read_b64_tr_b16 a[32:33], v16 offset:24576
    ds_read_b64_tr_b16 a[34:35], v16 offset:26624
    s_waitcnt lgkmcnt(12)
    v_mfma_f32_32x32x16_bf16 v[160:175], a[8:11], a[144:147], v[160:175]
    ds_read_b64_tr_b16 a[36:37], v17 offset:24576
    ds_read_b64_tr_b16 a[38:39], v17 offset:26624
    buffer_load_dwordx4 v10, s[12:15], s35 offen offset:2048 lds
    s_waitcnt lgkmcnt(12)
    v_mfma_f32_32x32x16_bf16 v[176:191], a[12:15], a[144:147], v[176:191]
    ds_read_b64_tr_b16 a[40:41], v18 offset:24576
    ds_read_b64_tr_b16 a[42:43], v18 offset:26624
    buffer_load_dwordx4 a[120:123], v2, s[8:11], s37 offen offset:2048 sc1
    s_waitcnt lgkmcnt(12)
    v_mfma_f32_32x32x16_bf16 v[128:143], a[16:19], a[148:151], v[128:143]
    ds_read_b64_tr_b16 a[44:45], v19 offset:24576
    ds_read_b64_tr_b16 a[46:47], v19 offset:26624
    s_waitcnt lgkmcnt(12)
    v_mfma_f32_32x32x16_bf16 v[144:159], a[20:23], a[148:151], v[144:159]
    ds_read_b64_tr_b16 a[48:49], v16 offset:28672
    ds_read_b64_tr_b16 a[50:51], v16 offset:30720
    buffer_load_dwordx4 v11, s[12:15], s35 offen offset:3072 lds
    s_add_u32 s32, s32, 262144
    s_waitcnt lgkmcnt(12)
    v_mfma_f32_32x32x16_bf16 v[160:175], a[24:27], a[148:151], v[160:175]
    ds_read_b64_tr_b16 a[52:53], v17 offset:28672
    ds_read_b64_tr_b16 a[54:55], v17 offset:30720
    s_waitcnt lgkmcnt(12)
    v_mfma_f32_32x32x16_bf16 v[176:191], a[28:31], a[148:151], v[176:191]
    ds_read_b64_tr_b16 a[56:57], v18 offset:28672
    ds_read_b64_tr_b16 a[58:59], v18 offset:30720
    buffer_load_dwordx4 a[124:127], v2, s[8:11], s37 offen offset:3072 sc1
    s_add_u32 s37, s37, 4096
    s_waitcnt lgkmcnt(12)
    v_mfma_f32_32x32x16_bf16 v[128:143], a[32:35], a[152:155], v[128:143]
    ds_read_b64_tr_b16 a[60:61], v19 offset:28672
    ds_read_b64_tr_b16 a[62:63], v19 offset:30720
    s_waitcnt lgkmcnt(12)
    v_mfma_f32_32x32x16_bf16 v[144:159], a[36:39], a[152:155], v[144:159]
    s_waitcnt lgkmcnt(10)
    v_mfma_f32_32x32x16_bf16 v[160:175], a[40:43], a[152:155], v[160:175]
    s_waitcnt lgkmcnt(8)
    v_mfma_f32_32x32x16_bf16 v[176:191], a[44:47], a[152:155], v[176:191]
    s_waitcnt vmcnt(32) lgkmcnt(0)
    s_barrier
    ds_read_b64_tr_b16 a[0:1], v16 offset:32768
    ds_read_b64_tr_b16 a[2:3], v16 offset:34816
    ds_read_b64_tr_b16 a[4:5], v17 offset:32768
    ds_read_b64_tr_b16 a[6:7], v17 offset:34816
    ds_read_b64_tr_b16 a[8:9], v18 offset:32768
    ds_read_b64_tr_b16 a[10:11], v18 offset:34816
    v_mfma_f32_32x32x16_bf16 v[128:143], a[48:51], a[156:159], v[128:143]
    ds_read_b64_tr_b16 a[12:13], v19 offset:32768
    ds_read_b64_tr_b16 a[14:15], v19 offset:34816
    v_mfma_f32_32x32x16_bf16 v[144:159], a[52:55], a[156:159], v[144:159]
    ds_read_b64_tr_b16 a[16:17], v16 offset:36864
    ds_read_b64_tr_b16 a[18:19], v16 offset:38912
    v_mfma_f32_32x32x16_bf16 v[160:175], a[56:59], a[156:159], v[160:175]
    ds_read_b64_tr_b16 a[20:21], v17 offset:36864
    ds_read_b64_tr_b16 a[22:23], v17 offset:38912
    v_mfma_f32_32x32x16_bf16 v[176:191], a[60:63], a[156:159], v[176:191]
    ds_read_b64_tr_b16 a[24:25], v18 offset:36864
    ds_read_b64_tr_b16 a[26:27], v18 offset:38912
    s_add_u32 m0, s34, 65536
    s_add_u32 s35, s32, 0
    buffer_load_dwordx4 v8, s[12:15], s35 offen offset:0 lds
    s_waitcnt lgkmcnt(12)
    v_mfma_f32_32x32x16_bf16 v[128:143], a[0:3], a[224:227], v[128:143]
    ds_read_b64_tr_b16 a[28:29], v19 offset:36864
    ds_read_b64_tr_b16 a[30:31], v19 offset:38912
    buffer_load_dwordx4 a[128:131], v2, s[8:11], s37 offen offset:0 sc1
    s_waitcnt lgkmcnt(12)
    v_mfma_f32_32x32x16_bf16 v[144:159], a[4:7], a[224:227], v[144:159]
    ds_read_b64_tr_b16 a[32:33], v16 offset:40960
    ds_read_b64_tr_b16 a[34:35], v16 offset:43008
    s_waitcnt lgkmcnt(12)
    v_mfma_f32_32x32x16_bf16 v[160:175], a[8:11], a[224:227], v[160:175]
    ds_read_b64_tr_b16 a[36:37], v17 offset:40960
    ds_read_b64_tr_b16 a[38:39], v17 offset:43008
    buffer_load_dwordx4 v9, s[12:15], s35 offen offset:1024 lds
    s_waitcnt lgkmcnt(12)
    v_mfma_f32_32x32x16_bf16 v[176:191], a[12:15], a[224:227], v[176:191]
    ds_read_b64_tr_b16 a[40:41], v18 offset:40960
    ds_read_b64_tr_b16 a[42:43], v18 offset:43008
    buffer_load_dwordx4 a[132:135], v2, s[8:11], s37 offen offset:1024 sc1
    s_waitcnt lgkmcnt(12)
    v_mfma_f32_32x32x16_bf16 v[128:143], a[16:19], a[228:231], v[128:143]
    ds_read_b64_tr_b16 a[44:45], v19 offset:40960
    ds_read_b64_tr_b16 a[46:47], v19 offset:43008
    s_waitcnt lgkmcnt(12)
    v_mfma_f32_32x32x16_bf16 v[144:159], a[20:23], a[228:231], v[144:159]
    ds_read_b64_tr_b16 a[48:49], v16 offset:45056
    ds_read_b64_tr_b16 a[50:51], v16 offset:47104
    buffer_load_dwordx4 v10, s[12:15], s35 offen offset:2048 lds
    s_waitcnt lgkmcnt(12)
    v_mfma_f32_32x32x16_bf16 v[160:175], a[24:27], a[228:231], v[160:175]
    ds_read_b64_tr_b16 a[52:53], v17 offset:45056
    ds_read_b64_tr_b16 a[54:55], v17 offset:47104
    s_waitcnt lgkmcnt(12)
    v_mfma_f32_32x32x16_bf16 v[176:191], a[28:31], a[228:231], v[176:191]
    ds_read_b64_tr_b16 a[56:57], v18 offset:45056
    ds_read_b64_tr_b16 a[58:59], v18 offset:47104
    buffer_load_dwordx4 a[136:139], v2, s[8:11], s37 offen offset:2048 sc1
    s_waitcnt lgkmcnt(12)
    v_mfma_f32_32x32x16_bf16 v[128:143], a[32:35], a[232:235], v[128:143]
    ds_read_b64_tr_b16 a[60:61], v19 offset:45056
    ds_read_b64_tr_b16 a[62:63], v19 offset:47104
    buffer_load_dwordx4 v11, s[12:15], s35 offen offset:3072 lds
    s_waitcnt lgkmcnt(12)
    v_mfma_f32_32x32x16_bf16 v[144:159], a[36:39], a[232:235], v[144:159]
    ds_read_b64_tr_b16 a[0:1], v16 offset:49152
    ds_read_b64_tr_b16 a[2:3], v16 offset:51200
    s_waitcnt lgkmcnt(12)
    v_mfma_f32_32x32x16_bf16 v[160:175], a[40:43], a[232:235], v[160:175]
    ds_read_b64_tr_b16 a[4:5], v17 offset:49152
    ds_read_b64_tr_b16 a[6:7], v17 offset:51200
    buffer_load_dwordx4 a[140:143], v2, s[8:11], s37 offen offset:3072 sc1
    s_add_u32 s37, s37, 4096
    s_waitcnt lgkmcnt(12)
    v_mfma_f32_32x32x16_bf16 v[176:191], a[44:47], a[232:235], v[176:191]
    ds_read_b64_tr_b16 a[8:9], v18 offset:49152
    ds_read_b64_tr_b16 a[10:11], v18 offset:51200
    s_add_u32 m0, s34, 69632
    s_add_u32 s35, s32, 32768
    buffer_load_dwordx4 v8, s[12:15], s35 offen offset:0 lds
    s_waitcnt lgkmcnt(12)
    v_mfma_f32_32x32x16_bf16 v[128:143], a[48:51], a[236:239], v[128:143]
    ds_read_b64_tr_b16 a[12:13], v19 offset:49152
    ds_read_b64_tr_b16 a[14:15], v19 offset:51200
    s_waitcnt lgkmcnt(12)
    v_mfma_f32_32x32x16_bf16 v[144:159], a[52:55], a[236:239], v[144:159]
    ds_read_b64_tr_b16 a[16:17], v16 offset:53248
    ds_read_b64_tr_b16 a[18:19], v16 offset:55296
    buffer_load_dwordx4 a[144:147], v2, s[8:11], s37 offen offset:0 sc1
    s_waitcnt lgkmcnt(12)
    v_mfma_f32_32x32x16_bf16 v[160:175], a[56:59], a[236:239], v[160:175]
    ds_read_b64_tr_b16 a[20:21], v17 offset:53248
    ds_read_b64_tr_b16 a[22:23], v17 offset:55296
    s_waitcnt lgkmcnt(12)
    v_mfma_f32_32x32x16_bf16 v[176:191], a[60:63], a[236:239], v[176:191]
    ds_read_b64_tr_b16 a[24:25], v18 offset:53248
    ds_read_b64_tr_b16 a[26:27], v18 offset:55296
    buffer_load_dwordx4 v9, s[12:15], s35 offen offset:1024 lds
    s_waitcnt lgkmcnt(12)
    v_mfma_f32_32x32x16_bf16 v[128:143], a[0:3], a[240:243], v[128:143]
    ds_read_b64_tr_b16 a[28:29], v19 offset:53248
    ds_read_b64_tr_b16 a[30:31], v19 offset:55296
    buffer_load_dwordx4 a[148:151], v2, s[8:11], s37 offen offset:1024 sc1
    s_waitcnt lgkmcnt(12)
    v_mfma_f32_32x32x16_bf16 v[144:159], a[4:7], a[240:243], v[144:159]
    ds_read_b64_tr_b16 a[32:33], v16 offset:57344
    ds_read_b64_tr_b16 a[34:35], v16 offset:59392
    s_waitcnt lgkmcnt(12)
    v_mfma_f32_32x32x16_bf16 v[160:175], a[8:11], a[240:243], v[160:175]
    ds_read_b64_tr_b16 a[36:37], v17 offset:57344
    ds_read_b64_tr_b16 a[38:39], v17 offset:59392
    buffer_load_dwordx4 v10, s[12:15], s35 offen offset:2048 lds
    s_waitcnt lgkmcnt(12)
    v_mfma_f32_32x32x16_bf16 v[176:191], a[12:15], a[240:243], v[176:191]
    ds_read_b64_tr_b16 a[40:41], v18 offset:57344
    ds_read_b64_tr_b16 a[42:43], v18 offset:59392
    buffer_load_dwordx4 a[152:155], v2, s[8:11], s37 offen offset:2048 sc1
    s_waitcnt lgkmcnt(12)
    v_mfma_f32_32x32x16_bf16 v[128:143], a[16:19], a[244:247], v[128:143]
    ds_read_b64_tr_b16 a[44:45], v19 offset:57344
    ds_read_b64_tr_b16 a[46:47], v19 offset:59392
    s_waitcnt lgkmcnt(12)
    v_mfma_f32_32x32x16_bf16 v[144:159], a[20:23], a[244:247], v[144:159]
    ds_read_b64_tr_b16 a[48:49], v16 offset:61440
    ds_read_b64_tr_b16 a[50:51], v16 offset:63488
    buffer_load_dwordx4 v11, s[12:15], s35 offen offset:3072 lds
    s_add_u32 s32, s32, 262144
    s_waitcnt lgkmcnt(12)
    v_mfma_f32_32x32x16_bf16 v[160:175], a[24:27], a[244:247], v[160:175]
    ds_read_b64_tr_b16 a[52:53], v17 offset:61440
    ds_read_b64_tr_b16 a[54:55], v17 offset:63488
    s_waitcnt lgkmcnt(12)
    v_mfma_f32_32x32x16_bf16 v[176:191], a[28:31], a[244:247], v[176:191]
    ds_read_b64_tr_b16 a[56:57], v18 offset:61440
    ds_read_b64_tr_b16 a[58:59], v18 offset:63488
    buffer_load_dwordx4 a[156:159], v2, s[8:11], s37 offen offset:3072 sc1
    s_add_u32 s37, s37, 4096
    s_waitcnt lgkmcnt(12)
    v_mfma_f32_32x32x16_bf16 v[128:143], a[32:35], a[248:251], v[128:143]
    ds_read_b64_tr_b16 a[60:61], v19 offset:61440
    ds_read_b64_tr_b16 a[62:63], v19 offset:63488
    s_waitcnt lgkmcnt(12)
    v_mfma_f32_32x32x16_bf16 v[144:159], a[36:39], a[248:251], v[144:159]
    s_waitcnt lgkmcnt(10)
    v_mfma_f32_32x32x16_bf16 v[160:175], a[40:43], a[248:251], v[160:175]
    s_waitcnt lgkmcnt(8)
    v_mfma_f32_32x32x16_bf16 v[176:191], a[44:47], a[248:251], v[176:191]
    s_waitcnt vmcnt(32) lgkmcnt(0)
    s_barrier
    ds_read_b64_tr_b16 a[0:1], v12 offset:0
    ds_read_b64_tr_b16 a[2:3], v12 offset:2048
    ds_read_b64_tr_b16 a[4:5], v13 offset:0
    ds_read_b64_tr_b16 a[6:7], v13 offset:2048
    ds_read_b64_tr_b16 a[8:9], v14 offset:0
    ds_read_b64_tr_b16 a[10:11], v14 offset:2048
    v_mfma_f32_32x32x16_bf16 v[128:143], a[48:51], a[252:255], v[128:143]
    ds_read_b64_tr_b16 a[12:13], v15 offset:0
    ds_read_b64_tr_b16 a[14:15], v15 offset:2048
    v_mfma_f32_32x32x16_bf16 v[144:159], a[52:55], a[252:255], v[144:159]
    ds_read_b64_tr_b16 a[16:17], v12 offset:4096
    ds_read_b64_tr_b16 a[18:19], v12 offset:6144
    v_mfma_f32_32x32x16_bf16 v[160:175], a[56:59], a[252:255], v[160:175]
    ds_read_b64_tr_b16 a[20:21], v13 offset:4096
    ds_read_b64_tr_b16 a[22:23], v13 offset:6144
    v_mfma_f32_32x32x16_bf16 v[176:191], a[60:63], a[252:255], v[176:191]
    ds_read_b64_tr_b16 a[24:25], v14 offset:4096
    ds_read_b64_tr_b16 a[26:27], v14 offset:6144
    s_add_u32 m0, s34, 98304
    s_add_u32 s35, s32, 0
    buffer_load_dwordx4 v8, s[12:15], s35 offen offset:0 lds
    s_waitcnt lgkmcnt(12)
    v_mfma_f32_32x32x16_bf16 v[128:143], a[0:3], a[64:67], v[128:143]
    ds_read_b64_tr_b16 a[28:29], v15 offset:4096
    ds_read_b64_tr_b16 a[30:31], v15 offset:6144
    buffer_load_dwordx4 a[224:227], v2, s[8:11], s37 offen offset:0 sc1
    s_waitcnt lgkmcnt(12)
    v_mfma_f32_32x32x16_bf16 v[144:159], a[4:7], a[64:67], v[144:159]
    ds_read_b64_tr_b16 a[32:33], v12 offset:8192
    ds_read_b64_tr_b16 a[34:35], v12 offset:10240
    s_waitcnt lgkmcnt(12)
    v_mfma_f32_32x32x16_bf16 v[160:175], a[8:11], a[64:67], v[160:175]
    ds_read_b64_tr_b16 a[36:37], v13 offset:8192
    ds_read_b64_tr_b16 a[38:39], v13 offset:10240
    buffer_load_dwordx4 v9, s[12:15], s35 offen offset:1024 lds
    s_waitcnt lgkmcnt(12)
    v_mfma_f32_32x32x16_bf16 v[176:191], a[12:15], a[64:67], v[176:191]
    ds_read_b64_tr_b16 a[40:41], v14 offset:8192
    ds_read_b64_tr_b16 a[42:43], v14 offset:10240
    buffer_load_dwordx4 a[228:231], v2, s[8:11], s37 offen offset:1024 sc1
    s_waitcnt lgkmcnt(12)
    v_mfma_f32_32x32x16_bf16 v[128:143], a[16:19], a[68:71], v[128:143]
    ds_read_b64_tr_b16 a[44:45], v15 offset:8192
    ds_read_b64_tr_b16 a[46:47], v15 offset:10240
    s_waitcnt lgkmcnt(12)
    v_mfma_f32_32x32x16_bf16 v[144:159], a[20:23], a[68:71], v[144:159]
    ds_read_b64_tr_b16 a[48:49], v12 offset:12288
    ds_read_b64_tr_b16 a[50:51], v12 offset:14336
    buffer_load_dwordx4 v10, s[12:15], s35 offen offset:2048 lds
    s_waitcnt lgkmcnt(12)
    v_mfma_f32_32x32x16_bf16 v[160:175], a[24:27], a[68:71], v[160:175]
    ds_read_b64_tr_b16 a[52:53], v13 offset:12288
    ds_read_b64_tr_b16 a[54:55], v13 offset:14336
    s_waitcnt lgkmcnt(12)
    v_mfma_f32_32x32x16_bf16 v[176:191], a[28:31], a[68:71], v[176:191]
    ds_read_b64_tr_b16 a[56:57], v14 offset:12288
    ds_read_b64_tr_b16 a[58:59], v14 offset:14336
    buffer_load_dwordx4 a[232:235], v2, s[8:11], s37 offen offset:2048 sc1
    s_waitcnt lgkmcnt(12)
    v_mfma_f32_32x32x16_bf16 v[128:143], a[32:35], a[72:75], v[128:143]
    ds_read_b64_tr_b16 a[60:61], v15 offset:12288
    ds_read_b64_tr_b16 a[62:63], v15 offset:14336
    buffer_load_dwordx4 v11, s[12:15], s35 offen offset:3072 lds
    s_waitcnt lgkmcnt(12)
    v_mfma_f32_32x32x16_bf16 v[144:159], a[36:39], a[72:75], v[144:159]
    ds_read_b64_tr_b16 a[0:1], v12 offset:16384
    ds_read_b64_tr_b16 a[2:3], v12 offset:18432
    s_waitcnt lgkmcnt(12)
    v_mfma_f32_32x32x16_bf16 v[160:175], a[40:43], a[72:75], v[160:175]
    ds_read_b64_tr_b16 a[4:5], v13 offset:16384
    ds_read_b64_tr_b16 a[6:7], v13 offset:18432
    buffer_load_dwordx4 a[236:239], v2, s[8:11], s37 offen offset:3072 sc1
    s_add_u32 s37, s37, 4096
    s_waitcnt lgkmcnt(12)
    v_mfma_f32_32x32x16_bf16 v[176:191], a[44:47], a[72:75], v[176:191]
    ds_read_b64_tr_b16 a[8:9], v14 offset:16384
    ds_read_b64_tr_b16 a[10:11], v14 offset:18432
    s_add_u32 m0, s34, 102400
    s_add_u32 s35, s32, 32768
    buffer_load_dwordx4 v8, s[12:15], s35 offen offset:0 lds
    s_waitcnt lgkmcnt(12)
    v_mfma_f32_32x32x16_bf16 v[128:143], a[48:51], a[76:79], v[128:143]
    ds_read_b64_tr_b16 a[12:13], v15 offset:16384
    ds_read_b64_tr_b16 a[14:15], v15 offset:18432
    s_waitcnt lgkmcnt(12)
    v_mfma_f32_32x32x16_bf16 v[144:159], a[52:55], a[76:79], v[144:159]
    ds_read_b64_tr_b16 a[16:17], v12 offset:20480
    ds_read_b64_tr_b16 a[18:19], v12 offset:22528
    buffer_load_dwordx4 a[240:243], v2, s[8:11], s37 offen offset:0 sc1
    s_waitcnt lgkmcnt(12)
    v_mfma_f32_32x32x16_bf16 v[160:175], a[56:59], a[76:79], v[160:175]
    ds_read_b64_tr_b16 a[20:21], v13 offset:20480
    ds_read_b64_tr_b16 a[22:23], v13 offset:22528
    s_waitcnt lgkmcnt(12)
    v_mfma_f32_32x32x16_bf16 v[176:191], a[60:63], a[76:79], v[176:191]
    ds_read_b64_tr_b16 a[24:25], v14 offset:20480
    ds_read_b64_tr_b16 a[26:27], v14 offset:22528
    buffer_load_dwordx4 v9, s[12:15], s35 offen offset:1024 lds
    s_waitcnt lgkmcnt(12)
    v_mfma_f32_32x32x16_bf16 v[128:143], a[0:3], a[80:83], v[128:143]
    ds_read_b64_tr_b16 a[28:29], v15 offset:20480
    ds_read_b64_tr_b16 a[30:31], v15 offset:22528
    buffer_load_dwordx4 a[244:247], v2, s[8:11], s37 offen offset:1024 sc1
    s_waitcnt lgkmcnt(12)
    v_mfma_f32_32x32x16_bf16 v[144:159], a[4:7], a[80:83], v[144:159]
    ds_read_b64_tr_b16 a[32:33], v12 offset:24576
    ds_read_b64_tr_b16 a[34:35], v12 offset:26624
    s_waitcnt lgkmcnt(12)
    v_mfma_f32_32x32x16_bf16 v[160:175], a[8:11], a[80:83], v[160:175]
    ds_read_b64_tr_b16 a[36:37], v13 offset:24576
    ds_read_b64_tr_b16 a[38:39], v13 offset:26624
    buffer_load_dwordx4 v10, s[12:15], s35 offen offset:2048 lds
    s_waitcnt lgkmcnt(12)
    v_mfma_f32_32x32x16_bf16 v[176:191], a[12:15], a[80:83], v[176:191]
    ds_read_b64_tr_b16 a[40:41], v14 offset:24576
    ds_read_b64_tr_b16 a[42:43], v14 offset:26624
    buffer_load_dwordx4 a[248:251], v2, s[8:11], s37 offen offset:2048 sc1
    s_waitcnt lgkmcnt(12)
    v_mfma_f32_32x32x16_bf16 v[128:143], a[16:19], a[84:87], v[128:143]
    ds_read_b64_tr_b16 a[44:45], v15 offset:24576
    ds_read_b64_tr_b16 a[46:47], v15 offset:26624
    s_waitcnt lgkmcnt(12)
    v_mfma_f32_32x32x16_bf16 v[144:159], a[20:23], a[84:87], v[144:159]
    ds_read_b64_tr_b16 a[48:49], v12 offset:28672
    ds_read_b64_tr_b16 a[50:51], v12 offset:30720
    buffer_load_dwordx4 v11, s[12:15], s35 offen offset:3072 lds
    s_add_u32 s32, s32, 262144
    s_waitcnt lgkmcnt(12)
    v_mfma_f32_32x32x16_bf16 v[160:175], a[24:27], a[84:87], v[160:175]
    ds_read_b64_tr_b16 a[52:53], v13 offset:28672
    ds_read_b64_tr_b16 a[54:55], v13 offset:30720
    s_waitcnt lgkmcnt(12)
    v_mfma_f32_32x32x16_bf16 v[176:191], a[28:31], a[84:87], v[176:191]
    ds_read_b64_tr_b16 a[56:57], v14 offset:28672
    ds_read_b64_tr_b16 a[58:59], v14 offset:30720
    buffer_load_dwordx4 a[252:255], v2, s[8:11], s37 offen offset:3072 sc1
    s_add_u32 s37, s37, 4096
    s_waitcnt lgkmcnt(12)
    v_mfma_f32_32x32x16_bf16 v[128:143], a[32:35], a[88:91], v[128:143]
    ds_read_b64_tr_b16 a[60:61], v15 offset:28672
    ds_read_b64_tr_b16 a[62:63], v15 offset:30720
    s_waitcnt lgkmcnt(12)
    v_mfma_f32_32x32x16_bf16 v[144:159], a[36:39], a[88:91], v[144:159]
    s_waitcnt lgkmcnt(10)
    v_mfma_f32_32x32x16_bf16 v[160:175], a[40:43], a[88:91], v[160:175]
    s_waitcnt lgkmcnt(8)
    v_mfma_f32_32x32x16_bf16 v[176:191], a[44:47], a[88:91], v[176:191]
    s_waitcnt vmcnt(32) lgkmcnt(0)
    s_barrier
    ds_read_b64_tr_b16 a[0:1], v12 offset:32768
    ds_read_b64_tr_b16 a[2:3], v12 offset:34816
    ds_read_b64_tr_b16 a[4:5], v13 offset:32768
    ds_read_b64_tr_b16 a[6:7], v13 offset:34816
    ds_read_b64_tr_b16 a[8:9], v14 offset:32768
    ds_read_b64_tr_b16 a[10:11], v14 offset:34816
    v_mfma_f32_32x32x16_bf16 v[128:143], a[48:51], a[92:95], v[128:143]
    ds_read_b64_tr_b16 a[12:13], v15 offset:32768
    ds_read_b64_tr_b16 a[14:15], v15 offset:34816
    v_mfma_f32_32x32x16_bf16 v[144:159], a[52:55], a[92:95], v[144:159]
    ds_read_b64_tr_b16 a[16:17], v12 offset:36864
    ds_read_b64_tr_b16 a[18:19], v12 offset:38912
    v_mfma_f32_32x32x16_bf16 v[160:175], a[56:59], a[92:95], v[160:175]
    ds_read_b64_tr_b16 a[20:21], v13 offset:36864
    ds_read_b64_tr_b16 a[22:23], v13 offset:38912
    v_mfma_f32_32x32x16_bf16 v[176:191], a[60:63], a[92:95], v[176:191]
    ds_read_b64_tr_b16 a[24:25], v14 offset:36864
    ds_read_b64_tr_b16 a[26:27], v14 offset:38912
    s_add_u32 m0, s34, 0
    s_add_u32 s35, s32, 0
    buffer_load_dwordx4 v8, s[12:15], s35 offen offset:0 lds
    s_waitcnt lgkmcnt(12)
    v_mfma_f32_32x32x16_bf16 v[128:143], a[0:3], a[96:99], v[128:143]
    ds_read_b64_tr_b16 a[28:29], v15 offset:36864
    ds_read_b64_tr_b16 a[30:31], v15 offset:38912
    buffer_load_dwordx4 a[64:67], v2, s[8:11], s37 offen offset:0 sc1
    s_waitcnt lgkmcnt(12)
    v_mfma_f32_32x32x16_bf16 v[144:159], a[4:7], a[96:99], v[144:159]
    ds_read_b64_tr_b16 a[32:33], v12 offset:40960
    ds_read_b64_tr_b16 a[34:35], v12 offset:43008
    s_waitcnt lgkmcnt(12)
    v_mfma_f32_32x32x16_bf16 v[160:175], a[8:11], a[96:99], v[160:175]
    ds_read_b64_tr_b16 a[36:37], v13 offset:40960
    ds_read_b64_tr_b16 a[38:39], v13 offset:43008
    buffer_load_dwordx4 v9, s[12:15], s35 offen offset:1024 lds
    s_waitcnt lgkmcnt(12)
    v_mfma_f32_32x32x16_bf16 v[176:191], a[12:15], a[96:99], v[176:191]
    ds_read_b64_tr_b16 a[40:41], v14 offset:40960
    ds_read_b64_tr_b16 a[42:43], v14 offset:43008
    buffer_load_dwordx4 a[68:71], v2, s[8:11], s37 offen offset:1024 sc1
    s_waitcnt lgkmcnt(12)
    v_mfma_f32_32x32x16_bf16 v[128:143], a[16:19], a[100:103], v[128:143]
    ds_read_b64_tr_b16 a[44:45], v15 offset:40960
    ds_read_b64_tr_b16 a[46:47], v15 offset:43008
    s_waitcnt lgkmcnt(12)
    v_mfma_f32_32x32x16_bf16 v[144:159], a[20:23], a[100:103], v[144:159]
    ds_read_b64_tr_b16 a[48:49], v12 offset:45056
    ds_read_b64_tr_b16 a[50:51], v12 offset:47104
    buffer_load_dwordx4 v10, s[12:15], s35 offen offset:2048 lds
    s_waitcnt lgkmcnt(12)
    v_mfma_f32_32x32x16_bf16 v[160:175], a[24:27], a[100:103], v[160:175]
    ds_read_b64_tr_b16 a[52:53], v13 offset:45056
    ds_read_b64_tr_b16 a[54:55], v13 offset:47104
    s_waitcnt lgkmcnt(12)
    v_mfma_f32_32x32x16_bf16 v[176:191], a[28:31], a[100:103], v[176:191]
    ds_read_b64_tr_b16 a[56:57], v14 offset:45056
    ds_read_b64_tr_b16 a[58:59], v14 offset:47104
    buffer_load_dwordx4 a[72:75], v2, s[8:11], s37 offen offset:2048 sc1
    s_waitcnt lgkmcnt(12)
    v_mfma_f32_32x32x16_bf16 v[128:143], a[32:35], a[104:107], v[128:143]
    ds_read_b64_tr_b16 a[60:61], v15 offset:45056
    ds_read_b64_tr_b16 a[62:63], v15 offset:47104
    buffer_load_dwordx4 v11, s[12:15], s35 offen offset:3072 lds
    s_waitcnt lgkmcnt(12)
    v_mfma_f32_32x32x16_bf16 v[144:159], a[36:39], a[104:107], v[144:159]
    ds_read_b64_tr_b16 a[0:1], v12 offset:49152
    ds_read_b64_tr_b16 a[2:3], v12 offset:51200
    s_waitcnt lgkmcnt(12)
    v_mfma_f32_32x32x16_bf16 v[160:175], a[40:43], a[104:107], v[160:175]
    ds_read_b64_tr_b16 a[4:5], v13 offset:49152
    ds_read_b64_tr_b16 a[6:7], v13 offset:51200
    buffer_load_dwordx4 a[76:79], v2, s[8:11], s37 offen offset:3072 sc1
    s_add_u32 s37, s37, 4096
    s_waitcnt lgkmcnt(12)
    v_mfma_f32_32x32x16_bf16 v[176:191], a[44:47], a[104:107], v[176:191]
    ds_read_b64_tr_b16 a[8:9], v14 offset:49152
    ds_read_b64_tr_b16 a[10:11], v14 offset:51200
    s_add_u32 m0, s34, 4096
    s_add_u32 s35, s32, 32768
    buffer_load_dwordx4 v8, s[12:15], s35 offen offset:0 lds
    s_waitcnt lgkmcnt(12)
    v_mfma_f32_32x32x16_bf16 v[128:143], a[48:51], a[108:111], v[128:143]
    ds_read_b64_tr_b16 a[12:13], v15 offset:49152
    ds_read_b64_tr_b16 a[14:15], v15 offset:51200
    s_waitcnt lgkmcnt(12)
    v_mfma_f32_32x32x16_bf16 v[144:159], a[52:55], a[108:111], v[144:159]
    ds_read_b64_tr_b16 a[16:17], v12 offset:53248
    ds_read_b64_tr_b16 a[18:19], v12 offset:55296
    buffer_load_dwordx4 a[80:83], v2, s[8:11], s37 offen offset:0 sc1
    s_waitcnt lgkmcnt(12)
    v_mfma_f32_32x32x16_bf16 v[160:175], a[56:59], a[108:111], v[160:175]
    ds_read_b64_tr_b16 a[20:21], v13 offset:53248
    ds_read_b64_tr_b16 a[22:23], v13 offset:55296
    s_waitcnt lgkmcnt(12)
    v_mfma_f32_32x32x16_bf16 v[176:191], a[60:63], a[108:111], v[176:191]
    ds_read_b64_tr_b16 a[24:25], v14 offset:53248
    ds_read_b64_tr_b16 a[26:27], v14 offset:55296
    buffer_load_dwordx4 v9, s[12:15], s35 offen offset:1024 lds
    s_waitcnt lgkmcnt(12)
    v_mfma_f32_32x32x16_bf16 v[128:143], a[0:3], a[112:115], v[128:143]
    ds_read_b64_tr_b16 a[28:29], v15 offset:53248
    ds_read_b64_tr_b16 a[30:31], v15 offset:55296
    buffer_load_dwordx4 a[84:87], v2, s[8:11], s37 offen offset:1024 sc1
    s_waitcnt lgkmcnt(12)
    v_mfma_f32_32x32x16_bf16 v[144:159], a[4:7], a[112:115], v[144:159]
    ds_read_b64_tr_b16 a[32:33], v12 offset:57344
    ds_read_b64_tr_b16 a[34:35], v12 offset:59392
    s_waitcnt lgkmcnt(12)
    v_mfma_f32_32x32x16_bf16 v[160:175], a[8:11], a[112:115], v[160:175]
    ds_read_b64_tr_b16 a[36:37], v13 offset:57344
    ds_read_b64_tr_b16 a[38:39], v13 offset:59392
    buffer_load_dwordx4 v10, s[12:15], s35 offen offset:2048 lds
    s_waitcnt lgkmcnt(12)
    v_mfma_f32_32x32x16_bf16 v[176:191], a[12:15], a[112:115], v[176:191]
    ds_read_b64_tr_b16 a[40:41], v14 offset:57344
    ds_read_b64_tr_b16 a[42:43], v14 offset:59392
    buffer_load_dwordx4 a[88:91], v2, s[8:11], s37 offen offset:2048 sc1
    s_waitcnt lgkmcnt(12)
    v_mfma_f32_32x32x16_bf16 v[128:143], a[16:19], a[116:119], v[128:143]
    ds_read_b64_tr_b16 a[44:45], v15 offset:57344
    ds_read_b64_tr_b16 a[46:47], v15 offset:59392
    s_waitcnt lgkmcnt(12)
    v_mfma_f32_32x32x16_bf16 v[144:159], a[20:23], a[116:119], v[144:159]
    ds_read_b64_tr_b16 a[48:49], v12 offset:61440
    ds_read_b64_tr_b16 a[50:51], v12 offset:63488
    buffer_load_dwordx4 v11, s[12:15], s35 offen offset:3072 lds
    s_add_u32 s32, s32, 262144
    s_waitcnt lgkmcnt(12)
    v_mfma_f32_32x32x16_bf16 v[160:175], a[24:27], a[116:119], v[160:175]
    ds_read_b64_tr_b16 a[52:53], v13 offset:61440
    ds_read_b64_tr_b16 a[54:55], v13 offset:63488
    s_waitcnt lgkmcnt(12)
    v_mfma_f32_32x32x16_bf16 v[176:191], a[28:31], a[116:119], v[176:191]
    ds_read_b64_tr_b16 a[56:57], v14 offset:61440
    ds_read_b64_tr_b16 a[58:59], v14 offset:63488
    buffer_load_dwordx4 a[92:95], v2, s[8:11], s37 offen offset:3072 sc1
    s_add_u32 s37, s37, 4096
    s_waitcnt lgkmcnt(12)
    v_mfma_f32_32x32x16_bf16 v[128:143], a[32:35], a[120:123], v[128:143]
    ds_read_b64_tr_b16 a[60:61], v15 offset:61440
    ds_read_b64_tr_b16 a[62:63], v15 offset:63488
    s_waitcnt lgkmcnt(12)
    v_mfma_f32_32x32x16_bf16 v[144:159], a[36:39], a[120:123], v[144:159]
    s_waitcnt lgkmcnt(10)
    v_mfma_f32_32x32x16_bf16 v[160:175], a[40:43], a[120:123], v[160:175]
    s_waitcnt lgkmcnt(8)
    v_mfma_f32_32x32x16_bf16 v[176:191], a[44:47], a[120:123], v[176:191]
    s_waitcnt vmcnt(32) lgkmcnt(0)
    s_barrier
    ds_read_b64_tr_b16 a[0:1], v16 offset:0
    ds_read_b64_tr_b16 a[2:3], v16 offset:2048
    ds_read_b64_tr_b16 a[4:5], v17 offset:0
    ds_read_b64_tr_b16 a[6:7], v17 offset:2048
    ds_read_b64_tr_b16 a[8:9], v18 offset:0
    ds_read_b64_tr_b16 a[10:11], v18 offset:2048
    v_mfma_f32_32x32x16_bf16 v[128:143], a[48:51], a[124:127], v[128:143]
    ds_read_b64_tr_b16 a[12:13], v19 offset:0
    ds_read_b64_tr_b16 a[14:15], v19 offset:2048
    v_mfma_f32_32x32x16_bf16 v[144:159], a[52:55], a[124:127], v[144:159]
    ds_read_b64_tr_b16 a[16:17], v16 offset:4096
    ds_read_b64_tr_b16 a[18:19], v16 offset:6144
    v_mfma_f32_32x32x16_bf16 v[160:175], a[56:59], a[124:127], v[160:175]
    ds_read_b64_tr_b16 a[20:21], v17 offset:4096
    ds_read_b64_tr_b16 a[22:23], v17 offset:6144
    v_mfma_f32_32x32x16_bf16 v[176:191], a[60:63], a[124:127], v[176:191]
    ds_read_b64_tr_b16 a[24:25], v18 offset:4096
    ds_read_b64_tr_b16 a[26:27], v18 offset:6144
    s_add_u32 m0, s34, 32768
    s_add_u32 s35, s32, 0
    buffer_load_dwordx4 v8, s[12:15], s35 offen offset:0 lds
    s_waitcnt lgkmcnt(12)
    v_mfma_f32_32x32x16_bf16 v[128:143], a[0:3], a[128:131], v[128:143]
    ds_read_b64_tr_b16 a[28:29], v19 offset:4096
    ds_read_b64_tr_b16 a[30:31], v19 offset:6144
    buffer_load_dwordx4 a[96:99], v2, s[8:11], s37 offen offset:0 sc1
    s_waitcnt lgkmcnt(12)
    v_mfma_f32_32x32x16_bf16 v[144:159], a[4:7], a[128:131], v[144:159]
    ds_read_b64_tr_b16 a[32:33], v16 offset:8192
    ds_read_b64_tr_b16 a[34:35], v16 offset:10240
    s_waitcnt lgkmcnt(12)
    v_mfma_f32_32x32x16_bf16 v[160:175], a[8:11], a[128:131], v[160:175]
    ds_read_b64_tr_b16 a[36:37], v17 offset:8192
    ds_read_b64_tr_b16 a[38:39], v17 offset:10240
    buffer_load_dwordx4 v9, s[12:15], s35 offen offset:1024 lds
    s_waitcnt lgkmcnt(12)
    v_mfma_f32_32x32x16_bf16 v[176:191], a[12:15], a[128:131], v[176:191]
    ds_read_b64_tr_b16 a[40:41], v18 offset:8192
    ds_read_b64_tr_b16 a[42:43], v18 offset:10240
    buffer_load_dwordx4 a[100:103], v2, s[8:11], s37 offen offset:1024 sc1
    s_waitcnt lgkmcnt(12)
    v_mfma_f32_32x32x16_bf16 v[128:143], a[16:19], a[132:135], v[128:143]
    ds_read_b64_tr_b16 a[44:45], v19 offset:8192
    ds_read_b64_tr_b16 a[46:47], v19 offset:10240
    s_waitcnt lgkmcnt(12)
    v_mfma_f32_32x32x16_bf16 v[144:159], a[20:23], a[132:135], v[144:159]
    ds_read_b64_tr_b16 a[48:49], v16 offset:12288
    ds_read_b64_tr_b16 a[50:51], v16 offset:14336
    buffer_load_dwordx4 v10, s[12:15], s35 offen offset:2048 lds
    s_waitcnt lgkmcnt(12)
    v_mfma_f32_32x32x16_bf16 v[160:175], a[24:27], a[132:135], v[160:175]
    ds_read_b64_tr_b16 a[52:53], v17 offset:12288
    ds_read_b64_tr_b16 a[54:55], v17 offset:14336
    s_waitcnt lgkmcnt(12)
    v_mfma_f32_32x32x16_bf16 v[176:191], a[28:31], a[132:135], v[176:191]
    ds_read_b64_tr_b16 a[56:57], v18 offset:12288
    ds_read_b64_tr_b16 a[58:59], v18 offset:14336
    buffer_load_dwordx4 a[104:107], v2, s[8:11], s37 offen offset:2048 sc1
    s_waitcnt lgkmcnt(12)
    v_mfma_f32_32x32x16_bf16 v[128:143], a[32:35], a[136:139], v[128:143]
    ds_read_b64_tr_b16 a[60:61], v19 offset:12288
    ds_read_b64_tr_b16 a[62:63], v19 offset:14336
    buffer_load_dwordx4 v11, s[12:15], s35 offen offset:3072 lds
    s_waitcnt lgkmcnt(12)
    v_mfma_f32_32x32x16_bf16 v[144:159], a[36:39], a[136:139], v[144:159]
    ds_read_b64_tr_b16 a[0:1], v16 offset:16384
    ds_read_b64_tr_b16 a[2:3], v16 offset:18432
    s_waitcnt lgkmcnt(12)
    v_mfma_f32_32x32x16_bf16 v[160:175], a[40:43], a[136:139], v[160:175]
    ds_read_b64_tr_b16 a[4:5], v17 offset:16384
    ds_read_b64_tr_b16 a[6:7], v17 offset:18432
    buffer_load_dwordx4 a[108:111], v2, s[8:11], s37 offen offset:3072 sc1
    s_add_u32 s37, s37, 4096
    s_waitcnt lgkmcnt(12)
    v_mfma_f32_32x32x16_bf16 v[176:191], a[44:47], a[136:139], v[176:191]
    ds_read_b64_tr_b16 a[8:9], v18 offset:16384
    ds_read_b64_tr_b16 a[10:11], v18 offset:18432
    s_add_u32 m0, s34, 36864
    s_add_u32 s35, s32, 32768
    buffer_load_dwordx4 v8, s[12:15], s35 offen offset:0 lds
    s_waitcnt lgkmcnt(12)
    v_mfma_f32_32x32x16_bf16 v[128:143], a[48:51], a[140:143], v[128:143]
    ds_read_b64_tr_b16 a[12:13], v19 offset:16384
    ds_read_b64_tr_b16 a[14:15], v19 offset:18432
    s_waitcnt lgkmcnt(12)
    v_mfma_f32_32x32x16_bf16 v[144:159], a[52:55], a[140:143], v[144:159]
    ds_read_b64_tr_b16 a[16:17], v16 offset:20480
    ds_read_b64_tr_b16 a[18:19], v16 offset:22528
    buffer_load_dwordx4 a[112:115], v2, s[8:11], s37 offen offset:0 sc1
    s_waitcnt lgkmcnt(12)
    v_mfma_f32_32x32x16_bf16 v[160:175], a[56:59], a[140:143], v[160:175]
    ds_read_b64_tr_b16 a[20:21], v17 offset:20480
    ds_read_b64_tr_b16 a[22:23], v17 offset:22528
    s_waitcnt lgkmcnt(12)
    v_mfma_f32_32x32x16_bf16 v[176:191], a[60:63], a[140:143], v[176:191]
    ds_read_b64_tr_b16 a[24:25], v18 offset:20480
    ds_read_b64_tr_b16 a[26:27], v18 offset:22528
    buffer_load_dwordx4 v9, s[12:15], s35 offen offset:1024 lds
    s_waitcnt lgkmcnt(12)
    v_mfma_f32_32x32x16_bf16 v[128:143], a[0:3], a[144:147], v[128:143]
    ds_read_b64_tr_b16 a[28:29], v19 offset:20480
    ds_read_b64_tr_b16 a[30:31], v19 offset:22528
    buffer_load_dwordx4 a[116:119], v2, s[8:11], s37 offen offset:1024 sc1
    s_waitcnt lgkmcnt(12)
    v_mfma_f32_32x32x16_bf16 v[144:159], a[4:7], a[144:147], v[144:159]
    ds_read_b64_tr_b16 a[32:33], v16 offset:24576
    ds_read_b64_tr_b16 a[34:35], v16 offset:26624
    s_waitcnt lgkmcnt(12)
    v_mfma_f32_32x32x16_bf16 v[160:175], a[8:11], a[144:147], v[160:175]
    ds_read_b64_tr_b16 a[36:37], v17 offset:24576
    ds_read_b64_tr_b16 a[38:39], v17 offset:26624
    buffer_load_dwordx4 v10, s[12:15], s35 offen offset:2048 lds
    s_waitcnt lgkmcnt(12)
    v_mfma_f32_32x32x16_bf16 v[176:191], a[12:15], a[144:147], v[176:191]
    ds_read_b64_tr_b16 a[40:41], v18 offset:24576
    ds_read_b64_tr_b16 a[42:43], v18 offset:26624
    buffer_load_dwordx4 a[120:123], v2, s[8:11], s37 offen offset:2048 sc1
    s_waitcnt lgkmcnt(12)
    v_mfma_f32_32x32x16_bf16 v[128:143], a[16:19], a[148:151], v[128:143]
    ds_read_b64_tr_b16 a[44:45], v19 offset:24576
    ds_read_b64_tr_b16 a[46:47], v19 offset:26624
    s_waitcnt lgkmcnt(12)
    v_mfma_f32_32x32x16_bf16 v[144:159], a[20:23], a[148:151], v[144:159]
    ds_read_b64_tr_b16 a[48:49], v16 offset:28672
    ds_read_b64_tr_b16 a[50:51], v16 offset:30720
    buffer_load_dwordx4 v11, s[12:15], s35 offen offset:3072 lds
    s_add_u32 s32, s32, 262144
    s_waitcnt lgkmcnt(12)
    v_mfma_f32_32x32x16_bf16 v[160:175], a[24:27], a[148:151], v[160:175]
    ds_read_b64_tr_b16 a[52:53], v17 offset:28672
    ds_read_b64_tr_b16 a[54:55], v17 offset:30720
    s_waitcnt lgkmcnt(12)
    v_mfma_f32_32x32x16_bf16 v[176:191], a[28:31], a[148:151], v[176:191]
    ds_read_b64_tr_b16 a[56:57], v18 offset:28672
    ds_read_b64_tr_b16 a[58:59], v18 offset:30720
    buffer_load_dwordx4 a[124:127], v2, s[8:11], s37 offen offset:3072 sc1
    s_add_u32 s37, s37, 4096
    s_waitcnt lgkmcnt(12)
    v_mfma_f32_32x32x16_bf16 v[128:143], a[32:35], a[152:155], v[128:143]
    ds_read_b64_tr_b16 a[60:61], v19 offset:28672
    ds_read_b64_tr_b16 a[62:63], v19 offset:30720
    s_waitcnt lgkmcnt(12)
    v_mfma_f32_32x32x16_bf16 v[144:159], a[36:39], a[152:155], v[144:159]
    s_waitcnt lgkmcnt(10)
    v_mfma_f32_32x32x16_bf16 v[160:175], a[40:43], a[152:155], v[160:175]
    s_waitcnt lgkmcnt(8)
    v_mfma_f32_32x32x16_bf16 v[176:191], a[44:47], a[152:155], v[176:191]
    s_waitcnt vmcnt(32) lgkmcnt(0)
    s_barrier
    ds_read_b64_tr_b16 a[0:1], v16 offset:32768
    ds_read_b64_tr_b16 a[2:3], v16 offset:34816
    ds_read_b64_tr_b16 a[4:5], v17 offset:32768
    ds_read_b64_tr_b16 a[6:7], v17 offset:34816
    ds_read_b64_tr_b16 a[8:9], v18 offset:32768
    ds_read_b64_tr_b16 a[10:11], v18 offset:34816
    v_mfma_f32_32x32x16_bf16 v[128:143], a[48:51], a[156:159], v[128:143]
    ds_read_b64_tr_b16 a[12:13], v19 offset:32768
    ds_read_b64_tr_b16 a[14:15], v19 offset:34816
    v_mfma_f32_32x32x16_bf16 v[144:159], a[52:55], a[156:159], v[144:159]
    ds_read_b64_tr_b16 a[16:17], v16 offset:36864
    ds_read_b64_tr_b16 a[18:19], v16 offset:38912
    v_mfma_f32_32x32x16_bf16 v[160:175], a[56:59], a[156:159], v[160:175]
    ds_read_b64_tr_b16 a[20:21], v17 offset:36864
    ds_read_b64_tr_b16 a[22:23], v17 offset:38912
    v_mfma_f32_32x32x16_bf16 v[176:191], a[60:63], a[156:159], v[176:191]
    ds_read_b64_tr_b16 a[24:25], v18 offset:36864
    ds_read_b64_tr_b16 a[26:27], v18 offset:38912
    s_add_u32 m0, s34, 65536
    s_add_u32 s35, s32, 0
    buffer_load_dwordx4 v8, s[12:15], s35 offen offset:0 lds
    s_waitcnt lgkmcnt(12)
    v_mfma_f32_32x32x16_bf16 v[128:143], a[0:3], a[224:227], v[128:143]
    ds_read_b64_tr_b16 a[28:29], v19 offset:36864
    ds_read_b64_tr_b16 a[30:31], v19 offset:38912
    buffer_load_dwordx4 a[128:131], v2, s[8:11], s37 offen offset:0 sc1
    s_waitcnt lgkmcnt(12)
    v_mfma_f32_32x32x16_bf16 v[144:159], a[4:7], a[224:227], v[144:159]
    ds_read_b64_tr_b16 a[32:33], v16 offset:40960
    ds_read_b64_tr_b16 a[34:35], v16 offset:43008
    s_waitcnt lgkmcnt(12)
    v_mfma_f32_32x32x16_bf16 v[160:175], a[8:11], a[224:227], v[160:175]
    ds_read_b64_tr_b16 a[36:37], v17 offset:40960
    ds_read_b64_tr_b16 a[38:39], v17 offset:43008
    buffer_load_dwordx4 v9, s[12:15], s35 offen offset:1024 lds
    s_waitcnt lgkmcnt(12)
    v_mfma_f32_32x32x16_bf16 v[176:191], a[12:15], a[224:227], v[176:191]
    ds_read_b64_tr_b16 a[40:41], v18 offset:40960
    ds_read_b64_tr_b16 a[42:43], v18 offset:43008
    buffer_load_dwordx4 a[132:135], v2, s[8:11], s37 offen offset:1024 sc1
    s_waitcnt lgkmcnt(12)
    v_mfma_f32_32x32x16_bf16 v[128:143], a[16:19], a[228:231], v[128:143]
    ds_read_b64_tr_b16 a[44:45], v19 offset:40960
    ds_read_b64_tr_b16 a[46:47], v19 offset:43008
    s_waitcnt lgkmcnt(12)
    v_mfma_f32_32x32x16_bf16 v[144:159], a[20:23], a[228:231], v[144:159]
    ds_read_b64_tr_b16 a[48:49], v16 offset:45056
    ds_read_b64_tr_b16 a[50:51], v16 offset:47104
    buffer_load_dwordx4 v10, s[12:15], s35 offen offset:2048 lds
    s_waitcnt lgkmcnt(12)
    v_mfma_f32_32x32x16_bf16 v[160:175], a[24:27], a[228:231], v[160:175]
    ds_read_b64_tr_b16 a[52:53], v17 offset:45056
    ds_read_b64_tr_b16 a[54:55], v17 offset:47104
    buffer_load_dwordx4 a[136:139], v2, s[8:11], s37 offen offset:2048 sc1
    s_waitcnt lgkmcnt(12)
    v_mfma_f32_32x32x16_bf16 v[176:191], a[28:31], a[228:231], v[176:191]
    ds_read_b64_tr_b16 a[56:57], v18 offset:45056
    ds_read_b64_tr_b16 a[58:59], v18 offset:47104
    s_waitcnt lgkmcnt(12)
    v_mfma_f32_32x32x16_bf16 v[128:143], a[32:35], a[232:235], v[128:143]
    ds_read_b64_tr_b16 a[60:61], v19 offset:45056
    ds_read_b64_tr_b16 a[62:63], v19 offset:47104
    buffer_load_dwordx4 v11, s[12:15], s35 offen offset:3072 lds
    s_waitcnt lgkmcnt(12)
    v_mfma_f32_32x32x16_bf16 v[144:159], a[36:39], a[232:235], v[144:159]
    ds_read_b64_tr_b16 a[0:1], v16 offset:49152
    ds_read_b64_tr_b16 a[2:3], v16 offset:51200
    buffer_load_dwordx4 a[140:143], v2, s[8:11], s37 offen offset:3072 sc1
    s_add_u32 s37, s37, 4096
    s_waitcnt lgkmcnt(12)
    v_mfma_f32_32x32x16_bf16 v[160:175], a[40:43], a[232:235], v[160:175]
    ds_read_b64_tr_b16 a[4:5], v17 offset:49152
    ds_read_b64_tr_b16 a[6:7], v17 offset:51200
    s_waitcnt lgkmcnt(12)
    v_mfma_f32_32x32x16_bf16 v[176:191], a[44:47], a[232:235], v[176:191]
    ds_read_b64_tr_b16 a[8:9], v18 offset:49152
    ds_read_b64_tr_b16 a[10:11], v18 offset:51200
    s_add_u32 m0, s34, 69632
    s_add_u32 s35, s32, 32768
    buffer_load_dwordx4 v8, s[12:15], s35 offen offset:0 lds
    s_waitcnt lgkmcnt(12)
    v_mfma_f32_32x32x16_bf16 v[128:143], a[48:51], a[236:239], v[128:143]
    ds_read_b64_tr_b16 a[12:13], v19 offset:49152
    ds_read_b64_tr_b16 a[14:15], v19 offset:51200
    buffer_load_dwordx4 a[144:147], v2, s[8:11], s37 offen offset:0 sc1
    s_waitcnt lgkmcnt(12)
    v_mfma_f32_32x32x16_bf16 v[144:159], a[52:55], a[236:239], v[144:159]
    ds_read_b64_tr_b16 a[16:17], v16 offset:53248
    ds_read_b64_tr_b16 a[18:19], v16 offset:55296
    s_waitcnt lgkmcnt(12)
    v_mfma_f32_32x32x16_bf16 v[160:175], a[56:59], a[236:239], v[160:175]
    ds_read_b64_tr_b16 a[20:21], v17 offset:53248
    ds_read_b64_tr_b16 a[22:23], v17 offset:55296
    buffer_load_dwordx4 v9, s[12:15], s35 offen offset:1024 lds
    s_waitcnt lgkmcnt(12)
    v_mfma_f32_32x32x16_bf16 v[176:191], a[60:63], a[236:239], v[176:191]
    ds_read_b64_tr_b16 a[24:25], v18 offset:53248
    ds_read_b64_tr_b16 a[26:27], v18 offset:55296
    buffer_load_dwordx4 a[148:151], v2, s[8:11], s37 offen offset:1024 sc1
    s_waitcnt lgkmcnt(12)
    v_mfma_f32_32x32x16_bf16 v[128:143], a[0:3], a[240:243], v[128:143]
    ds_read_b64_tr_b16 a[28:29], v19 offset:53248
    ds_read_b64_tr_b16 a[30:31], v19 offset:55296
    s_waitcnt lgkmcnt(12)
    v_mfma_f32_32x32x16_bf16 v[144:159], a[4:7], a[240:243], v[144:159]
    ds_read_b64_tr_b16 a[32:33], v16 offset:57344
    ds_read_b64_tr_b16 a[34:35], v16 offset:59392
    buffer_load_dwordx4 v10, s[12:15], s35 offen offset:2048 lds
    s_waitcnt lgkmcnt(12)
    v_mfma_f32_32x32x16_bf16 v[160:175], a[8:11], a[240:243], v[160:175]
    ds_read_b64_tr_b16 a[36:37], v17 offset:57344
    ds_read_b64_tr_b16 a[38:39], v17 offset:59392
    buffer_load_dwordx4 a[152:155], v2, s[8:11], s37 offen offset:2048 sc1
    s_waitcnt lgkmcnt(12)
    v_mfma_f32_32x32x16_bf16 v[176:191], a[12:15], a[240:243], v[176:191]
    ds_read_b64_tr_b16 a[40:41], v18 offset:57344
    ds_read_b64_tr_b16 a[42:43], v18 offset:59392
    s_waitcnt lgkmcnt(12)
    v_mfma_f32_32x32x16_bf16 v[128:143], a[16:19], a[244:247], v[128:143]
    ds_read_b64_tr_b16 a[44:45], v19 offset:57344
    ds_read_b64_tr_b16 a[46:47], v19 offset:59392
    buffer_load_dwordx4 v11, s[12:15], s35 offen offset:3072 lds
    s_add_u32 s32, s32, 262144
    s_waitcnt lgkmcnt(12)
    v_mfma_f32_32x32x16_bf16 v[144:159], a[20:23], a[244:247], v[144:159]
    ds_read_b64_tr_b16 a[48:49], v16 offset:61440
    ds_read_b64_tr_b16 a[50:51], v16 offset:63488
    buffer_load_dwordx4 a[156:159], v2, s[8:11], s37 offen offset:3072 sc1
    s_add_u32 s37, s37, 4096
    s_waitcnt lgkmcnt(12)
    v_mfma_f32_32x32x16_bf16 v[160:175], a[24:27], a[244:247], v[160:175]
    ds_read_b64_tr_b16 a[52:53], v17 offset:61440
    ds_read_b64_tr_b16 a[54:55], v17 offset:63488
    s_waitcnt lgkmcnt(12)
    v_mfma_f32_32x32x16_bf16 v[176:191], a[28:31], a[244:247], v[176:191]
    ds_read_b64_tr_b16 a[56:57], v18 offset:61440
    ds_read_b64_tr_b16 a[58:59], v18 offset:63488
    v_mov_b32 v23, s63
    global_load_dword v23, v23, s[6:7] sc1
    s_waitcnt lgkmcnt(12)
    v_mfma_f32_32x32x16_bf16 v[128:143], a[32:35], a[248:251], v[128:143]
    ds_read_b64_tr_b16 a[60:61], v19 offset:61440
    ds_read_b64_tr_b16 a[62:63], v19 offset:63488
    s_waitcnt lgkmcnt(12)
    v_mfma_f32_32x32x16_bf16 v[144:159], a[36:39], a[248:251], v[144:159]
    s_waitcnt lgkmcnt(10)
    v_mfma_f32_32x32x16_bf16 v[160:175], a[40:43], a[248:251], v[160:175]
    s_waitcnt lgkmcnt(8)
    v_mfma_f32_32x32x16_bf16 v[176:191], a[44:47], a[248:251], v[176:191]
    s_waitcnt vmcnt(33) lgkmcnt(0)
    s_barrier
    ds_read_b64_tr_b16 a[0:1], v12 offset:0
    ds_read_b64_tr_b16 a[2:3], v12 offset:2048
    ds_read_b64_tr_b16 a[4:5], v13 offset:0
    ds_read_b64_tr_b16 a[6:7], v13 offset:2048
    ds_read_b64_tr_b16 a[8:9], v14 offset:0
    ds_read_b64_tr_b16 a[10:11], v14 offset:2048
    v_mfma_f32_32x32x16_bf16 v[128:143], a[48:51], a[252:255], v[128:143]
    ds_read_b64_tr_b16 a[12:13], v15 offset:0
    ds_read_b64_tr_b16 a[14:15], v15 offset:2048
    v_mfma_f32_32x32x16_bf16 v[144:159], a[52:55], a[252:255], v[144:159]
    ds_read_b64_tr_b16 a[16:17], v12 offset:4096
    ds_read_b64_tr_b16 a[18:19], v12 offset:6144
    v_mfma_f32_32x32x16_bf16 v[160:175], a[56:59], a[252:255], v[160:175]
    ds_read_b64_tr_b16 a[20:21], v13 offset:4096
    ds_read_b64_tr_b16 a[22:23], v13 offset:6144
    v_mfma_f32_32x32x16_bf16 v[176:191], a[60:63], a[252:255], v[176:191]
    ds_read_b64_tr_b16 a[24:25], v14 offset:4096
    ds_read_b64_tr_b16 a[26:27], v14 offset:6144
    s_add_u32 m0, s34, 98304
    s_add_u32 s35, s32, 0
    buffer_load_dwordx4 v8, s[12:15], s35 offen offset:0 lds
    s_waitcnt lgkmcnt(12)
    v_mfma_f32_32x32x16_bf16 v[128:143], a[0:3], a[64:67], v[128:143]
    ds_read_b64_tr_b16 a[28:29], v15 offset:4096
    ds_read_b64_tr_b16 a[30:31], v15 offset:6144
    buffer_load_dwordx4 a[224:227], v2, s[8:11], s37 offen offset:0 sc1
    s_waitcnt lgkmcnt(12)
    v_mfma_f32_32x32x16_bf16 v[144:159], a[4:7], a[64:67], v[144:159]
    ds_read_b64_tr_b16 a[32:33], v12 offset:8192
    ds_read_b64_tr_b16 a[34:35], v12 offset:10240
    s_waitcnt lgkmcnt(12)
    v_mfma_f32_32x32x16_bf16 v[160:175], a[8:11], a[64:67], v[160:175]
    ds_read_b64_tr_b16 a[36:37], v13 offset:8192
    ds_read_b64_tr_b16 a[38:39], v13 offset:10240
    buffer_load_dwordx4 v9, s[12:15], s35 offen offset:1024 lds
    s_waitcnt lgkmcnt(12)
    v_mfma_f32_32x32x16_bf16 v[176:191], a[12:15], a[64:67], v[176:191]
    ds_read_b64_tr_b16 a[40:41], v14 offset:8192
    ds_read_b64_tr_b16 a[42:43], v14 offset:10240
    buffer_load_dwordx4 a[228:231], v2, s[8:11], s37 offen offset:1024 sc1
    s_waitcnt lgkmcnt(12)
    v_mfma_f32_32x32x16_bf16 v[128:143], a[16:19], a[68:71], v[128:143]
    ds_read_b64_tr_b16 a[44:45], v15 offset:8192
    ds_read_b64_tr_b16 a[46:47], v15 offset:10240
    s_waitcnt lgkmcnt(12)
    v_mfma_f32_32x32x16_bf16 v[144:159], a[20:23], a[68:71], v[144:159]
    ds_read_b64_tr_b16 a[48:49], v12 offset:12288
    ds_read_b64_tr_b16 a[50:51], v12 offset:14336
    buffer_load_dwordx4 v10, s[12:15], s35 offen offset:2048 lds
    s_waitcnt lgkmcnt(12)
    v_mfma_f32_32x32x16_bf16 v[160:175], a[24:27], a[68:71], v[160:175]
    ds_read_b64_tr_b16 a[52:53], v13 offset:12288
    ds_read_b64_tr_b16 a[54:55], v13 offset:14336
    s_waitcnt lgkmcnt(12)
    v_mfma_f32_32x32x16_bf16 v[176:191], a[28:31], a[68:71], v[176:191]
    ds_read_b64_tr_b16 a[56:57], v14 offset:12288
    ds_read_b64_tr_b16 a[58:59], v14 offset:14336
    buffer_load_dwordx4 a[232:235], v2, s[8:11], s37 offen offset:2048 sc1
    s_waitcnt lgkmcnt(12)
    v_mfma_f32_32x32x16_bf16 v[128:143], a[32:35], a[72:75], v[128:143]
    ds_read_b64_tr_b16 a[60:61], v15 offset:12288
    ds_read_b64_tr_b16 a[62:63], v15 offset:14336
    buffer_load_dwordx4 v11, s[12:15], s35 offen offset:3072 lds
    s_waitcnt lgkmcnt(12)
    v_mfma_f32_32x32x16_bf16 v[144:159], a[36:39], a[72:75], v[144:159]
    ds_read_b64_tr_b16 a[0:1], v12 offset:16384
    ds_read_b64_tr_b16 a[2:3], v12 offset:18432
    s_waitcnt lgkmcnt(12)
    v_mfma_f32_32x32x16_bf16 v[160:175], a[40:43], a[72:75], v[160:175]
    ds_read_b64_tr_b16 a[4:5], v13 offset:16384
    ds_read_b64_tr_b16 a[6:7], v13 offset:18432
    buffer_load_dwordx4 a[236:239], v2, s[8:11], s37 offen offset:3072 sc1
    s_add_u32 s37, s37, 4096
    s_waitcnt lgkmcnt(12)
    v_mfma_f32_32x32x16_bf16 v[176:191], a[44:47], a[72:75], v[176:191]
    ds_read_b64_tr_b16 a[8:9], v14 offset:16384
    ds_read_b64_tr_b16 a[10:11], v14 offset:18432
    s_add_u32 m0, s34, 102400
    s_add_u32 s35, s32, 32768
    buffer_load_dwordx4 v8, s[12:15], s35 offen offset:0 lds
    s_waitcnt lgkmcnt(12)
    v_mfma_f32_32x32x16_bf16 v[128:143], a[48:51], a[76:79], v[128:143]
    ds_read_b64_tr_b16 a[12:13], v15 offset:16384
    ds_read_b64_tr_b16 a[14:15], v15 offset:18432
    s_waitcnt lgkmcnt(12)
    v_mfma_f32_32x32x16_bf16 v[144:159], a[52:55], a[76:79], v[144:159]
    ds_read_b64_tr_b16 a[16:17], v12 offset:20480
    ds_read_b64_tr_b16 a[18:19], v12 offset:22528
    buffer_load_dwordx4 a[240:243], v2, s[8:11], s37 offen offset:0 sc1
    s_waitcnt lgkmcnt(12)
    v_mfma_f32_32x32x16_bf16 v[160:175], a[56:59], a[76:79], v[160:175]
    ds_read_b64_tr_b16 a[20:21], v13 offset:20480
    ds_read_b64_tr_b16 a[22:23], v13 offset:22528
    s_waitcnt lgkmcnt(12)
    v_mfma_f32_32x32x16_bf16 v[176:191], a[60:63], a[76:79], v[176:191]
    ds_read_b64_tr_b16 a[24:25], v14 offset:20480
    ds_read_b64_tr_b16 a[26:27], v14 offset:22528
    buffer_load_dwordx4 v9, s[12:15], s35 offen offset:1024 lds
    s_waitcnt lgkmcnt(12)
    v_mfma_f32_32x32x16_bf16 v[128:143], a[0:3], a[80:83], v[128:143]
    ds_read_b64_tr_b16 a[28:29], v15 offset:20480
    ds_read_b64_tr_b16 a[30:31], v15 offset:22528
    buffer_load_dwordx4 a[244:247], v2, s[8:11], s37 offen offset:1024 sc1
    s_waitcnt lgkmcnt(12)
    v_mfma_f32_32x32x16_bf16 v[144:159], a[4:7], a[80:83], v[144:159]
    ds_read_b64_tr_b16 a[32:33], v12 offset:24576
    ds_read_b64_tr_b16 a[34:35], v12 offset:26624
    s_waitcnt lgkmcnt(12)
    v_mfma_f32_32x32x16_bf16 v[160:175], a[8:11], a[80:83], v[160:175]
    ds_read_b64_tr_b16 a[36:37], v13 offset:24576
    ds_read_b64_tr_b16 a[38:39], v13 offset:26624
    buffer_load_dwordx4 v10, s[12:15], s35 offen offset:2048 lds
    s_waitcnt lgkmcnt(12)
    v_mfma_f32_32x32x16_bf16 v[176:191], a[12:15], a[80:83], v[176:191]
    ds_read_b64_tr_b16 a[40:41], v14 offset:24576
    ds_read_b64_tr_b16 a[42:43], v14 offset:26624
    buffer_load_dwordx4 a[248:251], v2, s[8:11], s37 offen offset:2048 sc1
    s_waitcnt lgkmcnt(12)
    v_mfma_f32_32x32x16_bf16 v[128:143], a[16:19], a[84:87], v[128:143]
    ds_read_b64_tr_b16 a[44:45], v15 offset:24576
    ds_read_b64_tr_b16 a[46:47], v15 offset:26624
    s_waitcnt lgkmcnt(12)
    v_mfma_f32_32x32x16_bf16 v[144:159], a[20:23], a[84:87], v[144:159]
    ds_read_b64_tr_b16 a[48:49], v12 offset:28672
    ds_read_b64_tr_b16 a[50:51], v12 offset:30720
    buffer_load_dwordx4 v11, s[12:15], s35 offen offset:3072 lds
    s_add_u32 s32, s32, 262144
    s_waitcnt lgkmcnt(12)
    v_mfma_f32_32x32x16_bf16 v[160:175], a[24:27], a[84:87], v[160:175]
    ds_read_b64_tr_b16 a[52:53], v13 offset:28672
    ds_read_b64_tr_b16 a[54:55], v13 offset:30720
    s_waitcnt lgkmcnt(12)
    v_mfma_f32_32x32x16_bf16 v[176:191], a[28:31], a[84:87], v[176:191]
    ds_read_b64_tr_b16 a[56:57], v14 offset:28672
    ds_read_b64_tr_b16 a[58:59], v14 offset:30720
    buffer_load_dwordx4 a[252:255], v2, s[8:11], s37 offen offset:3072 sc1
    s_add_u32 s37, s37, 4096
    s_waitcnt lgkmcnt(12)
    v_mfma_f32_32x32x16_bf16 v[128:143], a[32:35], a[88:91], v[128:143]
    ds_read_b64_tr_b16 a[60:61], v15 offset:28672
    ds_read_b64_tr_b16 a[62:63], v15 offset:30720
    s_waitcnt lgkmcnt(12)
    v_mfma_f32_32x32x16_bf16 v[144:159], a[36:39], a[88:91], v[144:159]
    s_waitcnt lgkmcnt(10)
    v_mfma_f32_32x32x16_bf16 v[160:175], a[40:43], a[88:91], v[160:175]
    s_waitcnt lgkmcnt(8)
    v_mfma_f32_32x32x16_bf16 v[176:191], a[44:47], a[88:91], v[176:191]
    s_waitcnt vmcnt(33) lgkmcnt(0)
    s_barrier
    ds_read_b64_tr_b16 a[0:1], v12 offset:32768
    ds_read_b64_tr_b16 a[2:3], v12 offset:34816
    ds_read_b64_tr_b16 a[4:5], v13 offset:32768
    ds_read_b64_tr_b16 a[6:7], v13 offset:34816
    ds_read_b64_tr_b16 a[8:9], v14 offset:32768
    ds_read_b64_tr_b16 a[10:11], v14 offset:34816
    v_mfma_f32_32x32x16_bf16 v[128:143], a[48:51], a[92:95], v[128:143]
    ds_read_b64_tr_b16 a[12:13], v15 offset:32768
    ds_read_b64_tr_b16 a[14:15], v15 offset:34816
    v_mfma_f32_32x32x16_bf16 v[144:159], a[52:55], a[92:95], v[144:159]
    ds_read_b64_tr_b16 a[16:17], v12 offset:36864
    ds_read_b64_tr_b16 a[18:19], v12 offset:38912
    v_mfma_f32_32x32x16_bf16 v[160:175], a[56:59], a[92:95], v[160:175]
    ds_read_b64_tr_b16 a[20:21], v13 offset:36864
    ds_read_b64_tr_b16 a[22:23], v13 offset:38912
    v_mfma_f32_32x32x16_bf16 v[176:191], a[60:63], a[92:95], v[176:191]
    ds_read_b64_tr_b16 a[24:25], v14 offset:36864
    ds_read_b64_tr_b16 a[26:27], v14 offset:38912
    s_waitcnt lgkmcnt(12)
    v_mfma_f32_32x32x16_bf16 v[128:143], a[0:3], a[96:99], v[128:143]
    ds_read_b64_tr_b16 a[28:29], v15 offset:36864
    ds_read_b64_tr_b16 a[30:31], v15 offset:38912
    s_waitcnt lgkmcnt(12)
    v_mfma_f32_32x32x16_bf16 v[144:159], a[4:7], a[96:99], v[144:159]
    ds_read_b64_tr_b16 a[32:33], v12 offset:40960
    ds_read_b64_tr_b16 a[34:35], v12 offset:43008
    s_waitcnt lgkmcnt(12)
    v_mfma_f32_32x32x16_bf16 v[160:175], a[8:11], a[96:99], v[160:175]
    ds_read_b64_tr_b16 a[36:37], v13 offset:40960
    ds_read_b64_tr_b16 a[38:39], v13 offset:43008
    s_waitcnt lgkmcnt(12)
    v_mfma_f32_32x32x16_bf16 v[176:191], a[12:15], a[96:99], v[176:191]
    ds_read_b64_tr_b16 a[40:41], v14 offset:40960
    ds_read_b64_tr_b16 a[42:43], v14 offset:43008
    s_waitcnt lgkmcnt(12)
    v_mfma_f32_32x32x16_bf16 v[128:143], a[16:19], a[100:103], v[128:143]
    ds_read_b64_tr_b16 a[44:45], v15 offset:40960
    ds_read_b64_tr_b16 a[46:47], v15 offset:43008
    s_waitcnt lgkmcnt(12)
    v_mfma_f32_32x32x16_bf16 v[144:159], a[20:23], a[100:103], v[144:159]
    ds_read_b64_tr_b16 a[48:49], v12 offset:45056
    ds_read_b64_tr_b16 a[50:51], v12 offset:47104
    s_waitcnt lgkmcnt(12)
    v_mfma_f32_32x32x16_bf16 v[160:175], a[24:27], a[100:103], v[160:175]
    ds_read_b64_tr_b16 a[52:53], v13 offset:45056
    ds_read_b64_tr_b16 a[54:55], v13 offset:47104
    s_waitcnt lgkmcnt(12)
    v_mfma_f32_32x32x16_bf16 v[176:191], a[28:31], a[100:103], v[176:191]
    ds_read_b64_tr_b16 a[56:57], v14 offset:45056
    ds_read_b64_tr_b16 a[58:59], v14 offset:47104
    s_waitcnt lgkmcnt(12)
    v_mfma_f32_32x32x16_bf16 v[128:143], a[32:35], a[104:107], v[128:143]
    ds_read_b64_tr_b16 a[60:61], v15 offset:45056
    ds_read_b64_tr_b16 a[62:63], v15 offset:47104
    s_waitcnt lgkmcnt(12)
    v_mfma_f32_32x32x16_bf16 v[144:159], a[36:39], a[104:107], v[144:159]
    ds_read_b64_tr_b16 a[0:1], v12 offset:49152
    ds_read_b64_tr_b16 a[2:3], v12 offset:51200
    s_waitcnt lgkmcnt(12)
    v_mfma_f32_32x32x16_bf16 v[160:175], a[40:43], a[104:107], v[160:175]
    ds_read_b64_tr_b16 a[4:5], v13 offset:49152
    ds_read_b64_tr_b16 a[6:7], v13 offset:51200
    s_waitcnt lgkmcnt(12)
    v_mfma_f32_32x32x16_bf16 v[176:191], a[44:47], a[104:107], v[176:191]
    ds_read_b64_tr_b16 a[8:9], v14 offset:49152
    ds_read_b64_tr_b16 a[10:11], v14 offset:51200
    s_waitcnt lgkmcnt(12)
    v_mfma_f32_32x32x16_bf16 v[128:143], a[48:51], a[108:111], v[128:143]
    ds_read_b64_tr_b16 a[12:13], v15 offset:49152
    ds_read_b64_tr_b16 a[14:15], v15 offset:51200
    s_waitcnt lgkmcnt(12)
    v_mfma_f32_32x32x16_bf16 v[144:159], a[52:55], a[108:111], v[144:159]
    ds_read_b64_tr_b16 a[16:17], v12 offset:53248
    ds_read_b64_tr_b16 a[18:19], v12 offset:55296
    s_waitcnt lgkmcnt(12)
    v_mfma_f32_32x32x16_bf16 v[160:175], a[56:59], a[108:111], v[160:175]
    ds_read_b64_tr_b16 a[20:21], v13 offset:53248
    ds_read_b64_tr_b16 a[22:23], v13 offset:55296
    s_waitcnt lgkmcnt(12)
    v_mfma_f32_32x32x16_bf16 v[176:191], a[60:63], a[108:111], v[176:191]
    ds_read_b64_tr_b16 a[24:25], v14 offset:53248
    ds_read_b64_tr_b16 a[26:27], v14 offset:55296
    s_waitcnt lgkmcnt(12)
    v_mfma_f32_32x32x16_bf16 v[128:143], a[0:3], a[112:115], v[128:143]
    ds_read_b64_tr_b16 a[28:29], v15 offset:53248
    ds_read_b64_tr_b16 a[30:31], v15 offset:55296
    s_waitcnt lgkmcnt(12)
    v_mfma_f32_32x32x16_bf16 v[144:159], a[4:7], a[112:115], v[144:159]
    ds_read_b64_tr_b16 a[32:33], v12 offset:57344
    ds_read_b64_tr_b16 a[34:35], v12 offset:59392
    s_waitcnt lgkmcnt(12)
    v_mfma_f32_32x32x16_bf16 v[160:175], a[8:11], a[112:115], v[160:175]
    ds_read_b64_tr_b16 a[36:37], v13 offset:57344
    ds_read_b64_tr_b16 a[38:39], v13 offset:59392
    s_waitcnt lgkmcnt(12)
    v_mfma_f32_32x32x16_bf16 v[176:191], a[12:15], a[112:115], v[176:191]
    ds_read_b64_tr_b16 a[40:41], v14 offset:57344
    ds_read_b64_tr_b16 a[42:43], v14 offset:59392
    s_waitcnt lgkmcnt(12)
    v_mfma_f32_32x32x16_bf16 v[128:143], a[16:19], a[116:119], v[128:143]
    ds_read_b64_tr_b16 a[44:45], v15 offset:57344
    ds_read_b64_tr_b16 a[46:47], v15 offset:59392
    s_waitcnt lgkmcnt(12)
    v_mfma_f32_32x32x16_bf16 v[144:159], a[20:23], a[116:119], v[144:159]
    ds_read_b64_tr_b16 a[48:49], v12 offset:61440
    ds_read_b64_tr_b16 a[50:51], v12 offset:63488
    s_waitcnt lgkmcnt(12)
    v_mfma_f32_32x32x16_bf16 v[160:175], a[24:27], a[116:119], v[160:175]
    ds_read_b64_tr_b16 a[52:53], v13 offset:61440
    ds_read_b64_tr_b16 a[54:55], v13 offset:63488
    s_waitcnt lgkmcnt(12)
    v_mfma_f32_32x32x16_bf16 v[176:191], a[28:31], a[116:119], v[176:191]
    ds_read_b64_tr_b16 a[56:57], v14 offset:61440
    ds_read_b64_tr_b16 a[58:59], v14 offset:63488
    s_waitcnt lgkmcnt(12)
    v_mfma_f32_32x32x16_bf16 v[128:143], a[32:35], a[120:123], v[128:143]
    ds_read_b64_tr_b16 a[60:61], v15 offset:61440
    ds_read_b64_tr_b16 a[62:63], v15 offset:63488
    s_waitcnt lgkmcnt(12)
    v_mfma_f32_32x32x16_bf16 v[144:159], a[36:39], a[120:123], v[144:159]
    s_waitcnt lgkmcnt(10)
    v_mfma_f32_32x32x16_bf16 v[160:175], a[40:43], a[120:123], v[160:175]
    s_waitcnt lgkmcnt(8)
    v_mfma_f32_32x32x16_bf16 v[176:191], a[44:47], a[120:123], v[176:191]
    s_waitcnt vmcnt(16) lgkmcnt(0)
    v_readfirstlane_b32 s3, v23
    s_cmp_ge_u32 s3, s65
    s_cbranch_scc0 L_gxw
L_gxb:
    s_barrier
    ds_read_b64_tr_b16 a[0:1], v16 offset:0
    ds_read_b64_tr_b16 a[2:3], v16 offset:2048
    ds_read_b64_tr_b16 a[4:5], v17 offset:0
    ds_read_b64_tr_b16 a[6:7], v17 offset:2048
    ds_read_b64_tr_b16 a[8:9], v18 offset:0
    ds_read_b64_tr_b16 a[10:11], v18 offset:2048
    v_mfma_f32_32x32x16_bf16 v[128:143], a[48:51], a[124:127], v[128:143]
    ds_read_b64_tr_b16 a[12:13], v19 offset:0
    ds_read_b64_tr_b16 a[14:15], v19 offset:2048
    v_mfma_f32_32x32x16_bf16 v[144:159], a[52:55], a[124:127], v[144:159]
    ds_read_b64_tr_b16 a[16:17], v16 offset:4096
    ds_read_b64_tr_b16 a[18:19], v16 offset:6144
    v_mfma_f32_32x32x16_bf16 v[160:175], a[56:59], a[124:127], v[160:175]
    ds_read_b64_tr_b16 a[20:21], v17 offset:4096
    ds_read_b64_tr_b16 a[22:23], v17 offset:6144
    v_mfma_f32_32x32x16_bf16 v[176:191], a[60:63], a[124:127], v[176:191]
    ds_read_b64_tr_b16 a[24:25], v18 offset:4096
    ds_read_b64_tr_b16 a[26:27], v18 offset:6144
    buffer_load_dwordx4 v[192:195], v2, s[8:11], s62 offen offset:0 sc1
    s_waitcnt lgkmcnt(12)
    v_mfma_f32_32x32x16_bf16 v[128:143], a[0:3], a[128:131], v[128:143]
    ds_read_b64_tr_b16 a[28:29], v19 offset:4096
    ds_read_b64_tr_b16 a[30:31], v19 offset:6144
    buffer_load_dwordx4 v[196:199], v2, s[8:11], s62 offen offset:1024 sc1
    s_waitcnt lgkmcnt(12)
    v_mfma_f32_32x32x16_bf16 v[144:159], a[4:7], a[128:131], v[144:159]
    ds_read_b64_tr_b16 a[32:33], v16 offset:8192
    ds_read_b64_tr_b16 a[34:35], v16 offset:10240
    s_waitcnt lgkmcnt(12)
    v_mfma_f32_32x32x16_bf16 v[160:175], a[8:11], a[128:131], v[160:175]
    ds_read_b64_tr_b16 a[36:37], v17 offset:8192
    ds_read_b64_tr_b16 a[38:39], v17 offset:10240
    buffer_load_dwordx4 v[200:203], v2, s[8:11], s62 offen offset:2048 sc1
    s_waitcnt lgkmcnt(12)
    v_mfma_f32_32x32x16_bf16 v[176:191], a[12:15], a[128:131], v[176:191]
    ds_read_b64_tr_b16 a[40:41], v18 offset:8192
    ds_read_b64_tr_b16 a[42:43], v18 offset:10240
    buffer_load_dwordx4 v[204:207], v2, s[8:11], s62 offen offset:3072 sc1
    s_add_u32 s62, s62, 4096
    s_waitcnt lgkmcnt(12)
    v_mfma_f32_32x32x16_bf16 v[128:143], a[16:19], a[132:135], v[128:143]
    ds_read_b64_tr_b16 a[44:45], v19 offset:8192
    ds_read_b64_tr_b16 a[46:47], v19 offset:10240
    s_waitcnt lgkmcnt(12)
    v_mfma_f32_32x32x16_bf16 v[144:159], a[20:23], a[132:135], v[144:159]
    ds_read_b64_tr_b16 a[48:49], v16 offset:12288
    ds_read_b64_tr_b16 a[50:51], v16 offset:14336
    buffer_load_dwordx4 v[208:211], v2, s[8:11], s62 offen offset:0 sc1
    s_waitcnt lgkmcnt(12)
    v_mfma_f32_32x32x16_bf16 v[160:175], a[24:27], a[132:135], v[160:175]
    ds_read_b64_tr_b16 a[52:53], v17 offset:12288
    ds_read_b64_tr_b16 a[54:55], v17 offset:14336
    s_waitcnt lgkmcnt(12)
    v_mfma_f32_32x32x16_bf16 v[176:191], a[28:31], a[132:135], v[176:191]
    ds_read_b64_tr_b16 a[56:57], v18 offset:12288
    ds_read_b64_tr_b16 a[58:59], v18 offset:14336
    buffer_load_dwordx4 v[212:215], v2, s[8:11], s62 offen offset:1024 sc1
    s_waitcnt lgkmcnt(12)
    v_mfma_f32_32x32x16_bf16 v[128:143], a[32:35], a[136:139], v[128:143]
    ds_read_b64_tr_b16 a[60:61], v19 offset:12288
    ds_read_b64_tr_b16 a[62:63], v19 offset:14336
    buffer_load_dwordx4 v[216:219], v2, s[8:11], s62 offen offset:2048 sc1
    s_waitcnt lgkmcnt(12)
    v_mfma_f32_32x32x16_bf16 v[144:159], a[36:39], a[136:139], v[144:159]
    ds_read_b64_tr_b16 a[0:1], v16 offset:16384
    ds_read_b64_tr_b16 a[2:3], v16 offset:18432
    s_waitcnt lgkmcnt(12)
    v_mfma_f32_32x32x16_bf16 v[160:175], a[40:43], a[136:139], v[160:175]
    ds_read_b64_tr_b16 a[4:5], v17 offset:16384
    ds_read_b64_tr_b16 a[6:7], v17 offset:18432
    buffer_load_dwordx4 v[220:223], v2, s[8:11], s62 offen offset:3072 sc1
    s_add_u32 s62, s62, 4096
    s_waitcnt lgkmcnt(12)
    v_mfma_f32_32x32x16_bf16 v[176:191], a[44:47], a[136:139], v[176:191]
    ds_read_b64_tr_b16 a[8:9], v18 offset:16384
    ds_read_b64_tr_b16 a[10:11], v18 offset:18432
    buffer_load_dwordx4 v[224:227], v2, s[8:11], s62 offen offset:0 sc1
    s_waitcnt lgkmcnt(12)
    v_mfma_f32_32x32x16_bf16 v[128:143], a[48:51], a[140:143], v[128:143]
    ds_read_b64_tr_b16 a[12:13], v19 offset:16384
    ds_read_b64_tr_b16 a[14:15], v19 offset:18432
    s_waitcnt lgkmcnt(12)
    v_mfma_f32_32x32x16_bf16 v[144:159], a[52:55], a[140:143], v[144:159]
    ds_read_b64_tr_b16 a[16:17], v16 offset:20480
    ds_read_b64_tr_b16 a[18:19], v16 offset:22528
    buffer_load_dwordx4 v[228:231], v2, s[8:11], s62 offen offset:1024 sc1
    s_waitcnt lgkmcnt(12)
    v_mfma_f32_32x32x16_bf16 v[160:175], a[56:59], a[140:143], v[160:175]
    ds_read_b64_tr_b16 a[20:21], v17 offset:20480
    ds_read_b64_tr_b16 a[22:23], v17 offset:22528
    s_waitcnt lgkmcnt(12)
    v_mfma_f32_32x32x16_bf16 v[176:191], a[60:63], a[140:143], v[176:191]
    ds_read_b64_tr_b16 a[24:25], v18 offset:20480
    ds_read_b64_tr_b16 a[26:27], v18 offset:22528
    buffer_load_dwordx4 v[232:235], v2, s[8:11], s62 offen offset:2048 sc1
    s_waitcnt lgkmcnt(12)
    v_mfma_f32_32x32x16_bf16 v[128:143], a[0:3], a[144:147], v[128:143]
    ds_read_b64_tr_b16 a[28:29], v19 offset:20480
    ds_read_b64_tr_b16 a[30:31], v19 offset:22528
    buffer_load_dwordx4 v[236:239], v2, s[8:11], s62 offen offset:3072 sc1
    s_add_u32 s62, s62, 4096
    s_waitcnt lgkmcnt(12)
    v_mfma_f32_32x32x16_bf16 v[144:159], a[4:7], a[144:147], v[144:159]
    ds_read_b64_tr_b16 a[32:33], v16 offset:24576
    ds_read_b64_tr_b16 a[34:35], v16 offset:26624
    s_waitcnt lgkmcnt(12)
    v_mfma_f32_32x32x16_bf16 v[160:175], a[8:11], a[144:147], v[160:175]
    ds_read_b64_tr_b16 a[36:37], v17 offset:24576
    ds_read_b64_tr_b16 a[38:39], v17 offset:26624
    buffer_load_dwordx4 v[240:243], v2, s[8:11], s62 offen offset:0 sc1
    s_waitcnt lgkmcnt(12)
    v_mfma_f32_32x32x16_bf16 v[176:191], a[12:15], a[144:147], v[176:191]
    ds_read_b64_tr_b16 a[40:41], v18 offset:24576
    ds_read_b64_tr_b16 a[42:43], v18 offset:26624
    buffer_load_dwordx4 v[244:247], v2, s[8:11], s62 offen offset:1024 sc1
    s_waitcnt lgkmcnt(12)
    v_mfma_f32_32x32x16_bf16 v[128:143], a[16:19], a[148:151], v[128:143]
    ds_read_b64_tr_b16 a[44:45], v19 offset:24576
    ds_read_b64_tr_b16 a[46:47], v19 offset:26624
    s_waitcnt lgkmcnt(12)
    v_mfma_f32_32x32x16_bf16 v[144:159], a[20:23], a[148:151], v[144:159]
    ds_read_b64_tr_b16 a[48:49], v16 offset:28672
    ds_read_b64_tr_b16 a[50:51], v16 offset:30720
    buffer_load_dwordx4 v[248:251], v2, s[8:11], s62 offen offset:2048 sc1
    s_waitcnt lgkmcnt(12)
    v_mfma_f32_32x32x16_bf16 v[160:175], a[24:27], a[148:151], v[160:175]
    ds_read_b64_tr_b16 a[52:53], v17 offset:28672
    ds_read_b64_tr_b16 a[54:55], v17 offset:30720
    s_waitcnt lgkmcnt(12)
    v_mfma_f32_32x32x16_bf16 v[176:191], a[28:31], a[148:151], v[176:191]
    ds_read_b64_tr_b16 a[56:57], v18 offset:28672
    ds_read_b64_tr_b16 a[58:59], v18 offset:30720
    buffer_load_dwordx4 v[252:255], v2, s[8:11], s62 offen offset:3072 sc1
    s_add_u32 s62, s62, 4096
    s_waitcnt lgkmcnt(12)
    v_mfma_f32_32x32x16_bf16 v[128:143], a[32:35], a[152:155], v[128:143]
    ds_read_b64_tr_b16 a[60:61], v19 offset:28672
    ds_read_b64_tr_b16 a[62:63], v19 offset:30720
    s_waitcnt lgkmcnt(12)
    v_mfma_f32_32x32x16_bf16 v[144:159], a[36:39], a[152:155], v[144:159]
    s_waitcnt lgkmcnt(10)
    v_mfma_f32_32x32x16_bf16 v[160:175], a[40:43], a[152:155], v[160:175]
    s_waitcnt lgkmcnt(8)
    v_mfma_f32_32x32x16_bf16 v[176:191], a[44:47], a[152:155], v[176:191]
    s_waitcnt vmcnt(16) lgkmcnt(0)
    s_barrier
    ds_read_b64_tr_b16 a[0:1], v16 offset:32768
    ds_read_b64_tr_b16 a[2:3], v16 offset:34816
    ds_read_b64_tr_b16 a[4:5], v17 offset:32768
    ds_read_b64_tr_b16 a[6:7], v17 offset:34816
    ds_read_b64_tr_b16 a[8:9], v18 offset:32768
    ds_read_b64_tr_b16 a[10:11], v18 offset:34816
    v_mfma_f32_32x32x16_bf16 v[128:143], a[48:51], a[156:159], v[128:143]
    ds_read_b64_tr_b16 a[12:13], v19 offset:32768
    ds_read_b64_tr_b16 a[14:15], v19 offset:34816
    v_mfma_f32_32x32x16_bf16 v[144:159], a[52:55], a[156:159], v[144:159]
    ds_read_b64_tr_b16 a[16:17], v16 offset:36864
    ds_read_b64_tr_b16 a[18:19], v16 offset:38912
    v_mfma_f32_32x32x16_bf16 v[160:175], a[56:59], a[156:159], v[160:175]
    ds_read_b64_tr_b16 a[20:21], v17 offset:36864
    ds_read_b64_tr_b16 a[22:23], v17 offset:38912
    v_mfma_f32_32x32x16_bf16 v[176:191], a[60:63], a[156:159], v[176:191]
    ds_read_b64_tr_b16 a[24:25], v18 offset:36864
    ds_read_b64_tr_b16 a[26:27], v18 offset:38912
    s_waitcnt lgkmcnt(12)
    v_mfma_f32_32x32x16_bf16 v[128:143], a[0:3], a[224:227], v[128:143]
    ds_read_b64_tr_b16 a[28:29], v19 offset:36864
    ds_read_b64_tr_b16 a[30:31], v19 offset:38912
    s_waitcnt lgkmcnt(12)
    v_mfma_f32_32x32x16_bf16 v[144:159], a[4:7], a[224:227], v[144:159]
    ds_read_b64_tr_b16 a[32:33], v16 offset:40960
    ds_read_b64_tr_b16 a[34:35], v16 offset:43008
    s_waitcnt lgkmcnt(12)
    v_mfma_f32_32x32x16_bf16 v[160:175], a[8:11], a[224:227], v[160:175]
    ds_read_b64_tr_b16 a[36:37], v17 offset:40960
    ds_read_b64_tr_b16 a[38:39], v17 offset:43008
    s_waitcnt lgkmcnt(12)
    v_mfma_f32_32x32x16_bf16 v[176:191], a[12:15], a[224:227], v[176:191]
    ds_read_b64_tr_b16 a[40:41], v18 offset:40960
    ds_read_b64_tr_b16 a[42:43], v18 offset:43008
    s_waitcnt lgkmcnt(12)
    v_mfma_f32_32x32x16_bf16 v[128:143], a[16:19], a[228:231], v[128:143]
    ds_read_b64_tr_b16 a[44:45], v19 offset:40960
    ds_read_b64_tr_b16 a[46:47], v19 offset:43008
    s_waitcnt lgkmcnt(12)
    v_mfma_f32_32x32x16_bf16 v[144:159], a[20:23], a[228:231], v[144:159]
    ds_read_b64_tr_b16 a[48:49], v16 offset:45056
    ds_read_b64_tr_b16 a[50:51], v16 offset:47104
    s_waitcnt lgkmcnt(12)
    v_mfma_f32_32x32x16_bf16 v[160:175], a[24:27], a[228:231], v[160:175]
    ds_read_b64_tr_b16 a[52:53], v17 offset:45056
    ds_read_b64_tr_b16 a[54:55], v17 offset:47104
    s_waitcnt lgkmcnt(12)
    v_mfma_f32_32x32x16_bf16 v[176:191], a[28:31], a[228:231], v[176:191]
    ds_read_b64_tr_b16 a[56:57], v18 offset:45056
    ds_read_b64_tr_b16 a[58:59], v18 offset:47104
    s_waitcnt lgkmcnt(12)
    v_mfma_f32_32x32x16_bf16 v[128:143], a[32:35], a[232:235], v[128:143]
    ds_read_b64_tr_b16 a[60:61], v19 offset:45056
    ds_read_b64_tr_b16 a[62:63], v19 offset:47104
    s_waitcnt lgkmcnt(12)
    v_mfma_f32_32x32x16_bf16 v[144:159], a[36:39], a[232:235], v[144:159]
    ds_read_b64_tr_b16 a[0:1], v16 offset:49152
    ds_read_b64_tr_b16 a[2:3], v16 offset:51200
    s_waitcnt lgkmcnt(12)
    v_mfma_f32_32x32x16_bf16 v[160:175], a[40:43], a[232:235], v[160:175]
    ds_read_b64_tr_b16 a[4:5], v17 offset:49152
    ds_read_b64_tr_b16 a[6:7], v17 offset:51200
    s_waitcnt lgkmcnt(12)
    v_mfma_f32_32x32x16_bf16 v[176:191], a[44:47], a[232:235], v[176:191]
    ds_read_b64_tr_b16 a[8:9], v18 offset:49152
    ds_read_b64_tr_b16 a[10:11], v18 offset:51200
    s_waitcnt lgkmcnt(12)
    v_mfma_f32_32x32x16_bf16 v[128:143], a[48:51], a[236:239], v[128:143]
    ds_read_b64_tr_b16 a[12:13], v19 offset:49152
    ds_read_b64_tr_b16 a[14:15], v19 offset:51200
    s_waitcnt lgkmcnt(12)
    v_mfma_f32_32x32x16_bf16 v[144:159], a[52:55], a[236:239], v[144:159]
    ds_read_b64_tr_b16 a[16:17], v16 offset:53248
    ds_read_b64_tr_b16 a[18:19], v16 offset:55296
    s_waitcnt lgkmcnt(12)
    v_mfma_f32_32x32x16_bf16 v[160:175], a[56:59], a[236:239], v[160:175]
    ds_read_b64_tr_b16 a[20:21], v17 offset:53248
    ds_read_b64_tr_b16 a[22:23], v17 offset:55296
    s_waitcnt lgkmcnt(12)
    v_mfma_f32_32x32x16_bf16 v[176:191], a[60:63], a[236:239], v[176:191]
    ds_read_b64_tr_b16 a[24:25], v18 offset:53248
    ds_read_b64_tr_b16 a[26:27], v18 offset:55296
    s_waitcnt lgkmcnt(12)
    v_mfma_f32_32x32x16_bf16 v[128:143], a[0:3], a[240:243], v[128:143]
    ds_read_b64_tr_b16 a[28:29], v19 offset:53248
    ds_read_b64_tr_b16 a[30:31], v19 offset:55296
    s_waitcnt lgkmcnt(12)
    v_mfma_f32_32x32x16_bf16 v[144:159], a[4:7], a[240:243], v[144:159]
    ds_read_b64_tr_b16 a[32:33], v16 offset:57344
    ds_read_b64_tr_b16 a[34:35], v16 offset:59392
    s_waitcnt lgkmcnt(12)
    v_mfma_f32_32x32x16_bf16 v[160:175], a[8:11], a[240:243], v[160:175]
    ds_read_b64_tr_b16 a[36:37], v17 offset:57344
    ds_read_b64_tr_b16 a[38:39], v17 offset:59392
    s_waitcnt lgkmcnt(12)
    v_mfma_f32_32x32x16_bf16 v[176:191], a[12:15], a[240:243], v[176:191]
    ds_read_b64_tr_b16 a[40:41], v18 offset:57344
    ds_read_b64_tr_b16 a[42:43], v18 offset:59392
    s_waitcnt lgkmcnt(12)
    v_mfma_f32_32x32x16_bf16 v[128:143], a[16:19], a[244:247], v[128:143]
    ds_read_b64_tr_b16 a[44:45], v19 offset:57344
    ds_read_b64_tr_b16 a[46:47], v19 offset:59392
    s_waitcnt lgkmcnt(12)
    v_mfma_f32_32x32x16_bf16 v[144:159], a[20:23], a[244:247], v[144:159]
    ds_read_b64_tr_b16 a[48:49], v16 offset:61440
    ds_read_b64_tr_b16 a[50:51], v16 offset:63488
    s_waitcnt lgkmcnt(12)
    v_mfma_f32_32x32x16_bf16 v[160:175], a[24:27], a[244:247], v[160:175]
    ds_read_b64_tr_b16 a[52:53], v17 offset:61440
    ds_read_b64_tr_b16 a[54:55], v17 offset:63488
    s_waitcnt lgkmcnt(12)
    v_mfma_f32_32x32x16_bf16 v[176:191], a[28:31], a[244:247], v[176:191]
    ds_read_b64_tr_b16 a[56:57], v18 offset:61440
    ds_read_b64_tr_b16 a[58:59], v18 offset:63488
    s_waitcnt lgkmcnt(12)
    v_mfma_f32_32x32x16_bf16 v[128:143], a[32:35], a[248:251], v[128:143]
    ds_read_b64_tr_b16 a[60:61], v19 offset:61440
    ds_read_b64_tr_b16 a[62:63], v19 offset:63488
    s_waitcnt lgkmcnt(12)
    v_mfma_f32_32x32x16_bf16 v[144:159], a[36:39], a[248:251], v[144:159]
    s_waitcnt lgkmcnt(10)
    v_mfma_f32_32x32x16_bf16 v[160:175], a[40:43], a[248:251], v[160:175]
    s_waitcnt lgkmcnt(8)
    v_mfma_f32_32x32x16_bf16 v[176:191], a[44:47], a[248:251], v[176:191]
    s_waitcnt lgkmcnt(6)
    v_mfma_f32_32x32x16_bf16 v[128:143], a[48:51], a[252:255], v[128:143]
    s_waitcnt lgkmcnt(4)
    v_mfma_f32_32x32x16_bf16 v[144:159], a[52:55], a[252:255], v[144:159]
    s_waitcnt lgkmcnt(2)
    v_mfma_f32_32x32x16_bf16 v[160:175], a[56:59], a[252:255], v[160:175]
    s_waitcnt lgkmcnt(0)
    v_mfma_f32_32x32x16_bf16 v[176:191], a[60:63], a[252:255], v[176:191]
    s_nop 7
    s_nop 3
    s_waitcnt vmcnt(14)
    v_pk_add_f32 v[128:129], v[128:129], v[192:193]
    v_pk_add_f32 v[130:131], v[130:131], v[194:195]
    v_xor_b32 v26, 0, v21
    v_cvt_pk_bf16_f32 v80, v128, v129
    v_cvt_pk_bf16_f32 v81, v130, v131
    ds_write_b64 v26, v[80:81]
    v_pk_add_f32 v[132:133], v[132:133], v[196:197]
    v_pk_add_f32 v[134:135], v[134:135], v[198:199]
    v_xor_b32 v26, 16, v21
    v_cvt_pk_bf16_f32 v82, v132, v133
    v_cvt_pk_bf16_f32 v83, v134, v135
    ds_write_b64 v26, v[82:83]
    s_waitcnt vmcnt(12)
    v_pk_add_f32 v[136:137], v[136:137], v[200:201]
    v_pk_add_f32 v[138:139], v[138:139], v[202:203]
    v_xor_b32 v26, 32, v21
    v_cvt_pk_bf16_f32 v84, v136, v137
    v_cvt_pk_bf16_f32 v85, v138, v139
    ds_write_b64 v26, v[84:85]
    v_pk_add_f32 v[140:141], v[140:141], v[204:205]
    v_pk_add_f32 v[142:143], v[142:143], v[206:207]
    v_xor_b32 v26, 48, v21
    v_cvt_pk_bf16_f32 v86, v140, v141
    v_cvt_pk_bf16_f32 v87, v142, v143
    ds_write_b64 v26, v[86:87]
    s_waitcnt vmcnt(10)
    v_pk_add_f32 v[144:145], v[144:145], v[208:209]
    v_pk_add_f32 v[146:147], v[146:147], v[210:211]
    v_xor_b32 v26, 64, v21
    v_cvt_pk_bf16_f32 v88, v144, v145
    v_cvt_pk_bf16_f32 v89, v146, v147
    ds_write_b64 v26, v[88:89]
    v_pk_add_f32 v[148:149], v[148:149], v[212:213]
    v_pk_add_f32 v[150:151], v[150:151], v[214:215]
    v_xor_b32 v26, 80, v21
    v_cvt_pk_bf16_f32 v90, v148, v149
    v_cvt_pk_bf16_f32 v91, v150, v151
    ds_write_b64 v26, v[90:91]
    s_waitcnt vmcnt(8)
    v_pk_add_f32 v[152:153], v[152:153], v[216:217]
    v_pk_add_f32 v[154:155], v[154:155], v[218:219]
    v_xor_b32 v26, 96, v21
    v_cvt_pk_bf16_f32 v92, v152, v153
    v_cvt_pk_bf16_f32 v93, v154, v155
    ds_write_b64 v26, v[92:93]
    v_pk_add_f32 v[156:157], v[156:157], v[220:221]
    v_pk_add_f32 v[158:159], v[158:159], v[222:223]
    v_xor_b32 v26, 112, v21
    v_cvt_pk_bf16_f32 v94, v156, v157
    v_cvt_pk_bf16_f32 v95, v158, v159
    ds_write_b64 v26, v[94:95]
    s_waitcnt lgkmcnt(4)
    s_waitcnt vmcnt(6)
    v_pk_add_f32 v[160:161], v[160:161], v[224:225]
    v_pk_add_f32 v[162:163], v[162:163], v[226:227]
    v_xor_b32 v26, 128, v21
    v_cvt_pk_bf16_f32 v96, v160, v161
    v_cvt_pk_bf16_f32 v97, v162, v163
    ds_write_b64 v26, v[96:97]
    v_pk_add_f32 v[164:165], v[164:165], v[228:229]
    v_pk_add_f32 v[166:167], v[166:167], v[230:231]
    v_xor_b32 v26, 144, v21
    v_cvt_pk_bf16_f32 v98, v164, v165
    v_cvt_pk_bf16_f32 v99, v166, v167
    ds_write_b64 v26, v[98:99]
    s_waitcnt vmcnt(4)
    v_pk_add_f32 v[168:169], v[168:169], v[232:233]
    v_pk_add_f32 v[170:171], v[170:171], v[234:235]
    v_xor_b32 v26, 160, v21
    v_cvt_pk_bf16_f32 v100, v168, v169
    v_cvt_pk_bf16_f32 v101, v170, v171
    ds_write_b64 v26, v[100:101]
    v_pk_add_f32 v[172:173], v[172:173], v[236:237]
    v_pk_add_f32 v[174:175], v[174:175], v[238:239]
    v_xor_b32 v26, 176, v21
    v_cvt_pk_bf16_f32 v102, v172, v173
    v_cvt_pk_bf16_f32 v103, v174, v175
    ds_write_b64 v26, v[102:103]
    s_waitcnt vmcnt(2)
    v_pk_add_f32 v[176:177], v[176:177], v[240:241]
    v_pk_add_f32 v[178:179], v[178:179], v[242:243]
    v_xor_b32 v26, 192, v21
    v_cvt_pk_bf16_f32 v104, v176, v177
    v_cvt_pk_bf16_f32 v105, v178, v179
    ds_write_b64 v26, v[104:105]
    v_pk_add_f32 v[180:181], v[180:181], v[244:245]
    v_pk_add_f32 v[182:183], v[182:183], v[246:247]
    v_xor_b32 v26, 208, v21
    v_cvt_pk_bf16_f32 v106, v180, v181
    v_cvt_pk_bf16_f32 v107, v182, v183
    ds_write_b64 v26, v[106:107]
    s_waitcnt vmcnt(0)
    v_pk_add_f32 v[184:185], v[184:185], v[248:249]
    v_pk_add_f32 v[186:187], v[186:187], v[250:251]
    v_xor_b32 v26, 224, v21
    v_cvt_pk_bf16_f32 v108, v184, v185
    v_cvt_pk_bf16_f32 v109, v186, v187
    ds_write_b64 v26, v[108:109]
    v_pk_add_f32 v[188:189], v[188:189], v[252:253]
    v_pk_add_f32 v[190:191], v[190:191], v[254:255]
    v_xor_b32 v26, 240, v21
    v_cvt_pk_bf16_f32 v110, v188, v189
    v_cvt_pk_bf16_f32 v111, v190, v191
    ds_write_b64 v26, v[110:111]
    s_add_u32 s3, s39, 32768
    s_waitcnt lgkmcnt(0)
    ds_read_b128 v[48:51], v20 offset:0
    ds_read_b128 v[52:55], v20 offset:1024
    ds_read_b128 v[56:59], v20 offset:2048
    ds_read_b128 v[60:63], v20 offset:3072
    ds_read_b128 v[64:67], v20 offset:4096
    ds_read_b128 v[68:71], v20 offset:5120
    ds_read_b128 v[72:75], v20 offset:6144
    ds_read_b128 v[76:79], v20 offset:7168
    s_waitcnt lgkmcnt(7)
    buffer_store_dwordx4 v[48:51], v28, s[20:23], s39 offen offset:0
    s_waitcnt lgkmcnt(6)
    buffer_store_dwordx4 v[52:55], v29, s[20:23], s39 offen offset:1024
    s_waitcnt lgkmcnt(5)
    buffer_store_dwordx4 v[56:59], v30, s[20:23], s39 offen offset:2048
    s_waitcnt lgkmcnt(4)
    buffer_store_dwordx4 v[60:63], v31, s[20:23], s39 offen offset:3072
    s_waitcnt lgkmcnt(3)
    buffer_store_dwordx4 v[64:67], v28, s[20:23], s3 offen offset:0
    s_waitcnt lgkmcnt(2)
    buffer_store_dwordx4 v[68:71], v29, s[20:23], s3 offen offset:1024
    s_waitcnt lgkmcnt(1)
    buffer_store_dwordx4 v[72:75], v30, s[20:23], s3 offen offset:2048
    s_waitcnt lgkmcnt(0)
    buffer_store_dwordx4 v[76:79], v31, s[20:23], s3 offen offset:3072
    s_endpgm
L_help:
    s_mov_b32 s20, s84
    s_mov_b32 s21, s85
    s_mov_b32 s22, 0x400000
    s_mov_b32 s23, 0x20000
    s_mov_b32 s44, s98
    s_mov_b32 s45, s99
    s_mov_b32 s46, 0x800
    s_mov_b32 s47, 0x20000
    s_mov_b32 s58, 0xffff0000
    s_waitcnt vmcnt(36)
    s_barrier
    ds_read_b64_tr_b16 a[0:1], v16 offset:32768
    ds_read_b64_tr_b16 a[2:3], v16 offset:34816
    ds_read_b64_tr_b16 a[4:5], v17 offset:32768
    ds_read_b64_tr_b16 a[6:7], v17 offset:34816
    ds_read_b64_tr_b16 a[8:9], v18 offset:32768
    ds_read_b64_tr_b16 a[10:11], v18 offset:34816
    ds_read_b64_tr_b16 a[12:13], v19 offset:32768
    ds_read_b64_tr_b16 a[14:15], v19 offset:34816
    ds_read_b64_tr_b16 a[16:17], v16 offset:36864
    ds_read_b64_tr_b16 a[18:19], v16 offset:38912
    ds_read_b64_tr_b16 a[20:21], v17 offset:36864
    ds_read_b64_tr_b16 a[22:23], v17 offset:38912
    ds_read_b64_tr_b16 a[24:25], v18 offset:36864
    ds_read_b64_tr_b16 a[26:27], v18 offset:38912
    s_add_u32 m0, s34, 65536
    s_add_u32 s35, s32, 0
    buffer_load_dwordx4 v8, s[16:19], s35 offen offset:0 lds
    s_waitcnt lgkmcnt(12)
    v_mfma_f32_32x32x16_bf16 v[128:143], a[0:3], a[224:227], 0
    ds_read_b64_tr_b16 a[28:29], v19 offset:36864
    ds_read_b64_tr_b16 a[30:31], v19 offset:38912
    buffer_load_dwordx4 a[128:131], v2, s[8:11], s37 offen offset:0 sc1
    s_waitcnt lgkmcnt(12)
    v_mfma_f32_32x32x16_bf16 v[144:159], a[4:7], a[224:227], 0
    ds_read_b64_tr_b16 a[32:33], v16 offset:40960
    ds_read_b64_tr_b16 a[34:35], v16 offset:43008
    s_waitcnt lgkmcnt(12)
    v_mfma_f32_32x32x16_bf16 v[160:175], a[8:11], a[224:227], 0
    ds_read_b64_tr_b16 a[36:37], v17 offset:40960
    ds_read_b64_tr_b16 a[38:39], v17 offset:43008
    buffer_load_dwordx4 v9, s[16:19], s35 offen offset:1024 lds
    s_waitcnt lgkmcnt(12)
    v_mfma_f32_32x32x16_bf16 v[176:191], a[12:15], a[224:227], 0
    ds_read_b64_tr_b16 a[40:41], v18 offset:40960
    ds_read_b64_tr_b16 a[42:43], v18 offset:43008
    buffer_load_dwordx4 a[132:135], v2, s[8:11], s37 offen offset:1024 sc1
    s_waitcnt lgkmcnt(12)
    v_mfma_f32_32x32x16_bf16 v[128:143], a[16:19], a[228:231], v[128:143]
    ds_read_b64_tr_b16 a[44:45], v19 offset:40960
    ds_read_b64_tr_b16 a[46:47], v19 offset:43008
    s_waitcnt lgkmcnt(12)
    v_mfma_f32_32x32x16_bf16 v[144:159], a[20:23], a[228:231], v[144:159]
    ds_read_b64_tr_b16 a[48:49], v16 offset:45056
    ds_read_b64_tr_b16 a[50:51], v16 offset:47104
    buffer_load_dwordx4 v10, s[16:19], s35 offen offset:2048 lds
    s_waitcnt lgkmcnt(12)
    v_mfma_f32_32x32x16_bf16 v[160:175], a[24:27], a[228:231], v[160:175]
    ds_read_b64_tr_b16 a[52:53], v17 offset:45056
    ds_read_b64_tr_b16 a[54:55], v17 offset:47104
    s_waitcnt lgkmcnt(12)
    v_mfma_f32_32x32x16_bf16 v[176:191], a[28:31], a[228:231], v[176:191]
    ds_read_b64_tr_b16 a[56:57], v18 offset:45056
    ds_read_b64_tr_b16 a[58:59], v18 offset:47104
    buffer_load_dwordx4 a[136:139], v2, s[8:11], s37 offen offset:2048 sc1
    s_waitcnt lgkmcnt(12)
    v_mfma_f32_32x32x16_bf16 v[128:143], a[32:35], a[232:235], v[128:143]
    ds_read_b64_tr_b16 a[60:61], v19 offset:45056
    ds_read_b64_tr_b16 a[62:63], v19 offset:47104
    buffer_load_dwordx4 v11, s[16:19], s35 offen offset:3072 lds
    s_waitcnt lgkmcnt(12)
    v_mfma_f32_32x32x16_bf16 v[144:159], a[36:39], a[232:235], v[144:159]
    ds_read_b64_tr_b16 a[0:1], v16 offset:49152
    ds_read_b64_tr_b16 a[2:3], v16 offset:51200
    s_waitcnt lgkmcnt(12)
    v_mfma_f32_32x32x16_bf16 v[160:175], a[40:43], a[232:235], v[160:175]
    ds_read_b64_tr_b16 a[4:5], v17 offset:49152
    ds_read_b64_tr_b16 a[6:7], v17 offset:51200
    buffer_load_dwordx4 a[140:143], v2, s[8:11], s37 offen offset:3072 sc1
    s_add_u32 s37, s37, 4096
    s_waitcnt lgkmcnt(12)
    v_mfma_f32_32x32x16_bf16 v[176:191], a[44:47], a[232:235], v[176:191]
    ds_read_b64_tr_b16 a[8:9], v18 offset:49152
    ds_read_b64_tr_b16 a[10:11], v18 offset:51200
    s_add_u32 m0, s34, 69632
    s_add_u32 s35, s32, 32768
    buffer_load_dwordx4 v8, s[16:19], s35 offen offset:0 lds
    s_waitcnt lgkmcnt(12)
    v_mfma_f32_32x32x16_bf16 v[128:143], a[48:51], a[236:239], v[128:143]
    ds_read_b64_tr_b16 a[12:13], v19 offset:49152
    ds_read_b64_tr_b16 a[14:15], v19 offset:51200
    s_waitcnt lgkmcnt(12)
    v_mfma_f32_32x32x16_bf16 v[144:159], a[52:55], a[236:239], v[144:159]
    ds_read_b64_tr_b16 a[16:17], v16 offset:53248
    ds_read_b64_tr_b16 a[18:19], v16 offset:55296
    buffer_load_dwordx4 a[144:147], v2, s[8:11], s37 offen offset:0 sc1
    s_waitcnt lgkmcnt(12)
    v_mfma_f32_32x32x16_bf16 v[160:175], a[56:59], a[236:239], v[160:175]
    ds_read_b64_tr_b16 a[20:21], v17 offset:53248
    ds_read_b64_tr_b16 a[22:23], v17 offset:55296
    s_waitcnt lgkmcnt(12)
    v_mfma_f32_32x32x16_bf16 v[176:191], a[60:63], a[236:239], v[176:191]
    ds_read_b64_tr_b16 a[24:25], v18 offset:53248
    ds_read_b64_tr_b16 a[26:27], v18 offset:55296
    buffer_load_dwordx4 v9, s[16:19], s35 offen offset:1024 lds
    s_waitcnt lgkmcnt(12)
    v_mfma_f32_32x32x16_bf16 v[128:143], a[0:3], a[240:243], v[128:143]
    ds_read_b64_tr_b16 a[28:29], v19 offset:53248
    ds_read_b64_tr_b16 a[30:31], v19 offset:55296
    buffer_load_dwordx4 a[148:151], v2, s[8:11], s37 offen offset:1024 sc1
    s_waitcnt lgkmcnt(12)
    v_mfma_f32_32x32x16_bf16 v[144:159], a[4:7], a[240:243], v[144:159]
    ds_read_b64_tr_b16 a[32:33], v16 offset:57344
    ds_read_b64_tr_b16 a[34:35], v16 offset:59392
    s_waitcnt lgkmcnt(12)
    v_mfma_f32_32x32x16_bf16 v[160:175], a[8:11], a[240:243], v[160:175]
    ds_read_b64_tr_b16 a[36:37], v17 offset:57344
    ds_read_b64_tr_b16 a[38:39], v17 offset:59392
    buffer_load_dwordx4 v10, s[16:19], s35 offen offset:2048 lds
    s_waitcnt lgkmcnt(12)
    v_mfma_f32_32x32x16_bf16 v[176:191], a[12:15], a[240:243], v[176:191]
    ds_read_b64_tr_b16 a[40:41], v18 offset:57344
    ds_read_b64_tr_b16 a[42:43], v18 offset:59392
    buffer_load_dwordx4 a[152:155], v2, s[8:11], s37 offen offset:2048 sc1
    s_waitcnt lgkmcnt(12)
    v_mfma_f32_32x32x16_bf16 v[128:143], a[16:19], a[244:247], v[128:143]
    ds_read_b64_tr_b16 a[44:45], v19 offset:57344
    ds_read_b64_tr_b16 a[46:47], v19 offset:59392
    s_waitcnt lgkmcnt(12)
    v_mfma_f32_32x32x16_bf16 v[144:159], a[20:23], a[244:247], v[144:159]
    ds_read_b64_tr_b16 a[48:49], v16 offset:61440
    ds_read_b64_tr_b16 a[50:51], v16 offset:63488
    buffer_load_dwordx4 v11, s[16:19], s35 offen offset:3072 lds
    s_add_u32 s32, s32, 262144
    s_waitcnt lgkmcnt(12)
    v_mfma_f32_32x32x16_bf16 v[160:175], a[24:27], a[244:247], v[160:175]
    ds_read_b64_tr_b16 a[52:53], v17 offset:61440
    ds_read_b64_tr_b16 a[54:55], v17 offset:63488
    s_waitcnt lgkmcnt(12)
    v_mfma_f32_32x32x16_bf16 v[176:191], a[28:31], a[244:247], v[176:191]
    ds_read_b64_tr_b16 a[56:57], v18 offset:61440
    ds_read_b64_tr_b16 a[58:59], v18 offset:63488
    buffer_load_dwordx4 a[156:159], v2, s[8:11], s37 offen offset:3072 sc1
    s_add_u32 s37, s37, 4096
    s_waitcnt lgkmcnt(12)
    v_mfma_f32_32x32x16_bf16 v[128:143], a[32:35], a[248:251], v[128:143]
    ds_read_b64_tr_b16 a[60:61], v19 offset:61440
    ds_read_b64_tr_b16 a[62:63], v19 offset:63488
    s_waitcnt lgkmcnt(12)
    v_mfma_f32_32x32x16_bf16 v[144:159], a[36:39], a[248:251], v[144:159]
    s_waitcnt lgkmcnt(10)
    v_mfma_f32_32x32x16_bf16 v[160:175], a[40:43], a[248:251], v[160:175]
    s_waitcnt lgkmcnt(8)
    v_mfma_f32_32x32x16_bf16 v[176:191], a[44:47], a[248:251], v[176:191]
    s_waitcnt vmcnt(28) lgkmcnt(0)
    s_barrier
    ds_read_b64_tr_b16 a[0:1], v12 offset:0
    ds_read_b64_tr_b16 a[2:3], v12 offset:2048
    ds_read_b64_tr_b16 a[4:5], v13 offset:0
    ds_read_b64_tr_b16 a[6:7], v13 offset:2048
    ds_read_b64_tr_b16 a[8:9], v14 offset:0
    ds_read_b64_tr_b16 a[10:11], v14 offset:2048
    v_mfma_f32_32x32x16_bf16 v[128:143], a[48:51], a[252:255], v[128:143]
    ds_read_b64_tr_b16 a[12:13], v15 offset:0
    ds_read_b64_tr_b16 a[14:15], v15 offset:2048
    v_mfma_f32_32x32x16_bf16 v[144:159], a[52:55], a[252:255], v[144:159]
    ds_read_b64_tr_b16 a[16:17], v12 offset:4096
    ds_read_b64_tr_b16 a[18:19], v12 offset:6144
    v_mfma_f32_32x32x16_bf16 v[160:175], a[56:59], a[252:255], v[160:175]
    ds_read_b64_tr_b16 a[20:21], v13 offset:4096
    ds_read_b64_tr_b16 a[22:23], v13 offset:6144
    v_mfma_f32_32x32x16_bf16 v[176:191], a[60:63], a[252:255], v[176:191]
    ds_read_b64_tr_b16 a[24:25], v14 offset:4096
    ds_read_b64_tr_b16 a[26:27], v14 offset:6144
    s_add_u32 m0, s34, 98304
    s_add_u32 s35, s32, 0
    buffer_load_dwordx4 v8, s[16:19], s35 offen offset:0 lds
    s_waitcnt lgkmcnt(12)
    v_mfma_f32_32x32x16_bf16 v[128:143], a[0:3], a[64:67], v[128:143]
    ds_read_b64_tr_b16 a[28:29], v15 offset:4096
    ds_read_b64_tr_b16 a[30:31], v15 offset:6144
    buffer_load_dwordx4 a[224:227], v2, s[8:11], s37 offen offset:0 sc1
    s_waitcnt lgkmcnt(12)
    v_mfma_f32_32x32x16_bf16 v[144:159], a[4:7], a[64:67], v[144:159]
    ds_read_b64_tr_b16 a[32:33], v12 offset:8192
    ds_read_b64_tr_b16 a[34:35], v12 offset:10240
    s_waitcnt lgkmcnt(12)
    v_mfma_f32_32x32x16_bf16 v[160:175], a[8:11], a[64:67], v[160:175]
    ds_read_b64_tr_b16 a[36:37], v13 offset:8192
    ds_read_b64_tr_b16 a[38:39], v13 offset:10240
    buffer_load_dwordx4 v9, s[16:19], s35 offen offset:1024 lds
    s_waitcnt lgkmcnt(12)
    v_mfma_f32_32x32x16_bf16 v[176:191], a[12:15], a[64:67], v[176:191]
    ds_read_b64_tr_b16 a[40:41], v14 offset:8192
    ds_read_b64_tr_b16 a[42:43], v14 offset:10240
    buffer_load_dwordx4 a[228:231], v2, s[8:11], s37 offen offset:1024 sc1
    s_waitcnt lgkmcnt(12)
    v_mfma_f32_32x32x16_bf16 v[128:143], a[16:19], a[68:71], v[128:143]
    ds_read_b64_tr_b16 a[44:45], v15 offset:8192
    ds_read_b64_tr_b16 a[46:47], v15 offset:10240
    s_waitcnt lgkmcnt(12)
    v_mfma_f32_32x32x16_bf16 v[144:159], a[20:23], a[68:71], v[144:159]
    ds_read_b64_tr_b16 a[48:49], v12 offset:12288
    ds_read_b64_tr_b16 a[50:51], v12 offset:14336
    buffer_load_dwordx4 v10, s[16:19], s35 offen offset:2048 lds
    s_waitcnt lgkmcnt(12)
    v_mfma_f32_32x32x16_bf16 v[160:175], a[24:27], a[68:71], v[160:175]
    ds_read_b64_tr_b16 a[52:53], v13 offset:12288
    ds_read_b64_tr_b16 a[54:55], v13 offset:14336
    s_waitcnt lgkmcnt(12)
    v_mfma_f32_32x32x16_bf16 v[176:191], a[28:31], a[68:71], v[176:191]
    ds_read_b64_tr_b16 a[56:57], v14 offset:12288
    ds_read_b64_tr_b16 a[58:59], v14 offset:14336
    buffer_load_dwordx4 a[232:235], v2, s[8:11], s37 offen offset:2048 sc1
    s_waitcnt lgkmcnt(12)
    v_mfma_f32_32x32x16_bf16 v[128:143], a[32:35], a[72:75], v[128:143]
    ds_read_b64_tr_b16 a[60:61], v15 offset:12288
    ds_read_b64_tr_b16 a[62:63], v15 offset:14336
    buffer_load_dwordx4 v11, s[16:19], s35 offen offset:3072 lds
    s_waitcnt lgkmcnt(12)
    v_mfma_f32_32x32x16_bf16 v[144:159], a[36:39], a[72:75], v[144:159]
    ds_read_b64_tr_b16 a[0:1], v12 offset:16384
    ds_read_b64_tr_b16 a[2:3], v12 offset:18432
    s_waitcnt lgkmcnt(12)
    v_mfma_f32_32x32x16_bf16 v[160:175], a[40:43], a[72:75], v[160:175]
    ds_read_b64_tr_b16 a[4:5], v13 offset:16384
    ds_read_b64_tr_b16 a[6:7], v13 offset:18432
    buffer_load_dwordx4 a[236:239], v2, s[8:11], s37 offen offset:3072 sc1
    s_add_u32 s37, s37, 4096
    s_waitcnt lgkmcnt(12)
    v_mfma_f32_32x32x16_bf16 v[176:191], a[44:47], a[72:75], v[176:191]
    ds_read_b64_tr_b16 a[8:9], v14 offset:16384
    ds_read_b64_tr_b16 a[10:11], v14 offset:18432
    s_add_u32 m0, s34, 102400
    s_add_u32 s35, s32, 32768
    buffer_load_dwordx4 v8, s[16:19], s35 offen offset:0 lds
    s_waitcnt lgkmcnt(12)
    v_mfma_f32_32x32x16_bf16 v[128:143], a[48:51], a[76:79], v[128:143]
    ds_read_b64_tr_b16 a[12:13], v15 offset:16384
    ds_read_b64_tr_b16 a[14:15], v15 offset:18432
    s_waitcnt lgkmcnt(12)
    v_mfma_f32_32x32x16_bf16 v[144:159], a[52:55], a[76:79], v[144:159]
    ds_read_b64_tr_b16 a[16:17], v12 offset:20480
    ds_read_b64_tr_b16 a[18:19], v12 offset:22528
    buffer_load_dwordx4 a[240:243], v2, s[8:11], s37 offen offset:0 sc1
    s_waitcnt lgkmcnt(12)
    v_mfma_f32_32x32x16_bf16 v[160:175], a[56:59], a[76:79], v[160:175]
    ds_read_b64_tr_b16 a[20:21], v13 offset:20480
    ds_read_b64_tr_b16 a[22:23], v13 offset:22528
    s_waitcnt lgkmcnt(12)
    v_mfma_f32_32x32x16_bf16 v[176:191], a[60:63], a[76:79], v[176:191]
    ds_read_b64_tr_b16 a[24:25], v14 offset:20480
    ds_read_b64_tr_b16 a[26:27], v14 offset:22528
    buffer_load_dwordx4 v9, s[16:19], s35 offen offset:1024 lds
    s_waitcnt lgkmcnt(12)
    v_mfma_f32_32x32x16_bf16 v[128:143], a[0:3], a[80:83], v[128:143]
    ds_read_b64_tr_b16 a[28:29], v15 offset:20480
    ds_read_b64_tr_b16 a[30:31], v15 offset:22528
    buffer_load_dwordx4 a[244:247], v2, s[8:11], s37 offen offset:1024 sc1
    s_waitcnt lgkmcnt(12)
    v_mfma_f32_32x32x16_bf16 v[144:159], a[4:7], a[80:83], v[144:159]
    ds_read_b64_tr_b16 a[32:33], v12 offset:24576
    ds_read_b64_tr_b16 a[34:35], v12 offset:26624
    s_waitcnt lgkmcnt(12)
    v_mfma_f32_32x32x16_bf16 v[160:175], a[8:11], a[80:83], v[160:175]
    ds_read_b64_tr_b16 a[36:37], v13 offset:24576
    ds_read_b64_tr_b16 a[38:39], v13 offset:26624
    buffer_load_dwordx4 v10, s[16:19], s35 offen offset:2048 lds
    s_waitcnt lgkmcnt(12)
    v_mfma_f32_32x32x16_bf16 v[176:191], a[12:15], a[80:83], v[176:191]
    ds_read_b64_tr_b16 a[40:41], v14 offset:24576
    ds_read_b64_tr_b16 a[42:43], v14 offset:26624
    buffer_load_dwordx4 a[248:251], v2, s[8:11], s37 offen offset:2048 sc1
    s_waitcnt lgkmcnt(12)
    v_mfma_f32_32x32x16_bf16 v[128:143], a[16:19], a[84:87], v[128:143]
    ds_read_b64_tr_b16 a[44:45], v15 offset:24576
    ds_read_b64_tr_b16 a[46:47], v15 offset:26624
    s_waitcnt lgkmcnt(12)
    v_mfma_f32_32x32x16_bf16 v[144:159], a[20:23], a[84:87], v[144:159]
    ds_read_b64_tr_b16 a[48:49], v12 offset:28672
    ds_read_b64_tr_b16 a[50:51], v12 offset:30720
    buffer_load_dwordx4 v11, s[16:19], s35 offen offset:3072 lds
    s_add_u32 s32, s32, 262144
    s_waitcnt lgkmcnt(12)
    v_mfma_f32_32x32x16_bf16 v[160:175], a[24:27], a[84:87], v[160:175]
    ds_read_b64_tr_b16 a[52:53], v13 offset:28672
    ds_read_b64_tr_b16 a[54:55], v13 offset:30720
    s_waitcnt lgkmcnt(12)
    v_mfma_f32_32x32x16_bf16 v[176:191], a[28:31], a[84:87], v[176:191]
    ds_read_b64_tr_b16 a[56:57], v14 offset:28672
    ds_read_b64_tr_b16 a[58:59], v14 offset:30720
    buffer_load_dwordx4 a[252:255], v2, s[8:11], s37 offen offset:3072 sc1
    s_add_u32 s37, s37, 4096
    s_waitcnt lgkmcnt(12)
    v_mfma_f32_32x32x16_bf16 v[128:143], a[32:35], a[88:91], v[128:143]
    ds_read_b64_tr_b16 a[60:61], v15 offset:28672
    ds_read_b64_tr_b16 a[62:63], v15 offset:30720
    s_waitcnt lgkmcnt(12)
    v_mfma_f32_32x32x16_bf16 v[144:159], a[36:39], a[88:91], v[144:159]
    s_waitcnt lgkmcnt(10)
    v_mfma_f32_32x32x16_bf16 v[160:175], a[40:43], a[88:91], v[160:175]
    s_waitcnt lgkmcnt(8)
    v_mfma_f32_32x32x16_bf16 v[176:191], a[44:47], a[88:91], v[176:191]
    s_waitcnt vmcnt(32) lgkmcnt(0)
    s_barrier
    ds_read_b64_tr_b16 a[0:1], v12 offset:32768
    ds_read_b64_tr_b16 a[2:3], v12 offset:34816
    ds_read_b64_tr_b16 a[4:5], v13 offset:32768
    ds_read_b64_tr_b16 a[6:7], v13 offset:34816
    ds_read_b64_tr_b16 a[8:9], v14 offset:32768
    ds_read_b64_tr_b16 a[10:11], v14 offset:34816
    v_mfma_f32_32x32x16_bf16 v[128:143], a[48:51], a[92:95], v[128:143]
    ds_read_b64_tr_b16 a[12:13], v15 offset:32768
    ds_read_b64_tr_b16 a[14:15], v15 offset:34816
    v_mfma_f32_32x32x16_bf16 v[144:159], a[52:55], a[92:95], v[144:159]
    ds_read_b64_tr_b16 a[16:17], v12 offset:36864
    ds_read_b64_tr_b16 a[18:19], v12 offset:38912
    v_mfma_f32_32x32x16_bf16 v[160:175], a[56:59], a[92:95], v[160:175]
    ds_read_b64_tr_b16 a[20:21], v13 offset:36864
    ds_read_b64_tr_b16 a[22:23], v13 offset:38912
    v_mfma_f32_32x32x16_bf16 v[176:191], a[60:63], a[92:95], v[176:191]
    ds_read_b64_tr_b16 a[24:25], v14 offset:36864
    ds_read_b64_tr_b16 a[26:27], v14 offset:38912
    s_mov_b64 exec, 1
    v_mov_b32 v3, 1
    buffer_atomic_add v3, off, s[8:11], s69 sc1
    s_mov_b64 exec, -1
    s_add_u32 m0, s34, 0
    s_add_u32 s35, s32, 0
    buffer_load_dwordx4 v8, s[16:19], s35 offen offset:0 lds
    s_waitcnt lgkmcnt(12)
    v_mfma_f32_32x32x16_bf16 v[128:143], a[0:3], a[96:99], v[128:143]
    ds_read_b64_tr_b16 a[28:29], v15 offset:36864
    ds_read_b64_tr_b16 a[30:31], v15 offset:38912
    buffer_load_dwordx4 a[64:67], v2, s[8:11], s37 offen offset:0 sc1
    buffer_load_dwordx2 v[48:49], v22, s[44:47], s59 offen offset:0
    s_waitcnt lgkmcnt(12)
    v_mfma_f32_32x32x16_bf16 v[144:159], a[4:7], a[96:99], v[144:159]
    ds_read_b64_tr_b16 a[32:33], v12 offset:40960
    ds_read_b64_tr_b16 a[34:35], v12 offset:43008
    s_waitcnt lgkmcnt(12)
    v_mfma_f32_32x32x16_bf16 v[160:175], a[8:11], a[96:99], v[160:175]
    ds_read_b64_tr_b16 a[36:37], v13 offset:40960
    ds_read_b64_tr_b16 a[38:39], v13 offset:43008
    buffer_load_dwordx4 v9, s[16:19], s35 offen offset:1024 lds
    s_waitcnt lgkmcnt(12)
    v_mfma_f32_32x32x16_bf16 v[176:191], a[12:15], a[96:99], v[176:191]
    ds_read_b64_tr_b16 a[40:41], v14 offset:40960
    ds_read_b64_tr_b16 a[42:43], v14 offset:43008
    buffer_load_dwordx4 a[68:71], v2, s[8:11], s37 offen offset:1024 sc1
    s_waitcnt lgkmcnt(12)
    v_mfma_f32_32x32x16_bf16 v[128:143], a[16:19], a[100:103], v[128:143]
    ds_read_b64_tr_b16 a[44:45], v15 offset:40960
    ds_read_b64_tr_b16 a[46:47], v15 offset:43008
    s_waitcnt lgkmcnt(12)
    v_mfma_f32_32x32x16_bf16 v[144:159], a[20:23], a[100:103], v[144:159]
    ds_read_b64_tr_b16 a[48:49], v12 offset:45056
    ds_read_b64_tr_b16 a[50:51], v12 offset:47104
    buffer_load_dwordx4 v10, s[16:19], s35 offen offset:2048 lds
    s_waitcnt lgkmcnt(12)
    v_mfma_f32_32x32x16_bf16 v[160:175], a[24:27], a[100:103], v[160:175]
    ds_read_b64_tr_b16 a[52:53], v13 offset:45056
    ds_read_b64_tr_b16 a[54:55], v13 offset:47104
    s_waitcnt lgkmcnt(12)
    v_mfma_f32_32x32x16_bf16 v[176:191], a[28:31], a[100:103], v[176:191]
    ds_read_b64_tr_b16 a[56:57], v14 offset:45056
    ds_read_b64_tr_b16 a[58:59], v14 offset:47104
    buffer_load_dwordx4 a[72:75], v2, s[8:11], s37 offen offset:2048 sc1
    buffer_load_dwordx2 v[50:51], v22, s[44:47], s59 offen offset:16
    s_waitcnt lgkmcnt(12)
    v_mfma_f32_32x32x16_bf16 v[128:143], a[32:35], a[104:107], v[128:143]
    ds_read_b64_tr_b16 a[60:61], v15 offset:45056
    ds_read_b64_tr_b16 a[62:63], v15 offset:47104
    buffer_load_dwordx4 v11, s[16:19], s35 offen offset:3072 lds
    s_waitcnt lgkmcnt(12)
    v_mfma_f32_32x32x16_bf16 v[144:159], a[36:39], a[104:107], v[144:159]
    ds_read_b64_tr_b16 a[0:1], v12 offset:49152
    ds_read_b64_tr_b16 a[2:3], v12 offset:51200
    s_waitcnt lgkmcnt(12)
    v_mfma_f32_32x32x16_bf16 v[160:175], a[40:43], a[104:107], v[160:175]
    ds_read_b64_tr_b16 a[4:5], v13 offset:49152
    ds_read_b64_tr_b16 a[6:7], v13 offset:51200
    buffer_load_dwordx4 a[76:79], v2, s[8:11], s37 offen offset:3072 sc1
    s_add_u32 s37, s37, 4096
    s_waitcnt lgkmcnt(12)
    v_mfma_f32_32x32x16_bf16 v[176:191], a[44:47], a[104:107], v[176:191]
    ds_read_b64_tr_b16 a[8:9], v14 offset:49152
    ds_read_b64_tr_b16 a[10:11], v14 offset:51200
    s_add_u32 m0, s34, 4096
    s_add_u32 s35, s32, 32768
    buffer_load_dwordx4 v8, s[16:19], s35 offen offset:0 lds
    s_waitcnt lgkmcnt(12)
    v_mfma_f32_32x32x16_bf16 v[128:143], a[48:51], a[108:111], v[128:143]
    ds_read_b64_tr_b16 a[12:13], v15 offset:49152
    ds_read_b64_tr_b16 a[14:15], v15 offset:51200
    s_waitcnt lgkmcnt(12)
    v_mfma_f32_32x32x16_bf16 v[144:159], a[52:55], a[108:111], v[144:159]
    ds_read_b64_tr_b16 a[16:17], v12 offset:53248
    ds_read_b64_tr_b16 a[18:19], v12 offset:55296
    buffer_load_dwordx4 a[80:83], v2, s[8:11], s37 offen offset:0 sc1
    buffer_load_dwordx2 v[52:53], v22, s[44:47], s59 offen offset:32
    s_waitcnt lgkmcnt(12)
    v_mfma_f32_32x32x16_bf16 v[160:175], a[56:59], a[108:111], v[160:175]
    ds_read_b64_tr_b16 a[20:21], v13 offset:53248
    ds_read_b64_tr_b16 a[22:23], v13 offset:55296
    s_waitcnt lgkmcnt(12)
    v_mfma_f32_32x32x16_bf16 v[176:191], a[60:63], a[108:111], v[176:191]
    ds_read_b64_tr_b16 a[24:25], v14 offset:53248
    ds_read_b64_tr_b16 a[26:27], v14 offset:55296
    buffer_load_dwordx4 v9, s[16:19], s35 offen offset:1024 lds
    s_waitcnt lgkmcnt(12)
    v_mfma_f32_32x32x16_bf16 v[128:143], a[0:3], a[112:115], v[128:143]
    ds_read_b64_tr_b16 a[28:29], v15 offset:53248
    ds_read_b64_tr_b16 a[30:31], v15 offset:55296
    buffer_load_dwordx4 a[84:87], v2, s[8:11], s37 offen offset:1024 sc1
    s_waitcnt lgkmcnt(12)
    v_mfma_f32_32x32x16_bf16 v[144:159], a[4:7], a[112:115], v[144:159]
    ds_read_b64_tr_b16 a[32:33], v12 offset:57344
    ds_read_b64_tr_b16 a[34:35], v12 offset:59392
    s_waitcnt lgkmcnt(12)
    v_mfma_f32_32x32x16_bf16 v[160:175], a[8:11], a[112:115], v[160:175]
    ds_read_b64_tr_b16 a[36:37], v13 offset:57344
    ds_read_b64_tr_b16 a[38:39], v13 offset:59392
    buffer_load_dwordx4 v10, s[16:19], s35 offen offset:2048 lds
    s_waitcnt lgkmcnt(12)
    v_mfma_f32_32x32x16_bf16 v[176:191], a[12:15], a[112:115], v[176:191]
    ds_read_b64_tr_b16 a[40:41], v14 offset:57344
    ds_read_b64_tr_b16 a[42:43], v14 offset:59392
    buffer_load_dwordx4 a[88:91], v2, s[8:11], s37 offen offset:2048 sc1
    buffer_load_dwordx2 v[54:55], v22, s[44:47], s59 offen offset:48
    s_waitcnt lgkmcnt(12)
    v_mfma_f32_32x32x16_bf16 v[128:143], a[16:19], a[116:119], v[128:143]
    ds_read_b64_tr_b16 a[44:45], v15 offset:57344
    ds_read_b64_tr_b16 a[46:47], v15 offset:59392
    s_waitcnt lgkmcnt(12)
    v_mfma_f32_32x32x16_bf16 v[144:159], a[20:23], a[116:119], v[144:159]
    ds_read_b64_tr_b16 a[48:49], v12 offset:61440
    ds_read_b64_tr_b16 a[50:51], v12 offset:63488
    buffer_load_dwordx4 v11, s[16:19], s35 offen offset:3072 lds
    s_add_u32 s32, s32, 262144
    s_waitcnt lgkmcnt(12)
    v_mfma_f32_32x32x16_bf16 v[160:175], a[24:27], a[116:119], v[160:175]
    ds_read_b64_tr_b16 a[52:53], v13 offset:61440
    ds_read_b64_tr_b16 a[54:55], v13 offset:63488
    s_waitcnt lgkmcnt(12)
    v_mfma_f32_32x32x16_bf16 v[176:191], a[28:31], a[116:119], v[176:191]
    ds_read_b64_tr_b16 a[56:57], v14 offset:61440
    ds_read_b64_tr_b16 a[58:59], v14 offset:63488
    buffer_load_dwordx4 a[92:95], v2, s[8:11], s37 offen offset:3072 sc1
    s_add_u32 s37, s37, 4096
    s_sub_u32 m0, s34, 32768
    s_add_u32 s3, s39, 0
    buffer_load_dwordx4 v28, s[20:23], s3 offen offset:0 lds
    buffer_load_dwordx4 v29, s[20:23], s3 offen offset:1024 lds
    buffer_load_dwordx4 v30, s[20:23], s3 offen offset:2048 lds
    buffer_load_dwordx4 v31, s[20:23], s3 offen offset:3072 lds
    s_waitcnt lgkmcnt(12)
    v_mfma_f32_32x32x16_bf16 v[128:143], a[32:35], a[120:123], v[128:143]
    ds_read_b64_tr_b16 a[60:61], v15 offset:61440
    ds_read_b64_tr_b16 a[62:63], v15 offset:63488
    s_waitcnt lgkmcnt(12)
    v_mfma_f32_32x32x16_bf16 v[144:159], a[36:39], a[120:123], v[144:159]
    s_waitcnt lgkmcnt(10)
    v_mfma_f32_32x32x16_bf16 v[160:175], a[40:43], a[120:123], v[160:175]
    s_waitcnt lgkmcnt(8)
    v_mfma_f32_32x32x16_bf16 v[176:191], a[44:47], a[120:123], v[176:191]
    s_waitcnt vmcnt(41) lgkmcnt(0)
    s_barrier
    ds_read_b64_tr_b16 a[0:1], v16 offset:0
    ds_read_b64_tr_b16 a[2:3], v16 offset:2048
    ds_read_b64_tr_b16 a[4:5], v17 offset:0
    ds_read_b64_tr_b16 a[6:7], v17 offset:2048
    ds_read_b64_tr_b16 a[8:9], v18 offset:0
    ds_read_b64_tr_b16 a[10:11], v18 offset:2048
    v_mfma_f32_32x32x16_bf16 v[128:143], a[48:51], a[124:127], v[128:143]
    ds_read_b64_tr_b16 a[12:13], v19 offset:0
    ds_read_b64_tr_b16 a[14:15], v19 offset:2048
    v_mfma_f32_32x32x16_bf16 v[144:159], a[52:55], a[124:127], v[144:159]
    ds_read_b64_tr_b16 a[16:17], v16 offset:4096
    ds_read_b64_tr_b16 a[18:19], v16 offset:6144
    v_mfma_f32_32x32x16_bf16 v[160:175], a[56:59], a[124:127], v[160:175]
    ds_read_b64_tr_b16 a[20:21], v17 offset:4096
    ds_read_b64_tr_b16 a[22:23], v17 offset:6144
    v_mfma_f32_32x32x16_bf16 v[176:191], a[60:63], a[124:127], v[176:191]
    ds_read_b64_tr_b16 a[24:25], v18 offset:4096
    ds_read_b64_tr_b16 a[26:27], v18 offset:6144
    s_add_u32 m0, s34, 32768
    s_add_u32 s35, s32, 0
    buffer_load_dwordx4 v8, s[16:19], s35 offen offset:0 lds
    s_waitcnt lgkmcnt(12)
    v_mfma_f32_32x32x16_bf16 v[128:143], a[0:3], a[128:131], v[128:143]
    ds_read_b64_tr_b16 a[28:29], v19 offset:4096
    ds_read_b64_tr_b16 a[30:31], v19 offset:6144
    buffer_load_dwordx4 a[96:99], v2, s[8:11], s37 offen offset:0 sc1
    buffer_load_dwordx2 v[56:57], v22, s[44:47], s59 offen offset:64
    s_waitcnt lgkmcnt(12)
    v_mfma_f32_32x32x16_bf16 v[144:159], a[4:7], a[128:131], v[144:159]
    ds_read_b64_tr_b16 a[32:33], v16 offset:8192
    ds_read_b64_tr_b16 a[34:35], v16 offset:10240
    s_waitcnt lgkmcnt(12)
    v_mfma_f32_32x32x16_bf16 v[160:175], a[8:11], a[128:131], v[160:175]
    ds_read_b64_tr_b16 a[36:37], v17 offset:8192
    ds_read_b64_tr_b16 a[38:39], v17 offset:10240
    buffer_load_dwordx4 v9, s[16:19], s35 offen offset:1024 lds
    s_waitcnt lgkmcnt(12)
    v_mfma_f32_32x32x16_bf16 v[176:191], a[12:15], a[128:131], v[176:191]
    ds_read_b64_tr_b16 a[40:41], v18 offset:8192
    ds_read_b64_tr_b16 a[42:43], v18 offset:10240
    buffer_load_dwordx4 a[100:103], v2, s[8:11], s37 offen offset:1024 sc1
    s_waitcnt lgkmcnt(12)
    v_mfma_f32_32x32x16_bf16 v[128:143], a[16:19], a[132:135], v[128:143]
    ds_read_b64_tr_b16 a[44:45], v19 offset:8192
    ds_read_b64_tr_b16 a[46:47], v19 offset:10240
    s_waitcnt lgkmcnt(12)
    v_mfma_f32_32x32x16_bf16 v[144:159], a[20:23], a[132:135], v[144:159]
    ds_read_b64_tr_b16 a[48:49], v16 offset:12288
    ds_read_b64_tr_b16 a[50:51], v16 offset:14336
    buffer_load_dwordx4 v10, s[16:19], s35 offen offset:2048 lds
    s_waitcnt lgkmcnt(12)
    v_mfma_f32_32x32x16_bf16 v[160:175], a[24:27], a[132:135], v[160:175]
    ds_read_b64_tr_b16 a[52:53], v17 offset:12288
    ds_read_b64_tr_b16 a[54:55], v17 offset:14336
    s_waitcnt lgkmcnt(12)
    v_mfma_f32_32x32x16_bf16 v[176:191], a[28:31], a[132:135], v[176:191]
    ds_read_b64_tr_b16 a[56:57], v18 offset:12288
    ds_read_b64_tr_b16 a[58:59], v18 offset:14336
    buffer_load_dwordx4 a[104:107], v2, s[8:11], s37 offen offset:2048 sc1
    buffer_load_dwordx2 v[58:59], v22, s[44:47], s59 offen offset:80
    s_waitcnt lgkmcnt(12)
    v_mfma_f32_32x32x16_bf16 v[128:143], a[32:35], a[136:139], v[128:143]
    ds_read_b64_tr_b16 a[60:61], v19 offset:12288
    ds_read_b64_tr_b16 a[62:63], v19 offset:14336
    buffer_load_dwordx4 v11, s[16:19], s35 offen offset:3072 lds
    s_waitcnt lgkmcnt(12)
    v_mfma_f32_32x32x16_bf16 v[144:159], a[36:39], a[136:139], v[144:159]
    ds_read_b64_tr_b16 a[0:1], v16 offset:16384
    ds_read_b64_tr_b16 a[2:3], v16 offset:18432
    s_waitcnt lgkmcnt(12)
    v_mfma_f32_32x32x16_bf16 v[160:175], a[40:43], a[136:139], v[160:175]
    ds_read_b64_tr_b16 a[4:5], v17 offset:16384
    ds_read_b64_tr_b16 a[6:7], v17 offset:18432
    buffer_load_dwordx4 a[108:111], v2, s[8:11], s37 offen offset:3072 sc1
    s_add_u32 s37, s37, 4096
    s_waitcnt lgkmcnt(12)
    v_mfma_f32_32x32x16_bf16 v[176:191], a[44:47], a[136:139], v[176:191]
    ds_read_b64_tr_b16 a[8:9], v18 offset:16384
    ds_read_b64_tr_b16 a[10:11], v18 offset:18432
    s_add_u32 m0, s34, 36864
    s_add_u32 s35, s32, 32768
    buffer_load_dwordx4 v8, s[16:19], s35 offen offset:0 lds
    s_waitcnt lgkmcnt(12)
    v_mfma_f32_32x32x16_bf16 v[128:143], a[48:51], a[140:143], v[128:143]
    ds_read_b64_tr_b16 a[12:13], v19 offset:16384
    ds_read_b64_tr_b16 a[14:15], v19 offset:18432
    s_waitcnt lgkmcnt(12)
    v_mfma_f32_32x32x16_bf16 v[144:159], a[52:55], a[140:143], v[144:159]
    ds_read_b64_tr_b16 a[16:17], v16 offset:20480
    ds_read_b64_tr_b16 a[18:19], v16 offset:22528
    buffer_load_dwordx4 a[112:115], v2, s[8:11], s37 offen offset:0 sc1
    buffer_load_dwordx2 v[60:61], v22, s[44:47], s59 offen offset:96
    s_waitcnt lgkmcnt(12)
    v_mfma_f32_32x32x16_bf16 v[160:175], a[56:59], a[140:143], v[160:175]
    ds_read_b64_tr_b16 a[20:21], v17 offset:20480
    ds_read_b64_tr_b16 a[22:23], v17 offset:22528
    s_waitcnt lgkmcnt(12)
    v_mfma_f32_32x32x16_bf16 v[176:191], a[60:63], a[140:143], v[176:191]
    ds_read_b64_tr_b16 a[24:25], v18 offset:20480
    ds_read_b64_tr_b16 a[26:27], v18 offset:22528
    buffer_load_dwordx4 v9, s[16:19], s35 offen offset:1024 lds
    s_waitcnt lgkmcnt(12)
    v_mfma_f32_32x32x16_bf16 v[128:143], a[0:3], a[144:147], v[128:143]
    ds_read_b64_tr_b16 a[28:29], v19 offset:20480
    ds_read_b64_tr_b16 a[30:31], v19 offset:22528
    buffer_load_dwordx4 a[116:119], v2, s[8:11], s37 offen offset:1024 sc1
    s_waitcnt lgkmcnt(12)
    v_mfma_f32_32x32x16_bf16 v[144:159], a[4:7], a[144:147], v[144:159]
    ds_read_b64_tr_b16 a[32:33], v16 offset:24576
    ds_read_b64_tr_b16 a[34:35], v16 offset:26624
    s_waitcnt lgkmcnt(12)
    v_mfma_f32_32x32x16_bf16 v[160:175], a[8:11], a[144:147], v[160:175]
    ds_read_b64_tr_b16 a[36:37], v17 offset:24576
    ds_read_b64_tr_b16 a[38:39], v17 offset:26624
    buffer_load_dwordx4 v10, s[16:19], s35 offen offset:2048 lds
    s_waitcnt lgkmcnt(12)
    v_mfma_f32_32x32x16_bf16 v[176:191], a[12:15], a[144:147], v[176:191]
    ds_read_b64_tr_b16 a[40:41], v18 offset:24576
    ds_read_b64_tr_b16 a[42:43], v18 offset:26624
    buffer_load_dwordx4 a[120:123], v2, s[8:11], s37 offen offset:2048 sc1
    buffer_load_dwordx2 v[62:63], v22, s[44:47], s59 offen offset:112
    s_waitcnt lgkmcnt(12)
    v_mfma_f32_32x32x16_bf16 v[128:143], a[16:19], a[148:151], v[128:143]
    ds_read_b64_tr_b16 a[44:45], v19 offset:24576
    ds_read_b64_tr_b16 a[46:47], v19 offset:26624
    s_waitcnt lgkmcnt(12)
    v_mfma_f32_32x32x16_bf16 v[144:159], a[20:23], a[148:151], v[144:159]
    ds_read_b64_tr_b16 a[48:49], v16 offset:28672
    ds_read_b64_tr_b16 a[50:51], v16 offset:30720
    buffer_load_dwordx4 v11, s[16:19], s35 offen offset:3072 lds
    s_add_u32 s32, s32, 262144
    s_waitcnt lgkmcnt(12)
    v_mfma_f32_32x32x16_bf16 v[160:175], a[24:27], a[148:151], v[160:175]
    ds_read_b64_tr_b16 a[52:53], v17 offset:28672
    ds_read_b64_tr_b16 a[54:55], v17 offset:30720
    s_waitcnt lgkmcnt(12)
    v_mfma_f32_32x32x16_bf16 v[176:191], a[28:31], a[148:151], v[176:191]
    ds_read_b64_tr_b16 a[56:57], v18 offset:28672
    ds_read_b64_tr_b16 a[58:59], v18 offset:30720
    buffer_load_dwordx4 a[124:127], v2, s[8:11], s37 offen offset:3072 sc1
    s_add_u32 s37, s37, 4096
    s_sub_u32 m0, s34, 28672
    s_add_u32 s3, s39, 32768
    buffer_load_dwordx4 v28, s[20:23], s3 offen offset:0 lds
    buffer_load_dwordx4 v29, s[20:23], s3 offen offset:1024 lds
    buffer_load_dwordx4 v30, s[20:23], s3 offen offset:2048 lds
    buffer_load_dwordx4 v31, s[20:23], s3 offen offset:3072 lds
    s_waitcnt lgkmcnt(12)
    v_mfma_f32_32x32x16_bf16 v[128:143], a[32:35], a[152:155], v[128:143]
    ds_read_b64_tr_b16 a[60:61], v19 offset:28672
    ds_read_b64_tr_b16 a[62:63], v19 offset:30720
    s_waitcnt lgkmcnt(12)
    v_mfma_f32_32x32x16_bf16 v[144:159], a[36:39], a[152:155], v[144:159]
    s_waitcnt lgkmcnt(10)
    v_mfma_f32_32x32x16_bf16 v[160:175], a[40:43], a[152:155], v[160:175]
    s_waitcnt lgkmcnt(8)
    v_mfma_f32_32x32x16_bf16 v[176:191], a[44:47], a[152:155], v[176:191]
    s_waitcnt vmcnt(49) lgkmcnt(0)
    s_barrier
    ds_read_b64_tr_b16 a[0:1], v16 offset:32768
    ds_read_b64_tr_b16 a[2:3], v16 offset:34816
    ds_read_b64_tr_b16 a[4:5], v17 offset:32768
    ds_read_b64_tr_b16 a[6:7], v17 offset:34816
    ds_read_b64_tr_b16 a[8:9], v18 offset:32768
    ds_read_b64_tr_b16 a[10:11], v18 offset:34816
    v_mfma_f32_32x32x16_bf16 v[128:143], a[48:51], a[156:159], v[128:143]
    ds_read_b64_tr_b16 a[12:13], v19 offset:32768
    ds_read_b64_tr_b16 a[14:15], v19 offset:34816
    v_mfma_f32_32x32x16_bf16 v[144:159], a[52:55], a[156:159], v[144:159]
    ds_read_b64_tr_b16 a[16:17], v16 offset:36864
    ds_read_b64_tr_b16 a[18:19], v16 offset:38912
    v_mfma_f32_32x32x16_bf16 v[160:175], a[56:59], a[156:159], v[160:175]
    ds_read_b64_tr_b16 a[20:21], v17 offset:36864
    ds_read_b64_tr_b16 a[22:23], v17 offset:38912
    v_mfma_f32_32x32x16_bf16 v[176:191], a[60:63], a[156:159], v[176:191]
    ds_read_b64_tr_b16 a[24:25], v18 offset:36864
    ds_read_b64_tr_b16 a[26:27], v18 offset:38912
    s_add_u32 m0, s34, 65536
    s_add_u32 s35, s32, 0
    buffer_load_dwordx4 v8, s[16:19], s35 offen offset:0 lds
    s_waitcnt lgkmcnt(12)
    v_mfma_f32_32x32x16_bf16 v[128:143], a[0:3], a[224:227], v[128:143]
    ds_read_b64_tr_b16 a[28:29], v19 offset:36864
    ds_read_b64_tr_b16 a[30:31], v19 offset:38912
    buffer_load_dwordx4 a[128:131], v2, s[8:11], s37 offen offset:0 sc1
    buffer_load_dwordx2 v[64:65], v22, s[44:47], s59 offen offset:128
    s_waitcnt lgkmcnt(12)
    v_mfma_f32_32x32x16_bf16 v[144:159], a[4:7], a[224:227], v[144:159]
    ds_read_b64_tr_b16 a[32:33], v16 offset:40960
    ds_read_b64_tr_b16 a[34:35], v16 offset:43008
    s_waitcnt lgkmcnt(12)
    v_mfma_f32_32x32x16_bf16 v[160:175], a[8:11], a[224:227], v[160:175]
    ds_read_b64_tr_b16 a[36:37], v17 offset:40960
    ds_read_b64_tr_b16 a[38:39], v17 offset:43008
    buffer_load_dwordx4 v9, s[16:19], s35 offen offset:1024 lds
    s_waitcnt lgkmcnt(12)
    v_mfma_f32_32x32x16_bf16 v[176:191], a[12:15], a[224:227], v[176:191]
    ds_read_b64_tr_b16 a[40:41], v18 offset:40960
    ds_read_b64_tr_b16 a[42:43], v18 offset:43008
    buffer_load_dwordx4 a[132:135], v2, s[8:11], s37 offen offset:1024 sc1
    s_waitcnt lgkmcnt(12)
    v_mfma_f32_32x32x16_bf16 v[128:143], a[16:19], a[228:231], v[128:143]
    ds_read_b64_tr_b16 a[44:45], v19 offset:40960
    ds_read_b64_tr_b16 a[46:47], v19 offset:43008
    s_waitcnt lgkmcnt(12)
    v_mfma_f32_32x32x16_bf16 v[144:159], a[20:23], a[228:231], v[144:159]
    ds_read_b64_tr_b16 a[48:49], v16 offset:45056
    ds_read_b64_tr_b16 a[50:51], v16 offset:47104
    buffer_load_dwordx4 v10, s[16:19], s35 offen offset:2048 lds
    s_waitcnt lgkmcnt(12)
    v_mfma_f32_32x32x16_bf16 v[160:175], a[24:27], a[228:231], v[160:175]
    ds_read_b64_tr_b16 a[52:53], v17 offset:45056
    ds_read_b64_tr_b16 a[54:55], v17 offset:47104
    s_waitcnt lgkmcnt(12)
    v_mfma_f32_32x32x16_bf16 v[176:191], a[28:31], a[228:231], v[176:191]
    ds_read_b64_tr_b16 a[56:57], v18 offset:45056
    ds_read_b64_tr_b16 a[58:59], v18 offset:47104
    buffer_load_dwordx4 a[136:139], v2, s[8:11], s37 offen offset:2048 sc1
    buffer_load_dwordx2 v[66:67], v22, s[44:47], s59 offen offset:144
    s_waitcnt lgkmcnt(12)
    v_mfma_f32_32x32x16_bf16 v[128:143], a[32:35], a[232:235], v[128:143]
    ds_read_b64_tr_b16 a[60:61], v19 offset:45056
    ds_read_b64_tr_b16 a[62:63], v19 offset:47104
    buffer_load_dwordx4 v11, s[16:19], s35 offen offset:3072 lds
    s_waitcnt lgkmcnt(12)
    v_mfma_f32_32x32x16_bf16 v[144:159], a[36:39], a[232:235], v[144:159]
    ds_read_b64_tr_b16 a[0:1], v16 offset:49152
    ds_read_b64_tr_b16 a[2:3], v16 offset:51200
    s_waitcnt lgkmcnt(12)
    v_mfma_f32_32x32x16_bf16 v[160:175], a[40:43], a[232:235], v[160:175]
    ds_read_b64_tr_b16 a[4:5], v17 offset:49152
    ds_read_b64_tr_b16 a[6:7], v17 offset:51200
    buffer_load_dwordx4 a[140:143], v2, s[8:11], s37 offen offset:3072 sc1
    s_add_u32 s37, s37, 4096
    s_waitcnt lgkmcnt(12)
    v_mfma_f32_32x32x16_bf16 v[176:191], a[44:47], a[232:235], v[176:191]
    ds_read_b64_tr_b16 a[8:9], v18 offset:49152
    ds_read_b64_tr_b16 a[10:11], v18 offset:51200
    s_add_u32 m0, s34, 69632
    s_add_u32 s35, s32, 32768
    buffer_load_dwordx4 v8, s[16:19], s35 offen offset:0 lds
    s_waitcnt lgkmcnt(12)
    v_mfma_f32_32x32x16_bf16 v[128:143], a[48:51], a[236:239], v[128:143]
    ds_read_b64_tr_b16 a[12:13], v19 offset:49152
    ds_read_b64_tr_b16 a[14:15], v19 offset:51200
    s_waitcnt lgkmcnt(12)
    v_mfma_f32_32x32x16_bf16 v[144:159], a[52:55], a[236:239], v[144:159]
    ds_read_b64_tr_b16 a[16:17], v16 offset:53248
    ds_read_b64_tr_b16 a[18:19], v16 offset:55296
    buffer_load_dwordx4 a[144:147], v2, s[8:11], s37 offen offset:0 sc1
    buffer_load_dwordx2 v[68:69], v22, s[44:47], s59 offen offset:160
    s_waitcnt lgkmcnt(12)
    v_mfma_f32_32x32x16_bf16 v[160:175], a[56:59], a[236:239], v[160:175]
    ds_read_b64_tr_b16 a[20:21], v17 offset:53248
    ds_read_b64_tr_b16 a[22:23], v17 offset:55296
    s_waitcnt lgkmcnt(12)
    v_mfma_f32_32x32x16_bf16 v[176:191], a[60:63], a[236:239], v[176:191]
    ds_read_b64_tr_b16 a[24:25], v18 offset:53248
    ds_read_b64_tr_b16 a[26:27], v18 offset:55296
    buffer_load_dwordx4 v9, s[16:19], s35 offen offset:1024 lds
    s_waitcnt lgkmcnt(12)
    v_mfma_f32_32x32x16_bf16 v[128:143], a[0:3], a[240:243], v[128:143]
    ds_read_b64_tr_b16 a[28:29], v19 offset:53248
    ds_read_b64_tr_b16 a[30:31], v19 offset:55296
    buffer_load_dwordx4 a[148:151], v2, s[8:11], s37 offen offset:1024 sc1
    s_waitcnt lgkmcnt(12)
    v_mfma_f32_32x32x16_bf16 v[144:159], a[4:7], a[240:243], v[144:159]
    ds_read_b64_tr_b16 a[32:33], v16 offset:57344
    ds_read_b64_tr_b16 a[34:35], v16 offset:59392
    s_waitcnt lgkmcnt(12)
    v_mfma_f32_32x32x16_bf16 v[160:175], a[8:11], a[240:243], v[160:175]
    ds_read_b64_tr_b16 a[36:37], v17 offset:57344
    ds_read_b64_tr_b16 a[38:39], v17 offset:59392
    buffer_load_dwordx4 v10, s[16:19], s35 offen offset:2048 lds
    s_waitcnt lgkmcnt(12)
    v_mfma_f32_32x32x16_bf16 v[176:191], a[12:15], a[240:243], v[176:191]
    ds_read_b64_tr_b16 a[40:41], v18 offset:57344
    ds_read_b64_tr_b16 a[42:43], v18 offset:59392
    buffer_load_dwordx4 a[152:155], v2, s[8:11], s37 offen offset:2048 sc1
    buffer_load_dwordx2 v[70:71], v22, s[44:47], s59 offen offset:176
    s_waitcnt lgkmcnt(12)
    v_mfma_f32_32x32x16_bf16 v[128:143], a[16:19], a[244:247], v[128:143]
    ds_read_b64_tr_b16 a[44:45], v19 offset:57344
    ds_read_b64_tr_b16 a[46:47], v19 offset:59392
    s_waitcnt lgkmcnt(12)
    v_mfma_f32_32x32x16_bf16 v[144:159], a[20:23], a[244:247], v[144:159]
    ds_read_b64_tr_b16 a[48:49], v16 offset:61440
    ds_read_b64_tr_b16 a[50:51], v16 offset:63488
    buffer_load_dwordx4 v11, s[16:19], s35 offen offset:3072 lds
    s_add_u32 s32, s32, 262144
    s_waitcnt lgkmcnt(12)
    v_mfma_f32_32x32x16_bf16 v[160:175], a[24:27], a[244:247], v[160:175]
    ds_read_b64_tr_b16 a[52:53], v17 offset:61440
    ds_read_b64_tr_b16 a[54:55], v17 offset:63488
    s_waitcnt lgkmcnt(12)
    v_mfma_f32_32x32x16_bf16 v[176:191], a[28:31], a[244:247], v[176:191]
    ds_read_b64_tr_b16 a[56:57], v18 offset:61440
    ds_read_b64_tr_b16 a[58:59], v18 offset:63488
    buffer_load_dwordx4 a[156:159], v2, s[8:11], s37 offen offset:3072 sc1
    s_add_u32 s37, s37, 4096
    s_waitcnt lgkmcnt(12)
    v_mfma_f32_32x32x16_bf16 v[128:143], a[32:35], a[248:251], v[128:143]
    ds_read_b64_tr_b16 a[60:61], v19 offset:61440
    ds_read_b64_tr_b16 a[62:63], v19 offset:63488
    s_waitcnt lgkmcnt(12)
    v_mfma_f32_32x32x16_bf16 v[144:159], a[36:39], a[248:251], v[144:159]
    s_waitcnt lgkmcnt(10)
    v_mfma_f32_32x32x16_bf16 v[160:175], a[40:43], a[248:251], v[160:175]
    s_waitcnt lgkmcnt(8)
    v_mfma_f32_32x32x16_bf16 v[176:191], a[44:47], a[248:251], v[176:191]
    s_waitcnt vmcnt(44) lgkmcnt(0)
    s_barrier
    ds_read_b64_tr_b16 a[0:1], v12 offset:0
    ds_read_b64_tr_b16 a[2:3], v12 offset:2048
    ds_read_b64_tr_b16 a[4:5], v13 offset:0
    ds_read_b64_tr_b16 a[6:7], v13 offset:2048
    ds_read_b64_tr_b16 a[8:9], v14 offset:0
    ds_read_b64_tr_b16 a[10:11], v14 offset:2048
    v_mfma_f32_32x32x16_bf16 v[128:143], a[48:51], a[252:255], v[128:143]
    ds_read_b64_tr_b16 a[12:13], v15 offset:0
    ds_read_b64_tr_b16 a[14:15], v15 offset:2048
    v_mfma_f32_32x32x16_bf16 v[144:159], a[52:55], a[252:255], v[144:159]
    ds_read_b64_tr_b16 a[16:17], v12 offset:4096
    ds_read_b64_tr_b16 a[18:19], v12 offset:6144
    v_mfma_f32_32x32x16_bf16 v[160:175], a[56:59], a[252:255], v[160:175]
    ds_read_b64_tr_b16 a[20:21], v13 offset:4096
    ds_read_b64_tr_b16 a[22:23], v13 offset:6144
    v_mfma_f32_32x32x16_bf16 v[176:191], a[60:63], a[252:255], v[176:191]
    ds_read_b64_tr_b16 a[24:25], v14 offset:4096
    ds_read_b64_tr_b16 a[26:27], v14 offset:6144
    s_add_u32 m0, s34, 98304
    s_add_u32 s35, s32, 0
    buffer_load_dwordx4 v8, s[16:19], s35 offen offset:0 lds
    s_waitcnt lgkmcnt(12)
    v_mfma_f32_32x32x16_bf16 v[128:143], a[0:3], a[64:67], v[128:143]
    ds_read_b64_tr_b16 a[28:29], v15 offset:4096
    ds_read_b64_tr_b16 a[30:31], v15 offset:6144
    buffer_load_dwordx4 a[224:227], v2, s[8:11], s37 offen offset:0 sc1
    buffer_load_dwordx2 v[72:73], v22, s[44:47], s59 offen offset:192
    s_waitcnt lgkmcnt(12)
    v_mfma_f32_32x32x16_bf16 v[144:159], a[4:7], a[64:67], v[144:159]
    ds_read_b64_tr_b16 a[32:33], v12 offset:8192
    ds_read_b64_tr_b16 a[34:35], v12 offset:10240
    s_waitcnt lgkmcnt(12)
    v_mfma_f32_32x32x16_bf16 v[160:175], a[8:11], a[64:67], v[160:175]
    ds_read_b64_tr_b16 a[36:37], v13 offset:8192
    ds_read_b64_tr_b16 a[38:39], v13 offset:10240
    buffer_load_dwordx4 v9, s[16:19], s35 offen offset:1024 lds
    s_waitcnt lgkmcnt(12)
    v_mfma_f32_32x32x16_bf16 v[176:191], a[12:15], a[64:67], v[176:191]
    ds_read_b64_tr_b16 a[40:41], v14 offset:8192
    ds_read_b64_tr_b16 a[42:43], v14 offset:10240
    buffer_load_dwordx4 a[228:231], v2, s[8:11], s37 offen offset:1024 sc1
    s_waitcnt lgkmcnt(12)
    v_mfma_f32_32x32x16_bf16 v[128:143], a[16:19], a[68:71], v[128:143]
    ds_read_b64_tr_b16 a[44:45], v15 offset:8192
    ds_read_b64_tr_b16 a[46:47], v15 offset:10240
    s_waitcnt lgkmcnt(12)
    v_mfma_f32_32x32x16_bf16 v[144:159], a[20:23], a[68:71], v[144:159]
    ds_read_b64_tr_b16 a[48:49], v12 offset:12288
    ds_read_b64_tr_b16 a[50:51], v12 offset:14336
    buffer_load_dwordx4 v10, s[16:19], s35 offen offset:2048 lds
    s_waitcnt lgkmcnt(12)
    v_mfma_f32_32x32x16_bf16 v[160:175], a[24:27], a[68:71], v[160:175]
    ds_read_b64_tr_b16 a[52:53], v13 offset:12288
    ds_read_b64_tr_b16 a[54:55], v13 offset:14336
    s_waitcnt lgkmcnt(12)
    v_mfma_f32_32x32x16_bf16 v[176:191], a[28:31], a[68:71], v[176:191]
    ds_read_b64_tr_b16 a[56:57], v14 offset:12288
    ds_read_b64_tr_b16 a[58:59], v14 offset:14336
    buffer_load_dwordx4 a[232:235], v2, s[8:11], s37 offen offset:2048 sc1
    buffer_load_dwordx2 v[74:75], v22, s[44:47], s59 offen offset:208
    s_waitcnt lgkmcnt(12)
    v_mfma_f32_32x32x16_bf16 v[128:143], a[32:35], a[72:75], v[128:143]
    ds_read_b64_tr_b16 a[60:61], v15 offset:12288
    ds_read_b64_tr_b16 a[62:63], v15 offset:14336
    buffer_load_dwordx4 v11, s[16:19], s35 offen offset:3072 lds
    s_waitcnt lgkmcnt(12)
    v_mfma_f32_32x32x16_bf16 v[144:159], a[36:39], a[72:75], v[144:159]
    ds_read_b64_tr_b16 a[0:1], v12 offset:16384
    ds_read_b64_tr_b16 a[2:3], v12 offset:18432
    s_waitcnt lgkmcnt(12)
    v_mfma_f32_32x32x16_bf16 v[160:175], a[40:43], a[72:75], v[160:175]
    ds_read_b64_tr_b16 a[4:5], v13 offset:16384
    ds_read_b64_tr_b16 a[6:7], v13 offset:18432
    buffer_load_dwordx4 a[236:239], v2, s[8:11], s37 offen offset:3072 sc1
    s_add_u32 s37, s37, 4096
    s_waitcnt lgkmcnt(12)
    v_mfma_f32_32x32x16_bf16 v[176:191], a[44:47], a[72:75], v[176:191]
    ds_read_b64_tr_b16 a[8:9], v14 offset:16384
    ds_read_b64_tr_b16 a[10:11], v14 offset:18432
    s_add_u32 m0, s34, 102400
    s_add_u32 s35, s32, 32768
    buffer_load_dwordx4 v8, s[16:19], s35 offen offset:0 lds
    s_waitcnt lgkmcnt(12)
    v_mfma_f32_32x32x16_bf16 v[128:143], a[48:51], a[76:79], v[128:143]
    ds_read_b64_tr_b16 a[12:13], v15 offset:16384
    ds_read_b64_tr_b16 a[14:15], v15 offset:18432
    s_waitcnt lgkmcnt(12)
    v_mfma_f32_32x32x16_bf16 v[144:159], a[52:55], a[76:79], v[144:159]
    ds_read_b64_tr_b16 a[16:17], v12 offset:20480
    ds_read_b64_tr_b16 a[18:19], v12 offset:22528
    buffer_load_dwordx4 a[240:243], v2, s[8:11], s37 offen offset:0 sc1
    buffer_load_dwordx2 v[76:77], v22, s[44:47], s59 offen offset:224
    s_waitcnt lgkmcnt(12)
    v_mfma_f32_32x32x16_bf16 v[160:175], a[56:59], a[76:79], v[160:175]
    ds_read_b64_tr_b16 a[20:21], v13 offset:20480
    ds_read_b64_tr_b16 a[22:23], v13 offset:22528
    s_waitcnt lgkmcnt(12)
    v_mfma_f32_32x32x16_bf16 v[176:191], a[60:63], a[76:79], v[176:191]
    ds_read_b64_tr_b16 a[24:25], v14 offset:20480
    ds_read_b64_tr_b16 a[26:27], v14 offset:22528
    buffer_load_dwordx4 v9, s[16:19], s35 offen offset:1024 lds
    s_waitcnt lgkmcnt(12)
    v_mfma_f32_32x32x16_bf16 v[128:143], a[0:3], a[80:83], v[128:143]
    ds_read_b64_tr_b16 a[28:29], v15 offset:20480
    ds_read_b64_tr_b16 a[30:31], v15 offset:22528
    buffer_load_dwordx4 a[244:247], v2, s[8:11], s37 offen offset:1024 sc1
    s_waitcnt lgkmcnt(12)
    v_mfma_f32_32x32x16_bf16 v[144:159], a[4:7], a[80:83], v[144:159]
    ds_read_b64_tr_b16 a[32:33], v12 offset:24576
    ds_read_b64_tr_b16 a[34:35], v12 offset:26624
    s_waitcnt lgkmcnt(12)
    v_mfma_f32_32x32x16_bf16 v[160:175], a[8:11], a[80:83], v[160:175]
    ds_read_b64_tr_b16 a[36:37], v13 offset:24576
    ds_read_b64_tr_b16 a[38:39], v13 offset:26624
    buffer_load_dwordx4 v10, s[16:19], s35 offen offset:2048 lds
    s_waitcnt lgkmcnt(12)
    v_mfma_f32_32x32x16_bf16 v[176:191], a[12:15], a[80:83], v[176:191]
    ds_read_b64_tr_b16 a[40:41], v14 offset:24576
    ds_read_b64_tr_b16 a[42:43], v14 offset:26624
    buffer_load_dwordx4 a[248:251], v2, s[8:11], s37 offen offset:2048 sc1
    buffer_load_dwordx2 v[78:79], v22, s[44:47], s59 offen offset:240
    s_waitcnt lgkmcnt(12)
    v_mfma_f32_32x32x16_bf16 v[128:143], a[16:19], a[84:87], v[128:143]
    ds_read_b64_tr_b16 a[44:45], v15 offset:24576
    ds_read_b64_tr_b16 a[46:47], v15 offset:26624
    s_waitcnt lgkmcnt(12)
    v_mfma_f32_32x32x16_bf16 v[144:159], a[20:23], a[84:87], v[144:159]
    ds_read_b64_tr_b16 a[48:49], v12 offset:28672
    ds_read_b64_tr_b16 a[50:51], v12 offset:30720
    buffer_load_dwordx4 v11, s[16:19], s35 offen offset:3072 lds
    s_add_u32 s32, s32, 262144
    s_waitcnt lgkmcnt(12)
    v_mfma_f32_32x32x16_bf16 v[160:175], a[24:27], a[84:87], v[160:175]
    ds_read_b64_tr_b16 a[52:53], v13 offset:28672
    ds_read_b64_tr_b16 a[54:55], v13 offset:30720
    s_waitcnt lgkmcnt(12)
    v_mfma_f32_32x32x16_bf16 v[176:191], a[28:31], a[84:87], v[176:191]
    ds_read_b64_tr_b16 a[56:57], v14 offset:28672
    ds_read_b64_tr_b16 a[58:59], v14 offset:30720
    buffer_load_dwordx4 a[252:255], v2, s[8:11], s37 offen offset:3072 sc1
    s_add_u32 s37, s37, 4096
    s_waitcnt lgkmcnt(12)
    v_mfma_f32_32x32x16_bf16 v[128:143], a[32:35], a[88:91], v[128:143]
    ds_read_b64_tr_b16 a[60:61], v15 offset:28672
    ds_read_b64_tr_b16 a[62:63], v15 offset:30720
    s_waitcnt lgkmcnt(12)
    v_mfma_f32_32x32x16_bf16 v[144:159], a[36:39], a[88:91], v[144:159]
    s_waitcnt lgkmcnt(10)
    v_mfma_f32_32x32x16_bf16 v[160:175], a[40:43], a[88:91], v[160:175]
    s_waitcnt lgkmcnt(8)
    v_mfma_f32_32x32x16_bf16 v[176:191], a[44:47], a[88:91], v[176:191]
    s_waitcnt vmcnt(40) lgkmcnt(0)
    s_barrier
    ds_read_b64_tr_b16 a[0:1], v12 offset:32768
    ds_read_b64_tr_b16 a[2:3], v12 offset:34816
    ds_read_b64_tr_b16 a[4:5], v13 offset:32768
    ds_read_b64_tr_b16 a[6:7], v13 offset:34816
    ds_read_b64_tr_b16 a[8:9], v14 offset:32768
    ds_read_b64_tr_b16 a[10:11], v14 offset:34816
    v_mfma_f32_32x32x16_bf16 v[128:143], a[48:51], a[92:95], v[128:143]
    ds_read_b64_tr_b16 a[12:13], v15 offset:32768
    ds_read_b64_tr_b16 a[14:15], v15 offset:34816
    v_mfma_f32_32x32x16_bf16 v[144:159], a[52:55], a[92:95], v[144:159]
    ds_read_b64_tr_b16 a[16:17], v12 offset:36864
    ds_read_b64_tr_b16 a[18:19], v12 offset:38912
    v_mfma_f32_32x32x16_bf16 v[160:175], a[56:59], a[92:95], v[160:175]
    ds_read_b64_tr_b16 a[20:21], v13 offset:36864
    ds_read_b64_tr_b16 a[22:23], v13 offset:38912
    v_mfma_f32_32x32x16_bf16 v[176:191], a[60:63], a[92:95], v[176:191]
    ds_read_b64_tr_b16 a[24:25], v14 offset:36864
    ds_read_b64_tr_b16 a[26:27], v14 offset:38912
    s_add_u32 m0, s34, 0
    s_add_u32 s35, s32, 0
    buffer_load_dwordx4 v8, s[16:19], s35 offen offset:0 lds
    v_xor_b32 v26, 0, v21
    ds_read_b64 v[80:81], v26
    s_waitcnt lgkmcnt(13)
    v_mfma_f32_32x32x16_bf16 v[128:143], a[0:3], a[96:99], v[128:143]
    ds_read_b64_tr_b16 a[28:29], v15 offset:36864
    ds_read_b64_tr_b16 a[30:31], v15 offset:38912
    buffer_load_dwordx4 a[64:67], v2, s[8:11], s37 offen offset:0 sc1
    s_waitcnt lgkmcnt(13)
    v_mfma_f32_32x32x16_bf16 v[144:159], a[4:7], a[96:99], v[144:159]
    ds_read_b64_tr_b16 a[32:33], v12 offset:40960
    ds_read_b64_tr_b16 a[34:35], v12 offset:43008
    s_waitcnt lgkmcnt(13)
    v_mfma_f32_32x32x16_bf16 v[160:175], a[8:11], a[96:99], v[160:175]
    ds_read_b64_tr_b16 a[36:37], v13 offset:40960
    ds_read_b64_tr_b16 a[38:39], v13 offset:43008
    buffer_load_dwordx4 v9, s[16:19], s35 offen offset:1024 lds
    s_waitcnt lgkmcnt(13)
    v_mfma_f32_32x32x16_bf16 v[176:191], a[12:15], a[96:99], v[176:191]
    ds_read_b64_tr_b16 a[40:41], v14 offset:40960
    ds_read_b64_tr_b16 a[42:43], v14 offset:43008
    buffer_load_dwordx4 a[68:71], v2, s[8:11], s37 offen offset:1024 sc1
    s_waitcnt lgkmcnt(13)
    v_mfma_f32_32x32x16_bf16 v[128:143], a[16:19], a[100:103], v[128:143]
    ds_read_b64_tr_b16 a[44:45], v15 offset:40960
    ds_read_b64_tr_b16 a[46:47], v15 offset:43008
    s_waitcnt lgkmcnt(13)
    v_mfma_f32_32x32x16_bf16 v[144:159], a[20:23], a[100:103], v[144:159]
    ds_read_b64_tr_b16 a[48:49], v12 offset:45056
    ds_read_b64_tr_b16 a[50:51], v12 offset:47104
    buffer_load_dwordx4 v10, s[16:19], s35 offen offset:2048 lds
    v_xor_b32 v26, 16, v21
    ds_read_b64 v[82:83], v26
    s_waitcnt lgkmcnt(14)
    v_mfma_f32_32x32x16_bf16 v[160:175], a[24:27], a[100:103], v[160:175]
    ds_read_b64_tr_b16 a[52:53], v13 offset:45056
    ds_read_b64_tr_b16 a[54:55], v13 offset:47104
    s_waitcnt lgkmcnt(13)
    v_mfma_f32_32x32x16_bf16 v[176:191], a[28:31], a[100:103], v[176:191]
    ds_read_b64_tr_b16 a[56:57], v14 offset:45056
    ds_read_b64_tr_b16 a[58:59], v14 offset:47104
    buffer_load_dwordx4 a[72:75], v2, s[8:11], s37 offen offset:2048 sc1
    s_waitcnt lgkmcnt(13)
    v_mfma_f32_32x32x16_bf16 v[128:143], a[32:35], a[104:107], v[128:143]
    ds_read_b64_tr_b16 a[60:61], v15 offset:45056
    ds_read_b64_tr_b16 a[62:63], v15 offset:47104
    buffer_load_dwordx4 v11, s[16:19], s35 offen offset:3072 lds
    s_waitcnt lgkmcnt(13)
    v_mfma_f32_32x32x16_bf16 v[144:159], a[36:39], a[104:107], v[144:159]
    ds_read_b64_tr_b16 a[0:1], v12 offset:49152
    ds_read_b64_tr_b16 a[2:3], v12 offset:51200
    s_waitcnt lgkmcnt(13)
    v_mfma_f32_32x32x16_bf16 v[160:175], a[40:43], a[104:107], v[160:175]
    ds_read_b64_tr_b16 a[4:5], v13 offset:49152
    ds_read_b64_tr_b16 a[6:7], v13 offset:51200
    buffer_load_dwordx4 a[76:79], v2, s[8:11], s37 offen offset:3072 sc1
    s_add_u32 s37, s37, 4096
    s_waitcnt lgkmcnt(13)
    v_mfma_f32_32x32x16_bf16 v[176:191], a[44:47], a[104:107], v[176:191]
    ds_read_b64_tr_b16 a[8:9], v14 offset:49152
    ds_read_b64_tr_b16 a[10:11], v14 offset:51200
    s_add_u32 m0, s34, 4096
    s_add_u32 s35, s32, 32768
    buffer_load_dwordx4 v8, s[16:19], s35 offen offset:0 lds
    v_xor_b32 v26, 32, v21
    ds_read_b64 v[84:85], v26
    s_waitcnt lgkmcnt(14)
    v_mfma_f32_32x32x16_bf16 v[128:143], a[48:51], a[108:111], v[128:143]
    ds_read_b64_tr_b16 a[12:13], v15 offset:49152
    ds_read_b64_tr_b16 a[14:15], v15 offset:51200
    s_waitcnt lgkmcnt(13)
    v_mfma_f32_32x32x16_bf16 v[144:159], a[52:55], a[108:111], v[144:159]
    ds_read_b64_tr_b16 a[16:17], v12 offset:53248
    ds_read_b64_tr_b16 a[18:19], v12 offset:55296
    buffer_load_dwordx4 a[80:83], v2, s[8:11], s37 offen offset:0 sc1
    s_waitcnt lgkmcnt(13)
    v_mfma_f32_32x32x16_bf16 v[160:175], a[56:59], a[108:111], v[160:175]
    ds_read_b64_tr_b16 a[20:21], v13 offset:53248
    ds_read_b64_tr_b16 a[22:23], v13 offset:55296
    s_waitcnt lgkmcnt(13)
    v_mfma_f32_32x32x16_bf16 v[176:191], a[60:63], a[108:111], v[176:191]
    ds_read_b64_tr_b16 a[24:25], v14 offset:53248
    ds_read_b64_tr_b16 a[26:27], v14 offset:55296
    buffer_load_dwordx4 v9, s[16:19], s35 offen offset:1024 lds
    s_waitcnt lgkmcnt(13)
    v_mfma_f32_32x32x16_bf16 v[128:143], a[0:3], a[112:115], v[128:143]
    ds_read_b64_tr_b16 a[28:29], v15 offset:53248
    ds_read_b64_tr_b16 a[30:31], v15 offset:55296
    buffer_load_dwordx4 a[84:87], v2, s[8:11], s37 offen offset:1024 sc1
    s_waitcnt lgkmcnt(13)
    v_mfma_f32_32x32x16_bf16 v[144:159], a[4:7], a[112:115], v[144:159]
    ds_read_b64_tr_b16 a[32:33], v12 offset:57344
    ds_read_b64_tr_b16 a[34:35], v12 offset:59392
    s_waitcnt lgkmcnt(13)
    v_mfma_f32_32x32x16_bf16 v[160:175], a[8:11], a[112:115], v[160:175]
    ds_read_b64_tr_b16 a[36:37], v13 offset:57344
    ds_read_b64_tr_b16 a[38:39], v13 offset:59392
    buffer_load_dwordx4 v10, s[16:19], s35 offen offset:2048 lds
    v_xor_b32 v26, 48, v21
    ds_read_b64 v[86:87], v26
    s_waitcnt lgkmcnt(13)
    v_mfma_f32_32x32x16_bf16 v[176:191], a[12:15], a[112:115], v[176:191]
    ds_read_b64_tr_b16 a[40:41], v14 offset:57344
    ds_read_b64_tr_b16 a[42:43], v14 offset:59392
    buffer_load_dwordx4 a[88:91], v2, s[8:11], s37 offen offset:2048 sc1
    s_waitcnt lgkmcnt(13)
    v_mfma_f32_32x32x16_bf16 v[128:143], a[16:19], a[116:119], v[128:143]
    ds_read_b64_tr_b16 a[44:45], v15 offset:57344
    ds_read_b64_tr_b16 a[46:47], v15 offset:59392
    s_waitcnt lgkmcnt(13)
    v_mfma_f32_32x32x16_bf16 v[144:159], a[20:23], a[116:119], v[144:159]
    ds_read_b64_tr_b16 a[48:49], v12 offset:61440
    ds_read_b64_tr_b16 a[50:51], v12 offset:63488
    buffer_load_dwordx4 v11, s[16:19], s35 offen offset:3072 lds
    s_add_u32 s32, s32, 262144
    s_waitcnt lgkmcnt(13)
    v_mfma_f32_32x32x16_bf16 v[160:175], a[24:27], a[116:119], v[160:175]
    ds_read_b64_tr_b16 a[52:53], v13 offset:61440
    ds_read_b64_tr_b16 a[54:55], v13 offset:63488
    s_waitcnt lgkmcnt(13)
    v_mfma_f32_32x32x16_bf16 v[176:191], a[28:31], a[116:119], v[176:191]
    ds_read_b64_tr_b16 a[56:57], v14 offset:61440
    ds_read_b64_tr_b16 a[58:59], v14 offset:63488
    buffer_load_dwordx4 a[92:95], v2, s[8:11], s37 offen offset:3072 sc1
    s_add_u32 s37, s37, 4096
    s_waitcnt lgkmcnt(13)
    v_mfma_f32_32x32x16_bf16 v[128:143], a[32:35], a[120:123], v[128:143]
    ds_read_b64_tr_b16 a[60:61], v15 offset:61440
    ds_read_b64_tr_b16 a[62:63], v15 offset:63488
    s_waitcnt lgkmcnt(13)
    v_mfma_f32_32x32x16_bf16 v[144:159], a[36:39], a[120:123], v[144:159]
    s_waitcnt lgkmcnt(10)
    v_mfma_f32_32x32x16_bf16 v[160:175], a[40:43], a[120:123], v[160:175]
    s_waitcnt lgkmcnt(8)
    v_mfma_f32_32x32x16_bf16 v[176:191], a[44:47], a[120:123], v[176:191]
    s_waitcnt vmcnt(36) lgkmcnt(0)
    s_barrier
    ds_read_b64_tr_b16 a[0:1], v16 offset:0
    ds_read_b64_tr_b16 a[2:3], v16 offset:2048
    ds_read_b64_tr_b16 a[4:5], v17 offset:0
    ds_read_b64_tr_b16 a[6:7], v17 offset:2048
    ds_read_b64_tr_b16 a[8:9], v18 offset:0
    ds_read_b64_tr_b16 a[10:11], v18 offset:2048
    v_mfma_f32_32x32x16_bf16 v[128:143], a[48:51], a[124:127], v[128:143]
    ds_read_b64_tr_b16 a[12:13], v19 offset:0
    ds_read_b64_tr_b16 a[14:15], v19 offset:2048
    v_mfma_f32_32x32x16_bf16 v[144:159], a[52:55], a[124:127], v[144:159]
    ds_read_b64_tr_b16 a[16:17], v16 offset:4096
    ds_read_b64_tr_b16 a[18:19], v16 offset:6144
    v_mfma_f32_32x32x16_bf16 v[160:175], a[56:59], a[124:127], v[160:175]
    ds_read_b64_tr_b16 a[20:21], v17 offset:4096
    ds_read_b64_tr_b16 a[22:23], v17 offset:6144
    v_mfma_f32_32x32x16_bf16 v[176:191], a[60:63], a[124:127], v[176:191]
    ds_read_b64_tr_b16 a[24:25], v18 offset:4096
    ds_read_b64_tr_b16 a[26:27], v18 offset:6144
    s_add_u32 m0, s34, 32768
    s_add_u32 s35, s32, 0
    buffer_load_dwordx4 v8, s[16:19], s35 offen offset:0 lds
    v_lshlrev_b32 v192, 16, v80
    v_and_b32 v193, s58, v80
    v_lshlrev_b32 v24, 16, v48
    v_xor_b32 v26, 64, v21
    ds_read_b64 v[88:89], v26
    s_waitcnt lgkmcnt(13)
    v_mfma_f32_32x32x16_bf16 v[128:143], a[0:3], a[128:131], v[128:143]
    ds_read_b64_tr_b16 a[28:29], v19 offset:4096
    ds_read_b64_tr_b16 a[30:31], v19 offset:6144
    buffer_load_dwordx4 a[96:99], v2, s[8:11], s37 offen offset:0 sc1
    v_and_b32 v25, s58, v48
    v_pk_add_f32 v[192:193], v[192:193], v[24:25]
    s_waitcnt lgkmcnt(13)
    v_mfma_f32_32x32x16_bf16 v[144:159], a[4:7], a[128:131], v[144:159]
    ds_read_b64_tr_b16 a[32:33], v16 offset:8192
    ds_read_b64_tr_b16 a[34:35], v16 offset:10240
    s_waitcnt lgkmcnt(13)
    v_mfma_f32_32x32x16_bf16 v[160:175], a[8:11], a[128:131], v[160:175]
    ds_read_b64_tr_b16 a[36:37], v17 offset:8192
    ds_read_b64_tr_b16 a[38:39], v17 offset:10240
    buffer_load_dwordx4 v9, s[16:19], s35 offen offset:1024 lds
    v_lshlrev_b32 v194, 16, v81
    v_and_b32 v195, s58, v81
    v_lshlrev_b32 v24, 16, v49
    s_waitcnt lgkmcnt(13)
    v_mfma_f32_32x32x16_bf16 v[176:191], a[12:15], a[128:131], v[176:191]
    ds_read_b64_tr_b16 a[40:41], v18 offset:8192
    ds_read_b64_tr_b16 a[42:43], v18 offset:10240
    buffer_load_dwordx4 a[100:103], v2, s[8:11], s37 offen offset:1024 sc1
    v_and_b32 v25, s58, v49
    v_pk_add_f32 v[194:195], v[194:195], v[24:25]
    s_waitcnt lgkmcnt(13)
    v_mfma_f32_32x32x16_bf16 v[128:143], a[16:19], a[132:135], v[128:143]
    ds_read_b64_tr_b16 a[44:45], v19 offset:8192
    ds_read_b64_tr_b16 a[46:47], v19 offset:10240
    s_waitcnt lgkmcnt(13)
    v_mfma_f32_32x32x16_bf16 v[144:159], a[20:23], a[132:135], v[144:159]
    ds_read_b64_tr_b16 a[48:49], v16 offset:12288
    ds_read_b64_tr_b16 a[50:51], v16 offset:14336
    buffer_load_dwordx4 v10, s[16:19], s35 offen offset:2048 lds
    v_lshlrev_b32 v196, 16, v82
    v_and_b32 v197, s58, v82
    v_lshlrev_b32 v24, 16, v50
    v_xor_b32 v26, 80, v21
    ds_read_b64 v[90:91], v26
    s_waitcnt lgkmcnt(14)
    v_mfma_f32_32x32x16_bf16 v[160:175], a[24:27], a[132:135], v[160:175]
    ds_read_b64_tr_b16 a[52:53], v17 offset:12288
    ds_read_b64_tr_b16 a[54:55], v17 offset:14336
    s_waitcnt lgkmcnt(13)
    v_mfma_f32_32x32x16_bf16 v[176:191], a[28:31], a[132:135], v[176:191]
    ds_read_b64_tr_b16 a[56:57], v18 offset:12288
    ds_read_b64_tr_b16 a[58:59], v18 offset:14336
    buffer_load_dwordx4 a[104:107], v2, s[8:11], s37 offen offset:2048 sc1
    v_and_b32 v25, s58, v50
    v_pk_add_f32 v[196:197], v[196:197], v[24:25]
    s_waitcnt lgkmcnt(13)
    v_mfma_f32_32x32x16_bf16 v[128:143], a[32:35], a[136:139], v[128:143]
    ds_read_b64_tr_b16 a[60:61], v19 offset:12288
    ds_read_b64_tr_b16 a[62:63], v19 offset:14336
    buffer_load_dwordx4 v11, s[16:19], s35 offen offset:3072 lds
    v_lshlrev_b32 v198, 16, v83
    v_and_b32 v199, s58, v83
    v_lshlrev_b32 v24, 16, v51
    s_waitcnt lgkmcnt(13)
    v_mfma_f32_32x32x16_bf16 v[144:159], a[36:39], a[136:139], v[144:159]
    ds_read_b64_tr_b16 a[0:1], v16 offset:16384
    ds_read_b64_tr_b16 a[2:3], v16 offset:18432
    s_waitcnt lgkmcnt(13)
    v_mfma_f32_32x32x16_bf16 v[160:175], a[40:43], a[136:139], v[160:175]
    ds_read_b64_tr_b16 a[4:5], v17 offset:16384
    ds_read_b64_tr_b16 a[6:7], v17 offset:18432
    buffer_load_dwordx4 a[108:111], v2, s[8:11], s37 offen offset:3072 sc1
    s_add_u32 s37, s37, 4096
    v_and_b32 v25, s58, v51
    v_pk_add_f32 v[198:199], v[198:199], v[24:25]
    s_waitcnt lgkmcnt(13)
    v_mfma_f32_32x32x16_bf16 v[176:191], a[44:47], a[136:139], v[176:191]
    ds_read_b64_tr_b16 a[8:9], v18 offset:16384
    ds_read_b64_tr_b16 a[10:11], v18 offset:18432
    s_add_u32 m0, s34, 36864
    s_add_u32 s35, s32, 32768
    buffer_load_dwordx4 v8, s[16:19], s35 offen offset:0 lds
    v_lshlrev_b32 v200, 16, v84
    v_and_b32 v201, s58, v84
    v_lshlrev_b32 v24, 16, v52
    v_xor_b32 v26, 96, v21
    ds_read_b64 v[92:93], v26
    s_waitcnt lgkmcnt(14)
    v_mfma_f32_32x32x16_bf16 v[128:143], a[48:51], a[140:143], v[128:143]
    ds_read_b64_tr_b16 a[12:13], v19 offset:16384
    ds_read_b64_tr_b16 a[14:15], v19 offset:18432
    s_waitcnt lgkmcnt(13)
    v_mfma_f32_32x32x16_bf16 v[144:159], a[52:55], a[140:143], v[144:159]
    ds_read_b64_tr_b16 a[16:17], v16 offset:20480
    ds_read_b64_tr_b16 a[18:19], v16 offset:22528
    buffer_load_dwordx4 a[112:115], v2, s[8:11], s37 offen offset:0 sc1
    v_and_b32 v25, s58, v52
    v_pk_add_f32 v[200:201], v[200:201], v[24:25]
    s_waitcnt lgkmcnt(13)
    v_mfma_f32_32x32x16_bf16 v[160:175], a[56:59], a[140:143], v[160:175]
    ds_read_b64_tr_b16 a[20:21], v17 offset:20480
    ds_read_b64_tr_b16 a[22:23], v17 offset:22528
    s_waitcnt lgkmcnt(13)
    v_mfma_f32_32x32x16_bf16 v[176:191], a[60:63], a[140:143], v[176:191]
    ds_read_b64_tr_b16 a[24:25], v18 offset:20480
    ds_read_b64_tr_b16 a[26:27], v18 offset:22528
    buffer_load_dwordx4 v9, s[16:19], s35 offen offset:1024 lds
    v_lshlrev_b32 v202, 16, v85
    v_and_b32 v203, s58, v85
    v_lshlrev_b32 v24, 16, v53
    s_waitcnt lgkmcnt(13)
    v_mfma_f32_32x32x16_bf16 v[128:143], a[0:3], a[144:147], v[128:143]
    ds_read_b64_tr_b16 a[28:29], v19 offset:20480
    ds_read_b64_tr_b16 a[30:31], v19 offset:22528
    buffer_load_dwordx4 a[116:119], v2, s[8:11], s37 offen offset:1024 sc1
    v_and_b32 v25, s58, v53
    v_pk_add_f32 v[202:203], v[202:203], v[24:25]
    s_waitcnt lgkmcnt(13)
    v_mfma_f32_32x32x16_bf16 v[144:159], a[4:7], a[144:147], v[144:159]
    ds_read_b64_tr_b16 a[32:33], v16 offset:24576
    ds_read_b64_tr_b16 a[34:35], v16 offset:26624
    s_waitcnt lgkmcnt(13)
    v_mfma_f32_32x32x16_bf16 v[160:175], a[8:11], a[144:147], v[160:175]
    ds_read_b64_tr_b16 a[36:37], v17 offset:24576
    ds_read_b64_tr_b16 a[38:39], v17 offset:26624
    buffer_load_dwordx4 v10, s[16:19], s35 offen offset:2048 lds
    v_lshlrev_b32 v204, 16, v86
    v_and_b32 v205, s58, v86
    v_lshlrev_b32 v24, 16, v54
    v_xor_b32 v26, 112, v21
    ds_read_b64 v[94:95], v26
    s_waitcnt lgkmcnt(13)
    v_mfma_f32_32x32x16_bf16 v[176:191], a[12:15], a[144:147], v[176:191]
    ds_read_b64_tr_b16 a[40:41], v18 offset:24576
    ds_read_b64_tr_b16 a[42:43], v18 offset:26624
    buffer_load_dwordx4 a[120:123], v2, s[8:11], s37 offen offset:2048 sc1
    v_and_b32 v25, s58, v54
    v_pk_add_f32 v[204:205], v[204:205], v[24:25]
    s_waitcnt lgkmcnt(13)
    v_mfma_f32_32x32x16_bf16 v[128:143], a[16:19], a[148:151], v[128:143]
    ds_read_b64_tr_b16 a[44:45], v19 offset:24576
    ds_read_b64_tr_b16 a[46:47], v19 offset:26624
    s_waitcnt lgkmcnt(13)
    v_mfma_f32_32x32x16_bf16 v[144:159], a[20:23], a[148:151], v[144:159]
    ds_read_b64_tr_b16 a[48:49], v16 offset:28672
    ds_read_b64_tr_b16 a[50:51], v16 offset:30720
    buffer_load_dwordx4 v11, s[16:19], s35 offen offset:3072 lds
    s_add_u32 s32, s32, 262144
    v_lshlrev_b32 v206, 16, v87
    v_and_b32 v207, s58, v87
    v_lshlrev_b32 v24, 16, v55
    s_waitcnt lgkmcnt(13)
    v_mfma_f32_32x32x16_bf16 v[160:175], a[24:27], a[148:151], v[160:175]
    ds_read_b64_tr_b16 a[52:53], v17 offset:28672
    ds_read_b64_tr_b16 a[54:55], v17 offset:30720
    s_waitcnt lgkmcnt(13)
    v_mfma_f32_32x32x16_bf16 v[176:191], a[28:31], a[148:151], v[176:191]
    ds_read_b64_tr_b16 a[56:57], v18 offset:28672
    ds_read_b64_tr_b16 a[58:59], v18 offset:30720
    buffer_load_dwordx4 a[124:127], v2, s[8:11], s37 offen offset:3072 sc1
    s_add_u32 s37, s37, 4096
    v_and_b32 v25, s58, v55
    v_pk_add_f32 v[206:207], v[206:207], v[24:25]
    s_waitcnt lgkmcnt(13)
    v_mfma_f32_32x32x16_bf16 v[128:143], a[32:35], a[152:155], v[128:143]
    ds_read_b64_tr_b16 a[60:61], v19 offset:28672
    ds_read_b64_tr_b16 a[62:63], v19 offset:30720
    s_waitcnt lgkmcnt(13)
    v_mfma_f32_32x32x16_bf16 v[144:159], a[36:39], a[152:155], v[144:159]
    s_waitcnt lgkmcnt(10)
    v_mfma_f32_32x32x16_bf16 v[160:175], a[40:43], a[152:155], v[160:175]
    s_waitcnt lgkmcnt(8)
    v_mfma_f32_32x32x16_bf16 v[176:191], a[44:47], a[152:155], v[176:191]
    s_waitcnt vmcnt(32) lgkmcnt(0)
    s_barrier
    ds_read_b64_tr_b16 a[0:1], v16 offset:32768
    ds_read_b64_tr_b16 a[2:3], v16 offset:34816
    ds_read_b64_tr_b16 a[4:5], v17 offset:32768
    ds_read_b64_tr_b16 a[6:7], v17 offset:34816
    ds_read_b64_tr_b16 a[8:9], v18 offset:32768
    ds_read_b64_tr_b16 a[10:11], v18 offset:34816
    v_mfma_f32_32x32x16_bf16 v[128:143], a[48:51], a[156:159], v[128:143]
    ds_read_b64_tr_b16 a[12:13], v19 offset:32768
    ds_read_b64_tr_b16 a[14:15], v19 offset:34816
    v_mfma_f32_32x32x16_bf16 v[144:159], a[52:55], a[156:159], v[144:159]
    ds_read_b64_tr_b16 a[16:17], v16 offset:36864
    ds_read_b64_tr_b16 a[18:19], v16 offset:38912
    v_mfma_f32_32x32x16_bf16 v[160:175], a[56:59], a[156:159], v[160:175]
    ds_read_b64_tr_b16 a[20:21], v17 offset:36864
    ds_read_b64_tr_b16 a[22:23], v17 offset:38912
    v_mfma_f32_32x32x16_bf16 v[176:191], a[60:63], a[156:159], v[176:191]
    ds_read_b64_tr_b16 a[24:25], v18 offset:36864
    ds_read_b64_tr_b16 a[26:27], v18 offset:38912
    s_add_u32 m0, s34, 65536
    s_add_u32 s35, s32, 0
    buffer_load_dwordx4 v8, s[16:19], s35 offen offset:0 lds
    v_lshlrev_b32 v208, 16, v88
    v_and_b32 v209, s58, v88
    v_lshlrev_b32 v24, 16, v56
    v_xor_b32 v26, 128, v21
    ds_read_b64 v[96:97], v26
    s_waitcnt lgkmcnt(13)
    v_mfma_f32_32x32x16_bf16 v[128:143], a[0:3], a[224:227], v[128:143]
    ds_read_b64_tr_b16 a[28:29], v19 offset:36864
    ds_read_b64_tr_b16 a[30:31], v19 offset:38912
    buffer_load_dwordx4 a[128:131], v2, s[8:11], s37 offen offset:0 sc1
    v_and_b32 v25, s58, v56
    v_pk_add_f32 v[208:209], v[208:209], v[24:25]
    s_waitcnt lgkmcnt(13)
    v_mfma_f32_32x32x16_bf16 v[144:159], a[4:7], a[224:227], v[144:159]
    ds_read_b64_tr_b16 a[32:33], v16 offset:40960
    ds_read_b64_tr_b16 a[34:35], v16 offset:43008
    s_waitcnt lgkmcnt(13)
    v_mfma_f32_32x32x16_bf16 v[160:175], a[8:11], a[224:227], v[160:175]
    ds_read_b64_tr_b16 a[36:37], v17 offset:40960
    ds_read_b64_tr_b16 a[38:39], v17 offset:43008
    buffer_load_dwordx4 v9, s[16:19], s35 offen offset:1024 lds
    v_lshlrev_b32 v210, 16, v89
    v_and_b32 v211, s58, v89
    v_lshlrev_b32 v24, 16, v57
    s_waitcnt lgkmcnt(13)
    v_mfma_f32_32x32x16_bf16 v[176:191], a[12:15], a[224:227], v[176:191]
    ds_read_b64_tr_b16 a[40:41], v18 offset:40960
    ds_read_b64_tr_b16 a[42:43], v18 offset:43008
    buffer_load_dwordx4 a[132:135], v2, s[8:11], s37 offen offset:1024 sc1
    v_and_b32 v25, s58, v57
    v_pk_add_f32 v[210:211], v[210:211], v[24:25]
    s_waitcnt lgkmcnt(13)
    v_mfma_f32_32x32x16_bf16 v[128:143], a[16:19], a[228:231], v[128:143]
    ds_read_b64_tr_b16 a[44:45], v19 offset:40960
    ds_read_b64_tr_b16 a[46:47], v19 offset:43008
    s_waitcnt lgkmcnt(13)
    v_mfma_f32_32x32x16_bf16 v[144:159], a[20:23], a[228:231], v[144:159]
    ds_read_b64_tr_b16 a[48:49], v16 offset:45056
    ds_read_b64_tr_b16 a[50:51], v16 offset:47104
    buffer_load_dwordx4 v10, s[16:19], s35 offen offset:2048 lds
    v_lshlrev_b32 v212, 16, v90
    v_and_b32 v213, s58, v90
    v_lshlrev_b32 v24, 16, v58
    v_xor_b32 v26, 144, v21
    ds_read_b64 v[98:99], v26
    s_waitcnt lgkmcnt(14)
    v_mfma_f32_32x32x16_bf16 v[160:175], a[24:27], a[228:231], v[160:175]
    ds_read_b64_tr_b16 a[52:53], v17 offset:45056
    ds_read_b64_tr_b16 a[54:55], v17 offset:47104
    s_waitcnt lgkmcnt(13)
    v_mfma_f32_32x32x16_bf16 v[176:191], a[28:31], a[228:231], v[176:191]
    ds_read_b64_tr_b16 a[56:57], v18 offset:45056
    ds_read_b64_tr_b16 a[58:59], v18 offset:47104
    buffer_load_dwordx4 a[136:139], v2, s[8:11], s37 offen offset:2048 sc1
    v_and_b32 v25, s58, v58
    v_pk_add_f32 v[212:213], v[212:213], v[24:25]
    s_waitcnt lgkmcnt(13)
    v_mfma_f32_32x32x16_bf16 v[128:143], a[32:35], a[232:235], v[128:143]
    ds_read_b64_tr_b16 a[60:61], v19 offset:45056
    ds_read_b64_tr_b16 a[62:63], v19 offset:47104
    buffer_load_dwordx4 v11, s[16:19], s35 offen offset:3072 lds
    v_lshlrev_b32 v214, 16, v91
    v_and_b32 v215, s58, v91
    v_lshlrev_b32 v24, 16, v59
    s_waitcnt lgkmcnt(13)
    v_mfma_f32_32x32x16_bf16 v[144:159], a[36:39], a[232:235], v[144:159]
    ds_read_b64_tr_b16 a[0:1], v16 offset:49152
    ds_read_b64_tr_b16 a[2:3], v16 offset:51200
    s_waitcnt lgkmcnt(13)
    v_mfma_f32_32x32x16_bf16 v[160:175], a[40:43], a[232:235], v[160:175]
    ds_read_b64_tr_b16 a[4:5], v17 offset:49152
    ds_read_b64_tr_b16 a[6:7], v17 offset:51200
    buffer_load_dwordx4 a[140:143], v2, s[8:11], s37 offen offset:3072 sc1
    s_add_u32 s37, s37, 4096
    v_and_b32 v25, s58, v59
    v_pk_add_f32 v[214:215], v[214:215], v[24:25]
    s_waitcnt lgkmcnt(13)
    v_mfma_f32_32x32x16_bf16 v[176:191], a[44:47], a[232:235], v[176:191]
    ds_read_b64_tr_b16 a[8:9], v18 offset:49152
    ds_read_b64_tr_b16 a[10:11], v18 offset:51200
    s_add_u32 m0, s34, 69632
    s_add_u32 s35, s32, 32768
    buffer_load_dwordx4 v8, s[16:19], s35 offen offset:0 lds
    v_lshlrev_b32 v216, 16, v92
    v_and_b32 v217, s58, v92
    v_lshlrev_b32 v24, 16, v60
    v_xor_b32 v26, 160, v21
    ds_read_b64 v[100:101], v26
    s_waitcnt lgkmcnt(14)
    v_mfma_f32_32x32x16_bf16 v[128:143], a[48:51], a[236:239], v[128:143]
    ds_read_b64_tr_b16 a[12:13], v19 offset:49152
    ds_read_b64_tr_b16 a[14:15], v19 offset:51200
    s_waitcnt lgkmcnt(13)
    v_mfma_f32_32x32x16_bf16 v[144:159], a[52:55], a[236:239], v[144:159]
    ds_read_b64_tr_b16 a[16:17], v16 offset:53248
    ds_read_b64_tr_b16 a[18:19], v16 offset:55296
    buffer_load_dwordx4 a[144:147], v2, s[8:11], s37 offen offset:0 sc1
    v_and_b32 v25, s58, v60
    v_pk_add_f32 v[216:217], v[216:217], v[24:25]
    s_waitcnt lgkmcnt(13)
    v_mfma_f32_32x32x16_bf16 v[160:175], a[56:59], a[236:239], v[160:175]
    ds_read_b64_tr_b16 a[20:21], v17 offset:53248
    ds_read_b64_tr_b16 a[22:23], v17 offset:55296
    s_waitcnt lgkmcnt(13)
    v_mfma_f32_32x32x16_bf16 v[176:191], a[60:63], a[236:239], v[176:191]
    ds_read_b64_tr_b16 a[24:25], v18 offset:53248
    ds_read_b64_tr_b16 a[26:27], v18 offset:55296
    buffer_load_dwordx4 v9, s[16:19], s35 offen offset:1024 lds
    v_lshlrev_b32 v218, 16, v93
    v_and_b32 v219, s58, v93
    v_lshlrev_b32 v24, 16, v61
    s_waitcnt lgkmcnt(13)
    v_mfma_f32_32x32x16_bf16 v[128:143], a[0:3], a[240:243], v[128:143]
    ds_read_b64_tr_b16 a[28:29], v19 offset:53248
    ds_read_b64_tr_b16 a[30:31], v19 offset:55296
    buffer_load_dwordx4 a[148:151], v2, s[8:11], s37 offen offset:1024 sc1
    v_and_b32 v25, s58, v61
    v_pk_add_f32 v[218:219], v[218:219], v[24:25]
    s_waitcnt lgkmcnt(13)
    v_mfma_f32_32x32x16_bf16 v[144:159], a[4:7], a[240:243], v[144:159]
    ds_read_b64_tr_b16 a[32:33], v16 offset:57344
    ds_read_b64_tr_b16 a[34:35], v16 offset:59392
    s_waitcnt lgkmcnt(13)
    v_mfma_f32_32x32x16_bf16 v[160:175], a[8:11], a[240:243], v[160:175]
    ds_read_b64_tr_b16 a[36:37], v17 offset:57344
    ds_read_b64_tr_b16 a[38:39], v17 offset:59392
    buffer_load_dwordx4 v10, s[16:19], s35 offen offset:2048 lds
    v_lshlrev_b32 v220, 16, v94
    v_and_b32 v221, s58, v94
    v_lshlrev_b32 v24, 16, v62
    v_xor_b32 v26, 176, v21
    ds_read_b64 v[102:103], v26
    s_waitcnt lgkmcnt(13)
    v_mfma_f32_32x32x16_bf16 v[176:191], a[12:15], a[240:243], v[176:191]
    ds_read_b64_tr_b16 a[40:41], v18 offset:57344
    ds_read_b64_tr_b16 a[42:43], v18 offset:59392
    buffer_load_dwordx4 a[152:155], v2, s[8:11], s37 offen offset:2048 sc1
    v_and_b32 v25, s58, v62
    v_pk_add_f32 v[220:221], v[220:221], v[24:25]
    s_waitcnt lgkmcnt(13)
    v_mfma_f32_32x32x16_bf16 v[128:143], a[16:19], a[244:247], v[128:143]
    ds_read_b64_tr_b16 a[44:45], v19 offset:57344
    ds_read_b64_tr_b16 a[46:47], v19 offset:59392
    s_waitcnt lgkmcnt(13)
    v_mfma_f32_32x32x16_bf16 v[144:159], a[20:23], a[244:247], v[144:159]
    ds_read_b64_tr_b16 a[48:49], v16 offset:61440
    ds_read_b64_tr_b16 a[50:51], v16 offset:63488
    buffer_load_dwordx4 v11, s[16:19], s35 offen offset:3072 lds
    s_add_u32 s32, s32, 262144
    v_lshlrev_b32 v222, 16, v95
    v_and_b32 v223, s58, v95
    v_lshlrev_b32 v24, 16, v63
    s_waitcnt lgkmcnt(13)
    v_mfma_f32_32x32x16_bf16 v[160:175], a[24:27], a[244:247], v[160:175]
    ds_read_b64_tr_b16 a[52:53], v17 offset:61440
    ds_read_b64_tr_b16 a[54:55], v17 offset:63488
    s_waitcnt lgkmcnt(13)
    v_mfma_f32_32x32x16_bf16 v[176:191], a[28:31], a[244:247], v[176:191]
    ds_read_b64_tr_b16 a[56:57], v18 offset:61440
    ds_read_b64_tr_b16 a[58:59], v18 offset:63488
    buffer_load_dwordx4 a[156:159], v2, s[8:11], s37 offen offset:3072 sc1
    s_add_u32 s37, s37, 4096
    v_and_b32 v25, s58, v63
    v_pk_add_f32 v[222:223], v[222:223], v[24:25]
    s_waitcnt lgkmcnt(13)
    v_mfma_f32_32x32x16_bf16 v[128:143], a[32:35], a[248:251], v[128:143]
    ds_read_b64_tr_b16 a[60:61], v19 offset:61440
    ds_read_b64_tr_b16 a[62:63], v19 offset:63488
    s_waitcnt lgkmcnt(13)
    v_mfma_f32_32x32x16_bf16 v[144:159], a[36:39], a[248:251], v[144:159]
    s_waitcnt lgkmcnt(10)
    v_mfma_f32_32x32x16_bf16 v[160:175], a[40:43], a[248:251], v[160:175]
    s_waitcnt lgkmcnt(8)
    v_mfma_f32_32x32x16_bf16 v[176:191], a[44:47], a[248:251], v[176:191]
    s_waitcnt vmcnt(32) lgkmcnt(0)
    s_barrier
    ds_read_b64_tr_b16 a[0:1], v12 offset:0
    ds_read_b64_tr_b16 a[2:3], v12 offset:2048
    ds_read_b64_tr_b16 a[4:5], v13 offset:0
    ds_read_b64_tr_b16 a[6:7], v13 offset:2048
    ds_read_b64_tr_b16 a[8:9], v14 offset:0
    ds_read_b64_tr_b16 a[10:11], v14 offset:2048
    v_mfma_f32_32x32x16_bf16 v[128:143], a[48:51], a[252:255], v[128:143]
    ds_read_b64_tr_b16 a[12:13], v15 offset:0
    ds_read_b64_tr_b16 a[14:15], v15 offset:2048
    v_mfma_f32_32x32x16_bf16 v[144:159], a[52:55], a[252:255], v[144:159]
    ds_read_b64_tr_b16 a[16:17], v12 offset:4096
    ds_read_b64_tr_b16 a[18:19], v12 offset:6144
    v_mfma_f32_32x32x16_bf16 v[160:175], a[56:59], a[252:255], v[160:175]
    ds_read_b64_tr_b16 a[20:21], v13 offset:4096
    ds_read_b64_tr_b16 a[22:23], v13 offset:6144
    v_mfma_f32_32x32x16_bf16 v[176:191], a[60:63], a[252:255], v[176:191]
    ds_read_b64_tr_b16 a[24:25], v14 offset:4096
    ds_read_b64_tr_b16 a[26:27], v14 offset:6144
    s_add_u32 m0, s34, 98304
    s_add_u32 s35, s32, 0
    buffer_load_dwordx4 v8, s[16:19], s35 offen offset:0 lds
    v_lshlrev_b32 v224, 16, v96
    v_and_b32 v225, s58, v96
    v_lshlrev_b32 v24, 16, v64
    v_xor_b32 v26, 192, v21
    ds_read_b64 v[104:105], v26
    s_waitcnt lgkmcnt(13)
    v_mfma_f32_32x32x16_bf16 v[128:143], a[0:3], a[64:67], v[128:143]
    ds_read_b64_tr_b16 a[28:29], v15 offset:4096
    ds_read_b64_tr_b16 a[30:31], v15 offset:6144
    buffer_load_dwordx4 a[224:227], v2, s[8:11], s37 offen offset:0 sc1
    v_and_b32 v25, s58, v64
    v_pk_add_f32 v[224:225], v[224:225], v[24:25]
    s_waitcnt lgkmcnt(13)
    v_mfma_f32_32x32x16_bf16 v[144:159], a[4:7], a[64:67], v[144:159]
    ds_read_b64_tr_b16 a[32:33], v12 offset:8192
    ds_read_b64_tr_b16 a[34:35], v12 offset:10240
    s_waitcnt lgkmcnt(13)
    v_mfma_f32_32x32x16_bf16 v[160:175], a[8:11], a[64:67], v[160:175]
    ds_read_b64_tr_b16 a[36:37], v13 offset:8192
    ds_read_b64_tr_b16 a[38:39], v13 offset:10240
    buffer_load_dwordx4 v9, s[16:19], s35 offen offset:1024 lds
    v_lshlrev_b32 v226, 16, v97
    v_and_b32 v227, s58, v97
    v_lshlrev_b32 v24, 16, v65
    s_waitcnt lgkmcnt(13)
    v_mfma_f32_32x32x16_bf16 v[176:191], a[12:15], a[64:67], v[176:191]
    ds_read_b64_tr_b16 a[40:41], v14 offset:8192
    ds_read_b64_tr_b16 a[42:43], v14 offset:10240
    buffer_load_dwordx4 a[228:231], v2, s[8:11], s37 offen offset:1024 sc1
    v_and_b32 v25, s58, v65
    v_pk_add_f32 v[226:227], v[226:227], v[24:25]
    s_waitcnt lgkmcnt(13)
    v_mfma_f32_32x32x16_bf16 v[128:143], a[16:19], a[68:71], v[128:143]
    ds_read_b64_tr_b16 a[44:45], v15 offset:8192
    ds_read_b64_tr_b16 a[46:47], v15 offset:10240
    s_waitcnt lgkmcnt(13)
    v_mfma_f32_32x32x16_bf16 v[144:159], a[20:23], a[68:71], v[144:159]
    ds_read_b64_tr_b16 a[48:49], v12 offset:12288
    ds_read_b64_tr_b16 a[50:51], v12 offset:14336
    buffer_load_dwordx4 v10, s[16:19], s35 offen offset:2048 lds
    v_lshlrev_b32 v228, 16, v98
    v_and_b32 v229, s58, v98
    v_lshlrev_b32 v24, 16, v66
    v_xor_b32 v26, 208, v21
    ds_read_b64 v[106:107], v26
    s_waitcnt lgkmcnt(14)
    v_mfma_f32_32x32x16_bf16 v[160:175], a[24:27], a[68:71], v[160:175]
    ds_read_b64_tr_b16 a[52:53], v13 offset:12288
    ds_read_b64_tr_b16 a[54:55], v13 offset:14336
    s_waitcnt lgkmcnt(13)
    v_mfma_f32_32x32x16_bf16 v[176:191], a[28:31], a[68:71], v[176:191]
    ds_read_b64_tr_b16 a[56:57], v14 offset:12288
    ds_read_b64_tr_b16 a[58:59], v14 offset:14336
    buffer_load_dwordx4 a[232:235], v2, s[8:11], s37 offen offset:2048 sc1
    v_and_b32 v25, s58, v66
    v_pk_add_f32 v[228:229], v[228:229], v[24:25]
    s_waitcnt lgkmcnt(13)
    v_mfma_f32_32x32x16_bf16 v[128:143], a[32:35], a[72:75], v[128:143]
    ds_read_b64_tr_b16 a[60:61], v15 offset:12288
    ds_read_b64_tr_b16 a[62:63], v15 offset:14336
    buffer_load_dwordx4 v11, s[16:19], s35 offen offset:3072 lds
    v_lshlrev_b32 v230, 16, v99
    v_and_b32 v231, s58, v99
    v_lshlrev_b32 v24, 16, v67
    s_waitcnt lgkmcnt(13)
    v_mfma_f32_32x32x16_bf16 v[144:159], a[36:39], a[72:75], v[144:159]
    ds_read_b64_tr_b16 a[0:1], v12 offset:16384
    ds_read_b64_tr_b16 a[2:3], v12 offset:18432
    s_waitcnt lgkmcnt(13)
    v_mfma_f32_32x32x16_bf16 v[160:175], a[40:43], a[72:75], v[160:175]
    ds_read_b64_tr_b16 a[4:5], v13 offset:16384
    ds_read_b64_tr_b16 a[6:7], v13 offset:18432
    buffer_load_dwordx4 a[236:239], v2, s[8:11], s37 offen offset:3072 sc1
    s_add_u32 s37, s37, 4096
    v_and_b32 v25, s58, v67
    v_pk_add_f32 v[230:231], v[230:231], v[24:25]
    s_waitcnt lgkmcnt(13)
    v_mfma_f32_32x32x16_bf16 v[176:191], a[44:47], a[72:75], v[176:191]
    ds_read_b64_tr_b16 a[8:9], v14 offset:16384
    ds_read_b64_tr_b16 a[10:11], v14 offset:18432
    s_add_u32 m0, s34, 102400
    s_add_u32 s35, s32, 32768
    buffer_load_dwordx4 v8, s[16:19], s35 offen offset:0 lds
    v_lshlrev_b32 v232, 16, v100
    v_and_b32 v233, s58, v100
    v_lshlrev_b32 v24, 16, v68
    v_xor_b32 v26, 224, v21
    ds_read_b64 v[108:109], v26
    s_waitcnt lgkmcnt(14)
    v_mfma_f32_32x32x16_bf16 v[128:143], a[48:51], a[76:79], v[128:143]
    ds_read_b64_tr_b16 a[12:13], v15 offset:16384
    ds_read_b64_tr_b16 a[14:15], v15 offset:18432
    s_waitcnt lgkmcnt(13)
    v_mfma_f32_32x32x16_bf16 v[144:159], a[52:55], a[76:79], v[144:159]
    ds_read_b64_tr_b16 a[16:17], v12 offset:20480
    ds_read_b64_tr_b16 a[18:19], v12 offset:22528
    buffer_load_dwordx4 a[240:243], v2, s[8:11], s37 offen offset:0 sc1
    v_and_b32 v25, s58, v68
    v_pk_add_f32 v[232:233], v[232:233], v[24:25]
    s_waitcnt lgkmcnt(13)
    v_mfma_f32_32x32x16_bf16 v[160:175], a[56:59], a[76:79], v[160:175]
    ds_read_b64_tr_b16 a[20:21], v13 offset:20480
    ds_read_b64_tr_b16 a[22:23], v13 offset:22528
    s_waitcnt lgkmcnt(13)
    v_mfma_f32_32x32x16_bf16 v[176:191], a[60:63], a[76:79], v[176:191]
    ds_read_b64_tr_b16 a[24:25], v14 offset:20480
    ds_read_b64_tr_b16 a[26:27], v14 offset:22528
    buffer_load_dwordx4 v9, s[16:19], s35 offen offset:1024 lds
    v_lshlrev_b32 v234, 16, v101
    v_and_b32 v235, s58, v101
    v_lshlrev_b32 v24, 16, v69
    s_waitcnt lgkmcnt(13)
    v_mfma_f32_32x32x16_bf16 v[128:143], a[0:3], a[80:83], v[128:143]
    ds_read_b64_tr_b16 a[28:29], v15 offset:20480
    ds_read_b64_tr_b16 a[30:31], v15 offset:22528
    buffer_load_dwordx4 a[244:247], v2, s[8:11], s37 offen offset:1024 sc1
    v_and_b32 v25, s58, v69
    v_pk_add_f32 v[234:235], v[234:235], v[24:25]
    s_waitcnt lgkmcnt(13)
    v_mfma_f32_32x32x16_bf16 v[144:159], a[4:7], a[80:83], v[144:159]
    ds_read_b64_tr_b16 a[32:33], v12 offset:24576
    ds_read_b64_tr_b16 a[34:35], v12 offset:26624
    s_waitcnt lgkmcnt(13)
    v_mfma_f32_32x32x16_bf16 v[160:175], a[8:11], a[80:83], v[160:175]
    ds_read_b64_tr_b16 a[36:37], v13 offset:24576
    ds_read_b64_tr_b16 a[38:39], v13 offset:26624
    buffer_load_dwordx4 v10, s[16:19], s35 offen offset:2048 lds
    v_lshlrev_b32 v236, 16, v102
    v_and_b32 v237, s58, v102
    v_lshlrev_b32 v24, 16, v70
    v_xor_b32 v26, 240, v21
    ds_read_b64 v[110:111], v26
    s_waitcnt lgkmcnt(13)
    v_mfma_f32_32x32x16_bf16 v[176:191], a[12:15], a[80:83], v[176:191]
    ds_read_b64_tr_b16 a[40:41], v14 offset:24576
    ds_read_b64_tr_b16 a[42:43], v14 offset:26624
    buffer_load_dwordx4 a[248:251], v2, s[8:11], s37 offen offset:2048 sc1
    v_and_b32 v25, s58, v70
    v_pk_add_f32 v[236:237], v[236:237], v[24:25]
    s_waitcnt lgkmcnt(13)
    v_mfma_f32_32x32x16_bf16 v[128:143], a[16:19], a[84:87], v[128:143]
    ds_read_b64_tr_b16 a[44:45], v15 offset:24576
    ds_read_b64_tr_b16 a[46:47], v15 offset:26624
    s_waitcnt lgkmcnt(13)
    v_mfma_f32_32x32x16_bf16 v[144:159], a[20:23], a[84:87], v[144:159]
    ds_read_b64_tr_b16 a[48:49], v12 offset:28672
    ds_read_b64_tr_b16 a[50:51], v12 offset:30720
    buffer_load_dwordx4 v11, s[16:19], s35 offen offset:3072 lds
    s_add_u32 s32, s32, 262144
    v_lshlrev_b32 v238, 16, v103
    v_and_b32 v239, s58, v103
    v_lshlrev_b32 v24, 16, v71
    s_waitcnt lgkmcnt(13)
    v_mfma_f32_32x32x16_bf16 v[160:175], a[24:27], a[84:87], v[160:175]
    ds_read_b64_tr_b16 a[52:53], v13 offset:28672
    ds_read_b64_tr_b16 a[54:55], v13 offset:30720
    s_waitcnt lgkmcnt(13)
    v_mfma_f32_32x32x16_bf16 v[176:191], a[28:31], a[84:87], v[176:191]
    ds_read_b64_tr_b16 a[56:57], v14 offset:28672
    ds_read_b64_tr_b16 a[58:59], v14 offset:30720
    buffer_load_dwordx4 a[252:255], v2, s[8:11], s37 offen offset:3072 sc1
    s_add_u32 s37, s37, 4096
    v_and_b32 v25, s58, v71
    v_pk_add_f32 v[238:239], v[238:239], v[24:25]
    s_waitcnt lgkmcnt(13)
    v_mfma_f32_32x32x16_bf16 v[128:143], a[32:35], a[88:91], v[128:143]
    ds_read_b64_tr_b16 a[60:61], v15 offset:28672
    ds_read_b64_tr_b16 a[62:63], v15 offset:30720
    s_waitcnt lgkmcnt(13)
    v_mfma_f32_32x32x16_bf16 v[144:159], a[36:39], a[88:91], v[144:159]
    s_waitcnt lgkmcnt(10)
    v_mfma_f32_32x32x16_bf16 v[160:175], a[40:43], a[88:91], v[160:175]
    s_waitcnt lgkmcnt(8)
    v_mfma_f32_32x32x16_bf16 v[176:191], a[44:47], a[88:91], v[176:191]
    s_waitcnt vmcnt(32) lgkmcnt(0)
    s_barrier
    ds_read_b64_tr_b16 a[0:1], v12 offset:32768
    ds_read_b64_tr_b16 a[2:3], v12 offset:34816
    ds_read_b64_tr_b16 a[4:5], v13 offset:32768
    ds_read_b64_tr_b16 a[6:7], v13 offset:34816
    ds_read_b64_tr_b16 a[8:9], v14 offset:32768
    ds_read_b64_tr_b16 a[10:11], v14 offset:34816
    v_mfma_f32_32x32x16_bf16 v[128:143], a[48:51], a[92:95], v[128:143]
    ds_read_b64_tr_b16 a[12:13], v15 offset:32768
    ds_read_b64_tr_b16 a[14:15], v15 offset:34816
    v_mfma_f32_32x32x16_bf16 v[144:159], a[52:55], a[92:95], v[144:159]
    ds_read_b64_tr_b16 a[16:17], v12 offset:36864
    ds_read_b64_tr_b16 a[18:19], v12 offset:38912
    v_mfma_f32_32x32x16_bf16 v[160:175], a[56:59], a[92:95], v[160:175]
    ds_read_b64_tr_b16 a[20:21], v13 offset:36864
    ds_read_b64_tr_b16 a[22:23], v13 offset:38912
    v_mfma_f32_32x32x16_bf16 v[176:191], a[60:63], a[92:95], v[176:191]
    ds_read_b64_tr_b16 a[24:25], v14 offset:36864
    ds_read_b64_tr_b16 a[26:27], v14 offset:38912
    s_add_u32 m0, s34, 0
    s_add_u32 s35, s32, 0
    buffer_load_dwordx4 v8, s[16:19], s35 offen offset:0 lds
    v_lshlrev_b32 v240, 16, v104
    v_and_b32 v241, s58, v104
    v_lshlrev_b32 v24, 16, v72
    s_waitcnt lgkmcnt(12)
    v_mfma_f32_32x32x16_bf16 v[128:143], a[0:3], a[96:99], v[128:143]
    ds_read_b64_tr_b16 a[28:29], v15 offset:36864
    ds_read_b64_tr_b16 a[30:31], v15 offset:38912
    buffer_load_dwordx4 a[64:67], v2, s[8:11], s37 offen offset:0 sc1
    v_and_b32 v25, s58, v72
    v_pk_add_f32 v[240:241], v[240:241], v[24:25]
    s_waitcnt lgkmcnt(12)
    v_mfma_f32_32x32x16_bf16 v[144:159], a[4:7], a[96:99], v[144:159]
    ds_read_b64_tr_b16 a[32:33], v12 offset:40960
    ds_read_b64_tr_b16 a[34:35], v12 offset:43008
    s_waitcnt lgkmcnt(12)
    v_mfma_f32_32x32x16_bf16 v[160:175], a[8:11], a[96:99], v[160:175]
    ds_read_b64_tr_b16 a[36:37], v13 offset:40960
    ds_read_b64_tr_b16 a[38:39], v13 offset:43008
    buffer_load_dwordx4 v9, s[16:19], s35 offen offset:1024 lds
    v_lshlrev_b32 v242, 16, v105
    v_and_b32 v243, s58, v105
    v_lshlrev_b32 v24, 16, v73
    s_waitcnt lgkmcnt(12)
    v_mfma_f32_32x32x16_bf16 v[176:191], a[12:15], a[96:99], v[176:191]
    ds_read_b64_tr_b16 a[40:41], v14 offset:40960
    ds_read_b64_tr_b16 a[42:43], v14 offset:43008
    buffer_load_dwordx4 a[68:71], v2, s[8:11], s37 offen offset:1024 sc1
    v_and_b32 v25, s58, v73
    v_pk_add_f32 v[242:243], v[242:243], v[24:25]
    s_waitcnt lgkmcnt(12)
    v_mfma_f32_32x32x16_bf16 v[128:143], a[16:19], a[100:103], v[128:143]
    ds_read_b64_tr_b16 a[44:45], v15 offset:40960
    ds_read_b64_tr_b16 a[46:47], v15 offset:43008
    s_waitcnt lgkmcnt(12)
    v_mfma_f32_32x32x16_bf16 v[144:159], a[20:23], a[100:103], v[144:159]
    ds_read_b64_tr_b16 a[48:49], v12 offset:45056
    ds_read_b64_tr_b16 a[50:51], v12 offset:47104
    buffer_load_dwordx4 v10, s[16:19], s35 offen offset:2048 lds
    v_lshlrev_b32 v244, 16, v106
    v_and_b32 v245, s58, v106
    v_lshlrev_b32 v24, 16, v74
    s_waitcnt lgkmcnt(12)
    v_mfma_f32_32x32x16_bf16 v[160:175], a[24:27], a[100:103], v[160:175]
    ds_read_b64_tr_b16 a[52:53], v13 offset:45056
    ds_read_b64_tr_b16 a[54:55], v13 offset:47104
    s_waitcnt lgkmcnt(12)
    v_mfma_f32_32x32x16_bf16 v[176:191], a[28:31], a[100:103], v[176:191]
    ds_read_b64_tr_b16 a[56:57], v14 offset:45056
    ds_read_b64_tr_b16 a[58:59], v14 offset:47104
    buffer_load_dwordx4 a[72:75], v2, s[8:11], s37 offen offset:2048 sc1
    v_and_b32 v25, s58, v74
    v_pk_add_f32 v[244:245], v[244:245], v[24:25]
    s_waitcnt lgkmcnt(12)
    v_mfma_f32_32x32x16_bf16 v[128:143], a[32:35], a[104:107], v[128:143]
    ds_read_b64_tr_b16 a[60:61], v15 offset:45056
    ds_read_b64_tr_b16 a[62:63], v15 offset:47104
    buffer_load_dwordx4 v11, s[16:19], s35 offen offset:3072 lds
    v_lshlrev_b32 v246, 16, v107
    v_and_b32 v247, s58, v107
    v_lshlrev_b32 v24, 16, v75
    s_waitcnt lgkmcnt(12)
    v_mfma_f32_32x32x16_bf16 v[144:159], a[36:39], a[104:107], v[144:159]
    ds_read_b64_tr_b16 a[0:1], v12 offset:49152
    ds_read_b64_tr_b16 a[2:3], v12 offset:51200
    s_waitcnt lgkmcnt(12)
    v_mfma_f32_32x32x16_bf16 v[160:175], a[40:43], a[104:107], v[160:175]
    ds_read_b64_tr_b16 a[4:5], v13 offset:49152
    ds_read_b64_tr_b16 a[6:7], v13 offset:51200
    buffer_load_dwordx4 a[76:79], v2, s[8:11], s37 offen offset:3072 sc1
    s_add_u32 s37, s37, 4096
    v_and_b32 v25, s58, v75
    v_pk_add_f32 v[246:247], v[246:247], v[24:25]
    s_waitcnt lgkmcnt(12)
    v_mfma_f32_32x32x16_bf16 v[176:191], a[44:47], a[104:107], v[176:191]
    ds_read_b64_tr_b16 a[8:9], v14 offset:49152
    ds_read_b64_tr_b16 a[10:11], v14 offset:51200
    s_add_u32 m0, s34, 4096
    s_add_u32 s35, s32, 32768
    buffer_load_dwordx4 v8, s[16:19], s35 offen offset:0 lds
    v_lshlrev_b32 v248, 16, v108
    v_and_b32 v249, s58, v108
    v_lshlrev_b32 v24, 16, v76
    s_waitcnt lgkmcnt(12)
    v_mfma_f32_32x32x16_bf16 v[128:143], a[48:51], a[108:111], v[128:143]
    ds_read_b64_tr_b16 a[12:13], v15 offset:49152
    ds_read_b64_tr_b16 a[14:15], v15 offset:51200
    s_waitcnt lgkmcnt(12)
    v_mfma_f32_32x32x16_bf16 v[144:159], a[52:55], a[108:111], v[144:159]
    ds_read_b64_tr_b16 a[16:17], v12 offset:53248
    ds_read_b64_tr_b16 a[18:19], v12 offset:55296
    buffer_load_dwordx4 a[80:83], v2, s[8:11], s37 offen offset:0 sc1
    v_and_b32 v25, s58, v76
    v_pk_add_f32 v[248:249], v[248:249], v[24:25]
    s_waitcnt lgkmcnt(12)
    v_mfma_f32_32x32x16_bf16 v[160:175], a[56:59], a[108:111], v[160:175]
    ds_read_b64_tr_b16 a[20:21], v13 offset:53248
    ds_read_b64_tr_b16 a[22:23], v13 offset:55296
    s_waitcnt lgkmcnt(12)
    v_mfma_f32_32x32x16_bf16 v[176:191], a[60:63], a[108:111], v[176:191]
    ds_read_b64_tr_b16 a[24:25], v14 offset:53248
    ds_read_b64_tr_b16 a[26:27], v14 offset:55296
    buffer_load_dwordx4 v9, s[16:19], s35 offen offset:1024 lds
    v_lshlrev_b32 v250, 16, v109
    v_and_b32 v251, s58, v109
    v_lshlrev_b32 v24, 16, v77
    s_waitcnt lgkmcnt(12)
    v_mfma_f32_32x32x16_bf16 v[128:143], a[0:3], a[112:115], v[128:143]
    ds_read_b64_tr_b16 a[28:29], v15 offset:53248
    ds_read_b64_tr_b16 a[30:31], v15 offset:55296
    buffer_load_dwordx4 a[84:87], v2, s[8:11], s37 offen offset:1024 sc1
    v_and_b32 v25, s58, v77
    v_pk_add_f32 v[250:251], v[250:251], v[24:25]
    s_waitcnt lgkmcnt(12)
    v_mfma_f32_32x32x16_bf16 v[144:159], a[4:7], a[112:115], v[144:159]
    ds_read_b64_tr_b16 a[32:33], v12 offset:57344
    ds_read_b64_tr_b16 a[34:35], v12 offset:59392
    s_waitcnt lgkmcnt(12)
    v_mfma_f32_32x32x16_bf16 v[160:175], a[8:11], a[112:115], v[160:175]
    ds_read_b64_tr_b16 a[36:37], v13 offset:57344
    ds_read_b64_tr_b16 a[38:39], v13 offset:59392
    buffer_load_dwordx4 v10, s[16:19], s35 offen offset:2048 lds
    v_lshlrev_b32 v252, 16, v110
    v_and_b32 v253, s58, v110
    v_lshlrev_b32 v24, 16, v78
    s_waitcnt lgkmcnt(12)
    v_mfma_f32_32x32x16_bf16 v[176:191], a[12:15], a[112:115], v[176:191]
    ds_read_b64_tr_b16 a[40:41], v14 offset:57344
    ds_read_b64_tr_b16 a[42:43], v14 offset:59392
    buffer_load_dwordx4 a[88:91], v2, s[8:11], s37 offen offset:2048 sc1
    v_and_b32 v25, s58, v78
    v_pk_add_f32 v[252:253], v[252:253], v[24:25]
    s_waitcnt lgkmcnt(12)
    v_mfma_f32_32x32x16_bf16 v[128:143], a[16:19], a[116:119], v[128:143]
    ds_read_b64_tr_b16 a[44:45], v15 offset:57344
    ds_read_b64_tr_b16 a[46:47], v15 offset:59392
    s_waitcnt lgkmcnt(12)
    v_mfma_f32_32x32x16_bf16 v[144:159], a[20:23], a[116:119], v[144:159]
    ds_read_b64_tr_b16 a[48:49], v12 offset:61440
    ds_read_b64_tr_b16 a[50:51], v12 offset:63488
    buffer_load_dwordx4 v11, s[16:19], s35 offen offset:3072 lds
    s_add_u32 s32, s32, 262144
    v_lshlrev_b32 v254, 16, v111
    v_and_b32 v255, s58, v111
    v_lshlrev_b32 v24, 16, v79
    s_waitcnt lgkmcnt(12)
    v_mfma_f32_32x32x16_bf16 v[160:175], a[24:27], a[116:119], v[160:175]
    ds_read_b64_tr_b16 a[52:53], v13 offset:61440
    ds_read_b64_tr_b16 a[54:55], v13 offset:63488
    s_waitcnt lgkmcnt(12)
    v_mfma_f32_32x32x16_bf16 v[176:191], a[28:31], a[116:119], v[176:191]
    ds_read_b64_tr_b16 a[56:57], v14 offset:61440
    ds_read_b64_tr_b16 a[58:59], v14 offset:63488
    buffer_load_dwordx4 a[92:95], v2, s[8:11], s37 offen offset:3072 sc1
    s_add_u32 s37, s37, 4096
    v_and_b32 v25, s58, v79
    v_pk_add_f32 v[254:255], v[254:255], v[24:25]
    s_waitcnt lgkmcnt(12)
    v_mfma_f32_32x32x16_bf16 v[128:143], a[32:35], a[120:123], v[128:143]
    ds_read_b64_tr_b16 a[60:61], v15 offset:61440
    ds_read_b64_tr_b16 a[62:63], v15 offset:63488
    s_waitcnt lgkmcnt(12)
    v_mfma_f32_32x32x16_bf16 v[144:159], a[36:39], a[120:123], v[144:159]
    s_waitcnt lgkmcnt(10)
    v_mfma_f32_32x32x16_bf16 v[160:175], a[40:43], a[120:123], v[160:175]
    s_waitcnt lgkmcnt(8)
    v_mfma_f32_32x32x16_bf16 v[176:191], a[44:47], a[120:123], v[176:191]
    s_waitcnt vmcnt(32) lgkmcnt(0)
    s_barrier
    ds_read_b64_tr_b16 a[0:1], v16 offset:0
    ds_read_b64_tr_b16 a[2:3], v16 offset:2048
    ds_read_b64_tr_b16 a[4:5], v17 offset:0
    ds_read_b64_tr_b16 a[6:7], v17 offset:2048
    ds_read_b64_tr_b16 a[8:9], v18 offset:0
    ds_read_b64_tr_b16 a[10:11], v18 offset:2048
    v_mfma_f32_32x32x16_bf16 v[128:143], a[48:51], a[124:127], v[128:143]
    ds_read_b64_tr_b16 a[12:13], v19 offset:0
    ds_read_b64_tr_b16 a[14:15], v19 offset:2048
    v_mfma_f32_32x32x16_bf16 v[144:159], a[52:55], a[124:127], v[144:159]
    ds_read_b64_tr_b16 a[16:17], v16 offset:4096
    ds_read_b64_tr_b16 a[18:19], v16 offset:6144
    v_mfma_f32_32x32x16_bf16 v[160:175], a[56:59], a[124:127], v[160:175]
    ds_read_b64_tr_b16 a[20:21], v17 offset:4096
    ds_read_b64_tr_b16 a[22:23], v17 offset:6144
    v_mfma_f32_32x32x16_bf16 v[176:191], a[60:63], a[124:127], v[176:191]
    ds_read_b64_tr_b16 a[24:25], v18 offset:4096
    ds_read_b64_tr_b16 a[26:27], v18 offset:6144
    s_add_u32 m0, s34, 32768
    s_add_u32 s35, s32, 0
    buffer_load_dwordx4 v8, s[16:19], s35 offen offset:0 lds
    s_waitcnt lgkmcnt(12)
    v_mfma_f32_32x32x16_bf16 v[128:143], a[0:3], a[128:131], v[128:143]
    ds_read_b64_tr_b16 a[28:29], v19 offset:4096
    ds_read_b64_tr_b16 a[30:31], v19 offset:6144
    buffer_load_dwordx4 a[96:99], v2, s[8:11], s37 offen offset:0 sc1
    s_waitcnt lgkmcnt(12)
    v_mfma_f32_32x32x16_bf16 v[144:159], a[4:7], a[128:131], v[144:159]
    ds_read_b64_tr_b16 a[32:33], v16 offset:8192
    ds_read_b64_tr_b16 a[34:35], v16 offset:10240
    s_waitcnt lgkmcnt(12)
    v_mfma_f32_32x32x16_bf16 v[160:175], a[8:11], a[128:131], v[160:175]
    ds_read_b64_tr_b16 a[36:37], v17 offset:8192
    ds_read_b64_tr_b16 a[38:39], v17 offset:10240
    buffer_load_dwordx4 v9, s[16:19], s35 offen offset:1024 lds
    s_waitcnt lgkmcnt(12)
    v_mfma_f32_32x32x16_bf16 v[176:191], a[12:15], a[128:131], v[176:191]
    ds_read_b64_tr_b16 a[40:41], v18 offset:8192
    ds_read_b64_tr_b16 a[42:43], v18 offset:10240
    buffer_load_dwordx4 a[100:103], v2, s[8:11], s37 offen offset:1024 sc1
    s_waitcnt lgkmcnt(12)
    v_mfma_f32_32x32x16_bf16 v[128:143], a[16:19], a[132:135], v[128:143]
    ds_read_b64_tr_b16 a[44:45], v19 offset:8192
    ds_read_b64_tr_b16 a[46:47], v19 offset:10240
    s_waitcnt lgkmcnt(12)
    v_mfma_f32_32x32x16_bf16 v[144:159], a[20:23], a[132:135], v[144:159]
    ds_read_b64_tr_b16 a[48:49], v16 offset:12288
    ds_read_b64_tr_b16 a[50:51], v16 offset:14336
    buffer_load_dwordx4 v10, s[16:19], s35 offen offset:2048 lds
    s_waitcnt lgkmcnt(12)
    v_mfma_f32_32x32x16_bf16 v[160:175], a[24:27], a[132:135], v[160:175]
    ds_read_b64_tr_b16 a[52:53], v17 offset:12288
    ds_read_b64_tr_b16 a[54:55], v17 offset:14336
    s_waitcnt lgkmcnt(12)
    v_mfma_f32_32x32x16_bf16 v[176:191], a[28:31], a[132:135], v[176:191]
    ds_read_b64_tr_b16 a[56:57], v18 offset:12288
    ds_read_b64_tr_b16 a[58:59], v18 offset:14336
    buffer_load_dwordx4 a[104:107], v2, s[8:11], s37 offen offset:2048 sc1
    s_waitcnt lgkmcnt(12)
    v_mfma_f32_32x32x16_bf16 v[128:143], a[32:35], a[136:139], v[128:143]
    ds_read_b64_tr_b16 a[60:61], v19 offset:12288
    ds_read_b64_tr_b16 a[62:63], v19 offset:14336
    buffer_load_dwordx4 v11, s[16:19], s35 offen offset:3072 lds
    s_waitcnt lgkmcnt(12)
    v_mfma_f32_32x32x16_bf16 v[144:159], a[36:39], a[136:139], v[144:159]
    ds_read_b64_tr_b16 a[0:1], v16 offset:16384
    ds_read_b64_tr_b16 a[2:3], v16 offset:18432
    s_waitcnt lgkmcnt(12)
    v_mfma_f32_32x32x16_bf16 v[160:175], a[40:43], a[136:139], v[160:175]
    ds_read_b64_tr_b16 a[4:5], v17 offset:16384
    ds_read_b64_tr_b16 a[6:7], v17 offset:18432
    buffer_load_dwordx4 a[108:111], v2, s[8:11], s37 offen offset:3072 sc1
    s_add_u32 s37, s37, 4096
    s_waitcnt lgkmcnt(12)
    v_mfma_f32_32x32x16_bf16 v[176:191], a[44:47], a[136:139], v[176:191]
    ds_read_b64_tr_b16 a[8:9], v18 offset:16384
    ds_read_b64_tr_b16 a[10:11], v18 offset:18432
    s_add_u32 m0, s34, 36864
    s_add_u32 s35, s32, 32768
    buffer_load_dwordx4 v8, s[16:19], s35 offen offset:0 lds
    s_waitcnt lgkmcnt(12)
    v_mfma_f32_32x32x16_bf16 v[128:143], a[48:51], a[140:143], v[128:143]
    ds_read_b64_tr_b16 a[12:13], v19 offset:16384
    ds_read_b64_tr_b16 a[14:15], v19 offset:18432
    s_waitcnt lgkmcnt(12)
    v_mfma_f32_32x32x16_bf16 v[144:159], a[52:55], a[140:143], v[144:159]
    ds_read_b64_tr_b16 a[16:17], v16 offset:20480
    ds_read_b64_tr_b16 a[18:19], v16 offset:22528
    buffer_load_dwordx4 a[112:115], v2, s[8:11], s37 offen offset:0 sc1
    s_waitcnt lgkmcnt(12)
    v_mfma_f32_32x32x16_bf16 v[160:175], a[56:59], a[140:143], v[160:175]
    ds_read_b64_tr_b16 a[20:21], v17 offset:20480
    ds_read_b64_tr_b16 a[22:23], v17 offset:22528
    s_waitcnt lgkmcnt(12)
    v_mfma_f32_32x32x16_bf16 v[176:191], a[60:63], a[140:143], v[176:191]
    ds_read_b64_tr_b16 a[24:25], v18 offset:20480
    ds_read_b64_tr_b16 a[26:27], v18 offset:22528
    buffer_load_dwordx4 v9, s[16:19], s35 offen offset:1024 lds
    s_waitcnt lgkmcnt(12)
    v_mfma_f32_32x32x16_bf16 v[128:143], a[0:3], a[144:147], v[128:143]
    ds_read_b64_tr_b16 a[28:29], v19 offset:20480
    ds_read_b64_tr_b16 a[30:31], v19 offset:22528
    buffer_load_dwordx4 a[116:119], v2, s[8:11], s37 offen offset:1024 sc1
    s_waitcnt lgkmcnt(12)
    v_mfma_f32_32x32x16_bf16 v[144:159], a[4:7], a[144:147], v[144:159]
    ds_read_b64_tr_b16 a[32:33], v16 offset:24576
    ds_read_b64_tr_b16 a[34:35], v16 offset:26624
    s_waitcnt lgkmcnt(12)
    v_mfma_f32_32x32x16_bf16 v[160:175], a[8:11], a[144:147], v[160:175]
    ds_read_b64_tr_b16 a[36:37], v17 offset:24576
    ds_read_b64_tr_b16 a[38:39], v17 offset:26624
    buffer_load_dwordx4 v10, s[16:19], s35 offen offset:2048 lds
    s_waitcnt lgkmcnt(12)
    v_mfma_f32_32x32x16_bf16 v[176:191], a[12:15], a[144:147], v[176:191]
    ds_read_b64_tr_b16 a[40:41], v18 offset:24576
    ds_read_b64_tr_b16 a[42:43], v18 offset:26624
    buffer_load_dwordx4 a[120:123], v2, s[8:11], s37 offen offset:2048 sc1
    s_waitcnt lgkmcnt(12)
    v_mfma_f32_32x32x16_bf16 v[128:143], a[16:19], a[148:151], v[128:143]
    ds_read_b64_tr_b16 a[44:45], v19 offset:24576
    ds_read_b64_tr_b16 a[46:47], v19 offset:26624
    s_waitcnt lgkmcnt(12)
    v_mfma_f32_32x32x16_bf16 v[144:159], a[20:23], a[148:151], v[144:159]
    ds_read_b64_tr_b16 a[48:49], v16 offset:28672
    ds_read_b64_tr_b16 a[50:51], v16 offset:30720
    buffer_load_dwordx4 v11, s[16:19], s35 offen offset:3072 lds
    s_add_u32 s32, s32, 262144
    s_waitcnt lgkmcnt(12)
    v_mfma_f32_32x32x16_bf16 v[160:175], a[24:27], a[148:151], v[160:175]
    ds_read_b64_tr_b16 a[52:53], v17 offset:28672
    ds_read_b64_tr_b16 a[54:55], v17 offset:30720
    s_waitcnt lgkmcnt(12)
    v_mfma_f32_32x32x16_bf16 v[176:191], a[28:31], a[148:151], v[176:191]
    ds_read_b64_tr_b16 a[56:57], v18 offset:28672
    ds_read_b64_tr_b16 a[58:59], v18 offset:30720
    buffer_load_dwordx4 a[124:127], v2, s[8:11], s37 offen offset:3072 sc1
    s_add_u32 s37, s37, 4096
    s_waitcnt lgkmcnt(12)
    v_mfma_f32_32x32x16_bf16 v[128:143], a[32:35], a[152:155], v[128:143]
    ds_read_b64_tr_b16 a[60:61], v19 offset:28672
    ds_read_b64_tr_b16 a[62:63], v19 offset:30720
    s_waitcnt lgkmcnt(12)
    v_mfma_f32_32x32x16_bf16 v[144:159], a[36:39], a[152:155], v[144:159]
    s_waitcnt lgkmcnt(10)
    v_mfma_f32_32x32x16_bf16 v[160:175], a[40:43], a[152:155], v[160:175]
    s_waitcnt lgkmcnt(8)
    v_mfma_f32_32x32x16_bf16 v[176:191], a[44:47], a[152:155], v[176:191]
    s_waitcnt vmcnt(32) lgkmcnt(0)
    s_barrier
    ds_read_b64_tr_b16 a[0:1], v16 offset:32768
    ds_read_b64_tr_b16 a[2:3], v16 offset:34816
    ds_read_b64_tr_b16 a[4:5], v17 offset:32768
    ds_read_b64_tr_b16 a[6:7], v17 offset:34816
    ds_read_b64_tr_b16 a[8:9], v18 offset:32768
    ds_read_b64_tr_b16 a[10:11], v18 offset:34816
    v_mfma_f32_32x32x16_bf16 v[128:143], a[48:51], a[156:159], v[128:143]
    ds_read_b64_tr_b16 a[12:13], v19 offset:32768
    ds_read_b64_tr_b16 a[14:15], v19 offset:34816
    v_mfma_f32_32x32x16_bf16 v[144:159], a[52:55], a[156:159], v[144:159]
    ds_read_b64_tr_b16 a[16:17], v16 offset:36864
    ds_read_b64_tr_b16 a[18:19], v16 offset:38912
    v_mfma_f32_32x32x16_bf16 v[160:175], a[56:59], a[156:159], v[160:175]
    ds_read_b64_tr_b16 a[20:21], v17 offset:36864
    ds_read_b64_tr_b16 a[22:23], v17 offset:38912
    v_mfma_f32_32x32x16_bf16 v[176:191], a[60:63], a[156:159], v[176:191]
    ds_read_b64_tr_b16 a[24:25], v18 offset:36864
    ds_read_b64_tr_b16 a[26:27], v18 offset:38912
    s_waitcnt lgkmcnt(12)
    v_mfma_f32_32x32x16_bf16 v[128:143], a[0:3], a[224:227], v[128:143]
    ds_read_b64_tr_b16 a[28:29], v19 offset:36864
    ds_read_b64_tr_b16 a[30:31], v19 offset:38912
    s_waitcnt lgkmcnt(12)
    v_mfma_f32_32x32x16_bf16 v[144:159], a[4:7], a[224:227], v[144:159]
    ds_read_b64_tr_b16 a[32:33], v16 offset:40960
    ds_read_b64_tr_b16 a[34:35], v16 offset:43008
    s_waitcnt lgkmcnt(12)
    v_mfma_f32_32x32x16_bf16 v[160:175], a[8:11], a[224:227], v[160:175]
    ds_read_b64_tr_b16 a[36:37], v17 offset:40960
    ds_read_b64_tr_b16 a[38:39], v17 offset:43008
    s_waitcnt lgkmcnt(12)
    v_mfma_f32_32x32x16_bf16 v[176:191], a[12:15], a[224:227], v[176:191]
    ds_read_b64_tr_b16 a[40:41], v18 offset:40960
    ds_read_b64_tr_b16 a[42:43], v18 offset:43008
    s_waitcnt lgkmcnt(12)
    v_mfma_f32_32x32x16_bf16 v[128:143], a[16:19], a[228:231], v[128:143]
    ds_read_b64_tr_b16 a[44:45], v19 offset:40960
    ds_read_b64_tr_b16 a[46:47], v19 offset:43008
    s_waitcnt lgkmcnt(12)
    v_mfma_f32_32x32x16_bf16 v[144:159], a[20:23], a[228:231], v[144:159]
    ds_read_b64_tr_b16 a[48:49], v16 offset:45056
    ds_read_b64_tr_b16 a[50:51], v16 offset:47104
    s_waitcnt lgkmcnt(12)
    v_mfma_f32_32x32x16_bf16 v[160:175], a[24:27], a[228:231], v[160:175]
    ds_read_b64_tr_b16 a[52:53], v17 offset:45056
    ds_read_b64_tr_b16 a[54:55], v17 offset:47104
    s_waitcnt lgkmcnt(12)
    v_mfma_f32_32x32x16_bf16 v[176:191], a[28:31], a[228:231], v[176:191]
    ds_read_b64_tr_b16 a[56:57], v18 offset:45056
    ds_read_b64_tr_b16 a[58:59], v18 offset:47104
    s_waitcnt lgkmcnt(12)
    v_mfma_f32_32x32x16_bf16 v[128:143], a[32:35], a[232:235], v[128:143]
    ds_read_b64_tr_b16 a[60:61], v19 offset:45056
    ds_read_b64_tr_b16 a[62:63], v19 offset:47104
    s_waitcnt lgkmcnt(12)
    v_mfma_f32_32x32x16_bf16 v[144:159], a[36:39], a[232:235], v[144:159]
    ds_read_b64_tr_b16 a[0:1], v16 offset:49152
    ds_read_b64_tr_b16 a[2:3], v16 offset:51200
    s_waitcnt lgkmcnt(12)
    v_mfma_f32_32x32x16_bf16 v[160:175], a[40:43], a[232:235], v[160:175]
    ds_read_b64_tr_b16 a[4:5], v17 offset:49152
    ds_read_b64_tr_b16 a[6:7], v17 offset:51200
    s_waitcnt lgkmcnt(12)
    v_mfma_f32_32x32x16_bf16 v[176:191], a[44:47], a[232:235], v[176:191]
    ds_read_b64_tr_b16 a[8:9], v18 offset:49152
    ds_read_b64_tr_b16 a[10:11], v18 offset:51200
    s_waitcnt lgkmcnt(12)
    v_mfma_f32_32x32x16_bf16 v[128:143], a[48:51], a[236:239], v[128:143]
    ds_read_b64_tr_b16 a[12:13], v19 offset:49152
    ds_read_b64_tr_b16 a[14:15], v19 offset:51200
    s_waitcnt lgkmcnt(12)
    v_mfma_f32_32x32x16_bf16 v[144:159], a[52:55], a[236:239], v[144:159]
    ds_read_b64_tr_b16 a[16:17], v16 offset:53248
    ds_read_b64_tr_b16 a[18:19], v16 offset:55296
    s_waitcnt lgkmcnt(12)
    v_mfma_f32_32x32x16_bf16 v[160:175], a[56:59], a[236:239], v[160:175]
    ds_read_b64_tr_b16 a[20:21], v17 offset:53248
    ds_read_b64_tr_b16 a[22:23], v17 offset:55296
    s_waitcnt lgkmcnt(12)
    v_mfma_f32_32x32x16_bf16 v[176:191], a[60:63], a[236:239], v[176:191]
    ds_read_b64_tr_b16 a[24:25], v18 offset:53248
    ds_read_b64_tr_b16 a[26:27], v18 offset:55296
    s_waitcnt lgkmcnt(12)
    v_mfma_f32_32x32x16_bf16 v[128:143], a[0:3], a[240:243], v[128:143]
    ds_read_b64_tr_b16 a[28:29], v19 offset:53248
    ds_read_b64_tr_b16 a[30:31], v19 offset:55296
    s_waitcnt lgkmcnt(12)
    v_mfma_f32_32x32x16_bf16 v[144:159], a[4:7], a[240:243], v[144:159]
    ds_read_b64_tr_b16 a[32:33], v16 offset:57344
    ds_read_b64_tr_b16 a[34:35], v16 offset:59392
    s_waitcnt lgkmcnt(12)
    v_mfma_f32_32x32x16_bf16 v[160:175], a[8:11], a[240:243], v[160:175]
    ds_read_b64_tr_b16 a[36:37], v17 offset:57344
    ds_read_b64_tr_b16 a[38:39], v17 offset:59392
    s_waitcnt lgkmcnt(12)
    v_mfma_f32_32x32x16_bf16 v[176:191], a[12:15], a[240:243], v[176:191]
    ds_read_b64_tr_b16 a[40:41], v18 offset:57344
    ds_read_b64_tr_b16 a[42:43], v18 offset:59392
    s_waitcnt lgkmcnt(12)
    v_mfma_f32_32x32x16_bf16 v[128:143], a[16:19], a[244:247], v[128:143]
    ds_read_b64_tr_b16 a[44:45], v19 offset:57344
    ds_read_b64_tr_b16 a[46:47], v19 offset:59392
    s_waitcnt lgkmcnt(12)
    v_mfma_f32_32x32x16_bf16 v[144:159], a[20:23], a[244:247], v[144:159]
    ds_read_b64_tr_b16 a[48:49], v16 offset:61440
    ds_read_b64_tr_b16 a[50:51], v16 offset:63488
    s_waitcnt lgkmcnt(12)
    v_mfma_f32_32x32x16_bf16 v[160:175], a[24:27], a[244:247], v[160:175]
    ds_read_b64_tr_b16 a[52:53], v17 offset:61440
    ds_read_b64_tr_b16 a[54:55], v17 offset:63488
    s_waitcnt lgkmcnt(12)
    v_mfma_f32_32x32x16_bf16 v[176:191], a[28:31], a[244:247], v[176:191]
    ds_read_b64_tr_b16 a[56:57], v18 offset:61440
    ds_read_b64_tr_b16 a[58:59], v18 offset:63488
    s_waitcnt lgkmcnt(12)
    v_mfma_f32_32x32x16_bf16 v[128:143], a[32:35], a[248:251], v[128:143]
    ds_read_b64_tr_b16 a[60:61], v19 offset:61440
    ds_read_b64_tr_b16 a[62:63], v19 offset:63488
    s_waitcnt lgkmcnt(12)
    v_mfma_f32_32x32x16_bf16 v[144:159], a[36:39], a[248:251], v[144:159]
    s_waitcnt lgkmcnt(10)
    v_mfma_f32_32x32x16_bf16 v[160:175], a[40:43], a[248:251], v[160:175]
    s_waitcnt lgkmcnt(8)
    v_mfma_f32_32x32x16_bf16 v[176:191], a[44:47], a[248:251], v[176:191]
    s_waitcnt vmcnt(16) lgkmcnt(0)
    s_barrier
    ds_read_b64_tr_b16 a[0:1], v12 offset:0
    ds_read_b64_tr_b16 a[2:3], v12 offset:2048
    ds_read_b64_tr_b16 a[4:5], v13 offset:0
    ds_read_b64_tr_b16 a[6:7], v13 offset:2048
    ds_read_b64_tr_b16 a[8:9], v14 offset:0
    ds_read_b64_tr_b16 a[10:11], v14 offset:2048
    v_mfma_f32_32x32x16_bf16 v[128:143], a[48:51], a[252:255], v[128:143]
    ds_read_b64_tr_b16 a[12:13], v15 offset:0
    ds_read_b64_tr_b16 a[14:15], v15 offset:2048
    v_mfma_f32_32x32x16_bf16 v[144:159], a[52:55], a[252:255], v[144:159]
    ds_read_b64_tr_b16 a[16:17], v12 offset:4096
    ds_read_b64_tr_b16 a[18:19], v12 offset:6144
    v_mfma_f32_32x32x16_bf16 v[160:175], a[56:59], a[252:255], v[160:175]
    ds_read_b64_tr_b16 a[20:21], v13 offset:4096
    ds_read_b64_tr_b16 a[22:23], v13 offset:6144
    v_mfma_f32_32x32x16_bf16 v[176:191], a[60:63], a[252:255], v[176:191]
    ds_read_b64_tr_b16 a[24:25], v14 offset:4096
    ds_read_b64_tr_b16 a[26:27], v14 offset:6144
    s_waitcnt lgkmcnt(12)
    v_mfma_f32_32x32x16_bf16 v[128:143], a[0:3], a[64:67], v[128:143]
    ds_read_b64_tr_b16 a[28:29], v15 offset:4096
    ds_read_b64_tr_b16 a[30:31], v15 offset:6144
    s_waitcnt lgkmcnt(12)
    v_mfma_f32_32x32x16_bf16 v[144:159], a[4:7], a[64:67], v[144:159]
    ds_read_b64_tr_b16 a[32:33], v12 offset:8192
    ds_read_b64_tr_b16 a[34:35], v12 offset:10240
    s_waitcnt lgkmcnt(12)
    v_mfma_f32_32x32x16_bf16 v[160:175], a[8:11], a[64:67], v[160:175]
    ds_read_b64_tr_b16 a[36:37], v13 offset:8192
    ds_read_b64_tr_b16 a[38:39], v13 offset:10240
    s_waitcnt lgkmcnt(12)
    v_mfma_f32_32x32x16_bf16 v[176:191], a[12:15], a[64:67], v[176:191]
    ds_read_b64_tr_b16 a[40:41], v14 offset:8192
    ds_read_b64_tr_b16 a[42:43], v14 offset:10240
    s_waitcnt lgkmcnt(12)
    v_mfma_f32_32x32x16_bf16 v[128:143], a[16:19], a[68:71], v[128:143]
    ds_read_b64_tr_b16 a[44:45], v15 offset:8192
    ds_read_b64_tr_b16 a[46:47], v15 offset:10240
    s_waitcnt lgkmcnt(12)
    v_mfma_f32_32x32x16_bf16 v[144:159], a[20:23], a[68:71], v[144:159]
    ds_read_b64_tr_b16 a[48:49], v12 offset:12288
    ds_read_b64_tr_b16 a[50:51], v12 offset:14336
    s_waitcnt lgkmcnt(12)
    v_mfma_f32_32x32x16_bf16 v[160:175], a[24:27], a[68:71], v[160:175]
    ds_read_b64_tr_b16 a[52:53], v13 offset:12288
    ds_read_b64_tr_b16 a[54:55], v13 offset:14336
    s_waitcnt lgkmcnt(12)
    v_mfma_f32_32x32x16_bf16 v[176:191], a[28:31], a[68:71], v[176:191]
    ds_read_b64_tr_b16 a[56:57], v14 offset:12288
    ds_read_b64_tr_b16 a[58:59], v14 offset:14336
    s_waitcnt lgkmcnt(12)
    v_mfma_f32_32x32x16_bf16 v[128:143], a[32:35], a[72:75], v[128:143]
    ds_read_b64_tr_b16 a[60:61], v15 offset:12288
    ds_read_b64_tr_b16 a[62:63], v15 offset:14336
    s_waitcnt lgkmcnt(12)
    v_mfma_f32_32x32x16_bf16 v[144:159], a[36:39], a[72:75], v[144:159]
    ds_read_b64_tr_b16 a[0:1], v12 offset:16384
    ds_read_b64_tr_b16 a[2:3], v12 offset:18432
    s_waitcnt lgkmcnt(12)
    v_mfma_f32_32x32x16_bf16 v[160:175], a[40:43], a[72:75], v[160:175]
    ds_read_b64_tr_b16 a[4:5], v13 offset:16384
    ds_read_b64_tr_b16 a[6:7], v13 offset:18432
    s_waitcnt lgkmcnt(12)
    v_mfma_f32_32x32x16_bf16 v[176:191], a[44:47], a[72:75], v[176:191]
    ds_read_b64_tr_b16 a[8:9], v14 offset:16384
    ds_read_b64_tr_b16 a[10:11], v14 offset:18432
    s_waitcnt lgkmcnt(12)
    v_mfma_f32_32x32x16_bf16 v[128:143], a[48:51], a[76:79], v[128:143]
    ds_read_b64_tr_b16 a[12:13], v15 offset:16384
    ds_read_b64_tr_b16 a[14:15], v15 offset:18432
    s_waitcnt lgkmcnt(12)
    v_mfma_f32_32x32x16_bf16 v[144:159], a[52:55], a[76:79], v[144:159]
    ds_read_b64_tr_b16 a[16:17], v12 offset:20480
    ds_read_b64_tr_b16 a[18:19], v12 offset:22528
    s_waitcnt lgkmcnt(12)
    v_mfma_f32_32x32x16_bf16 v[160:175], a[56:59], a[76:79], v[160:175]
    ds_read_b64_tr_b16 a[20:21], v13 offset:20480
    ds_read_b64_tr_b16 a[22:23], v13 offset:22528
    s_waitcnt lgkmcnt(12)
    v_mfma_f32_32x32x16_bf16 v[176:191], a[60:63], a[76:79], v[176:191]
    ds_read_b64_tr_b16 a[24:25], v14 offset:20480
    ds_read_b64_tr_b16 a[26:27], v14 offset:22528
    s_waitcnt lgkmcnt(12)
    v_mfma_f32_32x32x16_bf16 v[128:143], a[0:3], a[80:83], v[128:143]
    ds_read_b64_tr_b16 a[28:29], v15 offset:20480
    ds_read_b64_tr_b16 a[30:31], v15 offset:22528
    s_waitcnt lgkmcnt(12)
    v_mfma_f32_32x32x16_bf16 v[144:159], a[4:7], a[80:83], v[144:159]
    ds_read_b64_tr_b16 a[32:33], v12 offset:24576
    ds_read_b64_tr_b16 a[34:35], v12 offset:26624
    s_waitcnt lgkmcnt(12)
    v_mfma_f32_32x32x16_bf16 v[160:175], a[8:11], a[80:83], v[160:175]
    ds_read_b64_tr_b16 a[36:37], v13 offset:24576
    ds_read_b64_tr_b16 a[38:39], v13 offset:26624
    s_waitcnt lgkmcnt(12)
    v_mfma_f32_32x32x16_bf16 v[176:191], a[12:15], a[80:83], v[176:191]
    ds_read_b64_tr_b16 a[40:41], v14 offset:24576
    ds_read_b64_tr_b16 a[42:43], v14 offset:26624
    s_waitcnt lgkmcnt(12)
    v_mfma_f32_32x32x16_bf16 v[128:143], a[16:19], a[84:87], v[128:143]
    ds_read_b64_tr_b16 a[44:45], v15 offset:24576
    ds_read_b64_tr_b16 a[46:47], v15 offset:26624
    s_waitcnt lgkmcnt(12)
    v_mfma_f32_32x32x16_bf16 v[144:159], a[20:23], a[84:87], v[144:159]
    ds_read_b64_tr_b16 a[48:49], v12 offset:28672
    ds_read_b64_tr_b16 a[50:51], v12 offset:30720
    s_waitcnt lgkmcnt(12)
    v_mfma_f32_32x32x16_bf16 v[160:175], a[24:27], a[84:87], v[160:175]
    ds_read_b64_tr_b16 a[52:53], v13 offset:28672
    ds_read_b64_tr_b16 a[54:55], v13 offset:30720
    s_waitcnt lgkmcnt(12)
    v_mfma_f32_32x32x16_bf16 v[176:191], a[28:31], a[84:87], v[176:191]
    ds_read_b64_tr_b16 a[56:57], v14 offset:28672
    ds_read_b64_tr_b16 a[58:59], v14 offset:30720
    s_waitcnt lgkmcnt(12)
    v_mfma_f32_32x32x16_bf16 v[128:143], a[32:35], a[88:91], v[128:143]
    ds_read_b64_tr_b16 a[60:61], v15 offset:28672
    ds_read_b64_tr_b16 a[62:63], v15 offset:30720
    s_waitcnt lgkmcnt(12)
    v_mfma_f32_32x32x16_bf16 v[144:159], a[36:39], a[88:91], v[144:159]
    s_waitcnt lgkmcnt(10)
    v_mfma_f32_32x32x16_bf16 v[160:175], a[40:43], a[88:91], v[160:175]
    s_waitcnt lgkmcnt(8)
    v_mfma_f32_32x32x16_bf16 v[176:191], a[44:47], a[88:91], v[176:191]
    s_waitcnt vmcnt(0) lgkmcnt(0)
    s_barrier
    ds_read_b64_tr_b16 a[0:1], v12 offset:32768
    ds_read_b64_tr_b16 a[2:3], v12 offset:34816
    ds_read_b64_tr_b16 a[4:5], v13 offset:32768
    ds_read_b64_tr_b16 a[6:7], v13 offset:34816
    ds_read_b64_tr_b16 a[8:9], v14 offset:32768
    ds_read_b64_tr_b16 a[10:11], v14 offset:34816
    v_mfma_f32_32x32x16_bf16 v[128:143], a[48:51], a[92:95], v[128:143]
    ds_read_b64_tr_b16 a[12:13], v15 offset:32768
    ds_read_b64_tr_b16 a[14:15], v15 offset:34816
    v_mfma_f32_32x32x16_bf16 v[144:159], a[52:55], a[92:95], v[144:159]
    ds_read_b64_tr_b16 a[16:17], v12 offset:36864
    ds_read_b64_tr_b16 a[18:19], v12 offset:38912
    v_mfma_f32_32x32x16_bf16 v[160:175], a[56:59], a[92:95], v[160:175]
    ds_read_b64_tr_b16 a[20:21], v13 offset:36864
    ds_read_b64_tr_b16 a[22:23], v13 offset:38912
    v_mfma_f32_32x32x16_bf16 v[176:191], a[60:63], a[92:95], v[176:191]
    ds_read_b64_tr_b16 a[24:25], v14 offset:36864
    ds_read_b64_tr_b16 a[26:27], v14 offset:38912
    s_waitcnt lgkmcnt(12)
    v_mfma_f32_32x32x16_bf16 v[128:143], a[0:3], a[96:99], v[128:143]
    ds_read_b64_tr_b16 a[28:29], v15 offset:36864
    ds_read_b64_tr_b16 a[30:31], v15 offset:38912
    s_waitcnt lgkmcnt(12)
    v_mfma_f32_32x32x16_bf16 v[144:159], a[4:7], a[96:99], v[144:159]
    ds_read_b64_tr_b16 a[32:33], v12 offset:40960
    ds_read_b64_tr_b16 a[34:35], v12 offset:43008
    s_waitcnt lgkmcnt(12)
    v_mfma_f32_32x32x16_bf16 v[160:175], a[8:11], a[96:99], v[160:175]
    ds_read_b64_tr_b16 a[36:37], v13 offset:40960
    ds_read_b64_tr_b16 a[38:39], v13 offset:43008
    s_waitcnt lgkmcnt(12)
    v_mfma_f32_32x32x16_bf16 v[176:191], a[12:15], a[96:99], v[176:191]
    ds_read_b64_tr_b16 a[40:41], v14 offset:40960
    ds_read_b64_tr_b16 a[42:43], v14 offset:43008
    s_waitcnt lgkmcnt(12)
    v_mfma_f32_32x32x16_bf16 v[128:143], a[16:19], a[100:103], v[128:143]
    ds_read_b64_tr_b16 a[44:45], v15 offset:40960
    ds_read_b64_tr_b16 a[46:47], v15 offset:43008
    s_waitcnt lgkmcnt(12)
    v_mfma_f32_32x32x16_bf16 v[144:159], a[20:23], a[100:103], v[144:159]
    ds_read_b64_tr_b16 a[48:49], v12 offset:45056
    ds_read_b64_tr_b16 a[50:51], v12 offset:47104
    s_waitcnt lgkmcnt(12)
    v_mfma_f32_32x32x16_bf16 v[160:175], a[24:27], a[100:103], v[160:175]
    ds_read_b64_tr_b16 a[52:53], v13 offset:45056
    ds_read_b64_tr_b16 a[54:55], v13 offset:47104
    s_waitcnt lgkmcnt(12)
    v_mfma_f32_32x32x16_bf16 v[176:191], a[28:31], a[100:103], v[176:191]
    ds_read_b64_tr_b16 a[56:57], v14 offset:45056
    ds_read_b64_tr_b16 a[58:59], v14 offset:47104
    s_waitcnt lgkmcnt(12)
    v_mfma_f32_32x32x16_bf16 v[128:143], a[32:35], a[104:107], v[128:143]
    ds_read_b64_tr_b16 a[60:61], v15 offset:45056
    ds_read_b64_tr_b16 a[62:63], v15 offset:47104
    s_waitcnt lgkmcnt(12)
    v_mfma_f32_32x32x16_bf16 v[144:159], a[36:39], a[104:107], v[144:159]
    ds_read_b64_tr_b16 a[0:1], v12 offset:49152
    ds_read_b64_tr_b16 a[2:3], v12 offset:51200
    s_waitcnt lgkmcnt(12)
    v_mfma_f32_32x32x16_bf16 v[160:175], a[40:43], a[104:107], v[160:175]
    ds_read_b64_tr_b16 a[4:5], v13 offset:49152
    ds_read_b64_tr_b16 a[6:7], v13 offset:51200
    s_waitcnt lgkmcnt(12)
    v_mfma_f32_32x32x16_bf16 v[176:191], a[44:47], a[104:107], v[176:191]
    ds_read_b64_tr_b16 a[8:9], v14 offset:49152
    ds_read_b64_tr_b16 a[10:11], v14 offset:51200
    s_waitcnt lgkmcnt(12)
    v_mfma_f32_32x32x16_bf16 v[128:143], a[48:51], a[108:111], v[128:143]
    ds_read_b64_tr_b16 a[12:13], v15 offset:49152
    ds_read_b64_tr_b16 a[14:15], v15 offset:51200
    s_waitcnt lgkmcnt(12)
    v_mfma_f32_32x32x16_bf16 v[144:159], a[52:55], a[108:111], v[144:159]
    ds_read_b64_tr_b16 a[16:17], v12 offset:53248
    ds_read_b64_tr_b16 a[18:19], v12 offset:55296
    s_waitcnt lgkmcnt(12)
    v_mfma_f32_32x32x16_bf16 v[160:175], a[56:59], a[108:111], v[160:175]
    ds_read_b64_tr_b16 a[20:21], v13 offset:53248
    ds_read_b64_tr_b16 a[22:23], v13 offset:55296
    s_waitcnt lgkmcnt(12)
    v_mfma_f32_32x32x16_bf16 v[176:191], a[60:63], a[108:111], v[176:191]
    ds_read_b64_tr_b16 a[24:25], v14 offset:53248
    ds_read_b64_tr_b16 a[26:27], v14 offset:55296
    s_waitcnt lgkmcnt(12)
    v_mfma_f32_32x32x16_bf16 v[128:143], a[0:3], a[112:115], v[128:143]
    ds_read_b64_tr_b16 a[28:29], v15 offset:53248
    ds_read_b64_tr_b16 a[30:31], v15 offset:55296
    s_waitcnt lgkmcnt(12)
    v_mfma_f32_32x32x16_bf16 v[144:159], a[4:7], a[112:115], v[144:159]
    ds_read_b64_tr_b16 a[32:33], v12 offset:57344
    ds_read_b64_tr_b16 a[34:35], v12 offset:59392
    s_waitcnt lgkmcnt(12)
    v_mfma_f32_32x32x16_bf16 v[160:175], a[8:11], a[112:115], v[160:175]
    ds_read_b64_tr_b16 a[36:37], v13 offset:57344
    ds_read_b64_tr_b16 a[38:39], v13 offset:59392
    s_waitcnt lgkmcnt(12)
    v_mfma_f32_32x32x16_bf16 v[176:191], a[12:15], a[112:115], v[176:191]
    ds_read_b64_tr_b16 a[40:41], v14 offset:57344
    ds_read_b64_tr_b16 a[42:43], v14 offset:59392
    s_waitcnt lgkmcnt(12)
    v_mfma_f32_32x32x16_bf16 v[128:143], a[16:19], a[116:119], v[128:143]
    ds_read_b64_tr_b16 a[44:45], v15 offset:57344
    ds_read_b64_tr_b16 a[46:47], v15 offset:59392
    s_waitcnt lgkmcnt(12)
    v_mfma_f32_32x32x16_bf16 v[144:159], a[20:23], a[116:119], v[144:159]
    ds_read_b64_tr_b16 a[48:49], v12 offset:61440
    ds_read_b64_tr_b16 a[50:51], v12 offset:63488
    s_waitcnt lgkmcnt(12)
    v_mfma_f32_32x32x16_bf16 v[160:175], a[24:27], a[116:119], v[160:175]
    ds_read_b64_tr_b16 a[52:53], v13 offset:61440
    ds_read_b64_tr_b16 a[54:55], v13 offset:63488
    s_waitcnt lgkmcnt(12)
    v_mfma_f32_32x32x16_bf16 v[176:191], a[28:31], a[116:119], v[176:191]
    ds_read_b64_tr_b16 a[56:57], v14 offset:61440
    ds_read_b64_tr_b16 a[58:59], v14 offset:63488
    s_waitcnt lgkmcnt(12)
    v_mfma_f32_32x32x16_bf16 v[128:143], a[32:35], a[120:123], v[128:143]
    ds_read_b64_tr_b16 a[60:61], v15 offset:61440
    ds_read_b64_tr_b16 a[62:63], v15 offset:63488
    s_waitcnt lgkmcnt(12)
    v_mfma_f32_32x32x16_bf16 v[144:159], a[36:39], a[120:123], v[144:159]
    s_waitcnt lgkmcnt(10)
    v_mfma_f32_32x32x16_bf16 v[160:175], a[40:43], a[120:123], v[160:175]
    s_waitcnt lgkmcnt(8)
    v_mfma_f32_32x32x16_bf16 v[176:191], a[44:47], a[120:123], v[176:191]
    s_waitcnt lgkmcnt(6)
    v_mfma_f32_32x32x16_bf16 v[128:143], a[48:51], a[124:127], v[128:143]
    s_waitcnt lgkmcnt(4)
    v_mfma_f32_32x32x16_bf16 v[144:159], a[52:55], a[124:127], v[144:159]
    s_waitcnt lgkmcnt(2)
    v_mfma_f32_32x32x16_bf16 v[160:175], a[56:59], a[124:127], v[160:175]
    s_waitcnt lgkmcnt(0)
    v_mfma_f32_32x32x16_bf16 v[176:191], a[60:63], a[124:127], v[176:191]
    s_nop 7
    s_nop 3
    v_pk_add_f32 v[128:129], v[128:129], v[192:193]
    v_pk_add_f32 v[130:131], v[130:131], v[194:195]
    buffer_store_dwordx4 v[128:131], v2, s[8:11], s62 offen offset:0 sc1
    v_pk_add_f32 v[132:133], v[132:133], v[196:197]
    v_pk_add_f32 v[134:135], v[134:135], v[198:199]
    buffer_store_dwordx4 v[132:135], v2, s[8:11], s62 offen offset:1024 sc1
    v_pk_add_f32 v[136:137], v[136:137], v[200:201]
    v_pk_add_f32 v[138:139], v[138:139], v[202:203]
    buffer_store_dwordx4 v[136:139], v2, s[8:11], s62 offen offset:2048 sc1
    v_pk_add_f32 v[140:141], v[140:141], v[204:205]
    v_pk_add_f32 v[142:143], v[142:143], v[206:207]
    buffer_store_dwordx4 v[140:143], v2, s[8:11], s62 offen offset:3072 sc1
    s_add_u32 s62, s62, 4096
    v_pk_add_f32 v[144:145], v[144:145], v[208:209]
    v_pk_add_f32 v[146:147], v[146:147], v[210:211]
    buffer_store_dwordx4 v[144:147], v2, s[8:11], s62 offen offset:0 sc1
    v_pk_add_f32 v[148:149], v[148:149], v[212:213]
    v_pk_add_f32 v[150:151], v[150:151], v[214:215]
    buffer_store_dwordx4 v[148:151], v2, s[8:11], s62 offen offset:1024 sc1
    v_pk_add_f32 v[152:153], v[152:153], v[216:217]
    v_pk_add_f32 v[154:155], v[154:155], v[218:219]
    buffer_store_dwordx4 v[152:155], v2, s[8:11], s62 offen offset:2048 sc1
    v_pk_add_f32 v[156:157], v[156:157], v[220:221]
    v_pk_add_f32 v[158:159], v[158:159], v[222:223]
    buffer_store_dwordx4 v[156:159], v2, s[8:11], s62 offen offset:3072 sc1
    s_add_u32 s62, s62, 4096
    v_pk_add_f32 v[160:161], v[160:161], v[224:225]
    v_pk_add_f32 v[162:163], v[162:163], v[226:227]
    buffer_store_dwordx4 v[160:163], v2, s[8:11], s62 offen offset:0 sc1
    v_pk_add_f32 v[164:165], v[164:165], v[228:229]
    v_pk_add_f32 v[166:167], v[166:167], v[230:231]
    buffer_store_dwordx4 v[164:167], v2, s[8:11], s62 offen offset:1024 sc1
    v_pk_add_f32 v[168:169], v[168:169], v[232:233]
    v_pk_add_f32 v[170:171], v[170:171], v[234:235]
    buffer_store_dwordx4 v[168:171], v2, s[8:11], s62 offen offset:2048 sc1
    v_pk_add_f32 v[172:173], v[172:173], v[236:237]
    v_pk_add_f32 v[174:175], v[174:175], v[238:239]
    buffer_store_dwordx4 v[172:175], v2, s[8:11], s62 offen offset:3072 sc1
    s_add_u32 s62, s62, 4096
    v_pk_add_f32 v[176:177], v[176:177], v[240:241]
    v_pk_add_f32 v[178:179], v[178:179], v[242:243]
    buffer_store_dwordx4 v[176:179], v2, s[8:11], s62 offen offset:0 sc1
    v_pk_add_f32 v[180:181], v[180:181], v[244:245]
    v_pk_add_f32 v[182:183], v[182:183], v[246:247]
    buffer_store_dwordx4 v[180:183], v2, s[8:11], s62 offen offset:1024 sc1
    v_pk_add_f32 v[184:185], v[184:185], v[248:249]
    v_pk_add_f32 v[186:187], v[186:187], v[250:251]
    buffer_store_dwordx4 v[184:187], v2, s[8:11], s62 offen offset:2048 sc1
    v_pk_add_f32 v[188:189], v[188:189], v[252:253]
    v_pk_add_f32 v[190:191], v[190:191], v[254:255]
    buffer_store_dwordx4 v[188:191], v2, s[8:11], s62 offen offset:3072 sc1
    s_add_u32 s62, s62, 4096
    s_waitcnt vmcnt(0)
    s_barrier
    s_cmp_lg_u32 s24, 0
    s_cbranch_scc1 L_gf
    s_mov_b64 exec, 1
    v_mov_b32 v3, 1
    buffer_store_dword v3, off, s[8:11], s63 sc1
    s_mov_b64 exec, -1
L_gf:
L_end:
    s_endpgm
L_ghw:
    s_mov_b32 vcc_lo, 0x40000
L_ghp:
    v_mov_b32 v23, s60
    global_load_dword v23, v23, s[6:7] sc1
    s_sub_u32 vcc_lo, vcc_lo, 1
    s_cbranch_scc1 L_ghpx
    s_waitcnt vmcnt(0)
    v_readfirstlane_b32 s3, v23
    s_cmp_ge_u32 s3, s64
    s_cbranch_scc0 L_ghp
L_ghpx:
    s_waitcnt vmcnt(0)
    s_branch L_ghb
L_gow:
    s_mov_b32 vcc_lo, 0x40000
L_gop:
    v_mov_b32 v23, s61
    global_load_dword v23, v23, s[6:7] sc1
    s_sub_u32 vcc_lo, vcc_lo, 1
    s_cbranch_scc1 L_gopx
    s_waitcnt vmcnt(0)
    v_readfirstlane_b32 s3, v23
    s_cmp_ge_u32 s3, s64
    s_cbranch_scc0 L_gop
L_gopx:
    s_waitcnt vmcnt(0)
    s_branch L_gob
L_gxw:
    s_mov_b32 vcc_lo, 0x40000
L_gxp:
    v_mov_b32 v23, s63
    global_load_dword v23, v23, s[6:7] sc1
    s_sub_u32 vcc_lo, vcc_lo, 1
    s_cbranch_scc1 L_gxpx
    s_waitcnt vmcnt(0)
    v_readfirstlane_b32 s3, v23
    s_cmp_ge_u32 s3, s65
    s_cbranch_scc0 L_gxp
L_gxpx:
    s_waitcnt vmcnt(0)
    s_branch L_gxb
L_slow0:
    s_add_u32 s56, s29, 0x900000
    s_mov_b32 s58, 0
    v_mov_b32 v188, 0xff800000
L_slowa0:
    buffer_load_dwordx4 v[160:163], v2, s[8:11], s56 offen sc1
    buffer_load_dwordx4 v[164:167], v2, s[8:11], s56 offen offset:1024 sc1
    s_add_u32 s56, s56, 2048
    s_waitcnt vmcnt(0)
    v_mfma_f32_32x32x16_bf16 v[144:159], v[160:163], a[0:3], 0
    v_mfma_f32_32x32x16_bf16 v[144:159], v[164:167], a[4:7], v[144:159]
    s_nop 7
    s_nop 7
    v_max3_f32 v188, v188, v144, v145
    v_max3_f32 v188, v188, v146, v147
    v_max3_f32 v188, v188, v148, v149
    v_max3_f32 v188, v188, v150, v151
    v_max3_f32 v188, v188, v152, v153
    v_max3_f32 v188, v188, v154, v155
    v_max3_f32 v188, v188, v156, v157
    v_max3_f32 v188, v188, v158, v159
    s_add_u32 s58, s58, 1
    s_cmp_lt_u32 s58, 64
    s_cbranch_scc1 L_slowa0
    v_mov_b32 v189, v188
    s_nop 1
    v_permlane32_swap_b32 v188, v189
    s_nop 1
    v_max_f32 v188, v188, v189
    s_add_u32 s56, s29, 0x900000
    s_add_u32 s57, s29, 0xd00000
    s_mov_b32 s58, 0
    v_mov_b32 v48, 0
    v_mov_b32 v49, 0
    v_mov_b32 v50, 0
    v_mov_b32 v51, 0
    v_mov_b32 v52, 0
    v_mov_b32 v53, 0
    v_mov_b32 v54, 0
    v_mov_b32 v55, 0
    v_mov_b32 v56, 0
    v_mov_b32 v57, 0
    v_mov_b32 v58, 0
    v_mov_b32 v59, 0
    v_mov_b32 v60, 0
    v_mov_b32 v61, 0
    v_mov_b32 v62, 0
    v_mov_b32 v63, 0
    v_mov_b32 v184, 0
    v_mov_b32 v185, 0
    v_mov_b32 v186, 0
    v_mov_b32 v187, 0
L_slowb0:
    buffer_load_dwordx4 v[160:163], v2, s[8:11], s56 offen sc1
    buffer_load_dwordx4 v[164:167], v2, s[8:11], s56 offen offset:1024 sc1
    buffer_load_dwordx4 v[168:171], v2, s[8:11], s57 offen sc1
    buffer_load_dwordx4 v[172:175], v2, s[8:11], s57 offen offset:1024 sc1
    s_add_u32 s56, s56, 2048
    s_add_u32 s57, s57, 2048
    s_waitcnt vmcnt(0)
    v_mfma_f32_32x32x16_bf16 v[144:159], v[160:163], a[0:3], 0
    v_mfma_f32_32x32x16_bf16 v[144:159], v[164:167], a[4:7], v[144:159]
    s_nop 7
    s_nop 7
    v_sub_f32 v144, v144, v188
    v_sub_f32 v145, v145, v188
    v_sub_f32 v146, v146, v188
    v_sub_f32 v147, v147, v188
    v_sub_f32 v148, v148, v188
    v_sub_f32 v149, v149, v188
    v_sub_f32 v150, v150, v188
    v_sub_f32 v151, v151, v188
    v_sub_f32 v152, v152, v188
    v_sub_f32 v153, v153, v188
    v_sub_f32 v154, v154, v188
    v_sub_f32 v155, v155, v188
    v_sub_f32 v156, v156, v188
    v_sub_f32 v157, v157, v188
    v_sub_f32 v158, v158, v188
    v_sub_f32 v159, v159, v188
    v_exp_f32 v144, v144
    v_exp_f32 v145, v145
    v_exp_f32 v146, v146
    v_exp_f32 v147, v147
    v_exp_f32 v148, v148
    v_exp_f32 v149, v149
    v_exp_f32 v150, v150
    v_exp_f32 v151, v151
    v_exp_f32 v152, v152
    v_exp_f32 v153, v153
    v_exp_f32 v154, v154
    v_exp_f32 v155, v155
    v_exp_f32 v156, v156
    v_exp_f32 v157, v157
    v_exp_f32 v158, v158
    v_exp_f32 v159, v159
    s_nop 0
    v_cvt_pk_bf16_f32 v176, v144, v145
    v_cvt_pk_bf16_f32 v177, v146, v147
    v_cvt_pk_bf16_f32 v178, v148, v149
    v_cvt_pk_bf16_f32 v179, v150, v151
    v_cvt_pk_bf16_f32 v180, v152, v153
    v_cvt_pk_bf16_f32 v181, v154, v155
    v_cvt_pk_bf16_f32 v182, v156, v157
    v_cvt_pk_bf16_f32 v183, v158, v159
    s_nop 1
    v_mfma_f32_32x32x16_bf16 v[48:63], v[168:171], v[176:179], v[48:63]
    v_mfma_f32_16x16x32_bf16 v[184:187], v[88:91], v[176:179], v[184:187]
    v_mfma_f32_32x32x16_bf16 v[48:63], v[172:175], v[180:183], v[48:63]
    v_mfma_f32_16x16x32_bf16 v[184:187], v[88:91], v[180:183], v[184:187]
    s_add_u32 s58, s58, 1
    s_cmp_lt_u32 s58, 64
    s_cbranch_scc1 L_slowb0
    s_nop 7
    s_nop 7
    v_mov_b32 v80, v184
    s_branch L_fin0
L_slow1:
    s_add_u32 s56, s29, 0x900000
    s_mov_b32 s58, 0
    v_mov_b32 v188, 0xff800000
L_slowa1:
    buffer_load_dwordx4 v[160:163], v2, s[8:11], s56 offen sc1
    buffer_load_dwordx4 v[164:167], v2, s[8:11], s56 offen offset:1024 sc1
    s_add_u32 s56, s56, 2048
    s_waitcnt vmcnt(0)
    v_mfma_f32_32x32x16_bf16 v[144:159], v[160:163], a[8:11], 0
    v_mfma_f32_32x32x16_bf16 v[144:159], v[164:167], a[12:15], v[144:159]
    s_nop 7
    s_nop 7
    v_max3_f32 v188, v188, v144, v145
    v_max3_f32 v188, v188, v146, v147
    v_max3_f32 v188, v188, v148, v149
    v_max3_f32 v188, v188, v150, v151
    v_max3_f32 v188, v188, v152, v153
    v_max3_f32 v188, v188, v154, v155
    v_max3_f32 v188, v188, v156, v157
    v_max3_f32 v188, v188, v158, v159
    s_add_u32 s58, s58, 1
    s_cmp_lt_u32 s58, 64
    s_cbranch_scc1 L_slowa1
    v_mov_b32 v189, v188
    s_nop 1
    v_permlane32_swap_b32 v188, v189
    s_nop 1
    v_max_f32 v188, v188, v189
    s_add_u32 s56, s29, 0x900000
    s_add_u32 s57, s29, 0xd00000
    s_mov_b32 s58, 0
    v_mov_b32 v64, 0
    v_mov_b32 v65, 0
    v_mov_b32 v66, 0
    v_mov_b32 v67, 0
    v_mov_b32 v68, 0
    v_mov_b32 v69, 0
    v_mov_b32 v70, 0
    v_mov_b32 v71, 0
    v_mov_b32 v72, 0
    v_mov_b32 v73, 0
    v_mov_b32 v74, 0
    v_mov_b32 v75, 0
    v_mov_b32 v76, 0
    v_mov_b32 v77, 0
    v_mov_b32 v78, 0
    v_mov_b32 v79, 0
    v_mov_b32 v184, 0
    v_mov_b32 v185, 0
    v_mov_b32 v186, 0
    v_mov_b32 v187, 0
L_slowb1:
    buffer_load_dwordx4 v[160:163], v2, s[8:11], s56 offen sc1
    buffer_load_dwordx4 v[164:167], v2, s[8:11], s56 offen offset:1024 sc1
    buffer_load_dwordx4 v[168:171], v2, s[8:11], s57 offen sc1
    buffer_load_dwordx4 v[172:175], v2, s[8:11], s57 offen offset:1024 sc1
    s_add_u32 s56, s56, 2048
    s_add_u32 s57, s57, 2048
    s_waitcnt vmcnt(0)
    v_mfma_f32_32x32x16_bf16 v[144:159], v[160:163], a[8:11], 0
    v_mfma_f32_32x32x16_bf16 v[144:159], v[164:167], a[12:15], v[144:159]
    s_nop 7
    s_nop 7
    v_sub_f32 v144, v144, v188
    v_sub_f32 v145, v145, v188
    v_sub_f32 v146, v146, v188
    v_sub_f32 v147, v147, v188
    v_sub_f32 v148, v148, v188
    v_sub_f32 v149, v149, v188
    v_sub_f32 v150, v150, v188
    v_sub_f32 v151, v151, v188
    v_sub_f32 v152, v152, v188
    v_sub_f32 v153, v153, v188
    v_sub_f32 v154, v154, v188
    v_sub_f32 v155, v155, v188
    v_sub_f32 v156, v156, v188
    v_sub_f32 v157, v157, v188
    v_sub_f32 v158, v158, v188
    v_sub_f32 v159, v159, v188
    v_exp_f32 v144, v144
    v_exp_f32 v145, v145
    v_exp_f32 v146, v146
    v_exp_f32 v147, v147
    v_exp_f32 v148, v148
    v_exp_f32 v149, v149
    v_exp_f32 v150, v150
    v_exp_f32 v151, v151
    v_exp_f32 v152, v152
    v_exp_f32 v153, v153
    v_exp_f32 v154, v154
    v_exp_f32 v155, v155
    v_exp_f32 v156, v156
    v_exp_f32 v157, v157
    v_exp_f32 v158, v158
    v_exp_f32 v159, v159
    s_nop 0
    v_cvt_pk_bf16_f32 v176, v144, v145
    v_cvt_pk_bf16_f32 v177, v146, v147
    v_cvt_pk_bf16_f32 v178, v148, v149
    v_cvt_pk_bf16_f32 v179, v150, v151
    v_cvt_pk_bf16_f32 v180, v152, v153
    v_cvt_pk_bf16_f32 v181, v154, v155
    v_cvt_pk_bf16_f32 v182, v156, v157
    v_cvt_pk_bf16_f32 v183, v158, v159
    s_nop 1
    v_mfma_f32_32x32x16_bf16 v[64:79], v[168:171], v[176:179], v[64:79]
    v_mfma_f32_16x16x32_bf16 v[184:187], v[88:91], v[176:179], v[184:187]
    v_mfma_f32_32x32x16_bf16 v[64:79], v[172:175], v[180:183], v[64:79]
    v_mfma_f32_16x16x32_bf16 v[184:187], v[88:91], v[180:183], v[184:187]
    s_add_u32 s58, s58, 1
    s_cmp_lt_u32 s58, 64
    s_cbranch_scc1 L_slowb1
    s_nop 7
    s_nop 7
    v_mov_b32 v81, v184
    s_branch L_fin1
L_zend:
.section .rodata,"a"
.p2align 6
.amdhsa_kernel parallel_sum__softmax_full_mha__mixer_channel_mlp__prompt_kernel
  .amdhsa_next_free_vgpr 512
  .amdhsa_next_free_sgpr 102
  .amdhsa_accum_offset 256
  .amdhsa_group_segment_fixed_size 0
  .amdhsa_kernarg_size 88
  .amdhsa_user_sgpr_count 2
  .amdhsa_user_sgpr_kernarg_segment_ptr 1
  .amdhsa_system_sgpr_workgroup_id_x 1
.end_amdhsa_kernel
```
